```python
import torch

def _softmax(x, axis=-1):
    return torch.softmax(x, dim=axis)

def _gelu(x):
    return torch.nn.functional.gelu(x, approximate='tanh')

def _silu(x):
    return torch.nn.functional.silu(x)

def _sigmoid(x):
    return torch.sigmoid(x)

def _layernorm(x, axis=-1, eps=1e-05):
    m = x.mean(dim=axis, keepdim=True)
    v = x.var(dim=axis, keepdim=True, unbiased=False)
    return (x - m) / torch.sqrt(v + eps)

def _scatter_add(tgt, idx, src, axis=0):
    return tgt.clone().index_add_(axis, idx, src)

def _segment_sum(src, seg, n):
    out = torch.zeros((n,) + src.shape[1:], dtype=src.dtype)
    return out.index_add_(0, seg, src)

def _pad(x, pw):
    flat = tuple((v for pair in reversed(pw) for v in pair))
    return torch.nn.functional.pad(x, flat)
kernel_name = 'concat_heads__memory_aug_recurrent_mem_tr__ssm_conv_h3__prompt'

def setup_inputs():

    _w = lambda a: (lambda t: t.to(torch.bfloat16) if t.is_floating_point() else t)(torch.as_tensor(a))

    def _A_setup():
        B, S, Dm = (1, 2048, 1024)
        H, Dh = (32, 128)
        M, seg = (8, 32)
        seg = min(seg, S)
        S = S // seg * seg
        return {'x': _w((lambda *s: torch.randn(*s, dtype=torch.bfloat16) * 0.05)(B, S, Dm)), 'mem0': _w((lambda *s: torch.randn(*s, dtype=torch.bfloat16) * 0.4)(B, M, Dm)), 'Wq': _w((lambda *s: torch.randn(*s, dtype=torch.bfloat16) * 6.4)(Dm, H, Dh) * Dm ** (-0.5)), 'Wk': _w((lambda *s: torch.randn(*s, dtype=torch.bfloat16) * 6.4)(Dm, H, Dh) * Dm ** (-0.5)), 'Wv': _w((lambda *s: torch.randn(*s, dtype=torch.bfloat16) * 0.4)(Dm, H, Dh) * Dm ** (-0.5)), 'Wo': _w((lambda *s: torch.randn(*s, dtype=torch.bfloat16) * 0.4)(H, Dh, Dm) * (H * Dh) ** (-0.5)), 'seg_len': seg}
    _A_in = _A_setup()

    def _B_setup():
        B, S, D = (1, 2048, 1024)
        ks = 4
        return {'q': _w((lambda *s: torch.randn(*s, dtype=torch.bfloat16) * 0.05)(B, S, D)), 'k': _w((lambda *s: torch.randn(*s, dtype=torch.bfloat16) * 0.4)(B, S, D)), 'v': _w((lambda *s: torch.randn(*s, dtype=torch.bfloat16) * 0.4)(B, S, D)), 'shift_k': _w((lambda *s: torch.randn(*s, dtype=torch.bfloat16) * 0.4)(D, ks) * 0.5), 'ssm_k': _w((lambda *s: torch.randn(*s, dtype=torch.bfloat16) * 0.4)(D, S) * (1.0 / S ** 0.5)), 'ssm_D': _w((lambda *s: torch.randn(*s, dtype=torch.bfloat16) * 0.4)(D))}
    _B_in = _B_setup()
    return {'A_x': _A_in['x'], 'A_mem0': _A_in['mem0'], 'A_Wq': _A_in['Wq'], 'A_Wk': _A_in['Wk'], 'A_Wv': _A_in['Wv'], 'A_Wo': _A_in['Wo'], 'A_seg_len': _A_in['seg_len'], 'B_q': _B_in['q'], 'B_k': _B_in['k'], 'B_v': _B_in['v'], 'B_shift_k': _B_in['shift_k'], 'B_ssm_k': _B_in['ssm_k'], 'B_ssm_D': _B_in['ssm_D']}

def reference(A_x, A_mem0, A_Wq, A_Wk, A_Wv, A_Wo, A_seg_len, B_q, B_k, B_v, B_shift_k, B_ssm_k, B_ssm_D):

    def _A_ref(x, mem0, Wq, Wk, Wv, Wo, seg_len):
        B, S, Dm = x.shape
        H, Dh = (Wq.shape[1], Wq.shape[2])
        M = mem0.shape[1]
        scale = Dh ** (-0.5)
        n_seg = S // seg_len
        L = M + seg_len
        idx = torch.arange(L)
        mask = (idx[:, None] < M) | (idx[:, None] >= idx[None, :])
        mem = mem0
        outs = []
        for s in range(n_seg):
            xs = x[:, s * seg_len:(s + 1) * seg_len, :].clone()
            h = torch.concatenate([mem, xs], axis=1)
            q = torch.einsum('btd,dhe->bhte', h, Wq)
            k = torch.einsum('btd,dhe->bhte', h, Wk)
            v = torch.einsum('btd,dhe->bhte', h, Wv)
            scores = torch.einsum('bhqe,bhke->bhqk', q, k) * scale
            scores = torch.where(mask[None, None], scores, -1000000000.0)
            p = _softmax(scores, axis=-1)
            o = torch.einsum('bhqk,bhke->bhqe', p, v)
            o = torch.einsum('bhte,hed->btd', o, Wo)
            mem = o[:, :M, :].clone()
            outs.append(o[:, M:, :])
        return torch.concatenate(outs, axis=1)

    def _B_ref(q, k, v, shift_k, ssm_k, ssm_D):
        B, S, D = q.shape
        ks = shift_k.shape[-1]
        k_pad = _pad(k, ((0, 0), (ks - 1, 0), (0, 0)))
        k_shift = torch.zeros_like(k)
        for t in range(ks):
            k_shift = k_shift + k_pad[:, t:t + S, :] * shift_k[:, ks - 1 - t][None, None, :]
        kv = k_shift * v
        L = 2 * S
        kv_pad = _pad(kv, ((0, 0), (0, S), (0, 0)))
        kf_pad = _pad(ssm_k, ((0, 0), (0, S)))
        kv_f = (lambda x, axes=(-2, -1): torch.fft.rfft2(x.float(), dim=axes))(kv_pad[:, None, :, :], axes=(1, 2))
        kf_f = (lambda x, axes=(-2, -1): torch.fft.rfft2(x.float(), dim=axes))(kf_pad[:, None, :], axes=(1, 2))
        kf_f = (lambda x, *d: x.permute(*d))(kf_f, 1, 2, 0)
        y_f = kv_f * kf_f[None, :, :, :]
        y = (lambda x, s, axes=(-2, -1): torch.fft.irfft2(x, s=s, dim=axes).to(torch.bfloat16))(y_f, (1, L), axes=(1, 2))[:, 0, :S, :]
        y = y + kv * ssm_D[None, None, :]
        return q * y
    a = _A_ref(A_x, A_mem0, A_Wq, A_Wk, A_Wv, A_Wo, A_seg_len)
    b = _B_ref(B_q, B_k, B_v, B_shift_k, B_ssm_k, B_ssm_D)
    return torch.concatenate([a, b], axis=-1)
```

```asm
; @launch grid=(256,1,1) block=(256,1,1) lds=163840
.amdgcn_target "amdgcn-amd-amdhsa--gfx950"
.text
.globl concat_heads__memory_aug_recurrent_mem_tr__ssm_conv_h3__prompt_kernel
.p2align 8
.type concat_heads__memory_aug_recurrent_mem_tr__ssm_conv_h3__prompt_kernel,@function
concat_heads__memory_aug_recurrent_mem_tr__ssm_conv_h3__prompt_kernel:
L_0:
  s_cmp_lt_u32 s2, 256
  s_cbranch_scc1 L_in
  s_endpgm
L_in:
  s_load_dwordx16 s[4:19], s[0:1], 0
  s_load_dwordx16 s[20:35], s[0:1], 64
  s_getreg_b32 s37, hwreg(HW_REG_XCC_ID)
  s_and_b32 s37, s37, 7
  s_lshl_b32 s37, s37, 2
  s_lshr_b32 s37, 0x75643210, s37
  s_and_b32 s37, s37, 7
  v_lshrrev_b32 v1, 6, v0
  v_and_b32 v0, 63, v0
  v_readfirstlane_b32 s36, v1
  s_mov_b32 s39, 262144
  v_mov_b32 v2, 0
  v_mov_b32 v254, 4
  s_waitcnt lgkmcnt(0)
  s_cmp_eq_u32 s36, 0
  s_cbranch_scc0 L_tk_done
  s_lshl_b32 s40, s37, 5
  s_mov_b32 s38, 1
  s_atomic_add s38, s[32:33], s40 glc
  s_waitcnt lgkmcnt(0)
  s_cmp_lt_u32 s38, 32
  s_cbranch_scc1 L_tk_ok
  v_lshlrev_b32 v3, 5, v0
  v_and_b32 v3, 0xff, v3
L_ov_poll:
  global_load_dword v4, v3, s[32:33] sc1
  s_waitcnt vmcnt(0)
  s_mov_b32 s40, 0
  v_readlane_b32 s44, v4, 0
  v_readlane_b32 s45, v4, 1
  v_readlane_b32 s46, v4, 2
  v_readlane_b32 s47, v4, 3
  v_readlane_b32 s48, v4, 4
  v_readlane_b32 s49, v4, 5
  v_readlane_b32 s50, v4, 6
  v_readlane_b32 s51, v4, 7
  s_nop 3
  s_add_u32 s40, s40, s44
  s_add_u32 s40, s40, s45
  s_add_u32 s40, s40, s46
  s_add_u32 s40, s40, s47
  s_add_u32 s40, s40, s48
  s_add_u32 s40, s40, s49
  s_add_u32 s40, s40, s50
  s_add_u32 s40, s40, s51
  s_cmp_eq_u32 s40, 256
  s_cbranch_scc1 L_ov_all
  s_sleep 8
  s_cmp_gt_u32 s40, 256
  s_cbranch_scc1 L_ov_bad
  s_sub_u32 s39, s39, 1
  s_cbranch_scc0 L_ov_poll
  s_branch L_ov_bad
L_ov_all:
  s_sub_u32 s38, s38, 32
  s_max_u32 s40, s44, 32
  s_sub_u32 s40, s40, 32
  s_cmp_gt_u32 s37, 0
  s_cselect_b32 s40, s40, 0
  s_add_u32 s38, s38, s40
  s_max_u32 s40, s45, 32
  s_sub_u32 s40, s40, 32
  s_cmp_gt_u32 s37, 1
  s_cselect_b32 s40, s40, 0
  s_add_u32 s38, s38, s40
  s_max_u32 s40, s46, 32
  s_sub_u32 s40, s40, 32
  s_cmp_gt_u32 s37, 2
  s_cselect_b32 s40, s40, 0
  s_add_u32 s38, s38, s40
  s_max_u32 s40, s47, 32
  s_sub_u32 s40, s40, 32
  s_cmp_gt_u32 s37, 3
  s_cselect_b32 s40, s40, 0
  s_add_u32 s38, s38, s40
  s_max_u32 s40, s48, 32
  s_sub_u32 s40, s40, 32
  s_cmp_gt_u32 s37, 4
  s_cselect_b32 s40, s40, 0
  s_add_u32 s38, s38, s40
  s_max_u32 s40, s49, 32
  s_sub_u32 s40, s40, 32
  s_cmp_gt_u32 s37, 5
  s_cselect_b32 s40, s40, 0
  s_add_u32 s38, s38, s40
  s_max_u32 s40, s50, 32
  s_sub_u32 s40, s40, 32
  s_cmp_gt_u32 s37, 6
  s_cselect_b32 s40, s40, 0
  s_add_u32 s38, s38, s40
  s_max_u32 s40, s51, 32
  s_sub_u32 s40, s40, 32
  s_cmp_gt_u32 s37, 7
  s_cselect_b32 s40, s40, 0
  s_add_u32 s38, s38, s40
  s_min_u32 s41, s44, 32
  s_sub_u32 s40, 32, s41
  s_mov_b32 s37, 0
  s_cmp_lt_u32 s38, s40
  s_cbranch_scc1 L_ov_found
  s_sub_u32 s38, s38, s40
  s_min_u32 s41, s45, 32
  s_sub_u32 s40, 32, s41
  s_mov_b32 s37, 1
  s_cmp_lt_u32 s38, s40
  s_cbranch_scc1 L_ov_found
  s_sub_u32 s38, s38, s40
  s_min_u32 s41, s46, 32
  s_sub_u32 s40, 32, s41
  s_mov_b32 s37, 2
  s_cmp_lt_u32 s38, s40
  s_cbranch_scc1 L_ov_found
  s_sub_u32 s38, s38, s40
  s_min_u32 s41, s47, 32
  s_sub_u32 s40, 32, s41
  s_mov_b32 s37, 3
  s_cmp_lt_u32 s38, s40
  s_cbranch_scc1 L_ov_found
  s_sub_u32 s38, s38, s40
  s_min_u32 s41, s48, 32
  s_sub_u32 s40, 32, s41
  s_mov_b32 s37, 4
  s_cmp_lt_u32 s38, s40
  s_cbranch_scc1 L_ov_found
  s_sub_u32 s38, s38, s40
  s_min_u32 s41, s49, 32
  s_sub_u32 s40, 32, s41
  s_mov_b32 s37, 5
  s_cmp_lt_u32 s38, s40
  s_cbranch_scc1 L_ov_found
  s_sub_u32 s38, s38, s40
  s_min_u32 s41, s50, 32
  s_sub_u32 s40, 32, s41
  s_mov_b32 s37, 6
  s_cmp_lt_u32 s38, s40
  s_cbranch_scc1 L_ov_found
  s_sub_u32 s38, s38, s40
  s_min_u32 s41, s51, 32
  s_sub_u32 s40, 32, s41
  s_mov_b32 s37, 7
  s_cmp_lt_u32 s38, s40
  s_cbranch_scc1 L_ov_found
  s_sub_u32 s38, s38, s40
L_ov_bad:
  s_mov_b32 s37, 8
  s_mov_b32 s38, 0
  s_branch L_tk_ok
L_ov_found:
  s_add_u32 s38, s38, s41
L_tk_ok:
  s_lshl_b32 s40, s37, 5
  s_add_u32 s40, s40, s38
  v_mov_b32 v3, s40
  ds_write_b32 v2, v3
  s_waitcnt lgkmcnt(0)
L_tk_done:
  s_barrier
  ds_read_b32 v3, v2
  s_waitcnt lgkmcnt(0)
  v_readfirstlane_b32 s40, v3
  s_cmp_lt_u32 s40, 256
  s_cbranch_scc1 L_role_ok
  s_endpgm
L_role_ok:
  s_lshr_b32 s37, s40, 5
  s_and_b32 s38, s40, 31
  s_barrier
  s_cmp_lt_u32 s37, 4
  s_cbranch_scc1 L_chain
  s_cmp_lt_u32 s37, 7
  s_cbranch_scc1 L_proj
  s_branch L_xrole
L_chain:
  s_mov_b32 s44, s8
  s_and_b32 s45, s9, 0xffff
  s_mov_b32 s46, 0x800000
  s_mov_b32 s47, 0x20000
  s_mov_b32 s48, s10
  s_and_b32 s49, s11, 0xffff
  s_mov_b32 s50, 0x800000
  s_mov_b32 s51, 0x20000
  s_mov_b32 s52, s12
  s_and_b32 s53, s13, 0xffff
  s_mov_b32 s54, 0x800000
  s_mov_b32 s55, 0x20000
  s_mov_b32 s56, s14
  s_and_b32 s57, s15, 0xffff
  s_mov_b32 s58, 0x800000
  s_mov_b32 s59, 0x20000
  s_lshl_b32 s65, s37, 5
  s_add_u32 s65, s65, s38
  v_lshrrev_b32 v1, 2, v0
  v_and_b32 v2, 3, v0
  v_lshlrev_b32 v2, 4, v2
  v_lshl_add_u32 v40, v1, 13, v2
  v_lshl_add_u32 v41, v1, 11, v2
  s_lshl_b32 s62, s65, 6
  s_lshl_b32 s40, s36, 21
  s_add_u32 s62, s62, s40
  s_lshl_b32 s63, s37, 21
  s_lshl_b32 s40, s36, 19
  s_add_u32 s63, s63, s40
  s_lshl_b32 s40, s38, 6
  s_add_u32 s63, s63, s40
  s_lshl_b32 s60, s36, 15
  s_add_u32 s60, s60, 32768
  v_bfe_u32 v42, v0, 4, 1
  v_lshlrev_b32 v42, 4, v42
  v_bfe_u32 v1, v0, 5, 1
  v_lshl_add_u32 v42, v1, 3, v42
  v_bfe_u32 v1, v0, 3, 1
  v_lshl_add_u32 v42, v1, 2, v42
  v_bfe_u32 v1, v0, 2, 1
  v_add_u32 v42, v1, v42
  v_lshlrev_b32 v42, 6, v42
  v_and_b32 v1, 3, v0
  v_lshl_add_u32 v42, v1, 3, v42
  v_add_u32 v42, s60, v42
  v_bfe_u32 v43, v0, 5, 1
  v_lshlrev_b32 v43, 3, v43
  v_bfe_u32 v1, v0, 4, 1
  v_lshl_add_u32 v43, v1, 1, v43
  v_bfe_u32 v1, v0, 3, 1
  v_lshl_add_u32 v43, v1, 2, v43
  v_bfe_u32 v1, v0, 2, 1
  v_lshl_add_u32 v43, v1, 4, v43
  v_lshlrev_b32 v43, 6, v43
  v_and_b32 v1, 3, v0
  v_lshl_add_u32 v43, v1, 3, v43
  v_add_u32 v43, s60, v43
  s_and_b32 s40, s38, 1
  s_mul_i32 s40, s40, 4
  s_lshl_b32 s41, s40, 10
  s_add_u32 s60, s60, s41
  s_lshl_b32 s41, s40, 17
  s_add_u32 s62, s62, s41
  s_lshl_b32 s41, s40, 15
  s_add_u32 s63, s63, s41
  s_and_b32 s40, s38, 15
  s_lshl_b32 s40, s40, 4
  s_lshl_b32 s41, s36, 8
  s_add_u32 s40, s40, s41
  v_and_b32 v1, 15, v0
  v_add_u32 v1, s40, v1
  s_and_b32 s40, s65, 0x70
  s_cmp_eq_u32 s40, 0x70
  s_cselect_b32 s74, -1, 0xffff
  s_mov_b32 s75, 0
  s_lshl_b32 s40, s40, 6
  s_add_u32 s40, s40, 384
  v_bfe_u32 v2, v0, 4, 1
  v_lshl_add_u32 v2, v2, 9, s40
  v_lshl_add_u32 v44, v1, 13, v2
  v_and_b32 v2, 2047, v2
  s_lshl_b32 s41, s37, 21
  v_lshl_add_u32 v45, v1, 11, v2
  v_add_u32 v45, s41, v45
  s_mov_b64 exec, s[74:75]
  buffer_load_dword v46, v44, s[48:51], 0 offen
  s_mov_b64 exec, -1
  s_mov_b64 exec, s[74:75]
  buffer_load_dword v46, v44, s[52:55], 0 offen
  s_mov_b64 exec, -1
  s_xor_b32 m0, s60, 0
  s_xor_b32 s61, s62, 0
  buffer_load_dwordx4 v40, s[48:51], s61 offen lds
  s_xor_b32 m0, s60, 1024
  s_xor_b32 s61, s62, 131072
  buffer_load_dwordx4 v40, s[48:51], s61 offen lds
  s_xor_b32 m0, s60, 2048
  s_xor_b32 s61, s62, 262144
  buffer_load_dwordx4 v40, s[48:51], s61 offen lds
  s_xor_b32 m0, s60, 3072
  s_xor_b32 s61, s62, 393216
  buffer_load_dwordx4 v40, s[48:51], s61 offen lds
  s_xor_b32 m0, s60, 4096
  s_xor_b32 s61, s62, 524288
  buffer_load_dwordx4 v40, s[48:51], s61 offen lds
  s_xor_b32 m0, s60, 5120
  s_xor_b32 s61, s62, 655360
  buffer_load_dwordx4 v40, s[48:51], s61 offen lds
  s_xor_b32 m0, s60, 6144
  s_xor_b32 s61, s62, 786432
  buffer_load_dwordx4 v40, s[48:51], s61 offen lds
  s_xor_b32 m0, s60, 7168
  s_xor_b32 s61, s62, 917504
  buffer_load_dwordx4 v40, s[48:51], s61 offen lds
  s_xor_b32 m0, s60, 8192
  s_xor_b32 s61, s62, 1048576
  buffer_load_dwordx4 v40, s[48:51], s61 offen lds
  s_xor_b32 m0, s60, 9216
  s_xor_b32 s61, s62, 1179648
  buffer_load_dwordx4 v40, s[48:51], s61 offen lds
  s_xor_b32 m0, s60, 10240
  s_xor_b32 s61, s62, 1310720
  buffer_load_dwordx4 v40, s[48:51], s61 offen lds
  s_xor_b32 m0, s60, 11264
  s_xor_b32 s61, s62, 1441792
  buffer_load_dwordx4 v40, s[48:51], s61 offen lds
  s_xor_b32 m0, s60, 12288
  s_xor_b32 s61, s62, 1572864
  buffer_load_dwordx4 v40, s[48:51], s61 offen lds
  s_xor_b32 m0, s60, 13312
  s_xor_b32 s61, s62, 1703936
  buffer_load_dwordx4 v40, s[48:51], s61 offen lds
  s_xor_b32 m0, s60, 14336
  s_xor_b32 s61, s62, 1835008
  buffer_load_dwordx4 v40, s[48:51], s61 offen lds
  s_xor_b32 m0, s60, 15360
  s_xor_b32 s61, s62, 1966080
  buffer_load_dwordx4 v40, s[48:51], s61 offen lds
  v_lshrrev_b32 v2, 4, v0
  v_lshlrev_b32 v1, 12, v2
  v_and_b32 v2, 15, v0
  v_lshl_add_u32 v1, v2, 1, v1
  s_lshl_b32 s40, s38, 6
  v_add_u32 v1, s40, v1
  global_load_ushort v188, v1, s[6:7]
  global_load_ushort v189, v1, s[6:7] offset:2048
  global_load_ushort v190, v1, s[6:7] offset:32
  global_load_ushort v191, v1, s[6:7] offset:2080
  s_and_b32 s40, s34, 0x1fffff
  s_sub_u32 s40, 0x6200000, s40
  s_add_u32 s72, s34, s40
  s_addc_u32 s73, s35, 0
  s_mov_b32 s40, 0x1ff000
  s_load_dword s43, s[72:73], s40
  v_mov_b32 v36, -1
  v_mov_b32 v160, 0x3f803f80
  v_mov_b32 v135, 0
  v_mov_b32 v37, -1
  v_mov_b32 v161, 0x3f803f80
  v_mov_b32 v139, 0
  v_mov_b32 v38, -1
  v_mov_b32 v162, 0x3f803f80
  v_mov_b32 v143, 0
  v_mov_b32 v39, -1
  v_mov_b32 v163, 0x3f803f80
  v_mov_b32 v147, 0
  v_mov_b32 v183, 0
  v_mov_b32 v187, 0
  v_bfe_u32 v1, v0, 1, 1
  v_mul_u32_u24 v3, 0xaaaa, v1
  v_add_u32 v3, 0x4444, v3
  s_lshl_b32 s40, s37, 17
  s_add_u32 s40, s40, 75497472
  s_lshl_b32 s41, s36, 12
  s_add_u32 s41, s41, s40
  v_lshl_add_u32 v4, v0, 4, s41
  v_add_u32 v29, 16384, v4
  s_lshl_b32 s41, s38, 9
  s_add_u32 s41, s41, s40
  v_lshl_add_u32 v7, v0, 4, s41
  v_lshrrev_b32 v2, 5, v0
  v_mul_u32_u24 v2, 15872, v2
  v_add_u32 v7, v2, v7
  v_bfe_u32 v1, v0, 3, 1
  v_lshl_add_u32 v5, v1, 8, s41
  v_lshrrev_b32 v2, 4, v0
  v_lshl_add_u32 v5, v2, 6, v5
  v_bfe_u32 v2, v0, 2, 1
  v_lshl_add_u32 v5, v2, 5, v5
  v_and_b32 v2, 3, v0
  v_lshl_add_u32 v5, v2, 2, v5
  s_add_u32 s41, s41, 16384
  v_bfe_u32 v2, v0, 5, 1
  v_lshl_add_u32 v6, v2, 8, s41
  v_bfe_u32 v2, v0, 1, 2
  v_lshl_add_u32 v6, v2, 6, v6
  v_bfe_u32 v2, v0, 4, 1
  v_lshl_add_u32 v6, v2, 5, v6
  v_and_b32 v2, 1, v0
  v_lshl_add_u32 v6, v2, 4, v6
  v_cmp_gt_u32 vcc, 32, v0
  v_mov_b32 v35, 0x80000000
  v_mov_b32 v32, 0
  v_cndmask_b32 v35, v35, v36, vcc
  v_cndmask_b32 v32, v32, v36, vcc
  v_mov_b32 v33, v32
  v_mov_b32 v34, v32
  s_mov_b32 s77, 0x80000001
  s_lshl_b32 s41, s38, 11
  s_add_u32 s41, s41, s40
  s_add_u32 s41, s41, 65536
  v_lshl_add_u32 v8, v0, 4, s41
  v_xor_b32 v9, 2048, v8
  v_xor_b32 v10, 4096, v8
  v_xor_b32 v11, 6144, v8
  v_and_b32 v2, 7, v0
  v_lshl_add_u32 v12, v2, 5, s41
  v_bfe_u32 v2, v0, 4, 1
  v_lshl_add_u32 v12, v2, 4, v12
  s_and_b32 s41, s41, 0xffffe000
  v_lshl_add_u32 v13, v0, 2, s41
  v_add_u32 v14, 4096, v13
  s_mov_b32 s66, 0x00ff00ff
  s_mov_b32 s67, 0x00ff00ff
  s_mov_b32 s68, 0xff00ff00
  s_mov_b32 s69, 0xff00ff00
  s_lshr_b32 s40, s38, 1
  s_lshl_b32 s40, s40, 14
  s_and_b32 s41, s38, 1
  s_lshl_b32 s41, s41, 12
  s_add_u32 s40, s40, s41
  s_lshl_b32 s41, s37, 10
  s_add_u32 s40, s40, s41
  v_lshl_add_u32 v15, v0, 4, s40
  v_xor_b32 v16, 1024, v15
  v_xor_b32 v17, 2048, v15
  v_xor_b32 v18, 3072, v15
  v_bfe_u32 v19, v0, 2, 2
  v_mul_u32_u24 v19, 288, v19
  v_lshrrev_b32 v2, 4, v0
  v_lshl_add_u32 v19, v2, 4, v19
  v_and_b32 v2, 3, v0
  v_lshl_add_u32 v19, v2, 2, v19
  s_mul_i32 s40, s36, 2304
  v_add_u32 v19, s40, v19
  v_add_u32 v20, 1152, v19
  v_lshrrev_b32 v21, 4, v0
  v_mul_u32_u24 v21, 288, v21
  v_and_b32 v2, 8, v0
  v_lshl_add_u32 v21, v2, 4, v21
  v_and_b32 v2, 1, v0
  v_lshl_add_u32 v21, v2, 6, v21
  v_bfe_u32 v2, v0, 1, 2
  v_lshl_add_u32 v21, v2, 4, v21
  s_lshl_b32 s40, s36, 10
  v_lshl_add_u32 v22, v0, 4, s40
  s_lshl_b32 s40, s65, 11
  v_lshl_add_u32 v24, v0, 4, s40
  v_add_u32 v25, 16777216, v24
  v_lshrrev_b32 v2, 4, v0
  s_lshl_b32 s40, s65, 10
  s_add_u32 s40, s40, 67108864
  v_and_b32 v26, 7, v0
  v_lshl_add_u32 v26, v2, 3, v26
  v_lshl_add_u32 v26, v26, 4, s40
  v_lshl_add_u32 v27, v0, 2, s40
  s_mov_b32 s64, 0x3e0293ee
  s_and_b32 s40, s36, 1
  s_lshl_b32 s40, s40, 13
  s_lshr_b32 s41, s36, 1
  s_lshl_b32 s41, s41, 18
  s_add_u32 s40, s40, s41
  v_add_u32 v1, s40, v15
  global_store_dwordx4 v1, v[36:39], s[72:73] sc1
  s_lshr_b32 s40, s65, 2
  s_lshl_b32 s40, s40, 14
  s_and_b32 s41, s65, 3
  s_lshl_b32 s41, s41, 11
  s_add_u32 s40, s40, s41
  s_and_b32 s42, s36, 1
  s_lshl_b32 s41, s42, 13
  s_add_u32 s40, s40, s41
  s_lshl_b32 s41, s36, 8
  s_add_u32 s40, s40, s41
  s_add_u32 s76, s40, 0x180000
  v_lshl_add_u32 v1, v0, 4, s76
  s_mov_b64 exec, 0xff
  global_store_dwordx4 v1, v[36:39], s[72:73] sc1
  s_mov_b64 exec, -1
  s_lshl_b32 s40, s65, 14
  s_lshl_b32 s41, s36, 12
  s_add_u32 s40, s40, s41
  s_add_u32 s40, s40, 90177536
  v_lshl_add_u32 v1, v0, 4, s40
  global_store_dwordx4 v1, v[36:39], s[34:35] sc1
  global_store_dwordx4 v1, v[36:39], s[34:35] offset:1024 sc1
  global_store_dwordx4 v1, v[36:39], s[34:35] offset:2048 sc1
  s_cmp_eq_u32 s36, 1
  s_cbranch_scc0 L_c_ini
  global_store_dwordx4 v8, v[36:39], s[34:35] sc1
  s_mov_b32 exec_lo, 0
  global_store_dwordx4 v7, v[32:35], s[34:35] sc1
  s_mov_b64 exec, 0xffff
  global_store_dwordx4 v8, v[36:39], s[34:35] offset:1024 sc1
  s_lshl_b32 s40, s65, 6
  s_add_u32 s40, s40, 76546056
  v_mov_b32 v1, s40
  s_mov_b64 exec, 1
  global_store_dword v1, v183, s[34:35] sc1
  s_mov_b64 exec, -1
L_c_ini:
  s_mov_b64 exec, s[74:75]
  buffer_load_dword v46, v44, s[44:47], 0 offen
  s_mov_b64 exec, -1
  s_xor_b32 m0, s60, 16384
  s_xor_b32 s61, s62, 0
  buffer_load_dwordx4 v40, s[52:55], s61 offen lds
  s_xor_b32 m0, s60, 17408
  s_xor_b32 s61, s62, 131072
  buffer_load_dwordx4 v40, s[52:55], s61 offen lds
  s_xor_b32 m0, s60, 18432
  s_xor_b32 s61, s62, 262144
  buffer_load_dwordx4 v40, s[52:55], s61 offen lds
  s_xor_b32 m0, s60, 19456
  s_xor_b32 s61, s62, 393216
  buffer_load_dwordx4 v40, s[52:55], s61 offen lds
  s_xor_b32 m0, s60, 20480
  s_xor_b32 s61, s62, 524288
  buffer_load_dwordx4 v40, s[52:55], s61 offen lds
  s_xor_b32 m0, s60, 21504
  s_xor_b32 s61, s62, 655360
  buffer_load_dwordx4 v40, s[52:55], s61 offen lds
  s_xor_b32 m0, s60, 22528
  s_xor_b32 s61, s62, 786432
  buffer_load_dwordx4 v40, s[52:55], s61 offen lds
  s_waitcnt vmcnt(7)
  ds_read_b64_tr_b16 a[64:65], v43 offset:0
  ds_read_b64_tr_b16 a[66:67], v43 offset:64
  ds_read_b64_tr_b16 a[68:69], v43 offset:2048
  ds_read_b64_tr_b16 a[70:71], v43 offset:2112
  s_xor_b32 m0, s60, 23552
  s_xor_b32 s61, s62, 917504
  buffer_load_dwordx4 v40, s[52:55], s61 offen lds
  ds_read_b64_tr_b16 a[72:73], v43 offset:32
  ds_read_b64_tr_b16 a[74:75], v43 offset:96
  ds_read_b64_tr_b16 a[76:77], v43 offset:2080
  ds_read_b64_tr_b16 a[78:79], v43 offset:2144
  s_xor_b32 m0, s60, 24576
  s_xor_b32 s61, s62, 1048576
  buffer_load_dwordx4 v40, s[52:55], s61 offen lds
  ds_read_b64_tr_b16 a[80:81], v43 offset:4096
  ds_read_b64_tr_b16 a[82:83], v43 offset:4160
  ds_read_b64_tr_b16 a[84:85], v43 offset:6144
  ds_read_b64_tr_b16 a[86:87], v43 offset:6208
  s_xor_b32 m0, s60, 25600
  s_xor_b32 s61, s62, 1179648
  buffer_load_dwordx4 v40, s[52:55], s61 offen lds
  ds_read_b64_tr_b16 a[88:89], v43 offset:4128
  ds_read_b64_tr_b16 a[90:91], v43 offset:4192
  ds_read_b64_tr_b16 a[92:93], v43 offset:6176
  ds_read_b64_tr_b16 a[94:95], v43 offset:6240
  s_xor_b32 m0, s60, 26624
  s_xor_b32 s61, s62, 1310720
  buffer_load_dwordx4 v40, s[52:55], s61 offen lds
  ds_read_b64_tr_b16 a[96:97], v43 offset:8192
  ds_read_b64_tr_b16 a[98:99], v43 offset:8256
  ds_read_b64_tr_b16 a[100:101], v43 offset:10240
  ds_read_b64_tr_b16 a[102:103], v43 offset:10304
  s_xor_b32 m0, s60, 27648
  s_xor_b32 s61, s62, 1441792
  buffer_load_dwordx4 v40, s[52:55], s61 offen lds
  ds_read_b64_tr_b16 a[104:105], v43 offset:8224
  ds_read_b64_tr_b16 a[106:107], v43 offset:8288
  ds_read_b64_tr_b16 a[108:109], v43 offset:10272
  ds_read_b64_tr_b16 a[110:111], v43 offset:10336
  s_xor_b32 m0, s60, 28672
  s_xor_b32 s61, s62, 1572864
  buffer_load_dwordx4 v40, s[52:55], s61 offen lds
  ds_read_b64_tr_b16 a[112:113], v43 offset:12288
  ds_read_b64_tr_b16 a[114:115], v43 offset:12352
  ds_read_b64_tr_b16 a[116:117], v43 offset:14336
  ds_read_b64_tr_b16 a[118:119], v43 offset:14400
  s_xor_b32 m0, s60, 29696
  s_xor_b32 s61, s62, 1703936
  buffer_load_dwordx4 v40, s[52:55], s61 offen lds
  ds_read_b64_tr_b16 a[120:121], v43 offset:12320
  ds_read_b64_tr_b16 a[122:123], v43 offset:12384
  ds_read_b64_tr_b16 a[124:125], v43 offset:14368
  ds_read_b64_tr_b16 a[126:127], v43 offset:14432
  s_xor_b32 m0, s60, 30720
  s_xor_b32 s61, s62, 1835008
  buffer_load_dwordx4 v40, s[52:55], s61 offen lds
  s_xor_b32 m0, s60, 31744
  s_xor_b32 s61, s62, 1966080
  buffer_load_dwordx4 v40, s[52:55], s61 offen lds
  s_waitcnt lgkmcnt(0)
  v_lshl_or_b32 v188, v190, 16, v188
  v_lshl_or_b32 v189, v191, 16, v189
  s_cmp_eq_u32 s36, 0
  s_cbranch_scc0 L_c_ini2
  global_store_dword v5, v188, s[34:35] sc1
  global_store_dword v5, v189, s[34:35] offset:16 sc1
L_c_ini2:
  s_mov_b64 exec, s[74:75]
  buffer_load_dword v46, v45, s[56:59], 0 offen
  s_mov_b64 exec, -1
  s_xor_b32 m0, s60, 0
  s_xor_b32 s61, s62, 0
  buffer_load_dwordx4 v40, s[44:47], s61 offen lds
  s_xor_b32 m0, s60, 1024
  s_xor_b32 s61, s62, 131072
  buffer_load_dwordx4 v40, s[44:47], s61 offen lds
  s_xor_b32 m0, s60, 2048
  s_xor_b32 s61, s62, 262144
  buffer_load_dwordx4 v40, s[44:47], s61 offen lds
  s_xor_b32 m0, s60, 3072
  s_xor_b32 s61, s62, 393216
  buffer_load_dwordx4 v40, s[44:47], s61 offen lds
  s_xor_b32 m0, s60, 4096
  s_xor_b32 s61, s62, 524288
  buffer_load_dwordx4 v40, s[44:47], s61 offen lds
  s_xor_b32 m0, s60, 5120
  s_xor_b32 s61, s62, 655360
  buffer_load_dwordx4 v40, s[44:47], s61 offen lds
  s_xor_b32 m0, s60, 6144
  s_xor_b32 s61, s62, 786432
  buffer_load_dwordx4 v40, s[44:47], s61 offen lds
  s_waitcnt vmcnt(7)
  ds_read_b64_tr_b16 a[128:129], v43 offset:16384
  ds_read_b64_tr_b16 a[130:131], v43 offset:16448
  ds_read_b64_tr_b16 a[132:133], v43 offset:18432
  ds_read_b64_tr_b16 a[134:135], v43 offset:18496
  s_xor_b32 m0, s60, 7168
  s_xor_b32 s61, s62, 917504
  buffer_load_dwordx4 v40, s[44:47], s61 offen lds
  ds_read_b64_tr_b16 a[136:137], v43 offset:16416
  ds_read_b64_tr_b16 a[138:139], v43 offset:16480
  ds_read_b64_tr_b16 a[140:141], v43 offset:18464
  ds_read_b64_tr_b16 a[142:143], v43 offset:18528
  s_xor_b32 m0, s60, 8192
  s_xor_b32 s61, s62, 1048576
  buffer_load_dwordx4 v40, s[44:47], s61 offen lds
  ds_read_b64_tr_b16 a[144:145], v43 offset:20480
  ds_read_b64_tr_b16 a[146:147], v43 offset:20544
  ds_read_b64_tr_b16 a[148:149], v43 offset:22528
  ds_read_b64_tr_b16 a[150:151], v43 offset:22592
  s_xor_b32 m0, s60, 9216
  s_xor_b32 s61, s62, 1179648
  buffer_load_dwordx4 v40, s[44:47], s61 offen lds
  ds_read_b64_tr_b16 a[152:153], v43 offset:20512
  ds_read_b64_tr_b16 a[154:155], v43 offset:20576
  ds_read_b64_tr_b16 a[156:157], v43 offset:22560
  ds_read_b64_tr_b16 a[158:159], v43 offset:22624
  s_xor_b32 m0, s60, 10240
  s_xor_b32 s61, s62, 1310720
  buffer_load_dwordx4 v40, s[44:47], s61 offen lds
  ds_read_b64_tr_b16 a[160:161], v43 offset:24576
  ds_read_b64_tr_b16 a[162:163], v43 offset:24640
  ds_read_b64_tr_b16 a[164:165], v43 offset:26624
  ds_read_b64_tr_b16 a[166:167], v43 offset:26688
  s_xor_b32 m0, s60, 11264
  s_xor_b32 s61, s62, 1441792
  buffer_load_dwordx4 v40, s[44:47], s61 offen lds
  ds_read_b64_tr_b16 a[168:169], v43 offset:24608
  ds_read_b64_tr_b16 a[170:171], v43 offset:24672
  ds_read_b64_tr_b16 a[172:173], v43 offset:26656
  ds_read_b64_tr_b16 a[174:175], v43 offset:26720
  s_xor_b32 m0, s60, 12288
  s_xor_b32 s61, s62, 1572864
  buffer_load_dwordx4 v40, s[44:47], s61 offen lds
  ds_read_b64_tr_b16 a[176:177], v43 offset:28672
  ds_read_b64_tr_b16 a[178:179], v43 offset:28736
  ds_read_b64_tr_b16 a[180:181], v43 offset:30720
  ds_read_b64_tr_b16 a[182:183], v43 offset:30784
  s_xor_b32 m0, s60, 13312
  s_xor_b32 s61, s62, 1703936
  buffer_load_dwordx4 v40, s[44:47], s61 offen lds
  ds_read_b64_tr_b16 a[184:185], v43 offset:28704
  ds_read_b64_tr_b16 a[186:187], v43 offset:28768
  ds_read_b64_tr_b16 a[188:189], v43 offset:30752
  ds_read_b64_tr_b16 a[190:191], v43 offset:30816
  s_xor_b32 m0, s60, 14336
  s_xor_b32 s61, s62, 1835008
  buffer_load_dwordx4 v40, s[44:47], s61 offen lds
  s_xor_b32 m0, s60, 15360
  s_xor_b32 s61, s62, 1966080
  buffer_load_dwordx4 v40, s[44:47], s61 offen lds
  s_waitcnt lgkmcnt(0)
  s_memtime s[80:81]
  s_waitcnt lgkmcnt(0)
  s_load_dword s43, s[72:73], s76
  s_waitcnt lgkmcnt(0)
  s_memtime s[82:83]
  s_waitcnt lgkmcnt(0)
  s_sub_u32 s41, s82, s80
  v_mov_b32 v1, s41
  s_lshl_b32 s40, s36, 2
  v_mov_b32 v2, s40
  ds_write_b32 v2, v1 offset:24576
  s_waitcnt lgkmcnt(0)
  s_barrier
  ds_read_b128 v[88:91], v183 offset:24576
  s_waitcnt lgkmcnt(0)
  v_min_u32 v88, v88, v90
  v_min_u32 v89, v89, v91
  v_cmp_gt_u32 vcc, v88, v89
  s_and_b32 s42, vcc_lo, 1
  s_cmp_eq_u32 s36, 0
  s_cbranch_scc0 L_arr_1
  s_add_u32 s41, s42, 0x10000
  s_atomic_add s41, s[32:33], 4 glc
  s_waitcnt lgkmcnt(0)
  s_lshr_b32 s40, s41, 16
  s_cmp_eq_u32 s40, 255
  s_cbranch_scc0 L_arr_1
  s_mov_b32 s84, 0
  s_atomic_add s84, s[32:33], 0 glc
  s_mov_b32 s85, 0
  s_atomic_add s85, s[32:33], 32 glc
  s_mov_b32 s86, 0
  s_atomic_add s86, s[32:33], 64 glc
  s_mov_b32 s87, 0
  s_atomic_add s87, s[32:33], 96 glc
  s_mov_b32 s88, 0
  s_atomic_add s88, s[32:33], 128 glc
  s_mov_b32 s89, 0
  s_atomic_add s89, s[32:33], 160 glc
  s_mov_b32 s90, 0
  s_atomic_add s90, s[32:33], 192 glc
  s_mov_b32 s91, 0
  s_atomic_add s91, s[32:33], 224 glc
  s_and_b32 s41, s41, 0xffff
  s_cmp_ge_u32 s41, 64
  s_cselect_b32 s41, 3, 1
  s_mov_b32 s40, 4
  s_waitcnt lgkmcnt(0)
  s_cmp_eq_u32 s84, 32
  s_cselect_b32 s40, s40, 0
  s_cmp_eq_u32 s85, 32
  s_cselect_b32 s40, s40, 0
  s_cmp_eq_u32 s86, 32
  s_cselect_b32 s40, s40, 0
  s_cmp_eq_u32 s87, 32
  s_cselect_b32 s40, s40, 0
  s_cmp_eq_u32 s88, 32
  s_cselect_b32 s40, s40, 0
  s_cmp_eq_u32 s89, 32
  s_cselect_b32 s40, s40, 0
  s_cmp_eq_u32 s90, 32
  s_cselect_b32 s40, s40, 0
  s_cmp_eq_u32 s91, 32
  s_cselect_b32 s40, s40, 0
  s_add_u32 s41, s41, s40
  s_atomic_add s41, s[32:33], 252
L_arr_1:
  s_xor_b32 m0, s60, 16384
  s_xor_b32 s61, s63, 0
  buffer_load_dwordx4 v41, s[56:59], s61 offen lds
  s_xor_b32 m0, s60, 17408
  s_xor_b32 s61, s63, 32768
  buffer_load_dwordx4 v41, s[56:59], s61 offen lds
  s_xor_b32 m0, s60, 18432
  s_xor_b32 s61, s63, 65536
  buffer_load_dwordx4 v41, s[56:59], s61 offen lds
  s_xor_b32 m0, s60, 19456
  s_xor_b32 s61, s63, 98304
  buffer_load_dwordx4 v41, s[56:59], s61 offen lds
  s_xor_b32 m0, s60, 20480
  s_xor_b32 s61, s63, 131072
  buffer_load_dwordx4 v41, s[56:59], s61 offen lds
  s_xor_b32 m0, s60, 21504
  s_xor_b32 s61, s63, 163840
  buffer_load_dwordx4 v41, s[56:59], s61 offen lds
  s_xor_b32 m0, s60, 22528
  s_xor_b32 s61, s63, 196608
  buffer_load_dwordx4 v41, s[56:59], s61 offen lds
  s_waitcnt vmcnt(7)
  ds_read_b64_tr_b16 a[0:1], v43 offset:0
  ds_read_b64_tr_b16 a[2:3], v43 offset:64
  ds_read_b64_tr_b16 a[4:5], v43 offset:2048
  ds_read_b64_tr_b16 a[6:7], v43 offset:2112
  s_xor_b32 m0, s60, 23552
  s_xor_b32 s61, s63, 229376
  buffer_load_dwordx4 v41, s[56:59], s61 offen lds
  ds_read_b64_tr_b16 a[8:9], v43 offset:32
  ds_read_b64_tr_b16 a[10:11], v43 offset:96
  ds_read_b64_tr_b16 a[12:13], v43 offset:2080
  ds_read_b64_tr_b16 a[14:15], v43 offset:2144
  s_xor_b32 m0, s60, 24576
  s_xor_b32 s61, s63, 262144
  buffer_load_dwordx4 v41, s[56:59], s61 offen lds
  ds_read_b64_tr_b16 a[16:17], v43 offset:4096
  ds_read_b64_tr_b16 a[18:19], v43 offset:4160
  ds_read_b64_tr_b16 a[20:21], v43 offset:6144
  ds_read_b64_tr_b16 a[22:23], v43 offset:6208
  s_xor_b32 m0, s60, 25600
  s_xor_b32 s61, s63, 294912
  buffer_load_dwordx4 v41, s[56:59], s61 offen lds
  ds_read_b64_tr_b16 a[24:25], v43 offset:4128
  ds_read_b64_tr_b16 a[26:27], v43 offset:4192
  ds_read_b64_tr_b16 a[28:29], v43 offset:6176
  ds_read_b64_tr_b16 a[30:31], v43 offset:6240
  s_xor_b32 m0, s60, 26624
  s_xor_b32 s61, s63, 327680
  buffer_load_dwordx4 v41, s[56:59], s61 offen lds
  ds_read_b64_tr_b16 a[32:33], v43 offset:8192
  ds_read_b64_tr_b16 a[34:35], v43 offset:8256
  ds_read_b64_tr_b16 a[36:37], v43 offset:10240
  ds_read_b64_tr_b16 a[38:39], v43 offset:10304
  s_xor_b32 m0, s60, 27648
  s_xor_b32 s61, s63, 360448
  buffer_load_dwordx4 v41, s[56:59], s61 offen lds
  ds_read_b64_tr_b16 a[40:41], v43 offset:8224
  ds_read_b64_tr_b16 a[42:43], v43 offset:8288
  ds_read_b64_tr_b16 a[44:45], v43 offset:10272
  ds_read_b64_tr_b16 a[46:47], v43 offset:10336
  s_xor_b32 m0, s60, 28672
  s_xor_b32 s61, s63, 393216
  buffer_load_dwordx4 v41, s[56:59], s61 offen lds
  ds_read_b64_tr_b16 a[48:49], v43 offset:12288
  ds_read_b64_tr_b16 a[50:51], v43 offset:12352
  ds_read_b64_tr_b16 a[52:53], v43 offset:14336
  ds_read_b64_tr_b16 a[54:55], v43 offset:14400
  s_xor_b32 m0, s60, 29696
  s_xor_b32 s61, s63, 425984
  buffer_load_dwordx4 v41, s[56:59], s61 offen lds
  ds_read_b64_tr_b16 a[56:57], v43 offset:12320
  ds_read_b64_tr_b16 a[58:59], v43 offset:12384
  ds_read_b64_tr_b16 a[60:61], v43 offset:14368
  ds_read_b64_tr_b16 a[62:63], v43 offset:14432
  s_xor_b32 m0, s60, 30720
  s_xor_b32 s61, s63, 458752
  buffer_load_dwordx4 v41, s[56:59], s61 offen lds
  s_xor_b32 m0, s60, 31744
  s_xor_b32 s61, s63, 491520
  buffer_load_dwordx4 v41, s[56:59], s61 offen lds
  s_waitcnt lgkmcnt(0)
  s_mov_b64 exec, 0
  s_cmp_eq_u32 s36, 0
  s_cbranch_scc1 L_ct_w0
  s_cmp_eq_u32 s36, 1
  s_cbranch_scc1 L_ct_w1
  s_cmp_eq_u32 s36, 2
  s_cbranch_scc1 L_ct_w2
  s_branch L_ct_w3
L_ct_done:
  s_waitcnt vmcnt(0)
  ds_read_b64_tr_b16 a[192:193], v42 offset:16384
  ds_read_b64_tr_b16 a[194:195], v42 offset:16512
  ds_read_b64_tr_b16 a[196:197], v42 offset:18432
  ds_read_b64_tr_b16 a[198:199], v42 offset:18560
  ds_read_b64_tr_b16 a[200:201], v42 offset:16416
  ds_read_b64_tr_b16 a[202:203], v42 offset:16544
  ds_read_b64_tr_b16 a[204:205], v42 offset:18464
  ds_read_b64_tr_b16 a[206:207], v42 offset:18592
  ds_read_b64_tr_b16 a[208:209], v42 offset:20480
  ds_read_b64_tr_b16 a[210:211], v42 offset:20608
  ds_read_b64_tr_b16 a[212:213], v42 offset:22528
  ds_read_b64_tr_b16 a[214:215], v42 offset:22656
  ds_read_b64_tr_b16 a[216:217], v42 offset:20512
  ds_read_b64_tr_b16 a[218:219], v42 offset:20640
  ds_read_b64_tr_b16 a[220:221], v42 offset:22560
  ds_read_b64_tr_b16 a[222:223], v42 offset:22688
  ds_read_b64_tr_b16 a[224:225], v42 offset:24576
  ds_read_b64_tr_b16 a[226:227], v42 offset:24704
  ds_read_b64_tr_b16 a[228:229], v42 offset:26624
  ds_read_b64_tr_b16 a[230:231], v42 offset:26752
  ds_read_b64_tr_b16 a[232:233], v42 offset:24608
  ds_read_b64_tr_b16 a[234:235], v42 offset:24736
  ds_read_b64_tr_b16 a[236:237], v42 offset:26656
  ds_read_b64_tr_b16 a[238:239], v42 offset:26784
  ds_read_b64_tr_b16 a[240:241], v42 offset:28672
  ds_read_b64_tr_b16 a[242:243], v42 offset:28800
  ds_read_b64_tr_b16 a[244:245], v42 offset:30720
  ds_read_b64_tr_b16 a[246:247], v42 offset:30848
  ds_read_b64_tr_b16 a[248:249], v42 offset:28704
  ds_read_b64_tr_b16 a[250:251], v42 offset:28832
  ds_read_b64_tr_b16 a[252:253], v42 offset:30752
  ds_read_b64_tr_b16 a[254:255], v42 offset:30880
  s_waitcnt lgkmcnt(0)
  v_mov_b32 v56, 0
  v_mov_b32 v57, 0
  v_mov_b32 v58, 0
  v_mov_b32 v59, 0
  v_mov_b32 v60, 0
  v_mov_b32 v61, 0
  v_mov_b32 v62, 0
  v_mov_b32 v63, 0
  v_mov_b32 v64, 0
  v_mov_b32 v65, 0
  v_mov_b32 v66, 0
  v_mov_b32 v67, 0
  v_mov_b32 v68, 0
  v_mov_b32 v69, 0
  v_mov_b32 v70, 0
  v_mov_b32 v71, 0
  v_mov_b32 v72, 0
  v_mov_b32 v73, 0
  v_mov_b32 v74, 0
  v_mov_b32 v75, 0
  v_mov_b32 v76, 0
  v_mov_b32 v77, 0
  v_mov_b32 v78, 0
  v_mov_b32 v79, 0
  v_mov_b32 v80, 0
  v_mov_b32 v81, 0
  v_mov_b32 v82, 0
  v_mov_b32 v83, 0
  v_mov_b32 v84, 0
  v_mov_b32 v85, 0
  v_mov_b32 v86, 0
  v_mov_b32 v87, 0
  ds_write2_b32 v19, v36, v36 offset0:0 offset1:16
  ds_write2_b32 v20, v36, v36 offset0:0 offset1:16
  ds_write2_b32 v19, v36, v36 offset0:32 offset1:48
  ds_write2_b32 v20, v36, v36 offset0:32 offset1:48
  s_waitcnt lgkmcnt(0)
  v_mov_b32 v1, 252
  s_cmp_eq_u32 s36, 0
  s_cbranch_scc0 L_wib_4
L_wi_2:
  global_load_dword v2, v1, s[32:33] sc1
  s_waitcnt vmcnt(0)
  v_cmp_ne_u32 vcc, 0, v2
  s_cbranch_vccnz L_wid_3
  s_sleep 2
  s_sub_u32 s39, s39, 1
  s_cbranch_scc0 L_wi_2
  s_endpgm
L_wid_3:
  ds_write_b32 v1, v2 offset:16384
  s_waitcnt lgkmcnt(0)
L_wib_4:
  s_barrier
  ds_read_b32 v2, v1 offset:16384
  s_waitcnt lgkmcnt(0)
  v_readfirstlane_b32 s43, v2
  s_and_b32 s40, s43, 2
  s_lshl_b32 s40, s40, 12
  s_add_u32 s52, s72, s40
  s_addc_u32 s53, s73, 0
  s_mov_b64 s[48:49], s[52:53]
  s_add_u32 s50, s52, 524288
  s_addc_u32 s51, s53, 0
  s_mov_b64 s[44:45], s[34:35]
  s_add_u32 s46, s34, 524288
  s_addc_u32 s47, s35, 0
  s_mov_b64 s[54:55], s[34:35]
  s_mov_b64 s[56:57], s[34:35]
  s_mov_b32 s58, 0
  s_mov_b32 s59, 0
  s_mov_b32 s78, 0
  s_waitcnt lgkmcnt(0)
  s_lshl_b32 s60, s65, 6
  s_mov_b32 s41, 76546056
  s_cmp_eq_u32 s36, 2
  s_cselect_b32 s41, 76546048, s41
  s_cmp_eq_u32 s36, 3
  s_cselect_b32 s41, 76546052, s41
  s_add_u32 s60, s60, s41
  s_mov_b32 s62, 0xff00ff00
  s_mov_b32 s63, 0
  s_cmp_eq_u32 s36, 1
  s_cselect_b32 s59, 64, 0
  s_mov_b32 s79, 0
  s_cmp_eq_u32 s36, 0
  s_cbranch_scc0 L_c_nopre
  s_sub_u32 s42, s60, 8
  s_load_dwordx2 s[40:41], s[34:35], s42 glc
  s_waitcnt lgkmcnt(0)
  s_min_u32 s40, s40, s41
  s_cmp_eq_u32 s40, 0
  s_cbranch_scc1 L_c_nopre
  s_mov_b32 s79, 63
  global_load_dwordx4 v[124:127], v24, s[54:55] offset:0 sc1
  global_load_dwordx4 v[128:131], v24, s[54:55] offset:1024 sc1
  global_load_dwordx4 v[212:215], v25, s[54:55] offset:0 sc1
  global_load_dwordx4 v[216:219], v25, s[54:55] offset:1024 sc1
L_c_nopre:
  s_cmp_eq_u32 s36, 0
  s_cbranch_scc0 L_c_np
  s_setprio 3
L_c_np:
  s_bitcmp1_b32 s43, 2
  s_cbranch_scc0 L_c_safe_step
  .fill (((16 - (. - L_0)) & 31) >> 2), 4, 0xbf800000
L_c_fast_step:
  s_nop 15
  s_nop 3
  global_load_dwordx4 v[40:43], v4, s[44:45] offset:0 sc1
  s_nop 7
  global_load_dwordx4 v[44:47], v4, s[44:45] offset:1024 sc1
  s_nop 7
  global_load_dwordx4 v[48:51], v4, s[44:45] offset:2048 sc1
  s_nop 7
  global_load_dwordx4 v[52:55], v4, s[44:45] offset:3072 sc1
  .fill (((4 - (. - L_0)) & 31) >> 2), 4, 0xbf800000
  s_waitcnt vmcnt(3)
  v_cmp_eq_u32 vcc, -1, v43
  s_cbranch_vccnz L_c_fast_A_f0123
  v_smfmac_f32_16x16x64_bf16 v[56:59], v[40:43], a[0:7], v3
  v_smfmac_f32_16x16x64_bf16 v[60:63], v[40:43], a[8:15], v3
  s_waitcnt vmcnt(2)
  v_cmp_eq_u32 vcc, -1, v47
  v_smfmac_f32_16x16x64_bf16 v[64:67], v[40:43], a[64:71], v3
  v_smfmac_f32_16x16x64_bf16 v[68:71], v[40:43], a[72:79], v3
  s_cbranch_vccnz L_c_fast_A_f123
  v_smfmac_f32_16x16x64_bf16 v[56:59], v[44:47], a[16:23], v3
  v_smfmac_f32_16x16x64_bf16 v[60:63], v[44:47], a[24:31], v3
  s_waitcnt vmcnt(1)
  v_cmp_eq_u32 vcc, -1, v51
  v_smfmac_f32_16x16x64_bf16 v[64:67], v[44:47], a[80:87], v3
  v_smfmac_f32_16x16x64_bf16 v[68:71], v[44:47], a[88:95], v3
  s_cbranch_vccnz L_c_fast_A_f23
  v_smfmac_f32_16x16x64_bf16 v[56:59], v[48:51], a[32:39], v3
  v_smfmac_f32_16x16x64_bf16 v[60:63], v[48:51], a[40:47], v3
  s_waitcnt vmcnt(0)
  v_cmp_eq_u32 vcc, -1, v55
  v_smfmac_f32_16x16x64_bf16 v[64:67], v[48:51], a[96:103], v3
  v_smfmac_f32_16x16x64_bf16 v[68:71], v[48:51], a[104:111], v3
  s_cbranch_vccnz L_c_fast_A_f3
  v_smfmac_f32_16x16x64_bf16 v[56:59], v[52:55], a[48:55], v3
  v_smfmac_f32_16x16x64_bf16 v[60:63], v[52:55], a[56:63], v3
  v_smfmac_f32_16x16x64_bf16 v[64:67], v[52:55], a[112:119], v3
  v_smfmac_f32_16x16x64_bf16 v[68:71], v[52:55], a[120:127], v3
L_c_fast_A_done:
  s_cmp_eq_u32 s36, 0
  s_nop 3
  v_pk_add_f32 v[56:57], v[56:57], v[58:59]
  ds_write2_b32 v19, v56, v57 offset0:0 offset1:16
  v_pk_add_f32 v[60:61], v[60:61], v[62:63]
  ds_write2_b32 v20, v60, v61 offset0:0 offset1:16
  v_pk_add_f32 v[64:65], v[64:65], v[66:67]
  ds_write2_b32 v19, v64, v65 offset0:32 offset1:48
  v_pk_add_f32 v[68:69], v[68:69], v[70:71]
  ds_write2_b32 v20, v68, v69 offset0:32 offset1:48
  s_barrier
  s_cbranch_scc0 L_c_fast_helper
L_c_fast_B2:
  ds_read_b128 v[88:91], v21 offset:0
  ds_read_b128 v[92:95], v21 offset:1152
  ds_read_b128 v[96:99], v21 offset:2304
  ds_read_b128 v[100:103], v21 offset:3456
  ds_read_b128 v[104:107], v21 offset:4608
  ds_read_b128 v[108:111], v21 offset:5760
  ds_read_b128 v[112:115], v21 offset:6912
  ds_read_b128 v[116:119], v21 offset:8064
  s_cmp_eq_u32 s58, s79
  s_waitcnt lgkmcnt(4)
  v_pk_add_f32 v[88:89], v[88:89], v[96:97]
  v_pk_add_f32 v[90:91], v[90:91], v[98:99]
  v_pk_add_f32 v[92:93], v[92:93], v[100:101]
  v_pk_add_f32 v[94:95], v[94:95], v[102:103]
  s_waitcnt lgkmcnt(2)
  v_pk_add_f32 v[88:89], v[88:89], v[104:105]
  v_pk_add_f32 v[90:91], v[90:91], v[106:107]
  v_pk_add_f32 v[92:93], v[92:93], v[108:109]
  v_pk_add_f32 v[94:95], v[94:95], v[110:111]
  s_waitcnt lgkmcnt(1)
  v_pk_add_f32 v[88:89], v[88:89], v[112:113]
  v_pk_add_f32 v[90:91], v[90:91], v[114:115]
  v_cvt_pk_bf16_f32 v120, v88, v89
  v_cvt_pk_bf16_f32 v121, v90, v91
  s_waitcnt lgkmcnt(0)
  v_pk_add_f32 v[92:93], v[92:93], v[116:117]
  v_pk_add_f32 v[94:95], v[94:95], v[118:119]
  v_cvt_pk_bf16_f32 v122, v92, v93
  v_cvt_pk_bf16_f32 v123, v94, v95
  s_cbranch_scc1 L_c_fast_last
L_c_fast_Bret:
  s_nop 0
  v_mfma_f32_16x16x32_bf16 v[148:151], v[124:127], v[120:123], 0
  v_mfma_f32_16x16x32_bf16 v[152:155], v[128:131], v[120:123], 0
  v_mfma_f32_16x16x32_bf16 v[156:159], v[120:123], v[120:123], 0
  s_mov_b64 exec, s[66:67]
  s_nop 4
  global_store_dwordx4 v8, v[148:151], s[44:45]
  global_store_dwordx4 v8, v[152:155], s[44:45] offset:128
  s_mov_b64 exec, s[62:63]
  global_store_dwordx4 v12, v[156:159], s[44:45] offset:1024
  s_mov_b64 exec, -1
  v_cmp_u_f32 vcc, v156, v156
  v_mov_b32_dpp v148, v152 row_shr:8 row_mask:0xf bank_mask:0xc
  v_mov_b32_dpp v149, v153 row_shr:8 row_mask:0xf bank_mask:0xc
  v_mov_b32_dpp v150, v154 row_shr:8 row_mask:0xf bank_mask:0xc
  v_mov_b32_dpp v151, v155 row_shr:8 row_mask:0xf bank_mask:0xc
  s_cbranch_vccnz L_c_fast_Bredo
  v_smfmac_f32_16x16x64_bf16 v[72:75], v[40:43], a[128:135], v3
  v_smfmac_f32_16x16x64_bf16 v[76:79], v[40:43], a[136:143], v3
  v_smfmac_f32_16x16x64_bf16 v[72:75], v[44:47], a[144:151], v3
  v_smfmac_f32_16x16x64_bf16 v[76:79], v[44:47], a[152:159], v3
  v_smfmac_f32_16x16x64_bf16 v[72:75], v[48:51], a[160:167], v3
  v_smfmac_f32_16x16x64_bf16 v[76:79], v[48:51], a[168:175], v3
  v_smfmac_f32_16x16x64_bf16 v[72:75], v[52:55], a[176:183], v3
  v_smfmac_f32_16x16x64_bf16 v[76:79], v[52:55], a[184:191], v3
  global_load_dword v176, v13, s[44:45] offset:1024 sc1
  global_load_dword v177, v13, s[44:45] offset:3072 sc1
  global_load_dword v178, v14, s[44:45] offset:1024 sc1
  global_load_dword v179, v14, s[44:45] offset:3072 sc1
  global_load_dwordx4 v[164:167], v9, s[44:45] sc1
  global_load_dwordx4 v[168:171], v10, s[44:45] sc1
  global_load_dwordx4 v[172:175], v11, s[44:45] sc1
  s_barrier
  ds_read_b128 v[92:95], v22 offset:17408
  ds_read_b128 v[96:99], v22 offset:18432
  ds_read_b128 v[100:103], v22 offset:19456
  v_mov_b64 v[132:133], v[212:213]
  v_mov_b64 v[136:137], v[214:215]
  v_mov_b64 v[140:141], v[216:217]
  v_mov_b64 v[144:145], v[218:219]
  v_pk_add_f32 v[72:73], v[72:73], v[74:75]
  v_pk_add_f32 v[74:75], v[76:77], v[78:79]
  s_waitcnt lgkmcnt(0)
  v_pk_add_f32 v[88:89], v[72:73], v[92:93]
  v_pk_add_f32 v[90:91], v[74:75], v[94:95]
  v_pk_add_f32 v[76:77], v[96:97], v[100:101]
  v_pk_add_f32 v[78:79], v[98:99], v[102:103]
  v_pk_add_f32 v[76:77], v[76:77], v[88:89]
  v_pk_add_f32 v[78:79], v[78:79], v[90:91]
  v_cvt_pk_bf16_f32 v134, v76, v77
  v_cvt_pk_bf16_f32 v138, v77, v76
  v_cvt_pk_bf16_f32 v142, v78, v79
  v_cvt_pk_bf16_f32 v146, v79, v78
  global_load_dword v176, v13, s[44:45] offset:1024 sc1
  global_load_dword v177, v13, s[44:45] offset:3072 sc1
  global_load_dword v178, v14, s[44:45] offset:1024 sc1
  global_load_dword v179, v14, s[44:45] offset:3072 sc1
  global_load_dwordx4 v[164:167], v9, s[44:45] sc1
  global_load_dwordx4 v[168:171], v10, s[44:45] sc1
  global_load_dwordx4 v[172:175], v11, s[44:45] sc1
  .fill (((20 - (. - L_0)) & 31) >> 2), 4, 0xbf800000
L_c_fast_Schk:
  s_waitcnt vmcnt(10)
  v_pk_add_f32 v[108:109], v[176:177], v[178:179]
  v_add_f32 v108, v108, v109
  s_waitcnt vmcnt(9)
  v_pk_add_f32 v[104:105], v[148:149], v[164:165]
  v_pk_add_f32 v[106:107], v[150:151], v[166:167]
  s_waitcnt vmcnt(8)
  v_pk_add_f32 v[104:105], v[104:105], v[168:169]
  v_pk_add_f32 v[106:107], v[106:107], v[170:171]
  s_waitcnt vmcnt(7)
  v_pk_add_f32 v[104:105], v[104:105], v[172:173]
  v_pk_add_f32 v[106:107], v[106:107], v[174:175]
  v_maximum3_f32 v204, v104, v105, v108
  v_maximum3_f32 v204, v204, v106, v107
  v_cmp_u_f32 vcc, v204, v204
  v_mul_f32 v116, s64, v108
  v_max_f32_dpp v204, v204, v204 row_ror:8 row_mask:0xf bank_mask:0xf
  v_mov_b32 v206, v204
  v_pk_mul_f32 v[112:113], v[104:105], s[64:65] op_sel_hi:[1,0]
  v_pk_mul_f32 v[114:115], v[106:107], s[64:65] op_sel_hi:[1,0]
  v_permlane16_swap_b32 v206, v204
  v_max_f32 v204, v204, v206
  v_mov_b32 v206, v204
  s_cbranch_vccnz L_c_fast_Sret
  s_nop 0
  v_permlane32_swap_b32 v206, v204
  v_max_f32 v204, v204, v206
  v_fma_f32 v116, -v204, s64, v116
  v_pk_fma_f32 v[112:113], v[204:205], s[64:65], v[112:113] op_sel_hi:[0,0,1] neg_lo:[1,0,0] neg_hi:[1,0,0]
  v_exp_f32 v116, v116
  v_pk_fma_f32 v[114:115], v[204:205], s[64:65], v[114:115] op_sel_hi:[0,0,1] neg_lo:[1,0,0] neg_hi:[1,0,0]
  v_exp_f32 v112, v112
  v_exp_f32 v113, v113
  v_exp_f32 v114, v114
  v_exp_f32 v115, v115
  v_cvt_pk_bf16_f32 v182, v116, v183
  v_cvt_pk_bf16_f32 v180, v112, v113
  v_cvt_pk_bf16_f32 v181, v114, v115
  v_mov_b32_dpp v186, v182 row_ror:8 row_mask:0xf bank_mask:0xf
  v_mov_b32_dpp v184, v180 row_ror:8 row_mask:0xf bank_mask:0xf
  v_mfma_f32_16x16x32_bf16 v[156:159], v[160:163], v[180:183], 0
  v_mov_b32_dpp v185, v181 row_ror:8 row_mask:0xf bank_mask:0xf
  v_mfma_f32_16x16x32_bf16 v[148:151], v[132:135], v[180:183], 0
  v_mfma_f32_16x16x32_bf16 v[152:155], v[140:143], v[180:183], 0
  v_mfma_f32_16x16x32_bf16 v[148:151], v[136:139], v[184:187], v[148:151]
  v_mfma_f32_16x16x32_bf16 v[152:155], v[144:147], v[184:187], v[152:155]
  s_nop 2
  v_add_f32_dpp v206, v156, v156 row_ror:8 row_mask:0xf bank_mask:0xf
  v_rcp_f32 v206, v206
  s_mov_b64 exec, s[66:67]
  s_nop 0
  v_pk_mul_f32 v[148:149], v[148:149], v[206:207] op_sel_hi:[1,0]
  v_pk_mul_f32 v[154:155], v[154:155], v[206:207] op_sel_hi:[1,0]
  v_pk_mul_f32 v[150:151], v[150:151], v[206:207] op_sel_hi:[1,0]
  v_pk_mul_f32 v[152:153], v[152:153], v[206:207] op_sel_hi:[1,0]
  v_cvt_pk_bf16_f32 v211, v154, v155
  v_cvt_pk_bf16_f32 v208, v148, v149
  v_cvt_pk_bf16_f32 v209, v150, v151
  v_cvt_pk_bf16_f32 v210, v152, v153
  v_max_i32 v211, s77, v211
  global_store_dwordx4 v6, v[208:211], s[44:45]
  s_mov_b64 exec, -1
  s_nop 15
  s_nop 15
  s_nop 3
  s_barrier
  global_load_dwordx4 v[40:43], v29, s[44:45] offset:0 sc1
  s_nop 7
  global_load_dwordx4 v[44:47], v29, s[44:45] offset:1024 sc1
  s_nop 7
  global_load_dwordx4 v[48:51], v29, s[44:45] offset:2048 sc1
  s_nop 7
  global_load_dwordx4 v[52:55], v29, s[44:45] offset:3072 sc1
  .fill (((12 - (. - L_0)) & 31) >> 2), 4, 0xbf800000
  s_waitcnt vmcnt(3)
  v_smfmac_f32_16x16x64_bf16 v[80:83], v[40:43], a[192:199], v3
  v_cmp_gt_i32 vcc, s77, v43
  v_smfmac_f32_16x16x64_bf16 v[84:87], v[40:43], a[200:207], v3
  s_cbranch_vccnz L_c_fast_E0_f0123
  s_waitcnt vmcnt(2)
  v_smfmac_f32_16x16x64_bf16 v[80:83], v[44:47], a[208:215], v3
  v_cmp_gt_i32 vcc, s77, v47
  v_smfmac_f32_16x16x64_bf16 v[84:87], v[44:47], a[216:223], v3
  s_cbranch_vccnz L_c_fast_E0_f123
  s_waitcnt vmcnt(1)
  v_smfmac_f32_16x16x64_bf16 v[80:83], v[48:51], a[224:231], v3
  v_cmp_gt_i32 vcc, s77, v51
  v_smfmac_f32_16x16x64_bf16 v[84:87], v[48:51], a[232:239], v3
  s_cbranch_vccnz L_c_fast_E0_f23
  s_waitcnt vmcnt(0)
  v_smfmac_f32_16x16x64_bf16 v[80:83], v[52:55], a[240:247], v3
  v_cmp_gt_i32 vcc, s77, v55
  v_smfmac_f32_16x16x64_bf16 v[84:87], v[52:55], a[248:255], v3
  s_nop 5
  s_cbranch_vccnz L_c_fast_E0_f3
L_c_fast_E0_done:
  s_add_u32 s54, s54, 262144
  s_addc_u32 s55, s55, 0
  global_load_dwordx4 v[124:127], v24, s[54:55] offset:0 sc1
  global_load_dwordx4 v[128:131], v24, s[54:55] offset:1024 sc1
  global_load_dwordx4 v[212:215], v25, s[54:55] offset:0 sc1
  global_load_dwordx4 v[216:219], v25, s[54:55] offset:1024 sc1
  v_pk_add_f32 v[80:81], v[80:81], v[82:83]
  v_pk_add_f32 v[82:83], v[84:85], v[86:87]
  .fill (((8 - (. - L_0)) & 31) >> 2), 4, 0xbf800000
  s_barrier
L_c_fast_F2:
  ds_read_b128 v[92:95], v22 offset:25600
  ds_read_b128 v[96:99], v22 offset:26624
  ds_read_b128 v[100:103], v22 offset:27648
  s_waitcnt lgkmcnt(2)
  v_pk_add_f32 v[188:189], v[80:81], v[92:93]
  v_pk_add_f32 v[190:191], v[82:83], v[94:95]
  s_waitcnt lgkmcnt(1)
  v_pk_add_f32 v[188:189], v[188:189], v[96:97]
  v_pk_add_f32 v[190:191], v[190:191], v[98:99]
  s_waitcnt lgkmcnt(0)
  v_pk_add_f32 v[188:189], v[188:189], v[100:101]
  v_pk_add_f32 v[190:191], v[190:191], v[102:103]
  global_store_dwordx4 v15, v[188:191], s[48:49] sc1
  v_maximum3_f32 v1, v188, v189, v190
  v_cmp_u_f32 vcc, v1, v191
  s_cbranch_vccnz L_c_fast_Fredo
  v_mov_b32 v56, 0
  v_mov_b32 v57, 0
  v_mov_b32 v58, 0
  v_mov_b32 v59, 0
  v_mov_b32 v60, 0
  v_mov_b32 v61, 0
  v_mov_b32 v62, 0
  v_mov_b32 v63, 0
  v_mov_b32 v64, 0
  v_mov_b32 v65, 0
  v_mov_b32 v66, 0
  v_mov_b32 v67, 0
  v_mov_b32 v68, 0
  v_mov_b32 v69, 0
  v_mov_b32 v70, 0
  v_mov_b32 v71, 0
  v_mov_b32 v72, 0
  v_mov_b32 v73, 0
  v_mov_b32 v74, 0
  v_mov_b32 v75, 0
  v_mov_b32 v76, 0
  v_mov_b32 v77, 0
  v_mov_b32 v78, 0
  v_mov_b32 v79, 0
  v_mov_b32 v80, 0
  v_mov_b32 v81, 0
  v_mov_b32 v82, 0
  v_mov_b32 v83, 0
  v_mov_b32 v84, 0
  v_mov_b32 v85, 0
  v_mov_b32 v86, 0
  v_mov_b32 v87, 0
  s_add_u32 s58, s58, 1
  s_mov_b64 s[40:41], s[44:45]
  s_mov_b64 s[44:45], s[46:47]
  s_mov_b64 s[46:47], s[40:41]
  s_nop 15
  s_nop 15
  s_nop 1
  global_load_dwordx4 v[192:195], v16, s[48:49] sc1
  global_load_dwordx4 v[196:199], v17, s[48:49] sc1
  global_load_dwordx4 v[200:203], v18, s[48:49] sc1
  s_mov_b64 exec, s[68:69]
  global_store_dwordx4 v26, v[120:123], s[56:57] sc1
  s_mov_b64 exec, -1
  global_store_dword v27, v134, s[56:57] offset:512 sc1
  global_store_dword v27, v142, s[56:57] offset:768 sc1
  global_store_dwordx4 v15, v[36:39], s[50:51] sc1
  s_add_u32 s56, s56, 131072
  s_addc_u32 s57, s57, 0
  s_mov_b64 s[70:71], s[48:49]
  s_and_b32 s40, s58, 3
  s_lshl_b32 s40, s40, 18
  s_add_u32 s48, s52, s40
  s_addc_u32 s49, s53, 0
  s_xor_b32 s40, s40, 0x80000
  s_add_u32 s50, s52, s40
  s_addc_u32 s51, s53, 0
  .fill (((0 - (. - L_0)) & 31) >> 2), 4, 0xbf800000
  s_waitcnt vmcnt(6)
  v_pk_add_f32 v[88:89], v[188:189], v[192:193]
  v_pk_add_f32 v[90:91], v[190:191], v[194:195]
  s_waitcnt vmcnt(4)
  v_max3_u32 v1, v195, v199, v203
  v_cmp_eq_u32 vcc, -1, v1
  v_pk_add_f32 v[96:97], v[196:197], v[200:201]
  v_pk_add_f32 v[98:99], v[198:199], v[202:203]
  v_pk_add_f32 v[96:97], v[96:97], v[88:89]
  v_pk_add_f32 v[98:99], v[98:99], v[90:91]
  v_cvt_pk_bf16_f32 v208, v96, v98
  v_cvt_pk_bf16_f32 v209, v97, v99
  s_cbranch_vccnz L_c_fast_Gret
  global_store_dword v5, v208, s[44:45]
  global_store_dword v5, v209, s[44:45] offset:16
  s_barrier
  s_branch L_c_fast_step
L_ct_w0:
L_ct_0:
  s_branch L_ct_1
  .fill (((0 - (. - L_0)) & 31) >> 2), 4, 0xbf800000
L_c_fast_helper:
  s_cmp_eq_u32 s36, 1
  s_cbranch_scc0 L_c_fast_h1
  global_store_dwordx4 v7, v[32:35], s[46:47]
  global_store_dwordx4 v8, v[36:39], s[46:47]
  s_mov_b64 exec, 0xffff
  global_store_dwordx4 v8, v[36:39], s[46:47] offset:1024
  s_mov_b64 exec, -1
L_c_fast_h1:
  s_nop 15
  s_nop 15
  s_nop 3
  v_smfmac_f32_16x16x64_bf16 v[72:75], v[40:43], a[128:135], v3
  v_smfmac_f32_16x16x64_bf16 v[76:79], v[40:43], a[136:143], v3
  v_smfmac_f32_16x16x64_bf16 v[72:75], v[44:47], a[144:151], v3
  v_smfmac_f32_16x16x64_bf16 v[76:79], v[44:47], a[152:159], v3
  v_smfmac_f32_16x16x64_bf16 v[72:75], v[48:51], a[160:167], v3
  v_smfmac_f32_16x16x64_bf16 v[76:79], v[48:51], a[168:175], v3
  v_smfmac_f32_16x16x64_bf16 v[72:75], v[52:55], a[176:183], v3
  v_smfmac_f32_16x16x64_bf16 v[76:79], v[52:55], a[184:191], v3
  s_nop 7
  v_pk_add_f32 v[72:73], v[72:73], v[74:75]
  v_pk_add_f32 v[74:75], v[76:77], v[78:79]
  ds_write_b128 v22, v[72:75] offset:16384
  ds_write_b128 v22, v[36:39] offset:24576
  s_cmp_eq_u32 s36, 1
  s_waitcnt vmcnt(0) lgkmcnt(0)
  s_barrier
  s_cbranch_scc0 L_c_fast_h2
  s_min_u32 s40, s58, 1
  s_atomic_add s40, s[34:35], s60
  s_cmp_eq_u32 s58, 63
  s_cbranch_scc0 L_c_fast_join
  s_branch L_c_fast_hend
L_ct_1:
  s_branch L_ct_2
L_c_fast_h2:
  s_cmp_eq_u32 s58, 63
  s_cbranch_scc1 L_c_fast_hend
  s_add_u32 s42, s58, 2
  s_min_u32 s42, s42, 64
L_kv_5:
  s_cmp_ge_u32 s59, s42
  s_cbranch_scc1 L_kvd_6
  s_load_dword s59, s[34:35], s60 glc
  s_waitcnt lgkmcnt(0)
  s_sub_u32 s39, s39, 1
  s_cbranch_scc0 L_kv_5
  s_endpgm
L_kvd_6:
  .fill (((16 - (. - L_0)) & 31) >> 2), 4, 0xbf800000
L_c_fast_join:
  s_barrier
  global_load_dwordx4 v[40:43], v29, s[44:45] offset:0 sc1
  s_nop 7
  global_load_dwordx4 v[44:47], v29, s[44:45] offset:1024 sc1
  s_nop 7
  global_load_dwordx4 v[48:51], v29, s[44:45] offset:2048 sc1
  s_nop 7
  global_load_dwordx4 v[52:55], v29, s[44:45] offset:3072 sc1
  .fill (((12 - (. - L_0)) & 31) >> 2), 4, 0xbf800000
  s_waitcnt vmcnt(3)
  v_smfmac_f32_16x16x64_bf16 v[80:83], v[40:43], a[192:199], v3
  v_cmp_gt_i32 vcc, s77, v43
  v_smfmac_f32_16x16x64_bf16 v[84:87], v[40:43], a[200:207], v3
  s_cbranch_vccnz L_c_fast_EH_f0123
  s_waitcnt vmcnt(2)
  v_smfmac_f32_16x16x64_bf16 v[80:83], v[44:47], a[208:215], v3
  v_cmp_gt_i32 vcc, s77, v47
  v_smfmac_f32_16x16x64_bf16 v[84:87], v[44:47], a[216:223], v3
  s_cbranch_vccnz L_c_fast_EH_f123
  s_waitcnt vmcnt(1)
  v_smfmac_f32_16x16x64_bf16 v[80:83], v[48:51], a[224:231], v3
  v_cmp_gt_i32 vcc, s77, v51
  v_smfmac_f32_16x16x64_bf16 v[84:87], v[48:51], a[232:239], v3
  s_cbranch_vccnz L_c_fast_EH_f23
  s_waitcnt vmcnt(0)
  v_smfmac_f32_16x16x64_bf16 v[80:83], v[52:55], a[240:247], v3
  v_cmp_gt_i32 vcc, s77, v55
  v_smfmac_f32_16x16x64_bf16 v[84:87], v[52:55], a[248:255], v3
  s_nop 5
  s_cbranch_vccnz L_c_fast_EH_f3
L_c_fast_EH_done:
  v_pk_add_f32 v[80:81], v[80:81], v[82:83]
  v_pk_add_f32 v[82:83], v[84:85], v[86:87]
  ds_write_b128 v22, v[80:83] offset:24576
  s_barrier
  s_nop 15
  s_nop 7
  ds_write2_b32 v19, v36, v36 offset0:0 offset1:16
  ds_write2_b32 v20, v36, v36 offset0:0 offset1:16
  ds_write2_b32 v19, v36, v36 offset0:32 offset1:48
  ds_write2_b32 v20, v36, v36 offset0:32 offset1:48
  s_waitcnt lgkmcnt(0)
  v_mov_b32 v56, 0
  v_mov_b32 v57, 0
  v_mov_b32 v58, 0
  v_mov_b32 v59, 0
  v_mov_b32 v60, 0
  v_mov_b32 v61, 0
  v_mov_b32 v62, 0
  v_mov_b32 v63, 0
  v_mov_b32 v64, 0
  v_mov_b32 v65, 0
  v_mov_b32 v66, 0
  v_mov_b32 v67, 0
  v_mov_b32 v68, 0
  v_mov_b32 v69, 0
  v_mov_b32 v70, 0
  v_mov_b32 v71, 0
  v_mov_b32 v72, 0
  v_mov_b32 v73, 0
  v_mov_b32 v74, 0
  v_mov_b32 v75, 0
  v_mov_b32 v76, 0
  v_mov_b32 v77, 0
  v_mov_b32 v78, 0
  v_mov_b32 v79, 0
  v_mov_b32 v80, 0
  v_mov_b32 v81, 0
  v_mov_b32 v82, 0
  v_mov_b32 v83, 0
  v_mov_b32 v84, 0
  v_mov_b32 v85, 0
  v_mov_b32 v86, 0
  v_mov_b32 v87, 0
  s_add_u32 s58, s58, 1
  s_mov_b64 s[40:41], s[44:45]
  s_mov_b64 s[44:45], s[46:47]
  s_mov_b64 s[46:47], s[40:41]
  s_add_u32 s54, s54, 262144
  s_addc_u32 s55, s55, 0
  s_cmp_lt_u32 s59, 64
  s_cbranch_scc0 L_c_fast_asy
  s_load_dword s59, s[34:35], s60 glc
L_c_fast_asy:
  s_barrier
  s_branch L_c_fast_step
L_c_fast_hend:
  s_branch L_c_tail
L_ct_2:
  s_branch L_ct_3
L_c_fast_last:
  s_cmp_eq_u32 s58, 0
  s_cbranch_scc0 L_c_fast_last2
  s_mov_b32 s79, 63
  s_sub_u32 s42, s60, 8
L_c_fast_first:
  s_load_dwordx2 s[40:41], s[34:35], s42 glc
  s_waitcnt lgkmcnt(0)
  s_min_u32 s40, s40, s41
  s_cmp_ge_u32 s40, 1
  s_cbranch_scc1 L_c_fast_first2
  s_sub_u32 s39, s39, 1
  s_cbranch_scc0 L_c_fast_first
  s_endpgm
L_c_fast_first2:
  global_load_dwordx4 v[124:127], v24, s[54:55] offset:0 sc1
  global_load_dwordx4 v[128:131], v24, s[54:55] offset:1024 sc1
  global_load_dwordx4 v[212:215], v25, s[54:55] offset:0 sc1
  global_load_dwordx4 v[216:219], v25, s[54:55] offset:1024 sc1
  s_waitcnt vmcnt(0)
  s_branch L_c_fast_Bret
L_c_fast_last2:
  v_maximum3_f32 v1, v88, v89, v90
  v_maximum3_f32 v1, v1, v91, v92
  v_maximum3_f32 v1, v1, v93, v94
  v_cmp_u_f32 vcc, v1, v95
  s_cbranch_vccnz L_c_fast_Bredo
  v_smfmac_f32_16x16x64_bf16 v[72:75], v[40:43], a[128:135], v3
  v_smfmac_f32_16x16x64_bf16 v[76:79], v[40:43], a[136:143], v3
  v_smfmac_f32_16x16x64_bf16 v[72:75], v[44:47], a[144:151], v3
  v_smfmac_f32_16x16x64_bf16 v[76:79], v[44:47], a[152:159], v3
  v_smfmac_f32_16x16x64_bf16 v[72:75], v[48:51], a[160:167], v3
  v_smfmac_f32_16x16x64_bf16 v[76:79], v[48:51], a[168:175], v3
  v_smfmac_f32_16x16x64_bf16 v[72:75], v[52:55], a[176:183], v3
  v_smfmac_f32_16x16x64_bf16 v[76:79], v[52:55], a[184:191], v3
  s_barrier
  ds_read_b128 v[92:95], v22 offset:17408
  ds_read_b128 v[96:99], v22 offset:18432
  ds_read_b128 v[100:103], v22 offset:19456
  s_nop 3
  v_pk_add_f32 v[72:73], v[72:73], v[74:75]
  v_pk_add_f32 v[74:75], v[76:77], v[78:79]
  s_waitcnt lgkmcnt(0)
  v_pk_add_f32 v[88:89], v[72:73], v[92:93]
  v_pk_add_f32 v[90:91], v[74:75], v[94:95]
  v_pk_add_f32 v[76:77], v[96:97], v[100:101]
  v_pk_add_f32 v[78:79], v[98:99], v[102:103]
  v_pk_add_f32 v[76:77], v[76:77], v[88:89]
  v_pk_add_f32 v[78:79], v[78:79], v[90:91]
  v_cvt_pk_bf16_f32 v134, v76, v77
  v_cvt_pk_bf16_f32 v138, v77, v76
  v_cvt_pk_bf16_f32 v142, v78, v79
  v_cvt_pk_bf16_f32 v146, v79, v78
  s_mov_b64 exec, s[68:69]
  global_store_dwordx4 v26, v[120:123], s[56:57] sc1
  s_mov_b64 exec, -1
  global_store_dword v27, v134, s[56:57] offset:512 sc1
  global_store_dword v27, v142, s[56:57] offset:768 sc1
  s_branch L_c_tail
L_ct_3:
  s_branch L_ct_4
  .fill (((0 - (. - L_0)) & 31) >> 2), 4, 0xbf800000
L_c_fast_A_f0123:
  s_mov_b64 exec, vcc
  global_load_dwordx4 v[40:43], v4, s[44:45] offset:0 sc1
  s_mov_b64 exec, -1
  s_sub_u32 s39, s39, 1
  s_cbranch_scc1 L_c_fast_bail
  s_waitcnt vmcnt(3)
  v_cmp_eq_u32 vcc, -1, v47
  s_cbranch_vccnz L_c_fast_A_f1230
  v_smfmac_f32_16x16x64_bf16 v[56:59], v[44:47], a[16:23], v3
  v_smfmac_f32_16x16x64_bf16 v[60:63], v[44:47], a[24:31], v3
  s_waitcnt vmcnt(2)
  v_cmp_eq_u32 vcc, -1, v51
  v_smfmac_f32_16x16x64_bf16 v[64:67], v[44:47], a[80:87], v3
  v_smfmac_f32_16x16x64_bf16 v[68:71], v[44:47], a[88:95], v3
  s_cbranch_vccnz L_c_fast_A_f230
  v_smfmac_f32_16x16x64_bf16 v[56:59], v[48:51], a[32:39], v3
  v_smfmac_f32_16x16x64_bf16 v[60:63], v[48:51], a[40:47], v3
  s_waitcnt vmcnt(1)
  v_cmp_eq_u32 vcc, -1, v55
  v_smfmac_f32_16x16x64_bf16 v[64:67], v[48:51], a[96:103], v3
  v_smfmac_f32_16x16x64_bf16 v[68:71], v[48:51], a[104:111], v3
  s_cbranch_vccnz L_c_fast_A_f30
  v_smfmac_f32_16x16x64_bf16 v[56:59], v[52:55], a[48:55], v3
  v_smfmac_f32_16x16x64_bf16 v[60:63], v[52:55], a[56:63], v3
  s_waitcnt vmcnt(0)
  v_cmp_eq_u32 vcc, -1, v43
  v_smfmac_f32_16x16x64_bf16 v[64:67], v[52:55], a[112:119], v3
  v_smfmac_f32_16x16x64_bf16 v[68:71], v[52:55], a[120:127], v3
  s_cbranch_vccnz L_c_fast_A_f0
  v_smfmac_f32_16x16x64_bf16 v[56:59], v[40:43], a[0:7], v3
  v_smfmac_f32_16x16x64_bf16 v[60:63], v[40:43], a[8:15], v3
  v_smfmac_f32_16x16x64_bf16 v[64:67], v[40:43], a[64:71], v3
  v_smfmac_f32_16x16x64_bf16 v[68:71], v[40:43], a[72:79], v3
  s_branch L_c_fast_A_done
L_ct_4:
  s_branch L_ct_5
  .fill (((0 - (. - L_0)) & 31) >> 2), 4, 0xbf800000
L_c_fast_A_f123:
  s_mov_b64 exec, vcc
  global_load_dwordx4 v[44:47], v4, s[44:45] offset:1024 sc1
  s_mov_b64 exec, -1
  s_sub_u32 s39, s39, 1
  s_cbranch_scc1 L_c_fast_bail
  s_waitcnt vmcnt(2)
  v_cmp_eq_u32 vcc, -1, v51
  s_cbranch_vccnz L_c_fast_A_f231
  v_smfmac_f32_16x16x64_bf16 v[56:59], v[48:51], a[32:39], v3
  v_smfmac_f32_16x16x64_bf16 v[60:63], v[48:51], a[40:47], v3
  s_waitcnt vmcnt(1)
  v_cmp_eq_u32 vcc, -1, v55
  v_smfmac_f32_16x16x64_bf16 v[64:67], v[48:51], a[96:103], v3
  v_smfmac_f32_16x16x64_bf16 v[68:71], v[48:51], a[104:111], v3
  s_cbranch_vccnz L_c_fast_A_f31
  v_smfmac_f32_16x16x64_bf16 v[56:59], v[52:55], a[48:55], v3
  v_smfmac_f32_16x16x64_bf16 v[60:63], v[52:55], a[56:63], v3
  s_waitcnt vmcnt(0)
  v_cmp_eq_u32 vcc, -1, v47
  v_smfmac_f32_16x16x64_bf16 v[64:67], v[52:55], a[112:119], v3
  v_smfmac_f32_16x16x64_bf16 v[68:71], v[52:55], a[120:127], v3
  s_cbranch_vccnz L_c_fast_A_f1
  v_smfmac_f32_16x16x64_bf16 v[56:59], v[44:47], a[16:23], v3
  v_smfmac_f32_16x16x64_bf16 v[60:63], v[44:47], a[24:31], v3
  v_smfmac_f32_16x16x64_bf16 v[64:67], v[44:47], a[80:87], v3
  v_smfmac_f32_16x16x64_bf16 v[68:71], v[44:47], a[88:95], v3
  s_branch L_c_fast_A_done
L_ct_5:
  s_branch L_ct_6
  .fill (((0 - (. - L_0)) & 31) >> 2), 4, 0xbf800000
L_c_fast_A_f23:
  s_mov_b64 exec, vcc
  global_load_dwordx4 v[48:51], v4, s[44:45] offset:2048 sc1
  s_mov_b64 exec, -1
  s_sub_u32 s39, s39, 1
  s_cbranch_scc1 L_c_fast_bail
  s_waitcnt vmcnt(1)
  v_cmp_eq_u32 vcc, -1, v55
  s_cbranch_vccnz L_c_fast_A_f32
  v_smfmac_f32_16x16x64_bf16 v[56:59], v[52:55], a[48:55], v3
  v_smfmac_f32_16x16x64_bf16 v[60:63], v[52:55], a[56:63], v3
  s_waitcnt vmcnt(0)
  v_cmp_eq_u32 vcc, -1, v51
  v_smfmac_f32_16x16x64_bf16 v[64:67], v[52:55], a[112:119], v3
  v_smfmac_f32_16x16x64_bf16 v[68:71], v[52:55], a[120:127], v3
  s_cbranch_vccnz L_c_fast_A_f2
  v_smfmac_f32_16x16x64_bf16 v[56:59], v[48:51], a[32:39], v3
  v_smfmac_f32_16x16x64_bf16 v[60:63], v[48:51], a[40:47], v3
  v_smfmac_f32_16x16x64_bf16 v[64:67], v[48:51], a[96:103], v3
  v_smfmac_f32_16x16x64_bf16 v[68:71], v[48:51], a[104:111], v3
  s_branch L_c_fast_A_done
L_ct_6:
  s_branch L_ct_7
  .fill (((0 - (. - L_0)) & 31) >> 2), 4, 0xbf800000
L_c_fast_A_f3:
  s_mov_b64 exec, vcc
  global_load_dwordx4 v[52:55], v4, s[44:45] offset:3072 sc1
  s_mov_b64 exec, -1
  s_sub_u32 s39, s39, 1
  s_cbranch_scc1 L_c_fast_bail
  s_waitcnt vmcnt(0)
  v_cmp_eq_u32 vcc, -1, v55
  s_cbranch_vccnz L_c_fast_A_f3
  v_smfmac_f32_16x16x64_bf16 v[56:59], v[52:55], a[48:55], v3
  v_smfmac_f32_16x16x64_bf16 v[60:63], v[52:55], a[56:63], v3
  v_smfmac_f32_16x16x64_bf16 v[64:67], v[52:55], a[112:119], v3
  v_smfmac_f32_16x16x64_bf16 v[68:71], v[52:55], a[120:127], v3
  s_branch L_c_fast_A_done
L_ct_7:
  s_branch L_ct_8
  .fill (((0 - (. - L_0)) & 31) >> 2), 4, 0xbf800000
L_c_fast_A_f1230:
  s_mov_b64 exec, vcc
  global_load_dwordx4 v[44:47], v4, s[44:45] offset:1024 sc1
  s_mov_b64 exec, -1
  s_sub_u32 s39, s39, 1
  s_cbranch_scc1 L_c_fast_bail
  s_waitcnt vmcnt(3)
  v_cmp_eq_u32 vcc, -1, v51
  s_cbranch_vccnz L_c_fast_A_f2301
  v_smfmac_f32_16x16x64_bf16 v[56:59], v[48:51], a[32:39], v3
  v_smfmac_f32_16x16x64_bf16 v[60:63], v[48:51], a[40:47], v3
  s_waitcnt vmcnt(2)
  v_cmp_eq_u32 vcc, -1, v55
  v_smfmac_f32_16x16x64_bf16 v[64:67], v[48:51], a[96:103], v3
  v_smfmac_f32_16x16x64_bf16 v[68:71], v[48:51], a[104:111], v3
  s_cbranch_vccnz L_c_fast_A_f301
  v_smfmac_f32_16x16x64_bf16 v[56:59], v[52:55], a[48:55], v3
  v_smfmac_f32_16x16x64_bf16 v[60:63], v[52:55], a[56:63], v3
  s_waitcnt vmcnt(1)
  v_cmp_eq_u32 vcc, -1, v43
  v_smfmac_f32_16x16x64_bf16 v[64:67], v[52:55], a[112:119], v3
  v_smfmac_f32_16x16x64_bf16 v[68:71], v[52:55], a[120:127], v3
  s_cbranch_vccnz L_c_fast_A_f01
  v_smfmac_f32_16x16x64_bf16 v[56:59], v[40:43], a[0:7], v3
  v_smfmac_f32_16x16x64_bf16 v[60:63], v[40:43], a[8:15], v3
  s_waitcnt vmcnt(0)
  v_cmp_eq_u32 vcc, -1, v47
  v_smfmac_f32_16x16x64_bf16 v[64:67], v[40:43], a[64:71], v3
  v_smfmac_f32_16x16x64_bf16 v[68:71], v[40:43], a[72:79], v3
  s_cbranch_vccnz L_c_fast_A_f1
  v_smfmac_f32_16x16x64_bf16 v[56:59], v[44:47], a[16:23], v3
  v_smfmac_f32_16x16x64_bf16 v[60:63], v[44:47], a[24:31], v3
  v_smfmac_f32_16x16x64_bf16 v[64:67], v[44:47], a[80:87], v3
  v_smfmac_f32_16x16x64_bf16 v[68:71], v[44:47], a[88:95], v3
  s_branch L_c_fast_A_done
L_ct_8:
  s_branch L_ct_9
  .fill (((0 - (. - L_0)) & 31) >> 2), 4, 0xbf800000
L_c_fast_A_f230:
  s_mov_b64 exec, vcc
  global_load_dwordx4 v[48:51], v4, s[44:45] offset:2048 sc1
  s_mov_b64 exec, -1
  s_sub_u32 s39, s39, 1
  s_cbranch_scc1 L_c_fast_bail
  s_waitcnt vmcnt(2)
  v_cmp_eq_u32 vcc, -1, v55
  s_cbranch_vccnz L_c_fast_A_f302
  v_smfmac_f32_16x16x64_bf16 v[56:59], v[52:55], a[48:55], v3
  v_smfmac_f32_16x16x64_bf16 v[60:63], v[52:55], a[56:63], v3
  s_waitcnt vmcnt(1)
  v_cmp_eq_u32 vcc, -1, v43
  v_smfmac_f32_16x16x64_bf16 v[64:67], v[52:55], a[112:119], v3
  v_smfmac_f32_16x16x64_bf16 v[68:71], v[52:55], a[120:127], v3
  s_cbranch_vccnz L_c_fast_A_f02
  v_smfmac_f32_16x16x64_bf16 v[56:59], v[40:43], a[0:7], v3
  v_smfmac_f32_16x16x64_bf16 v[60:63], v[40:43], a[8:15], v3
  s_waitcnt vmcnt(0)
  v_cmp_eq_u32 vcc, -1, v51
  v_smfmac_f32_16x16x64_bf16 v[64:67], v[40:43], a[64:71], v3
  v_smfmac_f32_16x16x64_bf16 v[68:71], v[40:43], a[72:79], v3
  s_cbranch_vccnz L_c_fast_A_f2
  v_smfmac_f32_16x16x64_bf16 v[56:59], v[48:51], a[32:39], v3
  v_smfmac_f32_16x16x64_bf16 v[60:63], v[48:51], a[40:47], v3
  v_smfmac_f32_16x16x64_bf16 v[64:67], v[48:51], a[96:103], v3
  v_smfmac_f32_16x16x64_bf16 v[68:71], v[48:51], a[104:111], v3
  s_branch L_c_fast_A_done
L_ct_9:
  s_branch L_ct_10
  .fill (((0 - (. - L_0)) & 31) >> 2), 4, 0xbf800000
L_c_fast_A_f30:
  s_mov_b64 exec, vcc
  global_load_dwordx4 v[52:55], v4, s[44:45] offset:3072 sc1
  s_mov_b64 exec, -1
  s_sub_u32 s39, s39, 1
  s_cbranch_scc1 L_c_fast_bail
  s_waitcnt vmcnt(1)
  v_cmp_eq_u32 vcc, -1, v43
  s_cbranch_vccnz L_c_fast_A_f03
  v_smfmac_f32_16x16x64_bf16 v[56:59], v[40:43], a[0:7], v3
  v_smfmac_f32_16x16x64_bf16 v[60:63], v[40:43], a[8:15], v3
  s_waitcnt vmcnt(0)
  v_cmp_eq_u32 vcc, -1, v55
  v_smfmac_f32_16x16x64_bf16 v[64:67], v[40:43], a[64:71], v3
  v_smfmac_f32_16x16x64_bf16 v[68:71], v[40:43], a[72:79], v3
  s_cbranch_vccnz L_c_fast_A_f3
  v_smfmac_f32_16x16x64_bf16 v[56:59], v[52:55], a[48:55], v3
  v_smfmac_f32_16x16x64_bf16 v[60:63], v[52:55], a[56:63], v3
  v_smfmac_f32_16x16x64_bf16 v[64:67], v[52:55], a[112:119], v3
  v_smfmac_f32_16x16x64_bf16 v[68:71], v[52:55], a[120:127], v3
  s_branch L_c_fast_A_done
L_ct_10:
  s_branch L_ct_11
  .fill (((0 - (. - L_0)) & 31) >> 2), 4, 0xbf800000
L_c_fast_A_f0:
  s_mov_b64 exec, vcc
  global_load_dwordx4 v[40:43], v4, s[44:45] offset:0 sc1
  s_mov_b64 exec, -1
  s_sub_u32 s39, s39, 1
  s_cbranch_scc1 L_c_fast_bail
  s_waitcnt vmcnt(0)
  v_cmp_eq_u32 vcc, -1, v43
  s_cbranch_vccnz L_c_fast_A_f0
  v_smfmac_f32_16x16x64_bf16 v[56:59], v[40:43], a[0:7], v3
  v_smfmac_f32_16x16x64_bf16 v[60:63], v[40:43], a[8:15], v3
  v_smfmac_f32_16x16x64_bf16 v[64:67], v[40:43], a[64:71], v3
  v_smfmac_f32_16x16x64_bf16 v[68:71], v[40:43], a[72:79], v3
  s_branch L_c_fast_A_done
L_ct_11:
  s_branch L_ct_12
  .fill (((0 - (. - L_0)) & 31) >> 2), 4, 0xbf800000
L_c_fast_A_f231:
  s_mov_b64 exec, vcc
  global_load_dwordx4 v[48:51], v4, s[44:45] offset:2048 sc1
  s_mov_b64 exec, -1
  s_sub_u32 s39, s39, 1
  s_cbranch_scc1 L_c_fast_bail
  s_waitcnt vmcnt(2)
  v_cmp_eq_u32 vcc, -1, v55
  s_cbranch_vccnz L_c_fast_A_f312
  v_smfmac_f32_16x16x64_bf16 v[56:59], v[52:55], a[48:55], v3
  v_smfmac_f32_16x16x64_bf16 v[60:63], v[52:55], a[56:63], v3
  s_waitcnt vmcnt(1)
  v_cmp_eq_u32 vcc, -1, v47
  v_smfmac_f32_16x16x64_bf16 v[64:67], v[52:55], a[112:119], v3
  v_smfmac_f32_16x16x64_bf16 v[68:71], v[52:55], a[120:127], v3
  s_cbranch_vccnz L_c_fast_A_f12
  v_smfmac_f32_16x16x64_bf16 v[56:59], v[44:47], a[16:23], v3
  v_smfmac_f32_16x16x64_bf16 v[60:63], v[44:47], a[24:31], v3
  s_waitcnt vmcnt(0)
  v_cmp_eq_u32 vcc, -1, v51
  v_smfmac_f32_16x16x64_bf16 v[64:67], v[44:47], a[80:87], v3
  v_smfmac_f32_16x16x64_bf16 v[68:71], v[44:47], a[88:95], v3
  s_cbranch_vccnz L_c_fast_A_f2
  v_smfmac_f32_16x16x64_bf16 v[56:59], v[48:51], a[32:39], v3
  v_smfmac_f32_16x16x64_bf16 v[60:63], v[48:51], a[40:47], v3
  v_smfmac_f32_16x16x64_bf16 v[64:67], v[48:51], a[96:103], v3
  v_smfmac_f32_16x16x64_bf16 v[68:71], v[48:51], a[104:111], v3
  s_branch L_c_fast_A_done
L_ct_12:
  s_branch L_ct_13
  .fill (((0 - (. - L_0)) & 31) >> 2), 4, 0xbf800000
L_c_fast_A_f31:
  s_mov_b64 exec, vcc
  global_load_dwordx4 v[52:55], v4, s[44:45] offset:3072 sc1
  s_mov_b64 exec, -1
  s_sub_u32 s39, s39, 1
  s_cbranch_scc1 L_c_fast_bail
  s_waitcnt vmcnt(1)
  v_cmp_eq_u32 vcc, -1, v47
  s_cbranch_vccnz L_c_fast_A_f13
  v_smfmac_f32_16x16x64_bf16 v[56:59], v[44:47], a[16:23], v3
  v_smfmac_f32_16x16x64_bf16 v[60:63], v[44:47], a[24:31], v3
  s_waitcnt vmcnt(0)
  v_cmp_eq_u32 vcc, -1, v55
  v_smfmac_f32_16x16x64_bf16 v[64:67], v[44:47], a[80:87], v3
  v_smfmac_f32_16x16x64_bf16 v[68:71], v[44:47], a[88:95], v3
  s_cbranch_vccnz L_c_fast_A_f3
  v_smfmac_f32_16x16x64_bf16 v[56:59], v[52:55], a[48:55], v3
  v_smfmac_f32_16x16x64_bf16 v[60:63], v[52:55], a[56:63], v3
  v_smfmac_f32_16x16x64_bf16 v[64:67], v[52:55], a[112:119], v3
  v_smfmac_f32_16x16x64_bf16 v[68:71], v[52:55], a[120:127], v3
  s_branch L_c_fast_A_done
L_ct_13:
  s_branch L_ct_14
  .fill (((0 - (. - L_0)) & 31) >> 2), 4, 0xbf800000
L_c_fast_A_f1:
  s_mov_b64 exec, vcc
  global_load_dwordx4 v[44:47], v4, s[44:45] offset:1024 sc1
  s_mov_b64 exec, -1
  s_sub_u32 s39, s39, 1
  s_cbranch_scc1 L_c_fast_bail
  s_waitcnt vmcnt(0)
  v_cmp_eq_u32 vcc, -1, v47
  s_cbranch_vccnz L_c_fast_A_f1
  v_smfmac_f32_16x16x64_bf16 v[56:59], v[44:47], a[16:23], v3
  v_smfmac_f32_16x16x64_bf16 v[60:63], v[44:47], a[24:31], v3
  v_smfmac_f32_16x16x64_bf16 v[64:67], v[44:47], a[80:87], v3
  v_smfmac_f32_16x16x64_bf16 v[68:71], v[44:47], a[88:95], v3
  s_branch L_c_fast_A_done
L_ct_14:
  s_branch L_ct_15
  .fill (((0 - (. - L_0)) & 31) >> 2), 4, 0xbf800000
L_c_fast_A_f32:
  s_mov_b64 exec, vcc
  global_load_dwordx4 v[52:55], v4, s[44:45] offset:3072 sc1
  s_mov_b64 exec, -1
  s_sub_u32 s39, s39, 1
  s_cbranch_scc1 L_c_fast_bail
  s_waitcnt vmcnt(1)
  v_cmp_eq_u32 vcc, -1, v51
  s_cbranch_vccnz L_c_fast_A_f23
  v_smfmac_f32_16x16x64_bf16 v[56:59], v[48:51], a[32:39], v3
  v_smfmac_f32_16x16x64_bf16 v[60:63], v[48:51], a[40:47], v3
  s_waitcnt vmcnt(0)
  v_cmp_eq_u32 vcc, -1, v55
  v_smfmac_f32_16x16x64_bf16 v[64:67], v[48:51], a[96:103], v3
  v_smfmac_f32_16x16x64_bf16 v[68:71], v[48:51], a[104:111], v3
  s_cbranch_vccnz L_c_fast_A_f3
  v_smfmac_f32_16x16x64_bf16 v[56:59], v[52:55], a[48:55], v3
  v_smfmac_f32_16x16x64_bf16 v[60:63], v[52:55], a[56:63], v3
  v_smfmac_f32_16x16x64_bf16 v[64:67], v[52:55], a[112:119], v3
  v_smfmac_f32_16x16x64_bf16 v[68:71], v[52:55], a[120:127], v3
  s_branch L_c_fast_A_done
L_ct_15:
  s_branch L_ct_16
  .fill (((0 - (. - L_0)) & 31) >> 2), 4, 0xbf800000
L_c_fast_A_f2:
  s_mov_b64 exec, vcc
  global_load_dwordx4 v[48:51], v4, s[44:45] offset:2048 sc1
  s_mov_b64 exec, -1
  s_sub_u32 s39, s39, 1
  s_cbranch_scc1 L_c_fast_bail
  s_waitcnt vmcnt(0)
  v_cmp_eq_u32 vcc, -1, v51
  s_cbranch_vccnz L_c_fast_A_f2
  v_smfmac_f32_16x16x64_bf16 v[56:59], v[48:51], a[32:39], v3
  v_smfmac_f32_16x16x64_bf16 v[60:63], v[48:51], a[40:47], v3
  v_smfmac_f32_16x16x64_bf16 v[64:67], v[48:51], a[96:103], v3
  v_smfmac_f32_16x16x64_bf16 v[68:71], v[48:51], a[104:111], v3
  s_branch L_c_fast_A_done
L_ct_16:
  s_branch L_ct_17
  .fill (((0 - (. - L_0)) & 31) >> 2), 4, 0xbf800000
L_c_fast_A_f2301:
  s_mov_b64 exec, vcc
  global_load_dwordx4 v[48:51], v4, s[44:45] offset:2048 sc1
  s_mov_b64 exec, -1
  s_sub_u32 s39, s39, 1
  s_cbranch_scc1 L_c_fast_bail
  s_waitcnt vmcnt(3)
  v_cmp_eq_u32 vcc, -1, v55
  s_cbranch_vccnz L_c_fast_A_f3012
  v_smfmac_f32_16x16x64_bf16 v[56:59], v[52:55], a[48:55], v3
  v_smfmac_f32_16x16x64_bf16 v[60:63], v[52:55], a[56:63], v3
  s_waitcnt vmcnt(2)
  v_cmp_eq_u32 vcc, -1, v43
  v_smfmac_f32_16x16x64_bf16 v[64:67], v[52:55], a[112:119], v3
  v_smfmac_f32_16x16x64_bf16 v[68:71], v[52:55], a[120:127], v3
  s_cbranch_vccnz L_c_fast_A_f012
  v_smfmac_f32_16x16x64_bf16 v[56:59], v[40:43], a[0:7], v3
  v_smfmac_f32_16x16x64_bf16 v[60:63], v[40:43], a[8:15], v3
  s_waitcnt vmcnt(1)
  v_cmp_eq_u32 vcc, -1, v47
  v_smfmac_f32_16x16x64_bf16 v[64:67], v[40:43], a[64:71], v3
  v_smfmac_f32_16x16x64_bf16 v[68:71], v[40:43], a[72:79], v3
  s_cbranch_vccnz L_c_fast_A_f12
  v_smfmac_f32_16x16x64_bf16 v[56:59], v[44:47], a[16:23], v3
  v_smfmac_f32_16x16x64_bf16 v[60:63], v[44:47], a[24:31], v3
  s_waitcnt vmcnt(0)
  v_cmp_eq_u32 vcc, -1, v51
  v_smfmac_f32_16x16x64_bf16 v[64:67], v[44:47], a[80:87], v3
  v_smfmac_f32_16x16x64_bf16 v[68:71], v[44:47], a[88:95], v3
  s_cbranch_vccnz L_c_fast_A_f2
  v_smfmac_f32_16x16x64_bf16 v[56:59], v[48:51], a[32:39], v3
  v_smfmac_f32_16x16x64_bf16 v[60:63], v[48:51], a[40:47], v3
  v_smfmac_f32_16x16x64_bf16 v[64:67], v[48:51], a[96:103], v3
  v_smfmac_f32_16x16x64_bf16 v[68:71], v[48:51], a[104:111], v3
  s_branch L_c_fast_A_done
L_ct_17:
  s_branch L_ct_18
  .fill (((0 - (. - L_0)) & 31) >> 2), 4, 0xbf800000
L_c_fast_A_f301:
  s_mov_b64 exec, vcc
  global_load_dwordx4 v[52:55], v4, s[44:45] offset:3072 sc1
  s_mov_b64 exec, -1
  s_sub_u32 s39, s39, 1
  s_cbranch_scc1 L_c_fast_bail
  s_waitcnt vmcnt(2)
  v_cmp_eq_u32 vcc, -1, v43
  s_cbranch_vccnz L_c_fast_A_f013
  v_smfmac_f32_16x16x64_bf16 v[56:59], v[40:43], a[0:7], v3
  v_smfmac_f32_16x16x64_bf16 v[60:63], v[40:43], a[8:15], v3
  s_waitcnt vmcnt(1)
  v_cmp_eq_u32 vcc, -1, v47
  v_smfmac_f32_16x16x64_bf16 v[64:67], v[40:43], a[64:71], v3
  v_smfmac_f32_16x16x64_bf16 v[68:71], v[40:43], a[72:79], v3
  s_cbranch_vccnz L_c_fast_A_f13
  v_smfmac_f32_16x16x64_bf16 v[56:59], v[44:47], a[16:23], v3
  v_smfmac_f32_16x16x64_bf16 v[60:63], v[44:47], a[24:31], v3
  s_waitcnt vmcnt(0)
  v_cmp_eq_u32 vcc, -1, v55
  v_smfmac_f32_16x16x64_bf16 v[64:67], v[44:47], a[80:87], v3
  v_smfmac_f32_16x16x64_bf16 v[68:71], v[44:47], a[88:95], v3
  s_cbranch_vccnz L_c_fast_A_f3
  v_smfmac_f32_16x16x64_bf16 v[56:59], v[52:55], a[48:55], v3
  v_smfmac_f32_16x16x64_bf16 v[60:63], v[52:55], a[56:63], v3
  v_smfmac_f32_16x16x64_bf16 v[64:67], v[52:55], a[112:119], v3
  v_smfmac_f32_16x16x64_bf16 v[68:71], v[52:55], a[120:127], v3
  s_branch L_c_fast_A_done
L_ct_18:
  s_branch L_ct_19
  .fill (((0 - (. - L_0)) & 31) >> 2), 4, 0xbf800000
L_c_fast_A_f01:
  s_mov_b64 exec, vcc
  global_load_dwordx4 v[40:43], v4, s[44:45] offset:0 sc1
  s_mov_b64 exec, -1
  s_sub_u32 s39, s39, 1
  s_cbranch_scc1 L_c_fast_bail
  s_waitcnt vmcnt(1)
  v_cmp_eq_u32 vcc, -1, v47
  s_cbranch_vccnz L_c_fast_A_f10
  v_smfmac_f32_16x16x64_bf16 v[56:59], v[44:47], a[16:23], v3
  v_smfmac_f32_16x16x64_bf16 v[60:63], v[44:47], a[24:31], v3
  s_waitcnt vmcnt(0)
  v_cmp_eq_u32 vcc, -1, v43
  v_smfmac_f32_16x16x64_bf16 v[64:67], v[44:47], a[80:87], v3
  v_smfmac_f32_16x16x64_bf16 v[68:71], v[44:47], a[88:95], v3
  s_cbranch_vccnz L_c_fast_A_f0
  v_smfmac_f32_16x16x64_bf16 v[56:59], v[40:43], a[0:7], v3
  v_smfmac_f32_16x16x64_bf16 v[60:63], v[40:43], a[8:15], v3
  v_smfmac_f32_16x16x64_bf16 v[64:67], v[40:43], a[64:71], v3
  v_smfmac_f32_16x16x64_bf16 v[68:71], v[40:43], a[72:79], v3
  s_branch L_c_fast_A_done
L_ct_19:
  s_branch L_ct_20
  .fill (((0 - (. - L_0)) & 31) >> 2), 4, 0xbf800000
L_c_fast_A_f302:
  s_mov_b64 exec, vcc
  global_load_dwordx4 v[52:55], v4, s[44:45] offset:3072 sc1
  s_mov_b64 exec, -1
  s_sub_u32 s39, s39, 1
  s_cbranch_scc1 L_c_fast_bail
  s_waitcnt vmcnt(2)
  v_cmp_eq_u32 vcc, -1, v43
  s_cbranch_vccnz L_c_fast_A_f023
  v_smfmac_f32_16x16x64_bf16 v[56:59], v[40:43], a[0:7], v3
  v_smfmac_f32_16x16x64_bf16 v[60:63], v[40:43], a[8:15], v3
  s_waitcnt vmcnt(1)
  v_cmp_eq_u32 vcc, -1, v51
  v_smfmac_f32_16x16x64_bf16 v[64:67], v[40:43], a[64:71], v3
  v_smfmac_f32_16x16x64_bf16 v[68:71], v[40:43], a[72:79], v3
  s_cbranch_vccnz L_c_fast_A_f23
  v_smfmac_f32_16x16x64_bf16 v[56:59], v[48:51], a[32:39], v3
  v_smfmac_f32_16x16x64_bf16 v[60:63], v[48:51], a[40:47], v3
  s_waitcnt vmcnt(0)
  v_cmp_eq_u32 vcc, -1, v55
  v_smfmac_f32_16x16x64_bf16 v[64:67], v[48:51], a[96:103], v3
  v_smfmac_f32_16x16x64_bf16 v[68:71], v[48:51], a[104:111], v3
  s_cbranch_vccnz L_c_fast_A_f3
  v_smfmac_f32_16x16x64_bf16 v[56:59], v[52:55], a[48:55], v3
  v_smfmac_f32_16x16x64_bf16 v[60:63], v[52:55], a[56:63], v3
  v_smfmac_f32_16x16x64_bf16 v[64:67], v[52:55], a[112:119], v3
  v_smfmac_f32_16x16x64_bf16 v[68:71], v[52:55], a[120:127], v3
  s_branch L_c_fast_A_done
L_ct_20:
  s_branch L_ct_21
  .fill (((0 - (. - L_0)) & 31) >> 2), 4, 0xbf800000
L_c_fast_A_f02:
  s_mov_b64 exec, vcc
  global_load_dwordx4 v[40:43], v4, s[44:45] offset:0 sc1
  s_mov_b64 exec, -1
  s_sub_u32 s39, s39, 1
  s_cbranch_scc1 L_c_fast_bail
  s_waitcnt vmcnt(1)
  v_cmp_eq_u32 vcc, -1, v51
  s_cbranch_vccnz L_c_fast_A_f20
  v_smfmac_f32_16x16x64_bf16 v[56:59], v[48:51], a[32:39], v3
  v_smfmac_f32_16x16x64_bf16 v[60:63], v[48:51], a[40:47], v3
  s_waitcnt vmcnt(0)
  v_cmp_eq_u32 vcc, -1, v43
  v_smfmac_f32_16x16x64_bf16 v[64:67], v[48:51], a[96:103], v3
  v_smfmac_f32_16x16x64_bf16 v[68:71], v[48:51], a[104:111], v3
  s_cbranch_vccnz L_c_fast_A_f0
  v_smfmac_f32_16x16x64_bf16 v[56:59], v[40:43], a[0:7], v3
  v_smfmac_f32_16x16x64_bf16 v[60:63], v[40:43], a[8:15], v3
  v_smfmac_f32_16x16x64_bf16 v[64:67], v[40:43], a[64:71], v3
  v_smfmac_f32_16x16x64_bf16 v[68:71], v[40:43], a[72:79], v3
  s_branch L_c_fast_A_done
L_ct_21:
  s_branch L_ct_22
  .fill (((0 - (. - L_0)) & 31) >> 2), 4, 0xbf800000
L_c_fast_A_f03:
  s_mov_b64 exec, vcc
  global_load_dwordx4 v[40:43], v4, s[44:45] offset:0 sc1
  s_mov_b64 exec, -1
  s_sub_u32 s39, s39, 1
  s_cbranch_scc1 L_c_fast_bail
  s_waitcnt vmcnt(1)
  v_cmp_eq_u32 vcc, -1, v55
  s_cbranch_vccnz L_c_fast_A_f30
  v_smfmac_f32_16x16x64_bf16 v[56:59], v[52:55], a[48:55], v3
  v_smfmac_f32_16x16x64_bf16 v[60:63], v[52:55], a[56:63], v3
  s_waitcnt vmcnt(0)
  v_cmp_eq_u32 vcc, -1, v43
  v_smfmac_f32_16x16x64_bf16 v[64:67], v[52:55], a[112:119], v3
  v_smfmac_f32_16x16x64_bf16 v[68:71], v[52:55], a[120:127], v3
  s_cbranch_vccnz L_c_fast_A_f0
  v_smfmac_f32_16x16x64_bf16 v[56:59], v[40:43], a[0:7], v3
  v_smfmac_f32_16x16x64_bf16 v[60:63], v[40:43], a[8:15], v3
  v_smfmac_f32_16x16x64_bf16 v[64:67], v[40:43], a[64:71], v3
  v_smfmac_f32_16x16x64_bf16 v[68:71], v[40:43], a[72:79], v3
  s_branch L_c_fast_A_done
L_ct_22:
  s_branch L_ct_23
  .fill (((0 - (. - L_0)) & 31) >> 2), 4, 0xbf800000
L_c_fast_A_f312:
  s_mov_b64 exec, vcc
  global_load_dwordx4 v[52:55], v4, s[44:45] offset:3072 sc1
  s_mov_b64 exec, -1
  s_sub_u32 s39, s39, 1
  s_cbranch_scc1 L_c_fast_bail
  s_waitcnt vmcnt(2)
  v_cmp_eq_u32 vcc, -1, v47
  s_cbranch_vccnz L_c_fast_A_f123
  v_smfmac_f32_16x16x64_bf16 v[56:59], v[44:47], a[16:23], v3
  v_smfmac_f32_16x16x64_bf16 v[60:63], v[44:47], a[24:31], v3
  s_waitcnt vmcnt(1)
  v_cmp_eq_u32 vcc, -1, v51
  v_smfmac_f32_16x16x64_bf16 v[64:67], v[44:47], a[80:87], v3
  v_smfmac_f32_16x16x64_bf16 v[68:71], v[44:47], a[88:95], v3
  s_cbranch_vccnz L_c_fast_A_f23
  v_smfmac_f32_16x16x64_bf16 v[56:59], v[48:51], a[32:39], v3
  v_smfmac_f32_16x16x64_bf16 v[60:63], v[48:51], a[40:47], v3
  s_waitcnt vmcnt(0)
  v_cmp_eq_u32 vcc, -1, v55
  v_smfmac_f32_16x16x64_bf16 v[64:67], v[48:51], a[96:103], v3
  v_smfmac_f32_16x16x64_bf16 v[68:71], v[48:51], a[104:111], v3
  s_cbranch_vccnz L_c_fast_A_f3
  v_smfmac_f32_16x16x64_bf16 v[56:59], v[52:55], a[48:55], v3
  v_smfmac_f32_16x16x64_bf16 v[60:63], v[52:55], a[56:63], v3
  v_smfmac_f32_16x16x64_bf16 v[64:67], v[52:55], a[112:119], v3
  v_smfmac_f32_16x16x64_bf16 v[68:71], v[52:55], a[120:127], v3
  s_branch L_c_fast_A_done
L_ct_23:
  s_branch L_ct_24
  .fill (((0 - (. - L_0)) & 31) >> 2), 4, 0xbf800000
L_c_fast_A_f12:
  s_mov_b64 exec, vcc
  global_load_dwordx4 v[44:47], v4, s[44:45] offset:1024 sc1
  s_mov_b64 exec, -1
  s_sub_u32 s39, s39, 1
  s_cbranch_scc1 L_c_fast_bail
  s_waitcnt vmcnt(1)
  v_cmp_eq_u32 vcc, -1, v51
  s_cbranch_vccnz L_c_fast_A_f21
  v_smfmac_f32_16x16x64_bf16 v[56:59], v[48:51], a[32:39], v3
  v_smfmac_f32_16x16x64_bf16 v[60:63], v[48:51], a[40:47], v3
  s_waitcnt vmcnt(0)
  v_cmp_eq_u32 vcc, -1, v47
  v_smfmac_f32_16x16x64_bf16 v[64:67], v[48:51], a[96:103], v3
  v_smfmac_f32_16x16x64_bf16 v[68:71], v[48:51], a[104:111], v3
  s_cbranch_vccnz L_c_fast_A_f1
  v_smfmac_f32_16x16x64_bf16 v[56:59], v[44:47], a[16:23], v3
  v_smfmac_f32_16x16x64_bf16 v[60:63], v[44:47], a[24:31], v3
  v_smfmac_f32_16x16x64_bf16 v[64:67], v[44:47], a[80:87], v3
  v_smfmac_f32_16x16x64_bf16 v[68:71], v[44:47], a[88:95], v3
  s_branch L_c_fast_A_done
L_ct_24:
  s_branch L_ct_25
  .fill (((0 - (. - L_0)) & 31) >> 2), 4, 0xbf800000
L_c_fast_A_f13:
  s_mov_b64 exec, vcc
  global_load_dwordx4 v[44:47], v4, s[44:45] offset:1024 sc1
  s_mov_b64 exec, -1
  s_sub_u32 s39, s39, 1
  s_cbranch_scc1 L_c_fast_bail
  s_waitcnt vmcnt(1)
  v_cmp_eq_u32 vcc, -1, v55
  s_cbranch_vccnz L_c_fast_A_f31
  v_smfmac_f32_16x16x64_bf16 v[56:59], v[52:55], a[48:55], v3
  v_smfmac_f32_16x16x64_bf16 v[60:63], v[52:55], a[56:63], v3
  s_waitcnt vmcnt(0)
  v_cmp_eq_u32 vcc, -1, v47
  v_smfmac_f32_16x16x64_bf16 v[64:67], v[52:55], a[112:119], v3
  v_smfmac_f32_16x16x64_bf16 v[68:71], v[52:55], a[120:127], v3
  s_cbranch_vccnz L_c_fast_A_f1
  v_smfmac_f32_16x16x64_bf16 v[56:59], v[44:47], a[16:23], v3
  v_smfmac_f32_16x16x64_bf16 v[60:63], v[44:47], a[24:31], v3
  v_smfmac_f32_16x16x64_bf16 v[64:67], v[44:47], a[80:87], v3
  v_smfmac_f32_16x16x64_bf16 v[68:71], v[44:47], a[88:95], v3
  s_branch L_c_fast_A_done
L_ct_25:
  s_branch L_ct_26
  .fill (((0 - (. - L_0)) & 31) >> 2), 4, 0xbf800000
L_c_fast_A_f3012:
  s_mov_b64 exec, vcc
  global_load_dwordx4 v[52:55], v4, s[44:45] offset:3072 sc1
  s_mov_b64 exec, -1
  s_sub_u32 s39, s39, 1
  s_cbranch_scc1 L_c_fast_bail
  s_waitcnt vmcnt(3)
  v_cmp_eq_u32 vcc, -1, v43
  s_cbranch_vccnz L_c_fast_A_f0123
  v_smfmac_f32_16x16x64_bf16 v[56:59], v[40:43], a[0:7], v3
  v_smfmac_f32_16x16x64_bf16 v[60:63], v[40:43], a[8:15], v3
  s_waitcnt vmcnt(2)
  v_cmp_eq_u32 vcc, -1, v47
  v_smfmac_f32_16x16x64_bf16 v[64:67], v[40:43], a[64:71], v3
  v_smfmac_f32_16x16x64_bf16 v[68:71], v[40:43], a[72:79], v3
  s_cbranch_vccnz L_c_fast_A_f123
  v_smfmac_f32_16x16x64_bf16 v[56:59], v[44:47], a[16:23], v3
  v_smfmac_f32_16x16x64_bf16 v[60:63], v[44:47], a[24:31], v3
  s_waitcnt vmcnt(1)
  v_cmp_eq_u32 vcc, -1, v51
  v_smfmac_f32_16x16x64_bf16 v[64:67], v[44:47], a[80:87], v3
  v_smfmac_f32_16x16x64_bf16 v[68:71], v[44:47], a[88:95], v3
  s_cbranch_vccnz L_c_fast_A_f23
  v_smfmac_f32_16x16x64_bf16 v[56:59], v[48:51], a[32:39], v3
  v_smfmac_f32_16x16x64_bf16 v[60:63], v[48:51], a[40:47], v3
  s_waitcnt vmcnt(0)
  v_cmp_eq_u32 vcc, -1, v55
  v_smfmac_f32_16x16x64_bf16 v[64:67], v[48:51], a[96:103], v3
  v_smfmac_f32_16x16x64_bf16 v[68:71], v[48:51], a[104:111], v3
  s_cbranch_vccnz L_c_fast_A_f3
  v_smfmac_f32_16x16x64_bf16 v[56:59], v[52:55], a[48:55], v3
  v_smfmac_f32_16x16x64_bf16 v[60:63], v[52:55], a[56:63], v3
  v_smfmac_f32_16x16x64_bf16 v[64:67], v[52:55], a[112:119], v3
  v_smfmac_f32_16x16x64_bf16 v[68:71], v[52:55], a[120:127], v3
  s_branch L_c_fast_A_done
L_ct_26:
  s_branch L_ct_27
  .fill (((0 - (. - L_0)) & 31) >> 2), 4, 0xbf800000
L_c_fast_A_f012:
  s_mov_b64 exec, vcc
  global_load_dwordx4 v[40:43], v4, s[44:45] offset:0 sc1
  s_mov_b64 exec, -1
  s_sub_u32 s39, s39, 1
  s_cbranch_scc1 L_c_fast_bail
  s_waitcnt vmcnt(2)
  v_cmp_eq_u32 vcc, -1, v47
  s_cbranch_vccnz L_c_fast_A_f120
  v_smfmac_f32_16x16x64_bf16 v[56:59], v[44:47], a[16:23], v3
  v_smfmac_f32_16x16x64_bf16 v[60:63], v[44:47], a[24:31], v3
  s_waitcnt vmcnt(1)
  v_cmp_eq_u32 vcc, -1, v51
  v_smfmac_f32_16x16x64_bf16 v[64:67], v[44:47], a[80:87], v3
  v_smfmac_f32_16x16x64_bf16 v[68:71], v[44:47], a[88:95], v3
  s_cbranch_vccnz L_c_fast_A_f20
  v_smfmac_f32_16x16x64_bf16 v[56:59], v[48:51], a[32:39], v3
  v_smfmac_f32_16x16x64_bf16 v[60:63], v[48:51], a[40:47], v3
  s_waitcnt vmcnt(0)
  v_cmp_eq_u32 vcc, -1, v43
  v_smfmac_f32_16x16x64_bf16 v[64:67], v[48:51], a[96:103], v3
  v_smfmac_f32_16x16x64_bf16 v[68:71], v[48:51], a[104:111], v3
  s_cbranch_vccnz L_c_fast_A_f0
  v_smfmac_f32_16x16x64_bf16 v[56:59], v[40:43], a[0:7], v3
  v_smfmac_f32_16x16x64_bf16 v[60:63], v[40:43], a[8:15], v3
  v_smfmac_f32_16x16x64_bf16 v[64:67], v[40:43], a[64:71], v3
  v_smfmac_f32_16x16x64_bf16 v[68:71], v[40:43], a[72:79], v3
  s_branch L_c_fast_A_done
L_ct_27:
  s_branch L_ct_28
  .fill (((0 - (. - L_0)) & 31) >> 2), 4, 0xbf800000
L_c_fast_A_f013:
  s_mov_b64 exec, vcc
  global_load_dwordx4 v[40:43], v4, s[44:45] offset:0 sc1
  s_mov_b64 exec, -1
  s_sub_u32 s39, s39, 1
  s_cbranch_scc1 L_c_fast_bail
  s_waitcnt vmcnt(2)
  v_cmp_eq_u32 vcc, -1, v47
  s_cbranch_vccnz L_c_fast_A_f130
  v_smfmac_f32_16x16x64_bf16 v[56:59], v[44:47], a[16:23], v3
  v_smfmac_f32_16x16x64_bf16 v[60:63], v[44:47], a[24:31], v3
  s_waitcnt vmcnt(1)
  v_cmp_eq_u32 vcc, -1, v55
  v_smfmac_f32_16x16x64_bf16 v[64:67], v[44:47], a[80:87], v3
  v_smfmac_f32_16x16x64_bf16 v[68:71], v[44:47], a[88:95], v3
  s_cbranch_vccnz L_c_fast_A_f30
  v_smfmac_f32_16x16x64_bf16 v[56:59], v[52:55], a[48:55], v3
  v_smfmac_f32_16x16x64_bf16 v[60:63], v[52:55], a[56:63], v3
  s_waitcnt vmcnt(0)
  v_cmp_eq_u32 vcc, -1, v43
  v_smfmac_f32_16x16x64_bf16 v[64:67], v[52:55], a[112:119], v3
  v_smfmac_f32_16x16x64_bf16 v[68:71], v[52:55], a[120:127], v3
  s_cbranch_vccnz L_c_fast_A_f0
  v_smfmac_f32_16x16x64_bf16 v[56:59], v[40:43], a[0:7], v3
  v_smfmac_f32_16x16x64_bf16 v[60:63], v[40:43], a[8:15], v3
  v_smfmac_f32_16x16x64_bf16 v[64:67], v[40:43], a[64:71], v3
  v_smfmac_f32_16x16x64_bf16 v[68:71], v[40:43], a[72:79], v3
  s_branch L_c_fast_A_done
L_ct_28:
  s_branch L_ct_29
  .fill (((0 - (. - L_0)) & 31) >> 2), 4, 0xbf800000
L_c_fast_A_f10:
  s_mov_b64 exec, vcc
  global_load_dwordx4 v[44:47], v4, s[44:45] offset:1024 sc1
  s_mov_b64 exec, -1
  s_sub_u32 s39, s39, 1
  s_cbranch_scc1 L_c_fast_bail
  s_waitcnt vmcnt(1)
  v_cmp_eq_u32 vcc, -1, v43
  s_cbranch_vccnz L_c_fast_A_f01
  v_smfmac_f32_16x16x64_bf16 v[56:59], v[40:43], a[0:7], v3
  v_smfmac_f32_16x16x64_bf16 v[60:63], v[40:43], a[8:15], v3
  s_waitcnt vmcnt(0)
  v_cmp_eq_u32 vcc, -1, v47
  v_smfmac_f32_16x16x64_bf16 v[64:67], v[40:43], a[64:71], v3
  v_smfmac_f32_16x16x64_bf16 v[68:71], v[40:43], a[72:79], v3
  s_cbranch_vccnz L_c_fast_A_f1
  v_smfmac_f32_16x16x64_bf16 v[56:59], v[44:47], a[16:23], v3
  v_smfmac_f32_16x16x64_bf16 v[60:63], v[44:47], a[24:31], v3
  v_smfmac_f32_16x16x64_bf16 v[64:67], v[44:47], a[80:87], v3
  v_smfmac_f32_16x16x64_bf16 v[68:71], v[44:47], a[88:95], v3
  s_branch L_c_fast_A_done
L_ct_29:
  s_branch L_ct_30
  .fill (((0 - (. - L_0)) & 31) >> 2), 4, 0xbf800000
L_c_fast_A_f023:
  s_mov_b64 exec, vcc
  global_load_dwordx4 v[40:43], v4, s[44:45] offset:0 sc1
  s_mov_b64 exec, -1
  s_sub_u32 s39, s39, 1
  s_cbranch_scc1 L_c_fast_bail
  s_waitcnt vmcnt(2)
  v_cmp_eq_u32 vcc, -1, v51
  s_cbranch_vccnz L_c_fast_A_f230
  v_smfmac_f32_16x16x64_bf16 v[56:59], v[48:51], a[32:39], v3
  v_smfmac_f32_16x16x64_bf16 v[60:63], v[48:51], a[40:47], v3
  s_waitcnt vmcnt(1)
  v_cmp_eq_u32 vcc, -1, v55
  v_smfmac_f32_16x16x64_bf16 v[64:67], v[48:51], a[96:103], v3
  v_smfmac_f32_16x16x64_bf16 v[68:71], v[48:51], a[104:111], v3
  s_cbranch_vccnz L_c_fast_A_f30
  v_smfmac_f32_16x16x64_bf16 v[56:59], v[52:55], a[48:55], v3
  v_smfmac_f32_16x16x64_bf16 v[60:63], v[52:55], a[56:63], v3
  s_waitcnt vmcnt(0)
  v_cmp_eq_u32 vcc, -1, v43
  v_smfmac_f32_16x16x64_bf16 v[64:67], v[52:55], a[112:119], v3
  v_smfmac_f32_16x16x64_bf16 v[68:71], v[52:55], a[120:127], v3
  s_cbranch_vccnz L_c_fast_A_f0
  v_smfmac_f32_16x16x64_bf16 v[56:59], v[40:43], a[0:7], v3
  v_smfmac_f32_16x16x64_bf16 v[60:63], v[40:43], a[8:15], v3
  v_smfmac_f32_16x16x64_bf16 v[64:67], v[40:43], a[64:71], v3
  v_smfmac_f32_16x16x64_bf16 v[68:71], v[40:43], a[72:79], v3
  s_branch L_c_fast_A_done
L_ct_30:
  s_branch L_ct_31
  .fill (((0 - (. - L_0)) & 31) >> 2), 4, 0xbf800000
L_c_fast_A_f20:
  s_mov_b64 exec, vcc
  global_load_dwordx4 v[48:51], v4, s[44:45] offset:2048 sc1
  s_mov_b64 exec, -1
  s_sub_u32 s39, s39, 1
  s_cbranch_scc1 L_c_fast_bail
  s_waitcnt vmcnt(1)
  v_cmp_eq_u32 vcc, -1, v43
  s_cbranch_vccnz L_c_fast_A_f02
  v_smfmac_f32_16x16x64_bf16 v[56:59], v[40:43], a[0:7], v3
  v_smfmac_f32_16x16x64_bf16 v[60:63], v[40:43], a[8:15], v3
  s_waitcnt vmcnt(0)
  v_cmp_eq_u32 vcc, -1, v51
  v_smfmac_f32_16x16x64_bf16 v[64:67], v[40:43], a[64:71], v3
  v_smfmac_f32_16x16x64_bf16 v[68:71], v[40:43], a[72:79], v3
  s_cbranch_vccnz L_c_fast_A_f2
  v_smfmac_f32_16x16x64_bf16 v[56:59], v[48:51], a[32:39], v3
  v_smfmac_f32_16x16x64_bf16 v[60:63], v[48:51], a[40:47], v3
  v_smfmac_f32_16x16x64_bf16 v[64:67], v[48:51], a[96:103], v3
  v_smfmac_f32_16x16x64_bf16 v[68:71], v[48:51], a[104:111], v3
  s_branch L_c_fast_A_done
L_ct_31:
  s_branch L_ct_32
  .fill (((0 - (. - L_0)) & 31) >> 2), 4, 0xbf800000
L_c_fast_A_f21:
  s_mov_b64 exec, vcc
  global_load_dwordx4 v[48:51], v4, s[44:45] offset:2048 sc1
  s_mov_b64 exec, -1
  s_sub_u32 s39, s39, 1
  s_cbranch_scc1 L_c_fast_bail
  s_waitcnt vmcnt(1)
  v_cmp_eq_u32 vcc, -1, v47
  s_cbranch_vccnz L_c_fast_A_f12
  v_smfmac_f32_16x16x64_bf16 v[56:59], v[44:47], a[16:23], v3
  v_smfmac_f32_16x16x64_bf16 v[60:63], v[44:47], a[24:31], v3
  s_waitcnt vmcnt(0)
  v_cmp_eq_u32 vcc, -1, v51
  v_smfmac_f32_16x16x64_bf16 v[64:67], v[44:47], a[80:87], v3
  v_smfmac_f32_16x16x64_bf16 v[68:71], v[44:47], a[88:95], v3
  s_cbranch_vccnz L_c_fast_A_f2
  v_smfmac_f32_16x16x64_bf16 v[56:59], v[48:51], a[32:39], v3
  v_smfmac_f32_16x16x64_bf16 v[60:63], v[48:51], a[40:47], v3
  v_smfmac_f32_16x16x64_bf16 v[64:67], v[48:51], a[96:103], v3
  v_smfmac_f32_16x16x64_bf16 v[68:71], v[48:51], a[104:111], v3
  s_branch L_c_fast_A_done
L_ct_32:
  s_branch L_ct_33
  .fill (((0 - (. - L_0)) & 31) >> 2), 4, 0xbf800000
L_c_fast_A_f120:
  s_mov_b64 exec, vcc
  global_load_dwordx4 v[44:47], v4, s[44:45] offset:1024 sc1
  s_mov_b64 exec, -1
  s_sub_u32 s39, s39, 1
  s_cbranch_scc1 L_c_fast_bail
  s_waitcnt vmcnt(2)
  v_cmp_eq_u32 vcc, -1, v51
  s_cbranch_vccnz L_c_fast_A_f201
  v_smfmac_f32_16x16x64_bf16 v[56:59], v[48:51], a[32:39], v3
  v_smfmac_f32_16x16x64_bf16 v[60:63], v[48:51], a[40:47], v3
  s_waitcnt vmcnt(1)
  v_cmp_eq_u32 vcc, -1, v43
  v_smfmac_f32_16x16x64_bf16 v[64:67], v[48:51], a[96:103], v3
  v_smfmac_f32_16x16x64_bf16 v[68:71], v[48:51], a[104:111], v3
  s_cbranch_vccnz L_c_fast_A_f01
  v_smfmac_f32_16x16x64_bf16 v[56:59], v[40:43], a[0:7], v3
  v_smfmac_f32_16x16x64_bf16 v[60:63], v[40:43], a[8:15], v3
  s_waitcnt vmcnt(0)
  v_cmp_eq_u32 vcc, -1, v47
  v_smfmac_f32_16x16x64_bf16 v[64:67], v[40:43], a[64:71], v3
  v_smfmac_f32_16x16x64_bf16 v[68:71], v[40:43], a[72:79], v3
  s_cbranch_vccnz L_c_fast_A_f1
  v_smfmac_f32_16x16x64_bf16 v[56:59], v[44:47], a[16:23], v3
  v_smfmac_f32_16x16x64_bf16 v[60:63], v[44:47], a[24:31], v3
  v_smfmac_f32_16x16x64_bf16 v[64:67], v[44:47], a[80:87], v3
  v_smfmac_f32_16x16x64_bf16 v[68:71], v[44:47], a[88:95], v3
  s_branch L_c_fast_A_done
L_ct_33:
  s_branch L_ct_34
  .fill (((0 - (. - L_0)) & 31) >> 2), 4, 0xbf800000
L_c_fast_A_f130:
  s_mov_b64 exec, vcc
  global_load_dwordx4 v[44:47], v4, s[44:45] offset:1024 sc1
  s_mov_b64 exec, -1
  s_sub_u32 s39, s39, 1
  s_cbranch_scc1 L_c_fast_bail
  s_waitcnt vmcnt(2)
  v_cmp_eq_u32 vcc, -1, v55
  s_cbranch_vccnz L_c_fast_A_f301
  v_smfmac_f32_16x16x64_bf16 v[56:59], v[52:55], a[48:55], v3
  v_smfmac_f32_16x16x64_bf16 v[60:63], v[52:55], a[56:63], v3
  s_waitcnt vmcnt(1)
  v_cmp_eq_u32 vcc, -1, v43
  v_smfmac_f32_16x16x64_bf16 v[64:67], v[52:55], a[112:119], v3
  v_smfmac_f32_16x16x64_bf16 v[68:71], v[52:55], a[120:127], v3
  s_cbranch_vccnz L_c_fast_A_f01
  v_smfmac_f32_16x16x64_bf16 v[56:59], v[40:43], a[0:7], v3
  v_smfmac_f32_16x16x64_bf16 v[60:63], v[40:43], a[8:15], v3
  s_waitcnt vmcnt(0)
  v_cmp_eq_u32 vcc, -1, v47
  v_smfmac_f32_16x16x64_bf16 v[64:67], v[40:43], a[64:71], v3
  v_smfmac_f32_16x16x64_bf16 v[68:71], v[40:43], a[72:79], v3
  s_cbranch_vccnz L_c_fast_A_f1
  v_smfmac_f32_16x16x64_bf16 v[56:59], v[44:47], a[16:23], v3
  v_smfmac_f32_16x16x64_bf16 v[60:63], v[44:47], a[24:31], v3
  v_smfmac_f32_16x16x64_bf16 v[64:67], v[44:47], a[80:87], v3
  v_smfmac_f32_16x16x64_bf16 v[68:71], v[44:47], a[88:95], v3
  s_branch L_c_fast_A_done
L_ct_34:
  s_branch L_ct_143
  .fill (((0 - (. - L_0)) & 31) >> 2), 4, 0xbf800000
L_c_fast_A_f201:
  s_mov_b64 exec, vcc
  global_load_dwordx4 v[48:51], v4, s[44:45] offset:2048 sc1
  s_mov_b64 exec, -1
  s_sub_u32 s39, s39, 1
  s_cbranch_scc1 L_c_fast_bail
  s_waitcnt vmcnt(2)
  v_cmp_eq_u32 vcc, -1, v43
  s_cbranch_vccnz L_c_fast_A_f012
  v_smfmac_f32_16x16x64_bf16 v[56:59], v[40:43], a[0:7], v3
  v_smfmac_f32_16x16x64_bf16 v[60:63], v[40:43], a[8:15], v3
  s_waitcnt vmcnt(1)
  v_cmp_eq_u32 vcc, -1, v47
  v_smfmac_f32_16x16x64_bf16 v[64:67], v[40:43], a[64:71], v3
  v_smfmac_f32_16x16x64_bf16 v[68:71], v[40:43], a[72:79], v3
  s_cbranch_vccnz L_c_fast_A_f12
  v_smfmac_f32_16x16x64_bf16 v[56:59], v[44:47], a[16:23], v3
  v_smfmac_f32_16x16x64_bf16 v[60:63], v[44:47], a[24:31], v3
  s_waitcnt vmcnt(0)
  v_cmp_eq_u32 vcc, -1, v51
  v_smfmac_f32_16x16x64_bf16 v[64:67], v[44:47], a[80:87], v3
  v_smfmac_f32_16x16x64_bf16 v[68:71], v[44:47], a[88:95], v3
  s_cbranch_vccnz L_c_fast_A_f2
  v_smfmac_f32_16x16x64_bf16 v[56:59], v[48:51], a[32:39], v3
  v_smfmac_f32_16x16x64_bf16 v[60:63], v[48:51], a[40:47], v3
  v_smfmac_f32_16x16x64_bf16 v[64:67], v[48:51], a[96:103], v3
  v_smfmac_f32_16x16x64_bf16 v[68:71], v[48:51], a[104:111], v3
  s_branch L_c_fast_A_done
L_ct_w1:
L_ct_35:
  s_branch L_ct_36
  .fill (((0 - (. - L_0)) & 31) >> 2), 4, 0xbf800000
L_c_fast_Sret:
  global_load_dword v176, v13, s[44:45] offset:1024 sc1
  global_load_dword v177, v13, s[44:45] offset:3072 sc1
  global_load_dword v178, v14, s[44:45] offset:1024 sc1
  global_load_dword v179, v14, s[44:45] offset:3072 sc1
  global_load_dwordx4 v[164:167], v9, s[44:45] sc1
  global_load_dwordx4 v[168:171], v10, s[44:45] sc1
  global_load_dwordx4 v[172:175], v11, s[44:45] sc1
  s_sub_u32 s39, s39, 1
  s_cbranch_scc0 L_c_fast_Schk
  s_endpgm
L_ct_36:
  s_branch L_ct_37
  .fill (((0 - (. - L_0)) & 31) >> 2), 4, 0xbf800000
L_c_fast_E0_f0123:
  s_mov_b64 exec, vcc
  global_load_dwordx4 v[40:43], v29, s[44:45] offset:0 sc1
  s_not_b64 exec, vcc
  v_mov_b64 v[40:41], 0
  v_mov_b64 v[42:43], 0
  s_mov_b64 exec, -1
  s_sub_u32 s39, s39, 1
  s_cbranch_scc1 L_c_fast_bail
  s_waitcnt vmcnt(3)
  v_smfmac_f32_16x16x64_bf16 v[80:83], v[44:47], a[208:215], v3
  v_cmp_gt_i32 vcc, s77, v47
  v_smfmac_f32_16x16x64_bf16 v[84:87], v[44:47], a[216:223], v3
  s_cbranch_vccnz L_c_fast_E0_f1230
  s_waitcnt vmcnt(2)
  v_smfmac_f32_16x16x64_bf16 v[80:83], v[48:51], a[224:231], v3
  v_cmp_gt_i32 vcc, s77, v51
  v_smfmac_f32_16x16x64_bf16 v[84:87], v[48:51], a[232:239], v3
  s_cbranch_vccnz L_c_fast_E0_f230
  s_waitcnt vmcnt(1)
  v_smfmac_f32_16x16x64_bf16 v[80:83], v[52:55], a[240:247], v3
  v_cmp_gt_i32 vcc, s77, v55
  v_smfmac_f32_16x16x64_bf16 v[84:87], v[52:55], a[248:255], v3
  s_cbranch_vccnz L_c_fast_E0_f30
  s_waitcnt vmcnt(0)
  v_smfmac_f32_16x16x64_bf16 v[80:83], v[40:43], a[192:199], v3
  v_cmp_gt_i32 vcc, s77, v43
  v_smfmac_f32_16x16x64_bf16 v[84:87], v[40:43], a[200:207], v3
  s_nop 5
  s_cbranch_vccnz L_c_fast_E0_f0
  s_branch L_c_fast_E0_done
L_ct_37:
  s_branch L_ct_38
  .fill (((0 - (. - L_0)) & 31) >> 2), 4, 0xbf800000
L_c_fast_E0_f123:
  s_mov_b64 exec, vcc
  global_load_dwordx4 v[44:47], v29, s[44:45] offset:1024 sc1
  s_not_b64 exec, vcc
  v_mov_b64 v[44:45], 0
  v_mov_b64 v[46:47], 0
  s_mov_b64 exec, -1
  s_sub_u32 s39, s39, 1
  s_cbranch_scc1 L_c_fast_bail
  s_waitcnt vmcnt(2)
  v_smfmac_f32_16x16x64_bf16 v[80:83], v[48:51], a[224:231], v3
  v_cmp_gt_i32 vcc, s77, v51
  v_smfmac_f32_16x16x64_bf16 v[84:87], v[48:51], a[232:239], v3
  s_cbranch_vccnz L_c_fast_E0_f231
  s_waitcnt vmcnt(1)
  v_smfmac_f32_16x16x64_bf16 v[80:83], v[52:55], a[240:247], v3
  v_cmp_gt_i32 vcc, s77, v55
  v_smfmac_f32_16x16x64_bf16 v[84:87], v[52:55], a[248:255], v3
  s_cbranch_vccnz L_c_fast_E0_f31
  s_waitcnt vmcnt(0)
  v_smfmac_f32_16x16x64_bf16 v[80:83], v[44:47], a[208:215], v3
  v_cmp_gt_i32 vcc, s77, v47
  v_smfmac_f32_16x16x64_bf16 v[84:87], v[44:47], a[216:223], v3
  s_nop 5
  s_cbranch_vccnz L_c_fast_E0_f1
  s_branch L_c_fast_E0_done
L_ct_38:
  s_branch L_ct_39
  .fill (((0 - (. - L_0)) & 31) >> 2), 4, 0xbf800000
L_c_fast_E0_f23:
  s_mov_b64 exec, vcc
  global_load_dwordx4 v[48:51], v29, s[44:45] offset:2048 sc1
  s_not_b64 exec, vcc
  v_mov_b64 v[48:49], 0
  v_mov_b64 v[50:51], 0
  s_mov_b64 exec, -1
  s_sub_u32 s39, s39, 1
  s_cbranch_scc1 L_c_fast_bail
  s_waitcnt vmcnt(1)
  v_smfmac_f32_16x16x64_bf16 v[80:83], v[52:55], a[240:247], v3
  v_cmp_gt_i32 vcc, s77, v55
  v_smfmac_f32_16x16x64_bf16 v[84:87], v[52:55], a[248:255], v3
  s_cbranch_vccnz L_c_fast_E0_f32
  s_waitcnt vmcnt(0)
  v_smfmac_f32_16x16x64_bf16 v[80:83], v[48:51], a[224:231], v3
  v_cmp_gt_i32 vcc, s77, v51
  v_smfmac_f32_16x16x64_bf16 v[84:87], v[48:51], a[232:239], v3
  s_nop 5
  s_cbranch_vccnz L_c_fast_E0_f2
  s_branch L_c_fast_E0_done
L_ct_39:
  s_branch L_ct_40
  .fill (((0 - (. - L_0)) & 31) >> 2), 4, 0xbf800000
L_c_fast_E0_f3:
  s_mov_b64 exec, vcc
  global_load_dwordx4 v[52:55], v29, s[44:45] offset:3072 sc1
  s_not_b64 exec, vcc
  v_mov_b64 v[52:53], 0
  v_mov_b64 v[54:55], 0
  s_mov_b64 exec, -1
  s_sub_u32 s39, s39, 1
  s_cbranch_scc1 L_c_fast_bail
  s_waitcnt vmcnt(0)
  v_smfmac_f32_16x16x64_bf16 v[80:83], v[52:55], a[240:247], v3
  v_cmp_gt_i32 vcc, s77, v55
  v_smfmac_f32_16x16x64_bf16 v[84:87], v[52:55], a[248:255], v3
  s_nop 5
  s_cbranch_vccnz L_c_fast_E0_f3
  s_branch L_c_fast_E0_done
L_ct_40:
  s_branch L_ct_41
  .fill (((0 - (. - L_0)) & 31) >> 2), 4, 0xbf800000
L_c_fast_E0_f1230:
  s_mov_b64 exec, vcc
  global_load_dwordx4 v[44:47], v29, s[44:45] offset:1024 sc1
  s_not_b64 exec, vcc
  v_mov_b64 v[44:45], 0
  v_mov_b64 v[46:47], 0
  s_mov_b64 exec, -1
  s_sub_u32 s39, s39, 1
  s_cbranch_scc1 L_c_fast_bail
  s_waitcnt vmcnt(3)
  v_smfmac_f32_16x16x64_bf16 v[80:83], v[48:51], a[224:231], v3
  v_cmp_gt_i32 vcc, s77, v51
  v_smfmac_f32_16x16x64_bf16 v[84:87], v[48:51], a[232:239], v3
  s_cbranch_vccnz L_c_fast_E0_f2301
  s_waitcnt vmcnt(2)
  v_smfmac_f32_16x16x64_bf16 v[80:83], v[52:55], a[240:247], v3
  v_cmp_gt_i32 vcc, s77, v55
  v_smfmac_f32_16x16x64_bf16 v[84:87], v[52:55], a[248:255], v3
  s_cbranch_vccnz L_c_fast_E0_f301
  s_waitcnt vmcnt(1)
  v_smfmac_f32_16x16x64_bf16 v[80:83], v[40:43], a[192:199], v3
  v_cmp_gt_i32 vcc, s77, v43
  v_smfmac_f32_16x16x64_bf16 v[84:87], v[40:43], a[200:207], v3
  s_cbranch_vccnz L_c_fast_E0_f01
  s_waitcnt vmcnt(0)
  v_smfmac_f32_16x16x64_bf16 v[80:83], v[44:47], a[208:215], v3
  v_cmp_gt_i32 vcc, s77, v47
  v_smfmac_f32_16x16x64_bf16 v[84:87], v[44:47], a[216:223], v3
  s_nop 5
  s_cbranch_vccnz L_c_fast_E0_f1
  s_branch L_c_fast_E0_done
L_ct_41:
  s_branch L_ct_42
  .fill (((0 - (. - L_0)) & 31) >> 2), 4, 0xbf800000
L_c_fast_E0_f230:
  s_mov_b64 exec, vcc
  global_load_dwordx4 v[48:51], v29, s[44:45] offset:2048 sc1
  s_not_b64 exec, vcc
  v_mov_b64 v[48:49], 0
  v_mov_b64 v[50:51], 0
  s_mov_b64 exec, -1
  s_sub_u32 s39, s39, 1
  s_cbranch_scc1 L_c_fast_bail
  s_waitcnt vmcnt(2)
  v_smfmac_f32_16x16x64_bf16 v[80:83], v[52:55], a[240:247], v3
  v_cmp_gt_i32 vcc, s77, v55
  v_smfmac_f32_16x16x64_bf16 v[84:87], v[52:55], a[248:255], v3
  s_cbranch_vccnz L_c_fast_E0_f302
  s_waitcnt vmcnt(1)
  v_smfmac_f32_16x16x64_bf16 v[80:83], v[40:43], a[192:199], v3
  v_cmp_gt_i32 vcc, s77, v43
  v_smfmac_f32_16x16x64_bf16 v[84:87], v[40:43], a[200:207], v3
  s_cbranch_vccnz L_c_fast_E0_f02
  s_waitcnt vmcnt(0)
  v_smfmac_f32_16x16x64_bf16 v[80:83], v[48:51], a[224:231], v3
  v_cmp_gt_i32 vcc, s77, v51
  v_smfmac_f32_16x16x64_bf16 v[84:87], v[48:51], a[232:239], v3
  s_nop 5
  s_cbranch_vccnz L_c_fast_E0_f2
  s_branch L_c_fast_E0_done
L_ct_42:
  s_branch L_ct_43
  .fill (((0 - (. - L_0)) & 31) >> 2), 4, 0xbf800000
L_c_fast_E0_f30:
  s_mov_b64 exec, vcc
  global_load_dwordx4 v[52:55], v29, s[44:45] offset:3072 sc1
  s_not_b64 exec, vcc
  v_mov_b64 v[52:53], 0
  v_mov_b64 v[54:55], 0
  s_mov_b64 exec, -1
  s_sub_u32 s39, s39, 1
  s_cbranch_scc1 L_c_fast_bail
  s_waitcnt vmcnt(1)
  v_smfmac_f32_16x16x64_bf16 v[80:83], v[40:43], a[192:199], v3
  v_cmp_gt_i32 vcc, s77, v43
  v_smfmac_f32_16x16x64_bf16 v[84:87], v[40:43], a[200:207], v3
  s_cbranch_vccnz L_c_fast_E0_f03
  s_waitcnt vmcnt(0)
  v_smfmac_f32_16x16x64_bf16 v[80:83], v[52:55], a[240:247], v3
  v_cmp_gt_i32 vcc, s77, v55
  v_smfmac_f32_16x16x64_bf16 v[84:87], v[52:55], a[248:255], v3
  s_nop 5
  s_cbranch_vccnz L_c_fast_E0_f3
  s_branch L_c_fast_E0_done
L_ct_43:
  s_branch L_ct_44
  .fill (((0 - (. - L_0)) & 31) >> 2), 4, 0xbf800000
L_c_fast_E0_f0:
  s_mov_b64 exec, vcc
  global_load_dwordx4 v[40:43], v29, s[44:45] offset:0 sc1
  s_not_b64 exec, vcc
  v_mov_b64 v[40:41], 0
  v_mov_b64 v[42:43], 0
  s_mov_b64 exec, -1
  s_sub_u32 s39, s39, 1
  s_cbranch_scc1 L_c_fast_bail
  s_waitcnt vmcnt(0)
  v_smfmac_f32_16x16x64_bf16 v[80:83], v[40:43], a[192:199], v3
  v_cmp_gt_i32 vcc, s77, v43
  v_smfmac_f32_16x16x64_bf16 v[84:87], v[40:43], a[200:207], v3
  s_nop 5
  s_cbranch_vccnz L_c_fast_E0_f0
  s_branch L_c_fast_E0_done
L_ct_44:
  s_branch L_ct_45
  .fill (((0 - (. - L_0)) & 31) >> 2), 4, 0xbf800000
L_c_fast_E0_f231:
  s_mov_b64 exec, vcc
  global_load_dwordx4 v[48:51], v29, s[44:45] offset:2048 sc1
  s_not_b64 exec, vcc
  v_mov_b64 v[48:49], 0
  v_mov_b64 v[50:51], 0
  s_mov_b64 exec, -1
  s_sub_u32 s39, s39, 1
  s_cbranch_scc1 L_c_fast_bail
  s_waitcnt vmcnt(2)
  v_smfmac_f32_16x16x64_bf16 v[80:83], v[52:55], a[240:247], v3
  v_cmp_gt_i32 vcc, s77, v55
  v_smfmac_f32_16x16x64_bf16 v[84:87], v[52:55], a[248:255], v3
  s_cbranch_vccnz L_c_fast_E0_f312
  s_waitcnt vmcnt(1)
  v_smfmac_f32_16x16x64_bf16 v[80:83], v[44:47], a[208:215], v3
  v_cmp_gt_i32 vcc, s77, v47
  v_smfmac_f32_16x16x64_bf16 v[84:87], v[44:47], a[216:223], v3
  s_cbranch_vccnz L_c_fast_E0_f12
  s_waitcnt vmcnt(0)
  v_smfmac_f32_16x16x64_bf16 v[80:83], v[48:51], a[224:231], v3
  v_cmp_gt_i32 vcc, s77, v51
  v_smfmac_f32_16x16x64_bf16 v[84:87], v[48:51], a[232:239], v3
  s_nop 5
  s_cbranch_vccnz L_c_fast_E0_f2
  s_branch L_c_fast_E0_done
L_ct_45:
  s_branch L_ct_46
  .fill (((0 - (. - L_0)) & 31) >> 2), 4, 0xbf800000
L_c_fast_E0_f31:
  s_mov_b64 exec, vcc
  global_load_dwordx4 v[52:55], v29, s[44:45] offset:3072 sc1
  s_not_b64 exec, vcc
  v_mov_b64 v[52:53], 0
  v_mov_b64 v[54:55], 0
  s_mov_b64 exec, -1
  s_sub_u32 s39, s39, 1
  s_cbranch_scc1 L_c_fast_bail
  s_waitcnt vmcnt(1)
  v_smfmac_f32_16x16x64_bf16 v[80:83], v[44:47], a[208:215], v3
  v_cmp_gt_i32 vcc, s77, v47
  v_smfmac_f32_16x16x64_bf16 v[84:87], v[44:47], a[216:223], v3
  s_cbranch_vccnz L_c_fast_E0_f13
  s_waitcnt vmcnt(0)
  v_smfmac_f32_16x16x64_bf16 v[80:83], v[52:55], a[240:247], v3
  v_cmp_gt_i32 vcc, s77, v55
  v_smfmac_f32_16x16x64_bf16 v[84:87], v[52:55], a[248:255], v3
  s_nop 5
  s_cbranch_vccnz L_c_fast_E0_f3
  s_branch L_c_fast_E0_done
L_ct_46:
  s_branch L_ct_47
  .fill (((0 - (. - L_0)) & 31) >> 2), 4, 0xbf800000
L_c_fast_E0_f1:
  s_mov_b64 exec, vcc
  global_load_dwordx4 v[44:47], v29, s[44:45] offset:1024 sc1
  s_not_b64 exec, vcc
  v_mov_b64 v[44:45], 0
  v_mov_b64 v[46:47], 0
  s_mov_b64 exec, -1
  s_sub_u32 s39, s39, 1
  s_cbranch_scc1 L_c_fast_bail
  s_waitcnt vmcnt(0)
  v_smfmac_f32_16x16x64_bf16 v[80:83], v[44:47], a[208:215], v3
  v_cmp_gt_i32 vcc, s77, v47
  v_smfmac_f32_16x16x64_bf16 v[84:87], v[44:47], a[216:223], v3
  s_nop 5
  s_cbranch_vccnz L_c_fast_E0_f1
  s_branch L_c_fast_E0_done
L_ct_47:
  s_branch L_ct_48
  .fill (((0 - (. - L_0)) & 31) >> 2), 4, 0xbf800000
L_c_fast_E0_f32:
  s_mov_b64 exec, vcc
  global_load_dwordx4 v[52:55], v29, s[44:45] offset:3072 sc1
  s_not_b64 exec, vcc
  v_mov_b64 v[52:53], 0
  v_mov_b64 v[54:55], 0
  s_mov_b64 exec, -1
  s_sub_u32 s39, s39, 1
  s_cbranch_scc1 L_c_fast_bail
  s_waitcnt vmcnt(1)
  v_smfmac_f32_16x16x64_bf16 v[80:83], v[48:51], a[224:231], v3
  v_cmp_gt_i32 vcc, s77, v51
  v_smfmac_f32_16x16x64_bf16 v[84:87], v[48:51], a[232:239], v3
  s_cbranch_vccnz L_c_fast_E0_f23
  s_waitcnt vmcnt(0)
  v_smfmac_f32_16x16x64_bf16 v[80:83], v[52:55], a[240:247], v3
  v_cmp_gt_i32 vcc, s77, v55
  v_smfmac_f32_16x16x64_bf16 v[84:87], v[52:55], a[248:255], v3
  s_nop 5
  s_cbranch_vccnz L_c_fast_E0_f3
  s_branch L_c_fast_E0_done
L_ct_48:
  s_branch L_ct_49
  .fill (((0 - (. - L_0)) & 31) >> 2), 4, 0xbf800000
L_c_fast_E0_f2:
  s_mov_b64 exec, vcc
  global_load_dwordx4 v[48:51], v29, s[44:45] offset:2048 sc1
  s_not_b64 exec, vcc
  v_mov_b64 v[48:49], 0
  v_mov_b64 v[50:51], 0
  s_mov_b64 exec, -1
  s_sub_u32 s39, s39, 1
  s_cbranch_scc1 L_c_fast_bail
  s_waitcnt vmcnt(0)
  v_smfmac_f32_16x16x64_bf16 v[80:83], v[48:51], a[224:231], v3
  v_cmp_gt_i32 vcc, s77, v51
  v_smfmac_f32_16x16x64_bf16 v[84:87], v[48:51], a[232:239], v3
  s_nop 5
  s_cbranch_vccnz L_c_fast_E0_f2
  s_branch L_c_fast_E0_done
L_ct_49:
  s_branch L_ct_50
  .fill (((0 - (. - L_0)) & 31) >> 2), 4, 0xbf800000
L_c_fast_E0_f2301:
  s_mov_b64 exec, vcc
  global_load_dwordx4 v[48:51], v29, s[44:45] offset:2048 sc1
  s_not_b64 exec, vcc
  v_mov_b64 v[48:49], 0
  v_mov_b64 v[50:51], 0
  s_mov_b64 exec, -1
  s_sub_u32 s39, s39, 1
  s_cbranch_scc1 L_c_fast_bail
  s_waitcnt vmcnt(3)
  v_smfmac_f32_16x16x64_bf16 v[80:83], v[52:55], a[240:247], v3
  v_cmp_gt_i32 vcc, s77, v55
  v_smfmac_f32_16x16x64_bf16 v[84:87], v[52:55], a[248:255], v3
  s_cbranch_vccnz L_c_fast_E0_f3012
  s_waitcnt vmcnt(2)
  v_smfmac_f32_16x16x64_bf16 v[80:83], v[40:43], a[192:199], v3
  v_cmp_gt_i32 vcc, s77, v43
  v_smfmac_f32_16x16x64_bf16 v[84:87], v[40:43], a[200:207], v3
  s_cbranch_vccnz L_c_fast_E0_f012
  s_waitcnt vmcnt(1)
  v_smfmac_f32_16x16x64_bf16 v[80:83], v[44:47], a[208:215], v3
  v_cmp_gt_i32 vcc, s77, v47
  v_smfmac_f32_16x16x64_bf16 v[84:87], v[44:47], a[216:223], v3
  s_cbranch_vccnz L_c_fast_E0_f12
  s_waitcnt vmcnt(0)
  v_smfmac_f32_16x16x64_bf16 v[80:83], v[48:51], a[224:231], v3
  v_cmp_gt_i32 vcc, s77, v51
  v_smfmac_f32_16x16x64_bf16 v[84:87], v[48:51], a[232:239], v3
  s_nop 5
  s_cbranch_vccnz L_c_fast_E0_f2
  s_branch L_c_fast_E0_done
L_ct_50:
  s_branch L_ct_51
  .fill (((0 - (. - L_0)) & 31) >> 2), 4, 0xbf800000
L_c_fast_E0_f301:
  s_mov_b64 exec, vcc
  global_load_dwordx4 v[52:55], v29, s[44:45] offset:3072 sc1
  s_not_b64 exec, vcc
  v_mov_b64 v[52:53], 0
  v_mov_b64 v[54:55], 0
  s_mov_b64 exec, -1
  s_sub_u32 s39, s39, 1
  s_cbranch_scc1 L_c_fast_bail
  s_waitcnt vmcnt(2)
  v_smfmac_f32_16x16x64_bf16 v[80:83], v[40:43], a[192:199], v3
  v_cmp_gt_i32 vcc, s77, v43
  v_smfmac_f32_16x16x64_bf16 v[84:87], v[40:43], a[200:207], v3
  s_cbranch_vccnz L_c_fast_E0_f013
  s_waitcnt vmcnt(1)
  v_smfmac_f32_16x16x64_bf16 v[80:83], v[44:47], a[208:215], v3
  v_cmp_gt_i32 vcc, s77, v47
  v_smfmac_f32_16x16x64_bf16 v[84:87], v[44:47], a[216:223], v3
  s_cbranch_vccnz L_c_fast_E0_f13
  s_waitcnt vmcnt(0)
  v_smfmac_f32_16x16x64_bf16 v[80:83], v[52:55], a[240:247], v3
  v_cmp_gt_i32 vcc, s77, v55
  v_smfmac_f32_16x16x64_bf16 v[84:87], v[52:55], a[248:255], v3
  s_nop 5
  s_cbranch_vccnz L_c_fast_E0_f3
  s_branch L_c_fast_E0_done
L_ct_51:
  s_branch L_ct_52
  .fill (((0 - (. - L_0)) & 31) >> 2), 4, 0xbf800000
L_c_fast_E0_f01:
  s_mov_b64 exec, vcc
  global_load_dwordx4 v[40:43], v29, s[44:45] offset:0 sc1
  s_not_b64 exec, vcc
  v_mov_b64 v[40:41], 0
  v_mov_b64 v[42:43], 0
  s_mov_b64 exec, -1
  s_sub_u32 s39, s39, 1
  s_cbranch_scc1 L_c_fast_bail
  s_waitcnt vmcnt(1)
  v_smfmac_f32_16x16x64_bf16 v[80:83], v[44:47], a[208:215], v3
  v_cmp_gt_i32 vcc, s77, v47
  v_smfmac_f32_16x16x64_bf16 v[84:87], v[44:47], a[216:223], v3
  s_cbranch_vccnz L_c_fast_E0_f10
  s_waitcnt vmcnt(0)
  v_smfmac_f32_16x16x64_bf16 v[80:83], v[40:43], a[192:199], v3
  v_cmp_gt_i32 vcc, s77, v43
  v_smfmac_f32_16x16x64_bf16 v[84:87], v[40:43], a[200:207], v3
  s_nop 5
  s_cbranch_vccnz L_c_fast_E0_f0
  s_branch L_c_fast_E0_done
L_ct_52:
  s_branch L_ct_53
  .fill (((0 - (. - L_0)) & 31) >> 2), 4, 0xbf800000
L_c_fast_E0_f302:
  s_mov_b64 exec, vcc
  global_load_dwordx4 v[52:55], v29, s[44:45] offset:3072 sc1
  s_not_b64 exec, vcc
  v_mov_b64 v[52:53], 0
  v_mov_b64 v[54:55], 0
  s_mov_b64 exec, -1
  s_sub_u32 s39, s39, 1
  s_cbranch_scc1 L_c_fast_bail
  s_waitcnt vmcnt(2)
  v_smfmac_f32_16x16x64_bf16 v[80:83], v[40:43], a[192:199], v3
  v_cmp_gt_i32 vcc, s77, v43
  v_smfmac_f32_16x16x64_bf16 v[84:87], v[40:43], a[200:207], v3
  s_cbranch_vccnz L_c_fast_E0_f023
  s_waitcnt vmcnt(1)
  v_smfmac_f32_16x16x64_bf16 v[80:83], v[48:51], a[224:231], v3
  v_cmp_gt_i32 vcc, s77, v51
  v_smfmac_f32_16x16x64_bf16 v[84:87], v[48:51], a[232:239], v3
  s_cbranch_vccnz L_c_fast_E0_f23
  s_waitcnt vmcnt(0)
  v_smfmac_f32_16x16x64_bf16 v[80:83], v[52:55], a[240:247], v3
  v_cmp_gt_i32 vcc, s77, v55
  v_smfmac_f32_16x16x64_bf16 v[84:87], v[52:55], a[248:255], v3
  s_nop 5
  s_cbranch_vccnz L_c_fast_E0_f3
  s_branch L_c_fast_E0_done
L_ct_53:
  s_branch L_ct_54
  .fill (((0 - (. - L_0)) & 31) >> 2), 4, 0xbf800000
L_c_fast_E0_f02:
  s_mov_b64 exec, vcc
  global_load_dwordx4 v[40:43], v29, s[44:45] offset:0 sc1
  s_not_b64 exec, vcc
  v_mov_b64 v[40:41], 0
  v_mov_b64 v[42:43], 0
  s_mov_b64 exec, -1
  s_sub_u32 s39, s39, 1
  s_cbranch_scc1 L_c_fast_bail
  s_waitcnt vmcnt(1)
  v_smfmac_f32_16x16x64_bf16 v[80:83], v[48:51], a[224:231], v3
  v_cmp_gt_i32 vcc, s77, v51
  v_smfmac_f32_16x16x64_bf16 v[84:87], v[48:51], a[232:239], v3
  s_cbranch_vccnz L_c_fast_E0_f20
  s_waitcnt vmcnt(0)
  v_smfmac_f32_16x16x64_bf16 v[80:83], v[40:43], a[192:199], v3
  v_cmp_gt_i32 vcc, s77, v43
  v_smfmac_f32_16x16x64_bf16 v[84:87], v[40:43], a[200:207], v3
  s_nop 5
  s_cbranch_vccnz L_c_fast_E0_f0
  s_branch L_c_fast_E0_done
L_ct_54:
  s_branch L_ct_55
  .fill (((0 - (. - L_0)) & 31) >> 2), 4, 0xbf800000
L_c_fast_E0_f03:
  s_mov_b64 exec, vcc
  global_load_dwordx4 v[40:43], v29, s[44:45] offset:0 sc1
  s_not_b64 exec, vcc
  v_mov_b64 v[40:41], 0
  v_mov_b64 v[42:43], 0
  s_mov_b64 exec, -1
  s_sub_u32 s39, s39, 1
  s_cbranch_scc1 L_c_fast_bail
  s_waitcnt vmcnt(1)
  v_smfmac_f32_16x16x64_bf16 v[80:83], v[52:55], a[240:247], v3
  v_cmp_gt_i32 vcc, s77, v55
  v_smfmac_f32_16x16x64_bf16 v[84:87], v[52:55], a[248:255], v3
  s_cbranch_vccnz L_c_fast_E0_f30
  s_waitcnt vmcnt(0)
  v_smfmac_f32_16x16x64_bf16 v[80:83], v[40:43], a[192:199], v3
  v_cmp_gt_i32 vcc, s77, v43
  v_smfmac_f32_16x16x64_bf16 v[84:87], v[40:43], a[200:207], v3
  s_nop 5
  s_cbranch_vccnz L_c_fast_E0_f0
  s_branch L_c_fast_E0_done
L_ct_55:
  s_branch L_ct_56
  .fill (((0 - (. - L_0)) & 31) >> 2), 4, 0xbf800000
L_c_fast_E0_f312:
  s_mov_b64 exec, vcc
  global_load_dwordx4 v[52:55], v29, s[44:45] offset:3072 sc1
  s_not_b64 exec, vcc
  v_mov_b64 v[52:53], 0
  v_mov_b64 v[54:55], 0
  s_mov_b64 exec, -1
  s_sub_u32 s39, s39, 1
  s_cbranch_scc1 L_c_fast_bail
  s_waitcnt vmcnt(2)
  v_smfmac_f32_16x16x64_bf16 v[80:83], v[44:47], a[208:215], v3
  v_cmp_gt_i32 vcc, s77, v47
  v_smfmac_f32_16x16x64_bf16 v[84:87], v[44:47], a[216:223], v3
  s_cbranch_vccnz L_c_fast_E0_f123
  s_waitcnt vmcnt(1)
  v_smfmac_f32_16x16x64_bf16 v[80:83], v[48:51], a[224:231], v3
  v_cmp_gt_i32 vcc, s77, v51
  v_smfmac_f32_16x16x64_bf16 v[84:87], v[48:51], a[232:239], v3
  s_cbranch_vccnz L_c_fast_E0_f23
  s_waitcnt vmcnt(0)
  v_smfmac_f32_16x16x64_bf16 v[80:83], v[52:55], a[240:247], v3
  v_cmp_gt_i32 vcc, s77, v55
  v_smfmac_f32_16x16x64_bf16 v[84:87], v[52:55], a[248:255], v3
  s_nop 5
  s_cbranch_vccnz L_c_fast_E0_f3
  s_branch L_c_fast_E0_done
L_ct_56:
  s_branch L_ct_57
  .fill (((0 - (. - L_0)) & 31) >> 2), 4, 0xbf800000
L_c_fast_E0_f12:
  s_mov_b64 exec, vcc
  global_load_dwordx4 v[44:47], v29, s[44:45] offset:1024 sc1
  s_not_b64 exec, vcc
  v_mov_b64 v[44:45], 0
  v_mov_b64 v[46:47], 0
  s_mov_b64 exec, -1
  s_sub_u32 s39, s39, 1
  s_cbranch_scc1 L_c_fast_bail
  s_waitcnt vmcnt(1)
  v_smfmac_f32_16x16x64_bf16 v[80:83], v[48:51], a[224:231], v3
  v_cmp_gt_i32 vcc, s77, v51
  v_smfmac_f32_16x16x64_bf16 v[84:87], v[48:51], a[232:239], v3
  s_cbranch_vccnz L_c_fast_E0_f21
  s_waitcnt vmcnt(0)
  v_smfmac_f32_16x16x64_bf16 v[80:83], v[44:47], a[208:215], v3
  v_cmp_gt_i32 vcc, s77, v47
  v_smfmac_f32_16x16x64_bf16 v[84:87], v[44:47], a[216:223], v3
  s_nop 5
  s_cbranch_vccnz L_c_fast_E0_f1
  s_branch L_c_fast_E0_done
L_ct_57:
  s_branch L_ct_58
  .fill (((0 - (. - L_0)) & 31) >> 2), 4, 0xbf800000
L_c_fast_E0_f13:
  s_mov_b64 exec, vcc
  global_load_dwordx4 v[44:47], v29, s[44:45] offset:1024 sc1
  s_not_b64 exec, vcc
  v_mov_b64 v[44:45], 0
  v_mov_b64 v[46:47], 0
  s_mov_b64 exec, -1
  s_sub_u32 s39, s39, 1
  s_cbranch_scc1 L_c_fast_bail
  s_waitcnt vmcnt(1)
  v_smfmac_f32_16x16x64_bf16 v[80:83], v[52:55], a[240:247], v3
  v_cmp_gt_i32 vcc, s77, v55
  v_smfmac_f32_16x16x64_bf16 v[84:87], v[52:55], a[248:255], v3
  s_cbranch_vccnz L_c_fast_E0_f31
  s_waitcnt vmcnt(0)
  v_smfmac_f32_16x16x64_bf16 v[80:83], v[44:47], a[208:215], v3
  v_cmp_gt_i32 vcc, s77, v47
  v_smfmac_f32_16x16x64_bf16 v[84:87], v[44:47], a[216:223], v3
  s_nop 5
  s_cbranch_vccnz L_c_fast_E0_f1
  s_branch L_c_fast_E0_done
L_ct_58:
  s_branch L_ct_59
  .fill (((0 - (. - L_0)) & 31) >> 2), 4, 0xbf800000
L_c_fast_E0_f3012:
  s_mov_b64 exec, vcc
  global_load_dwordx4 v[52:55], v29, s[44:45] offset:3072 sc1
  s_not_b64 exec, vcc
  v_mov_b64 v[52:53], 0
  v_mov_b64 v[54:55], 0
  s_mov_b64 exec, -1
  s_sub_u32 s39, s39, 1
  s_cbranch_scc1 L_c_fast_bail
  s_waitcnt vmcnt(3)
  v_smfmac_f32_16x16x64_bf16 v[80:83], v[40:43], a[192:199], v3
  v_cmp_gt_i32 vcc, s77, v43
  v_smfmac_f32_16x16x64_bf16 v[84:87], v[40:43], a[200:207], v3
  s_cbranch_vccnz L_c_fast_E0_f0123
  s_waitcnt vmcnt(2)
  v_smfmac_f32_16x16x64_bf16 v[80:83], v[44:47], a[208:215], v3
  v_cmp_gt_i32 vcc, s77, v47
  v_smfmac_f32_16x16x64_bf16 v[84:87], v[44:47], a[216:223], v3
  s_cbranch_vccnz L_c_fast_E0_f123
  s_waitcnt vmcnt(1)
  v_smfmac_f32_16x16x64_bf16 v[80:83], v[48:51], a[224:231], v3
  v_cmp_gt_i32 vcc, s77, v51
  v_smfmac_f32_16x16x64_bf16 v[84:87], v[48:51], a[232:239], v3
  s_cbranch_vccnz L_c_fast_E0_f23
  s_waitcnt vmcnt(0)
  v_smfmac_f32_16x16x64_bf16 v[80:83], v[52:55], a[240:247], v3
  v_cmp_gt_i32 vcc, s77, v55
  v_smfmac_f32_16x16x64_bf16 v[84:87], v[52:55], a[248:255], v3
  s_nop 5
  s_cbranch_vccnz L_c_fast_E0_f3
  s_branch L_c_fast_E0_done
L_ct_59:
  s_branch L_ct_60
  .fill (((0 - (. - L_0)) & 31) >> 2), 4, 0xbf800000
L_c_fast_E0_f012:
  s_mov_b64 exec, vcc
  global_load_dwordx4 v[40:43], v29, s[44:45] offset:0 sc1
  s_not_b64 exec, vcc
  v_mov_b64 v[40:41], 0
  v_mov_b64 v[42:43], 0
  s_mov_b64 exec, -1
  s_sub_u32 s39, s39, 1
  s_cbranch_scc1 L_c_fast_bail
  s_waitcnt vmcnt(2)
  v_smfmac_f32_16x16x64_bf16 v[80:83], v[44:47], a[208:215], v3
  v_cmp_gt_i32 vcc, s77, v47
  v_smfmac_f32_16x16x64_bf16 v[84:87], v[44:47], a[216:223], v3
  s_cbranch_vccnz L_c_fast_E0_f120
  s_waitcnt vmcnt(1)
  v_smfmac_f32_16x16x64_bf16 v[80:83], v[48:51], a[224:231], v3
  v_cmp_gt_i32 vcc, s77, v51
  v_smfmac_f32_16x16x64_bf16 v[84:87], v[48:51], a[232:239], v3
  s_cbranch_vccnz L_c_fast_E0_f20
  s_waitcnt vmcnt(0)
  v_smfmac_f32_16x16x64_bf16 v[80:83], v[40:43], a[192:199], v3
  v_cmp_gt_i32 vcc, s77, v43
  v_smfmac_f32_16x16x64_bf16 v[84:87], v[40:43], a[200:207], v3
  s_nop 5
  s_cbranch_vccnz L_c_fast_E0_f0
  s_branch L_c_fast_E0_done
L_ct_60:
  s_branch L_ct_61
  .fill (((0 - (. - L_0)) & 31) >> 2), 4, 0xbf800000
L_c_fast_E0_f013:
  s_mov_b64 exec, vcc
  global_load_dwordx4 v[40:43], v29, s[44:45] offset:0 sc1
  s_not_b64 exec, vcc
  v_mov_b64 v[40:41], 0
  v_mov_b64 v[42:43], 0
  s_mov_b64 exec, -1
  s_sub_u32 s39, s39, 1
  s_cbranch_scc1 L_c_fast_bail
  s_waitcnt vmcnt(2)
  v_smfmac_f32_16x16x64_bf16 v[80:83], v[44:47], a[208:215], v3
  v_cmp_gt_i32 vcc, s77, v47
  v_smfmac_f32_16x16x64_bf16 v[84:87], v[44:47], a[216:223], v3
  s_cbranch_vccnz L_c_fast_E0_f130
  s_waitcnt vmcnt(1)
  v_smfmac_f32_16x16x64_bf16 v[80:83], v[52:55], a[240:247], v3
  v_cmp_gt_i32 vcc, s77, v55
  v_smfmac_f32_16x16x64_bf16 v[84:87], v[52:55], a[248:255], v3
  s_cbranch_vccnz L_c_fast_E0_f30
  s_waitcnt vmcnt(0)
  v_smfmac_f32_16x16x64_bf16 v[80:83], v[40:43], a[192:199], v3
  v_cmp_gt_i32 vcc, s77, v43
  v_smfmac_f32_16x16x64_bf16 v[84:87], v[40:43], a[200:207], v3
  s_nop 5
  s_cbranch_vccnz L_c_fast_E0_f0
  s_branch L_c_fast_E0_done
L_ct_61:
  s_branch L_ct_62
  .fill (((0 - (. - L_0)) & 31) >> 2), 4, 0xbf800000
L_c_fast_E0_f10:
  s_mov_b64 exec, vcc
  global_load_dwordx4 v[44:47], v29, s[44:45] offset:1024 sc1
  s_not_b64 exec, vcc
  v_mov_b64 v[44:45], 0
  v_mov_b64 v[46:47], 0
  s_mov_b64 exec, -1
  s_sub_u32 s39, s39, 1
  s_cbranch_scc1 L_c_fast_bail
  s_waitcnt vmcnt(1)
  v_smfmac_f32_16x16x64_bf16 v[80:83], v[40:43], a[192:199], v3
  v_cmp_gt_i32 vcc, s77, v43
  v_smfmac_f32_16x16x64_bf16 v[84:87], v[40:43], a[200:207], v3
  s_cbranch_vccnz L_c_fast_E0_f01
  s_waitcnt vmcnt(0)
  v_smfmac_f32_16x16x64_bf16 v[80:83], v[44:47], a[208:215], v3
  v_cmp_gt_i32 vcc, s77, v47
  v_smfmac_f32_16x16x64_bf16 v[84:87], v[44:47], a[216:223], v3
  s_nop 5
  s_cbranch_vccnz L_c_fast_E0_f1
  s_branch L_c_fast_E0_done
L_ct_62:
  s_branch L_ct_63
  .fill (((0 - (. - L_0)) & 31) >> 2), 4, 0xbf800000
L_c_fast_E0_f023:
  s_mov_b64 exec, vcc
  global_load_dwordx4 v[40:43], v29, s[44:45] offset:0 sc1
  s_not_b64 exec, vcc
  v_mov_b64 v[40:41], 0
  v_mov_b64 v[42:43], 0
  s_mov_b64 exec, -1
  s_sub_u32 s39, s39, 1
  s_cbranch_scc1 L_c_fast_bail
  s_waitcnt vmcnt(2)
  v_smfmac_f32_16x16x64_bf16 v[80:83], v[48:51], a[224:231], v3
  v_cmp_gt_i32 vcc, s77, v51
  v_smfmac_f32_16x16x64_bf16 v[84:87], v[48:51], a[232:239], v3
  s_cbranch_vccnz L_c_fast_E0_f230
  s_waitcnt vmcnt(1)
  v_smfmac_f32_16x16x64_bf16 v[80:83], v[52:55], a[240:247], v3
  v_cmp_gt_i32 vcc, s77, v55
  v_smfmac_f32_16x16x64_bf16 v[84:87], v[52:55], a[248:255], v3
  s_cbranch_vccnz L_c_fast_E0_f30
  s_waitcnt vmcnt(0)
  v_smfmac_f32_16x16x64_bf16 v[80:83], v[40:43], a[192:199], v3
  v_cmp_gt_i32 vcc, s77, v43
  v_smfmac_f32_16x16x64_bf16 v[84:87], v[40:43], a[200:207], v3
  s_nop 5
  s_cbranch_vccnz L_c_fast_E0_f0
  s_branch L_c_fast_E0_done
L_ct_63:
  s_branch L_ct_64
  .fill (((0 - (. - L_0)) & 31) >> 2), 4, 0xbf800000
L_c_fast_E0_f20:
  s_mov_b64 exec, vcc
  global_load_dwordx4 v[48:51], v29, s[44:45] offset:2048 sc1
  s_not_b64 exec, vcc
  v_mov_b64 v[48:49], 0
  v_mov_b64 v[50:51], 0
  s_mov_b64 exec, -1
  s_sub_u32 s39, s39, 1
  s_cbranch_scc1 L_c_fast_bail
  s_waitcnt vmcnt(1)
  v_smfmac_f32_16x16x64_bf16 v[80:83], v[40:43], a[192:199], v3
  v_cmp_gt_i32 vcc, s77, v43
  v_smfmac_f32_16x16x64_bf16 v[84:87], v[40:43], a[200:207], v3
  s_cbranch_vccnz L_c_fast_E0_f02
  s_waitcnt vmcnt(0)
  v_smfmac_f32_16x16x64_bf16 v[80:83], v[48:51], a[224:231], v3
  v_cmp_gt_i32 vcc, s77, v51
  v_smfmac_f32_16x16x64_bf16 v[84:87], v[48:51], a[232:239], v3
  s_nop 5
  s_cbranch_vccnz L_c_fast_E0_f2
  s_branch L_c_fast_E0_done
L_ct_64:
  s_branch L_ct_65
  .fill (((0 - (. - L_0)) & 31) >> 2), 4, 0xbf800000
L_c_fast_E0_f21:
  s_mov_b64 exec, vcc
  global_load_dwordx4 v[48:51], v29, s[44:45] offset:2048 sc1
  s_not_b64 exec, vcc
  v_mov_b64 v[48:49], 0
  v_mov_b64 v[50:51], 0
  s_mov_b64 exec, -1
  s_sub_u32 s39, s39, 1
  s_cbranch_scc1 L_c_fast_bail
  s_waitcnt vmcnt(1)
  v_smfmac_f32_16x16x64_bf16 v[80:83], v[44:47], a[208:215], v3
  v_cmp_gt_i32 vcc, s77, v47
  v_smfmac_f32_16x16x64_bf16 v[84:87], v[44:47], a[216:223], v3
  s_cbranch_vccnz L_c_fast_E0_f12
  s_waitcnt vmcnt(0)
  v_smfmac_f32_16x16x64_bf16 v[80:83], v[48:51], a[224:231], v3
  v_cmp_gt_i32 vcc, s77, v51
  v_smfmac_f32_16x16x64_bf16 v[84:87], v[48:51], a[232:239], v3
  s_nop 5
  s_cbranch_vccnz L_c_fast_E0_f2
  s_branch L_c_fast_E0_done
L_ct_65:
  s_branch L_ct_66
  .fill (((0 - (. - L_0)) & 31) >> 2), 4, 0xbf800000
L_c_fast_E0_f120:
  s_mov_b64 exec, vcc
  global_load_dwordx4 v[44:47], v29, s[44:45] offset:1024 sc1
  s_not_b64 exec, vcc
  v_mov_b64 v[44:45], 0
  v_mov_b64 v[46:47], 0
  s_mov_b64 exec, -1
  s_sub_u32 s39, s39, 1
  s_cbranch_scc1 L_c_fast_bail
  s_waitcnt vmcnt(2)
  v_smfmac_f32_16x16x64_bf16 v[80:83], v[48:51], a[224:231], v3
  v_cmp_gt_i32 vcc, s77, v51
  v_smfmac_f32_16x16x64_bf16 v[84:87], v[48:51], a[232:239], v3
  s_cbranch_vccnz L_c_fast_E0_f201
  s_waitcnt vmcnt(1)
  v_smfmac_f32_16x16x64_bf16 v[80:83], v[40:43], a[192:199], v3
  v_cmp_gt_i32 vcc, s77, v43
  v_smfmac_f32_16x16x64_bf16 v[84:87], v[40:43], a[200:207], v3
  s_cbranch_vccnz L_c_fast_E0_f01
  s_waitcnt vmcnt(0)
  v_smfmac_f32_16x16x64_bf16 v[80:83], v[44:47], a[208:215], v3
  v_cmp_gt_i32 vcc, s77, v47
  v_smfmac_f32_16x16x64_bf16 v[84:87], v[44:47], a[216:223], v3
  s_nop 5
  s_cbranch_vccnz L_c_fast_E0_f1
  s_branch L_c_fast_E0_done
L_ct_66:
  s_branch L_ct_67
  .fill (((0 - (. - L_0)) & 31) >> 2), 4, 0xbf800000
L_c_fast_E0_f130:
  s_mov_b64 exec, vcc
  global_load_dwordx4 v[44:47], v29, s[44:45] offset:1024 sc1
  s_not_b64 exec, vcc
  v_mov_b64 v[44:45], 0
  v_mov_b64 v[46:47], 0
  s_mov_b64 exec, -1
  s_sub_u32 s39, s39, 1
  s_cbranch_scc1 L_c_fast_bail
  s_waitcnt vmcnt(2)
  v_smfmac_f32_16x16x64_bf16 v[80:83], v[52:55], a[240:247], v3
  v_cmp_gt_i32 vcc, s77, v55
  v_smfmac_f32_16x16x64_bf16 v[84:87], v[52:55], a[248:255], v3
  s_cbranch_vccnz L_c_fast_E0_f301
  s_waitcnt vmcnt(1)
  v_smfmac_f32_16x16x64_bf16 v[80:83], v[40:43], a[192:199], v3
  v_cmp_gt_i32 vcc, s77, v43
  v_smfmac_f32_16x16x64_bf16 v[84:87], v[40:43], a[200:207], v3
  s_cbranch_vccnz L_c_fast_E0_f01
  s_waitcnt vmcnt(0)
  v_smfmac_f32_16x16x64_bf16 v[80:83], v[44:47], a[208:215], v3
  v_cmp_gt_i32 vcc, s77, v47
  v_smfmac_f32_16x16x64_bf16 v[84:87], v[44:47], a[216:223], v3
  s_nop 5
  s_cbranch_vccnz L_c_fast_E0_f1
  s_branch L_c_fast_E0_done
L_ct_67:
  s_branch L_ct_68
  .fill (((0 - (. - L_0)) & 31) >> 2), 4, 0xbf800000
L_c_fast_E0_f201:
  s_mov_b64 exec, vcc
  global_load_dwordx4 v[48:51], v29, s[44:45] offset:2048 sc1
  s_not_b64 exec, vcc
  v_mov_b64 v[48:49], 0
  v_mov_b64 v[50:51], 0
  s_mov_b64 exec, -1
  s_sub_u32 s39, s39, 1
  s_cbranch_scc1 L_c_fast_bail
  s_waitcnt vmcnt(2)
  v_smfmac_f32_16x16x64_bf16 v[80:83], v[40:43], a[192:199], v3
  v_cmp_gt_i32 vcc, s77, v43
  v_smfmac_f32_16x16x64_bf16 v[84:87], v[40:43], a[200:207], v3
  s_cbranch_vccnz L_c_fast_E0_f012
  s_waitcnt vmcnt(1)
  v_smfmac_f32_16x16x64_bf16 v[80:83], v[44:47], a[208:215], v3
  v_cmp_gt_i32 vcc, s77, v47
  v_smfmac_f32_16x16x64_bf16 v[84:87], v[44:47], a[216:223], v3
  s_cbranch_vccnz L_c_fast_E0_f12
  s_waitcnt vmcnt(0)
  v_smfmac_f32_16x16x64_bf16 v[80:83], v[48:51], a[224:231], v3
  v_cmp_gt_i32 vcc, s77, v51
  v_smfmac_f32_16x16x64_bf16 v[84:87], v[48:51], a[232:239], v3
  s_nop 5
  s_cbranch_vccnz L_c_fast_E0_f2
  s_branch L_c_fast_E0_done
L_ct_68:
  s_branch L_ct_69
L_c_fast_Gret:
  global_load_dwordx4 v[192:195], v16, s[70:71] sc1
  global_load_dwordx4 v[196:199], v17, s[70:71] sc1
  global_load_dwordx4 v[200:203], v18, s[70:71] sc1
  s_sub_u32 s39, s39, 1
  s_cbranch_scc1 L_c_fast_bail
  s_waitcnt vmcnt(2)
  v_pk_add_f32 v[88:89], v[188:189], v[192:193]
  v_pk_add_f32 v[90:91], v[190:191], v[194:195]
  s_waitcnt vmcnt(0)
  v_max3_u32 v1, v195, v199, v203
  v_cmp_eq_u32 vcc, -1, v1
  v_pk_add_f32 v[96:97], v[196:197], v[200:201]
  v_pk_add_f32 v[98:99], v[198:199], v[202:203]
  v_pk_add_f32 v[96:97], v[96:97], v[88:89]
  v_pk_add_f32 v[98:99], v[98:99], v[90:91]
  v_cvt_pk_bf16_f32 v208, v96, v98
  v_cvt_pk_bf16_f32 v209, v97, v99
  s_cbranch_vccnz L_c_fast_Gret
  global_store_dword v5, v208, s[44:45]
  global_store_dword v5, v209, s[44:45] offset:16
  s_barrier
  s_branch L_c_fast_step
L_ct_69:
  s_branch L_ct_70
  .fill (((0 - (. - L_0)) & 31) >> 2), 4, 0xbf800000
L_c_fast_EH_f0123:
  s_mov_b64 exec, vcc
  global_load_dwordx4 v[40:43], v29, s[44:45] offset:0 sc1
  s_not_b64 exec, vcc
  v_mov_b64 v[40:41], 0
  v_mov_b64 v[42:43], 0
  s_mov_b64 exec, -1
  s_sub_u32 s39, s39, 1
  s_cbranch_scc1 L_c_fast_bail
  s_waitcnt vmcnt(3)
  v_smfmac_f32_16x16x64_bf16 v[80:83], v[44:47], a[208:215], v3
  v_cmp_gt_i32 vcc, s77, v47
  v_smfmac_f32_16x16x64_bf16 v[84:87], v[44:47], a[216:223], v3
  s_cbranch_vccnz L_c_fast_EH_f1230
  s_waitcnt vmcnt(2)
  v_smfmac_f32_16x16x64_bf16 v[80:83], v[48:51], a[224:231], v3
  v_cmp_gt_i32 vcc, s77, v51
  v_smfmac_f32_16x16x64_bf16 v[84:87], v[48:51], a[232:239], v3
  s_cbranch_vccnz L_c_fast_EH_f230
  s_waitcnt vmcnt(1)
  v_smfmac_f32_16x16x64_bf16 v[80:83], v[52:55], a[240:247], v3
  v_cmp_gt_i32 vcc, s77, v55
  v_smfmac_f32_16x16x64_bf16 v[84:87], v[52:55], a[248:255], v3
  s_cbranch_vccnz L_c_fast_EH_f30
  s_waitcnt vmcnt(0)
  v_smfmac_f32_16x16x64_bf16 v[80:83], v[40:43], a[192:199], v3
  v_cmp_gt_i32 vcc, s77, v43
  v_smfmac_f32_16x16x64_bf16 v[84:87], v[40:43], a[200:207], v3
  s_nop 5
  s_cbranch_vccnz L_c_fast_EH_f0
  s_branch L_c_fast_EH_done
L_ct_70:
  s_branch L_ct_143
  .fill (((0 - (. - L_0)) & 31) >> 2), 4, 0xbf800000
L_c_fast_EH_f123:
  s_mov_b64 exec, vcc
  global_load_dwordx4 v[44:47], v29, s[44:45] offset:1024 sc1
  s_not_b64 exec, vcc
  v_mov_b64 v[44:45], 0
  v_mov_b64 v[46:47], 0
  s_mov_b64 exec, -1
  s_sub_u32 s39, s39, 1
  s_cbranch_scc1 L_c_fast_bail
  s_waitcnt vmcnt(2)
  v_smfmac_f32_16x16x64_bf16 v[80:83], v[48:51], a[224:231], v3
  v_cmp_gt_i32 vcc, s77, v51
  v_smfmac_f32_16x16x64_bf16 v[84:87], v[48:51], a[232:239], v3
  s_cbranch_vccnz L_c_fast_EH_f231
  s_waitcnt vmcnt(1)
  v_smfmac_f32_16x16x64_bf16 v[80:83], v[52:55], a[240:247], v3
  v_cmp_gt_i32 vcc, s77, v55
  v_smfmac_f32_16x16x64_bf16 v[84:87], v[52:55], a[248:255], v3
  s_cbranch_vccnz L_c_fast_EH_f31
  s_waitcnt vmcnt(0)
  v_smfmac_f32_16x16x64_bf16 v[80:83], v[44:47], a[208:215], v3
  v_cmp_gt_i32 vcc, s77, v47
  v_smfmac_f32_16x16x64_bf16 v[84:87], v[44:47], a[216:223], v3
  s_nop 5
  s_cbranch_vccnz L_c_fast_EH_f1
  s_branch L_c_fast_EH_done
L_ct_w2:
L_ct_71:
  s_branch L_ct_72
  .fill (((0 - (. - L_0)) & 31) >> 2), 4, 0xbf800000
L_c_fast_EH_f23:
  s_mov_b64 exec, vcc
  global_load_dwordx4 v[48:51], v29, s[44:45] offset:2048 sc1
  s_not_b64 exec, vcc
  v_mov_b64 v[48:49], 0
  v_mov_b64 v[50:51], 0
  s_mov_b64 exec, -1
  s_sub_u32 s39, s39, 1
  s_cbranch_scc1 L_c_fast_bail
  s_waitcnt vmcnt(1)
  v_smfmac_f32_16x16x64_bf16 v[80:83], v[52:55], a[240:247], v3
  v_cmp_gt_i32 vcc, s77, v55
  v_smfmac_f32_16x16x64_bf16 v[84:87], v[52:55], a[248:255], v3
  s_cbranch_vccnz L_c_fast_EH_f32
  s_waitcnt vmcnt(0)
  v_smfmac_f32_16x16x64_bf16 v[80:83], v[48:51], a[224:231], v3
  v_cmp_gt_i32 vcc, s77, v51
  v_smfmac_f32_16x16x64_bf16 v[84:87], v[48:51], a[232:239], v3
  s_nop 5
  s_cbranch_vccnz L_c_fast_EH_f2
  s_branch L_c_fast_EH_done
L_ct_72:
  s_branch L_ct_73
  .fill (((0 - (. - L_0)) & 31) >> 2), 4, 0xbf800000
L_c_fast_EH_f3:
  s_mov_b64 exec, vcc
  global_load_dwordx4 v[52:55], v29, s[44:45] offset:3072 sc1
  s_not_b64 exec, vcc
  v_mov_b64 v[52:53], 0
  v_mov_b64 v[54:55], 0
  s_mov_b64 exec, -1
  s_sub_u32 s39, s39, 1
  s_cbranch_scc1 L_c_fast_bail
  s_waitcnt vmcnt(0)
  v_smfmac_f32_16x16x64_bf16 v[80:83], v[52:55], a[240:247], v3
  v_cmp_gt_i32 vcc, s77, v55
  v_smfmac_f32_16x16x64_bf16 v[84:87], v[52:55], a[248:255], v3
  s_nop 5
  s_cbranch_vccnz L_c_fast_EH_f3
  s_branch L_c_fast_EH_done
L_ct_73:
  s_branch L_ct_74
  .fill (((0 - (. - L_0)) & 31) >> 2), 4, 0xbf800000
L_c_fast_EH_f1230:
  s_mov_b64 exec, vcc
  global_load_dwordx4 v[44:47], v29, s[44:45] offset:1024 sc1
  s_not_b64 exec, vcc
  v_mov_b64 v[44:45], 0
  v_mov_b64 v[46:47], 0
  s_mov_b64 exec, -1
  s_sub_u32 s39, s39, 1
  s_cbranch_scc1 L_c_fast_bail
  s_waitcnt vmcnt(3)
  v_smfmac_f32_16x16x64_bf16 v[80:83], v[48:51], a[224:231], v3
  v_cmp_gt_i32 vcc, s77, v51
  v_smfmac_f32_16x16x64_bf16 v[84:87], v[48:51], a[232:239], v3
  s_cbranch_vccnz L_c_fast_EH_f2301
  s_waitcnt vmcnt(2)
  v_smfmac_f32_16x16x64_bf16 v[80:83], v[52:55], a[240:247], v3
  v_cmp_gt_i32 vcc, s77, v55
  v_smfmac_f32_16x16x64_bf16 v[84:87], v[52:55], a[248:255], v3
  s_cbranch_vccnz L_c_fast_EH_f301
  s_waitcnt vmcnt(1)
  v_smfmac_f32_16x16x64_bf16 v[80:83], v[40:43], a[192:199], v3
  v_cmp_gt_i32 vcc, s77, v43
  v_smfmac_f32_16x16x64_bf16 v[84:87], v[40:43], a[200:207], v3
  s_cbranch_vccnz L_c_fast_EH_f01
  s_waitcnt vmcnt(0)
  v_smfmac_f32_16x16x64_bf16 v[80:83], v[44:47], a[208:215], v3
  v_cmp_gt_i32 vcc, s77, v47
  v_smfmac_f32_16x16x64_bf16 v[84:87], v[44:47], a[216:223], v3
  s_nop 5
  s_cbranch_vccnz L_c_fast_EH_f1
  s_branch L_c_fast_EH_done
L_ct_74:
  s_branch L_ct_75
  .fill (((0 - (. - L_0)) & 31) >> 2), 4, 0xbf800000
L_c_fast_EH_f230:
  s_mov_b64 exec, vcc
  global_load_dwordx4 v[48:51], v29, s[44:45] offset:2048 sc1
  s_not_b64 exec, vcc
  v_mov_b64 v[48:49], 0
  v_mov_b64 v[50:51], 0
  s_mov_b64 exec, -1
  s_sub_u32 s39, s39, 1
  s_cbranch_scc1 L_c_fast_bail
  s_waitcnt vmcnt(2)
  v_smfmac_f32_16x16x64_bf16 v[80:83], v[52:55], a[240:247], v3
  v_cmp_gt_i32 vcc, s77, v55
  v_smfmac_f32_16x16x64_bf16 v[84:87], v[52:55], a[248:255], v3
  s_cbranch_vccnz L_c_fast_EH_f302
  s_waitcnt vmcnt(1)
  v_smfmac_f32_16x16x64_bf16 v[80:83], v[40:43], a[192:199], v3
  v_cmp_gt_i32 vcc, s77, v43
  v_smfmac_f32_16x16x64_bf16 v[84:87], v[40:43], a[200:207], v3
  s_cbranch_vccnz L_c_fast_EH_f02
  s_waitcnt vmcnt(0)
  v_smfmac_f32_16x16x64_bf16 v[80:83], v[48:51], a[224:231], v3
  v_cmp_gt_i32 vcc, s77, v51
  v_smfmac_f32_16x16x64_bf16 v[84:87], v[48:51], a[232:239], v3
  s_nop 5
  s_cbranch_vccnz L_c_fast_EH_f2
  s_branch L_c_fast_EH_done
L_ct_75:
  s_branch L_ct_76
  .fill (((0 - (. - L_0)) & 31) >> 2), 4, 0xbf800000
L_c_fast_EH_f30:
  s_mov_b64 exec, vcc
  global_load_dwordx4 v[52:55], v29, s[44:45] offset:3072 sc1
  s_not_b64 exec, vcc
  v_mov_b64 v[52:53], 0
  v_mov_b64 v[54:55], 0
  s_mov_b64 exec, -1
  s_sub_u32 s39, s39, 1
  s_cbranch_scc1 L_c_fast_bail
  s_waitcnt vmcnt(1)
  v_smfmac_f32_16x16x64_bf16 v[80:83], v[40:43], a[192:199], v3
  v_cmp_gt_i32 vcc, s77, v43
  v_smfmac_f32_16x16x64_bf16 v[84:87], v[40:43], a[200:207], v3
  s_cbranch_vccnz L_c_fast_EH_f03
  s_waitcnt vmcnt(0)
  v_smfmac_f32_16x16x64_bf16 v[80:83], v[52:55], a[240:247], v3
  v_cmp_gt_i32 vcc, s77, v55
  v_smfmac_f32_16x16x64_bf16 v[84:87], v[52:55], a[248:255], v3
  s_nop 5
  s_cbranch_vccnz L_c_fast_EH_f3
  s_branch L_c_fast_EH_done
L_ct_76:
  s_branch L_ct_77
  .fill (((0 - (. - L_0)) & 31) >> 2), 4, 0xbf800000
L_c_fast_EH_f0:
  s_mov_b64 exec, vcc
  global_load_dwordx4 v[40:43], v29, s[44:45] offset:0 sc1
  s_not_b64 exec, vcc
  v_mov_b64 v[40:41], 0
  v_mov_b64 v[42:43], 0
  s_mov_b64 exec, -1
  s_sub_u32 s39, s39, 1
  s_cbranch_scc1 L_c_fast_bail
  s_waitcnt vmcnt(0)
  v_smfmac_f32_16x16x64_bf16 v[80:83], v[40:43], a[192:199], v3
  v_cmp_gt_i32 vcc, s77, v43
  v_smfmac_f32_16x16x64_bf16 v[84:87], v[40:43], a[200:207], v3
  s_nop 5
  s_cbranch_vccnz L_c_fast_EH_f0
  s_branch L_c_fast_EH_done
L_ct_77:
  s_branch L_ct_78
  .fill (((0 - (. - L_0)) & 31) >> 2), 4, 0xbf800000
L_c_fast_EH_f231:
  s_mov_b64 exec, vcc
  global_load_dwordx4 v[48:51], v29, s[44:45] offset:2048 sc1
  s_not_b64 exec, vcc
  v_mov_b64 v[48:49], 0
  v_mov_b64 v[50:51], 0
  s_mov_b64 exec, -1
  s_sub_u32 s39, s39, 1
  s_cbranch_scc1 L_c_fast_bail
  s_waitcnt vmcnt(2)
  v_smfmac_f32_16x16x64_bf16 v[80:83], v[52:55], a[240:247], v3
  v_cmp_gt_i32 vcc, s77, v55
  v_smfmac_f32_16x16x64_bf16 v[84:87], v[52:55], a[248:255], v3
  s_cbranch_vccnz L_c_fast_EH_f312
  s_waitcnt vmcnt(1)
  v_smfmac_f32_16x16x64_bf16 v[80:83], v[44:47], a[208:215], v3
  v_cmp_gt_i32 vcc, s77, v47
  v_smfmac_f32_16x16x64_bf16 v[84:87], v[44:47], a[216:223], v3
  s_cbranch_vccnz L_c_fast_EH_f12
  s_waitcnt vmcnt(0)
  v_smfmac_f32_16x16x64_bf16 v[80:83], v[48:51], a[224:231], v3
  v_cmp_gt_i32 vcc, s77, v51
  v_smfmac_f32_16x16x64_bf16 v[84:87], v[48:51], a[232:239], v3
  s_nop 5
  s_cbranch_vccnz L_c_fast_EH_f2
  s_branch L_c_fast_EH_done
L_ct_78:
  s_branch L_ct_79
  .fill (((0 - (. - L_0)) & 31) >> 2), 4, 0xbf800000
L_c_fast_EH_f31:
  s_mov_b64 exec, vcc
  global_load_dwordx4 v[52:55], v29, s[44:45] offset:3072 sc1
  s_not_b64 exec, vcc
  v_mov_b64 v[52:53], 0
  v_mov_b64 v[54:55], 0
  s_mov_b64 exec, -1
  s_sub_u32 s39, s39, 1
  s_cbranch_scc1 L_c_fast_bail
  s_waitcnt vmcnt(1)
  v_smfmac_f32_16x16x64_bf16 v[80:83], v[44:47], a[208:215], v3
  v_cmp_gt_i32 vcc, s77, v47
  v_smfmac_f32_16x16x64_bf16 v[84:87], v[44:47], a[216:223], v3
  s_cbranch_vccnz L_c_fast_EH_f13
  s_waitcnt vmcnt(0)
  v_smfmac_f32_16x16x64_bf16 v[80:83], v[52:55], a[240:247], v3
  v_cmp_gt_i32 vcc, s77, v55
  v_smfmac_f32_16x16x64_bf16 v[84:87], v[52:55], a[248:255], v3
  s_nop 5
  s_cbranch_vccnz L_c_fast_EH_f3
  s_branch L_c_fast_EH_done
L_ct_79:
  s_branch L_ct_80
  .fill (((0 - (. - L_0)) & 31) >> 2), 4, 0xbf800000
L_c_fast_EH_f1:
  s_mov_b64 exec, vcc
  global_load_dwordx4 v[44:47], v29, s[44:45] offset:1024 sc1
  s_not_b64 exec, vcc
  v_mov_b64 v[44:45], 0
  v_mov_b64 v[46:47], 0
  s_mov_b64 exec, -1
  s_sub_u32 s39, s39, 1
  s_cbranch_scc1 L_c_fast_bail
  s_waitcnt vmcnt(0)
  v_smfmac_f32_16x16x64_bf16 v[80:83], v[44:47], a[208:215], v3
  v_cmp_gt_i32 vcc, s77, v47
  v_smfmac_f32_16x16x64_bf16 v[84:87], v[44:47], a[216:223], v3
  s_nop 5
  s_cbranch_vccnz L_c_fast_EH_f1
  s_branch L_c_fast_EH_done
L_ct_80:
  s_branch L_ct_81
  .fill (((0 - (. - L_0)) & 31) >> 2), 4, 0xbf800000
L_c_fast_EH_f32:
  s_mov_b64 exec, vcc
  global_load_dwordx4 v[52:55], v29, s[44:45] offset:3072 sc1
  s_not_b64 exec, vcc
  v_mov_b64 v[52:53], 0
  v_mov_b64 v[54:55], 0
  s_mov_b64 exec, -1
  s_sub_u32 s39, s39, 1
  s_cbranch_scc1 L_c_fast_bail
  s_waitcnt vmcnt(1)
  v_smfmac_f32_16x16x64_bf16 v[80:83], v[48:51], a[224:231], v3
  v_cmp_gt_i32 vcc, s77, v51
  v_smfmac_f32_16x16x64_bf16 v[84:87], v[48:51], a[232:239], v3
  s_cbranch_vccnz L_c_fast_EH_f23
  s_waitcnt vmcnt(0)
  v_smfmac_f32_16x16x64_bf16 v[80:83], v[52:55], a[240:247], v3
  v_cmp_gt_i32 vcc, s77, v55
  v_smfmac_f32_16x16x64_bf16 v[84:87], v[52:55], a[248:255], v3
  s_nop 5
  s_cbranch_vccnz L_c_fast_EH_f3
  s_branch L_c_fast_EH_done
L_ct_81:
  s_branch L_ct_82
  .fill (((0 - (. - L_0)) & 31) >> 2), 4, 0xbf800000
L_c_fast_EH_f2:
  s_mov_b64 exec, vcc
  global_load_dwordx4 v[48:51], v29, s[44:45] offset:2048 sc1
  s_not_b64 exec, vcc
  v_mov_b64 v[48:49], 0
  v_mov_b64 v[50:51], 0
  s_mov_b64 exec, -1
  s_sub_u32 s39, s39, 1
  s_cbranch_scc1 L_c_fast_bail
  s_waitcnt vmcnt(0)
  v_smfmac_f32_16x16x64_bf16 v[80:83], v[48:51], a[224:231], v3
  v_cmp_gt_i32 vcc, s77, v51
  v_smfmac_f32_16x16x64_bf16 v[84:87], v[48:51], a[232:239], v3
  s_nop 5
  s_cbranch_vccnz L_c_fast_EH_f2
  s_branch L_c_fast_EH_done
L_ct_82:
  s_branch L_ct_83
  .fill (((0 - (. - L_0)) & 31) >> 2), 4, 0xbf800000
L_c_fast_EH_f2301:
  s_mov_b64 exec, vcc
  global_load_dwordx4 v[48:51], v29, s[44:45] offset:2048 sc1
  s_not_b64 exec, vcc
  v_mov_b64 v[48:49], 0
  v_mov_b64 v[50:51], 0
  s_mov_b64 exec, -1
  s_sub_u32 s39, s39, 1
  s_cbranch_scc1 L_c_fast_bail
  s_waitcnt vmcnt(3)
  v_smfmac_f32_16x16x64_bf16 v[80:83], v[52:55], a[240:247], v3
  v_cmp_gt_i32 vcc, s77, v55
  v_smfmac_f32_16x16x64_bf16 v[84:87], v[52:55], a[248:255], v3
  s_cbranch_vccnz L_c_fast_EH_f3012
  s_waitcnt vmcnt(2)
  v_smfmac_f32_16x16x64_bf16 v[80:83], v[40:43], a[192:199], v3
  v_cmp_gt_i32 vcc, s77, v43
  v_smfmac_f32_16x16x64_bf16 v[84:87], v[40:43], a[200:207], v3
  s_cbranch_vccnz L_c_fast_EH_f012
  s_waitcnt vmcnt(1)
  v_smfmac_f32_16x16x64_bf16 v[80:83], v[44:47], a[208:215], v3
  v_cmp_gt_i32 vcc, s77, v47
  v_smfmac_f32_16x16x64_bf16 v[84:87], v[44:47], a[216:223], v3
  s_cbranch_vccnz L_c_fast_EH_f12
  s_waitcnt vmcnt(0)
  v_smfmac_f32_16x16x64_bf16 v[80:83], v[48:51], a[224:231], v3
  v_cmp_gt_i32 vcc, s77, v51
  v_smfmac_f32_16x16x64_bf16 v[84:87], v[48:51], a[232:239], v3
  s_nop 5
  s_cbranch_vccnz L_c_fast_EH_f2
  s_branch L_c_fast_EH_done
L_ct_83:
  s_branch L_ct_84
  .fill (((0 - (. - L_0)) & 31) >> 2), 4, 0xbf800000
L_c_fast_EH_f301:
  s_mov_b64 exec, vcc
  global_load_dwordx4 v[52:55], v29, s[44:45] offset:3072 sc1
  s_not_b64 exec, vcc
  v_mov_b64 v[52:53], 0
  v_mov_b64 v[54:55], 0
  s_mov_b64 exec, -1
  s_sub_u32 s39, s39, 1
  s_cbranch_scc1 L_c_fast_bail
  s_waitcnt vmcnt(2)
  v_smfmac_f32_16x16x64_bf16 v[80:83], v[40:43], a[192:199], v3
  v_cmp_gt_i32 vcc, s77, v43
  v_smfmac_f32_16x16x64_bf16 v[84:87], v[40:43], a[200:207], v3
  s_cbranch_vccnz L_c_fast_EH_f013
  s_waitcnt vmcnt(1)
  v_smfmac_f32_16x16x64_bf16 v[80:83], v[44:47], a[208:215], v3
  v_cmp_gt_i32 vcc, s77, v47
  v_smfmac_f32_16x16x64_bf16 v[84:87], v[44:47], a[216:223], v3
  s_cbranch_vccnz L_c_fast_EH_f13
  s_waitcnt vmcnt(0)
  v_smfmac_f32_16x16x64_bf16 v[80:83], v[52:55], a[240:247], v3
  v_cmp_gt_i32 vcc, s77, v55
  v_smfmac_f32_16x16x64_bf16 v[84:87], v[52:55], a[248:255], v3
  s_nop 5
  s_cbranch_vccnz L_c_fast_EH_f3
  s_branch L_c_fast_EH_done
L_ct_84:
  s_branch L_ct_85
  .fill (((0 - (. - L_0)) & 31) >> 2), 4, 0xbf800000
L_c_fast_EH_f01:
  s_mov_b64 exec, vcc
  global_load_dwordx4 v[40:43], v29, s[44:45] offset:0 sc1
  s_not_b64 exec, vcc
  v_mov_b64 v[40:41], 0
  v_mov_b64 v[42:43], 0
  s_mov_b64 exec, -1
  s_sub_u32 s39, s39, 1
  s_cbranch_scc1 L_c_fast_bail
  s_waitcnt vmcnt(1)
  v_smfmac_f32_16x16x64_bf16 v[80:83], v[44:47], a[208:215], v3
  v_cmp_gt_i32 vcc, s77, v47
  v_smfmac_f32_16x16x64_bf16 v[84:87], v[44:47], a[216:223], v3
  s_cbranch_vccnz L_c_fast_EH_f10
  s_waitcnt vmcnt(0)
  v_smfmac_f32_16x16x64_bf16 v[80:83], v[40:43], a[192:199], v3
  v_cmp_gt_i32 vcc, s77, v43
  v_smfmac_f32_16x16x64_bf16 v[84:87], v[40:43], a[200:207], v3
  s_nop 5
  s_cbranch_vccnz L_c_fast_EH_f0
  s_branch L_c_fast_EH_done
L_ct_85:
  s_branch L_ct_86
  .fill (((0 - (. - L_0)) & 31) >> 2), 4, 0xbf800000
L_c_fast_EH_f302:
  s_mov_b64 exec, vcc
  global_load_dwordx4 v[52:55], v29, s[44:45] offset:3072 sc1
  s_not_b64 exec, vcc
  v_mov_b64 v[52:53], 0
  v_mov_b64 v[54:55], 0
  s_mov_b64 exec, -1
  s_sub_u32 s39, s39, 1
  s_cbranch_scc1 L_c_fast_bail
  s_waitcnt vmcnt(2)
  v_smfmac_f32_16x16x64_bf16 v[80:83], v[40:43], a[192:199], v3
  v_cmp_gt_i32 vcc, s77, v43
  v_smfmac_f32_16x16x64_bf16 v[84:87], v[40:43], a[200:207], v3
  s_cbranch_vccnz L_c_fast_EH_f023
  s_waitcnt vmcnt(1)
  v_smfmac_f32_16x16x64_bf16 v[80:83], v[48:51], a[224:231], v3
  v_cmp_gt_i32 vcc, s77, v51
  v_smfmac_f32_16x16x64_bf16 v[84:87], v[48:51], a[232:239], v3
  s_cbranch_vccnz L_c_fast_EH_f23
  s_waitcnt vmcnt(0)
  v_smfmac_f32_16x16x64_bf16 v[80:83], v[52:55], a[240:247], v3
  v_cmp_gt_i32 vcc, s77, v55
  v_smfmac_f32_16x16x64_bf16 v[84:87], v[52:55], a[248:255], v3
  s_nop 5
  s_cbranch_vccnz L_c_fast_EH_f3
  s_branch L_c_fast_EH_done
L_ct_86:
  s_branch L_ct_87
  .fill (((0 - (. - L_0)) & 31) >> 2), 4, 0xbf800000
L_c_fast_EH_f02:
  s_mov_b64 exec, vcc
  global_load_dwordx4 v[40:43], v29, s[44:45] offset:0 sc1
  s_not_b64 exec, vcc
  v_mov_b64 v[40:41], 0
  v_mov_b64 v[42:43], 0
  s_mov_b64 exec, -1
  s_sub_u32 s39, s39, 1
  s_cbranch_scc1 L_c_fast_bail
  s_waitcnt vmcnt(1)
  v_smfmac_f32_16x16x64_bf16 v[80:83], v[48:51], a[224:231], v3
  v_cmp_gt_i32 vcc, s77, v51
  v_smfmac_f32_16x16x64_bf16 v[84:87], v[48:51], a[232:239], v3
  s_cbranch_vccnz L_c_fast_EH_f20
  s_waitcnt vmcnt(0)
  v_smfmac_f32_16x16x64_bf16 v[80:83], v[40:43], a[192:199], v3
  v_cmp_gt_i32 vcc, s77, v43
  v_smfmac_f32_16x16x64_bf16 v[84:87], v[40:43], a[200:207], v3
  s_nop 5
  s_cbranch_vccnz L_c_fast_EH_f0
  s_branch L_c_fast_EH_done
L_ct_87:
  s_branch L_ct_88
  .fill (((0 - (. - L_0)) & 31) >> 2), 4, 0xbf800000
L_c_fast_EH_f03:
  s_mov_b64 exec, vcc
  global_load_dwordx4 v[40:43], v29, s[44:45] offset:0 sc1
  s_not_b64 exec, vcc
  v_mov_b64 v[40:41], 0
  v_mov_b64 v[42:43], 0
  s_mov_b64 exec, -1
  s_sub_u32 s39, s39, 1
  s_cbranch_scc1 L_c_fast_bail
  s_waitcnt vmcnt(1)
  v_smfmac_f32_16x16x64_bf16 v[80:83], v[52:55], a[240:247], v3
  v_cmp_gt_i32 vcc, s77, v55
  v_smfmac_f32_16x16x64_bf16 v[84:87], v[52:55], a[248:255], v3
  s_cbranch_vccnz L_c_fast_EH_f30
  s_waitcnt vmcnt(0)
  v_smfmac_f32_16x16x64_bf16 v[80:83], v[40:43], a[192:199], v3
  v_cmp_gt_i32 vcc, s77, v43
  v_smfmac_f32_16x16x64_bf16 v[84:87], v[40:43], a[200:207], v3
  s_nop 5
  s_cbranch_vccnz L_c_fast_EH_f0
  s_branch L_c_fast_EH_done
L_ct_88:
  s_branch L_ct_89
  .fill (((0 - (. - L_0)) & 31) >> 2), 4, 0xbf800000
L_c_fast_EH_f312:
  s_mov_b64 exec, vcc
  global_load_dwordx4 v[52:55], v29, s[44:45] offset:3072 sc1
  s_not_b64 exec, vcc
  v_mov_b64 v[52:53], 0
  v_mov_b64 v[54:55], 0
  s_mov_b64 exec, -1
  s_sub_u32 s39, s39, 1
  s_cbranch_scc1 L_c_fast_bail
  s_waitcnt vmcnt(2)
  v_smfmac_f32_16x16x64_bf16 v[80:83], v[44:47], a[208:215], v3
  v_cmp_gt_i32 vcc, s77, v47
  v_smfmac_f32_16x16x64_bf16 v[84:87], v[44:47], a[216:223], v3
  s_cbranch_vccnz L_c_fast_EH_f123
  s_waitcnt vmcnt(1)
  v_smfmac_f32_16x16x64_bf16 v[80:83], v[48:51], a[224:231], v3
  v_cmp_gt_i32 vcc, s77, v51
  v_smfmac_f32_16x16x64_bf16 v[84:87], v[48:51], a[232:239], v3
  s_cbranch_vccnz L_c_fast_EH_f23
  s_waitcnt vmcnt(0)
  v_smfmac_f32_16x16x64_bf16 v[80:83], v[52:55], a[240:247], v3
  v_cmp_gt_i32 vcc, s77, v55
  v_smfmac_f32_16x16x64_bf16 v[84:87], v[52:55], a[248:255], v3
  s_nop 5
  s_cbranch_vccnz L_c_fast_EH_f3
  s_branch L_c_fast_EH_done
L_ct_89:
  s_branch L_ct_90
  .fill (((0 - (. - L_0)) & 31) >> 2), 4, 0xbf800000
L_c_fast_EH_f12:
  s_mov_b64 exec, vcc
  global_load_dwordx4 v[44:47], v29, s[44:45] offset:1024 sc1
  s_not_b64 exec, vcc
  v_mov_b64 v[44:45], 0
  v_mov_b64 v[46:47], 0
  s_mov_b64 exec, -1
  s_sub_u32 s39, s39, 1
  s_cbranch_scc1 L_c_fast_bail
  s_waitcnt vmcnt(1)
  v_smfmac_f32_16x16x64_bf16 v[80:83], v[48:51], a[224:231], v3
  v_cmp_gt_i32 vcc, s77, v51
  v_smfmac_f32_16x16x64_bf16 v[84:87], v[48:51], a[232:239], v3
  s_cbranch_vccnz L_c_fast_EH_f21
  s_waitcnt vmcnt(0)
  v_smfmac_f32_16x16x64_bf16 v[80:83], v[44:47], a[208:215], v3
  v_cmp_gt_i32 vcc, s77, v47
  v_smfmac_f32_16x16x64_bf16 v[84:87], v[44:47], a[216:223], v3
  s_nop 5
  s_cbranch_vccnz L_c_fast_EH_f1
  s_branch L_c_fast_EH_done
L_ct_90:
  s_branch L_ct_91
  .fill (((0 - (. - L_0)) & 31) >> 2), 4, 0xbf800000
L_c_fast_EH_f13:
  s_mov_b64 exec, vcc
  global_load_dwordx4 v[44:47], v29, s[44:45] offset:1024 sc1
  s_not_b64 exec, vcc
  v_mov_b64 v[44:45], 0
  v_mov_b64 v[46:47], 0
  s_mov_b64 exec, -1
  s_sub_u32 s39, s39, 1
  s_cbranch_scc1 L_c_fast_bail
  s_waitcnt vmcnt(1)
  v_smfmac_f32_16x16x64_bf16 v[80:83], v[52:55], a[240:247], v3
  v_cmp_gt_i32 vcc, s77, v55
  v_smfmac_f32_16x16x64_bf16 v[84:87], v[52:55], a[248:255], v3
  s_cbranch_vccnz L_c_fast_EH_f31
  s_waitcnt vmcnt(0)
  v_smfmac_f32_16x16x64_bf16 v[80:83], v[44:47], a[208:215], v3
  v_cmp_gt_i32 vcc, s77, v47
  v_smfmac_f32_16x16x64_bf16 v[84:87], v[44:47], a[216:223], v3
  s_nop 5
  s_cbranch_vccnz L_c_fast_EH_f1
  s_branch L_c_fast_EH_done
L_ct_91:
  s_branch L_ct_92
  .fill (((0 - (. - L_0)) & 31) >> 2), 4, 0xbf800000
L_c_fast_EH_f3012:
  s_mov_b64 exec, vcc
  global_load_dwordx4 v[52:55], v29, s[44:45] offset:3072 sc1
  s_not_b64 exec, vcc
  v_mov_b64 v[52:53], 0
  v_mov_b64 v[54:55], 0
  s_mov_b64 exec, -1
  s_sub_u32 s39, s39, 1
  s_cbranch_scc1 L_c_fast_bail
  s_waitcnt vmcnt(3)
  v_smfmac_f32_16x16x64_bf16 v[80:83], v[40:43], a[192:199], v3
  v_cmp_gt_i32 vcc, s77, v43
  v_smfmac_f32_16x16x64_bf16 v[84:87], v[40:43], a[200:207], v3
  s_cbranch_vccnz L_c_fast_EH_f0123
  s_waitcnt vmcnt(2)
  v_smfmac_f32_16x16x64_bf16 v[80:83], v[44:47], a[208:215], v3
  v_cmp_gt_i32 vcc, s77, v47
  v_smfmac_f32_16x16x64_bf16 v[84:87], v[44:47], a[216:223], v3
  s_cbranch_vccnz L_c_fast_EH_f123
  s_waitcnt vmcnt(1)
  v_smfmac_f32_16x16x64_bf16 v[80:83], v[48:51], a[224:231], v3
  v_cmp_gt_i32 vcc, s77, v51
  v_smfmac_f32_16x16x64_bf16 v[84:87], v[48:51], a[232:239], v3
  s_cbranch_vccnz L_c_fast_EH_f23
  s_waitcnt vmcnt(0)
  v_smfmac_f32_16x16x64_bf16 v[80:83], v[52:55], a[240:247], v3
  v_cmp_gt_i32 vcc, s77, v55
  v_smfmac_f32_16x16x64_bf16 v[84:87], v[52:55], a[248:255], v3
  s_nop 5
  s_cbranch_vccnz L_c_fast_EH_f3
  s_branch L_c_fast_EH_done
L_ct_92:
  s_branch L_ct_93
  .fill (((0 - (. - L_0)) & 31) >> 2), 4, 0xbf800000
L_c_fast_EH_f012:
  s_mov_b64 exec, vcc
  global_load_dwordx4 v[40:43], v29, s[44:45] offset:0 sc1
  s_not_b64 exec, vcc
  v_mov_b64 v[40:41], 0
  v_mov_b64 v[42:43], 0
  s_mov_b64 exec, -1
  s_sub_u32 s39, s39, 1
  s_cbranch_scc1 L_c_fast_bail
  s_waitcnt vmcnt(2)
  v_smfmac_f32_16x16x64_bf16 v[80:83], v[44:47], a[208:215], v3
  v_cmp_gt_i32 vcc, s77, v47
  v_smfmac_f32_16x16x64_bf16 v[84:87], v[44:47], a[216:223], v3
  s_cbranch_vccnz L_c_fast_EH_f120
  s_waitcnt vmcnt(1)
  v_smfmac_f32_16x16x64_bf16 v[80:83], v[48:51], a[224:231], v3
  v_cmp_gt_i32 vcc, s77, v51
  v_smfmac_f32_16x16x64_bf16 v[84:87], v[48:51], a[232:239], v3
  s_cbranch_vccnz L_c_fast_EH_f20
  s_waitcnt vmcnt(0)
  v_smfmac_f32_16x16x64_bf16 v[80:83], v[40:43], a[192:199], v3
  v_cmp_gt_i32 vcc, s77, v43
  v_smfmac_f32_16x16x64_bf16 v[84:87], v[40:43], a[200:207], v3
  s_nop 5
  s_cbranch_vccnz L_c_fast_EH_f0
  s_branch L_c_fast_EH_done
L_ct_93:
  s_branch L_ct_94
  .fill (((0 - (. - L_0)) & 31) >> 2), 4, 0xbf800000
L_c_fast_EH_f013:
  s_mov_b64 exec, vcc
  global_load_dwordx4 v[40:43], v29, s[44:45] offset:0 sc1
  s_not_b64 exec, vcc
  v_mov_b64 v[40:41], 0
  v_mov_b64 v[42:43], 0
  s_mov_b64 exec, -1
  s_sub_u32 s39, s39, 1
  s_cbranch_scc1 L_c_fast_bail
  s_waitcnt vmcnt(2)
  v_smfmac_f32_16x16x64_bf16 v[80:83], v[44:47], a[208:215], v3
  v_cmp_gt_i32 vcc, s77, v47
  v_smfmac_f32_16x16x64_bf16 v[84:87], v[44:47], a[216:223], v3
  s_cbranch_vccnz L_c_fast_EH_f130
  s_waitcnt vmcnt(1)
  v_smfmac_f32_16x16x64_bf16 v[80:83], v[52:55], a[240:247], v3
  v_cmp_gt_i32 vcc, s77, v55
  v_smfmac_f32_16x16x64_bf16 v[84:87], v[52:55], a[248:255], v3
  s_cbranch_vccnz L_c_fast_EH_f30
  s_waitcnt vmcnt(0)
  v_smfmac_f32_16x16x64_bf16 v[80:83], v[40:43], a[192:199], v3
  v_cmp_gt_i32 vcc, s77, v43
  v_smfmac_f32_16x16x64_bf16 v[84:87], v[40:43], a[200:207], v3
  s_nop 5
  s_cbranch_vccnz L_c_fast_EH_f0
  s_branch L_c_fast_EH_done
L_ct_94:
  s_branch L_ct_95
  .fill (((0 - (. - L_0)) & 31) >> 2), 4, 0xbf800000
L_c_fast_EH_f10:
  s_mov_b64 exec, vcc
  global_load_dwordx4 v[44:47], v29, s[44:45] offset:1024 sc1
  s_not_b64 exec, vcc
  v_mov_b64 v[44:45], 0
  v_mov_b64 v[46:47], 0
  s_mov_b64 exec, -1
  s_sub_u32 s39, s39, 1
  s_cbranch_scc1 L_c_fast_bail
  s_waitcnt vmcnt(1)
  v_smfmac_f32_16x16x64_bf16 v[80:83], v[40:43], a[192:199], v3
  v_cmp_gt_i32 vcc, s77, v43
  v_smfmac_f32_16x16x64_bf16 v[84:87], v[40:43], a[200:207], v3
  s_cbranch_vccnz L_c_fast_EH_f01
  s_waitcnt vmcnt(0)
  v_smfmac_f32_16x16x64_bf16 v[80:83], v[44:47], a[208:215], v3
  v_cmp_gt_i32 vcc, s77, v47
  v_smfmac_f32_16x16x64_bf16 v[84:87], v[44:47], a[216:223], v3
  s_nop 5
  s_cbranch_vccnz L_c_fast_EH_f1
  s_branch L_c_fast_EH_done
L_ct_95:
  s_branch L_ct_96
  .fill (((0 - (. - L_0)) & 31) >> 2), 4, 0xbf800000
L_c_fast_EH_f023:
  s_mov_b64 exec, vcc
  global_load_dwordx4 v[40:43], v29, s[44:45] offset:0 sc1
  s_not_b64 exec, vcc
  v_mov_b64 v[40:41], 0
  v_mov_b64 v[42:43], 0
  s_mov_b64 exec, -1
  s_sub_u32 s39, s39, 1
  s_cbranch_scc1 L_c_fast_bail
  s_waitcnt vmcnt(2)
  v_smfmac_f32_16x16x64_bf16 v[80:83], v[48:51], a[224:231], v3
  v_cmp_gt_i32 vcc, s77, v51
  v_smfmac_f32_16x16x64_bf16 v[84:87], v[48:51], a[232:239], v3
  s_cbranch_vccnz L_c_fast_EH_f230
  s_waitcnt vmcnt(1)
  v_smfmac_f32_16x16x64_bf16 v[80:83], v[52:55], a[240:247], v3
  v_cmp_gt_i32 vcc, s77, v55
  v_smfmac_f32_16x16x64_bf16 v[84:87], v[52:55], a[248:255], v3
  s_cbranch_vccnz L_c_fast_EH_f30
  s_waitcnt vmcnt(0)
  v_smfmac_f32_16x16x64_bf16 v[80:83], v[40:43], a[192:199], v3
  v_cmp_gt_i32 vcc, s77, v43
  v_smfmac_f32_16x16x64_bf16 v[84:87], v[40:43], a[200:207], v3
  s_nop 5
  s_cbranch_vccnz L_c_fast_EH_f0
  s_branch L_c_fast_EH_done
L_ct_96:
  s_branch L_ct_97
  .fill (((0 - (. - L_0)) & 31) >> 2), 4, 0xbf800000
L_c_fast_EH_f20:
  s_mov_b64 exec, vcc
  global_load_dwordx4 v[48:51], v29, s[44:45] offset:2048 sc1
  s_not_b64 exec, vcc
  v_mov_b64 v[48:49], 0
  v_mov_b64 v[50:51], 0
  s_mov_b64 exec, -1
  s_sub_u32 s39, s39, 1
  s_cbranch_scc1 L_c_fast_bail
  s_waitcnt vmcnt(1)
  v_smfmac_f32_16x16x64_bf16 v[80:83], v[40:43], a[192:199], v3
  v_cmp_gt_i32 vcc, s77, v43
  v_smfmac_f32_16x16x64_bf16 v[84:87], v[40:43], a[200:207], v3
  s_cbranch_vccnz L_c_fast_EH_f02
  s_waitcnt vmcnt(0)
  v_smfmac_f32_16x16x64_bf16 v[80:83], v[48:51], a[224:231], v3
  v_cmp_gt_i32 vcc, s77, v51
  v_smfmac_f32_16x16x64_bf16 v[84:87], v[48:51], a[232:239], v3
  s_nop 5
  s_cbranch_vccnz L_c_fast_EH_f2
  s_branch L_c_fast_EH_done
L_ct_97:
  s_branch L_ct_98
  .fill (((0 - (. - L_0)) & 31) >> 2), 4, 0xbf800000
L_c_fast_EH_f21:
  s_mov_b64 exec, vcc
  global_load_dwordx4 v[48:51], v29, s[44:45] offset:2048 sc1
  s_not_b64 exec, vcc
  v_mov_b64 v[48:49], 0
  v_mov_b64 v[50:51], 0
  s_mov_b64 exec, -1
  s_sub_u32 s39, s39, 1
  s_cbranch_scc1 L_c_fast_bail
  s_waitcnt vmcnt(1)
  v_smfmac_f32_16x16x64_bf16 v[80:83], v[44:47], a[208:215], v3
  v_cmp_gt_i32 vcc, s77, v47
  v_smfmac_f32_16x16x64_bf16 v[84:87], v[44:47], a[216:223], v3
  s_cbranch_vccnz L_c_fast_EH_f12
  s_waitcnt vmcnt(0)
  v_smfmac_f32_16x16x64_bf16 v[80:83], v[48:51], a[224:231], v3
  v_cmp_gt_i32 vcc, s77, v51
  v_smfmac_f32_16x16x64_bf16 v[84:87], v[48:51], a[232:239], v3
  s_nop 5
  s_cbranch_vccnz L_c_fast_EH_f2
  s_branch L_c_fast_EH_done
L_ct_98:
  s_branch L_ct_99
  .fill (((0 - (. - L_0)) & 31) >> 2), 4, 0xbf800000
L_c_fast_EH_f120:
  s_mov_b64 exec, vcc
  global_load_dwordx4 v[44:47], v29, s[44:45] offset:1024 sc1
  s_not_b64 exec, vcc
  v_mov_b64 v[44:45], 0
  v_mov_b64 v[46:47], 0
  s_mov_b64 exec, -1
  s_sub_u32 s39, s39, 1
  s_cbranch_scc1 L_c_fast_bail
  s_waitcnt vmcnt(2)
  v_smfmac_f32_16x16x64_bf16 v[80:83], v[48:51], a[224:231], v3
  v_cmp_gt_i32 vcc, s77, v51
  v_smfmac_f32_16x16x64_bf16 v[84:87], v[48:51], a[232:239], v3
  s_cbranch_vccnz L_c_fast_EH_f201
  s_waitcnt vmcnt(1)
  v_smfmac_f32_16x16x64_bf16 v[80:83], v[40:43], a[192:199], v3
  v_cmp_gt_i32 vcc, s77, v43
  v_smfmac_f32_16x16x64_bf16 v[84:87], v[40:43], a[200:207], v3
  s_cbranch_vccnz L_c_fast_EH_f01
  s_waitcnt vmcnt(0)
  v_smfmac_f32_16x16x64_bf16 v[80:83], v[44:47], a[208:215], v3
  v_cmp_gt_i32 vcc, s77, v47
  v_smfmac_f32_16x16x64_bf16 v[84:87], v[44:47], a[216:223], v3
  s_nop 5
  s_cbranch_vccnz L_c_fast_EH_f1
  s_branch L_c_fast_EH_done
L_ct_99:
  s_branch L_ct_100
  .fill (((0 - (. - L_0)) & 31) >> 2), 4, 0xbf800000
L_c_fast_EH_f130:
  s_mov_b64 exec, vcc
  global_load_dwordx4 v[44:47], v29, s[44:45] offset:1024 sc1
  s_not_b64 exec, vcc
  v_mov_b64 v[44:45], 0
  v_mov_b64 v[46:47], 0
  s_mov_b64 exec, -1
  s_sub_u32 s39, s39, 1
  s_cbranch_scc1 L_c_fast_bail
  s_waitcnt vmcnt(2)
  v_smfmac_f32_16x16x64_bf16 v[80:83], v[52:55], a[240:247], v3
  v_cmp_gt_i32 vcc, s77, v55
  v_smfmac_f32_16x16x64_bf16 v[84:87], v[52:55], a[248:255], v3
  s_cbranch_vccnz L_c_fast_EH_f301
  s_waitcnt vmcnt(1)
  v_smfmac_f32_16x16x64_bf16 v[80:83], v[40:43], a[192:199], v3
  v_cmp_gt_i32 vcc, s77, v43
  v_smfmac_f32_16x16x64_bf16 v[84:87], v[40:43], a[200:207], v3
  s_cbranch_vccnz L_c_fast_EH_f01
  s_waitcnt vmcnt(0)
  v_smfmac_f32_16x16x64_bf16 v[80:83], v[44:47], a[208:215], v3
  v_cmp_gt_i32 vcc, s77, v47
  v_smfmac_f32_16x16x64_bf16 v[84:87], v[44:47], a[216:223], v3
  s_nop 5
  s_cbranch_vccnz L_c_fast_EH_f1
  s_branch L_c_fast_EH_done
L_ct_100:
  s_branch L_ct_101
  .fill (((0 - (. - L_0)) & 31) >> 2), 4, 0xbf800000
L_c_fast_EH_f201:
  s_mov_b64 exec, vcc
  global_load_dwordx4 v[48:51], v29, s[44:45] offset:2048 sc1
  s_not_b64 exec, vcc
  v_mov_b64 v[48:49], 0
  v_mov_b64 v[50:51], 0
  s_mov_b64 exec, -1
  s_sub_u32 s39, s39, 1
  s_cbranch_scc1 L_c_fast_bail
  s_waitcnt vmcnt(2)
  v_smfmac_f32_16x16x64_bf16 v[80:83], v[40:43], a[192:199], v3
  v_cmp_gt_i32 vcc, s77, v43
  v_smfmac_f32_16x16x64_bf16 v[84:87], v[40:43], a[200:207], v3
  s_cbranch_vccnz L_c_fast_EH_f012
  s_waitcnt vmcnt(1)
  v_smfmac_f32_16x16x64_bf16 v[80:83], v[44:47], a[208:215], v3
  v_cmp_gt_i32 vcc, s77, v47
  v_smfmac_f32_16x16x64_bf16 v[84:87], v[44:47], a[216:223], v3
  s_cbranch_vccnz L_c_fast_EH_f12
  s_waitcnt vmcnt(0)
  v_smfmac_f32_16x16x64_bf16 v[80:83], v[48:51], a[224:231], v3
  v_cmp_gt_i32 vcc, s77, v51
  v_smfmac_f32_16x16x64_bf16 v[84:87], v[48:51], a[232:239], v3
  s_nop 5
  s_cbranch_vccnz L_c_fast_EH_f2
  s_branch L_c_fast_EH_done
L_c_fast_Bredo:
  s_sub_u32 s39, s39, 1
  s_cbranch_scc0 L_c_fast_B2
  s_endpgm
L_c_fast_Fredo:
  s_sub_u32 s39, s39, 1
  s_cbranch_scc0 L_c_fast_F2
  s_endpgm
L_c_fast_bail:
  s_endpgm
L_c_tail:
L_ct_101:
  s_cbranch_execz L_ct_102
  s_lshl_b32 s40, s37, 16
  s_lshl_b32 s41, s36, 14
  s_add_u32 s40, s40, s41
  s_add_u32 s40, s40, 66322432
  v_lshl_add_u32 v4, v0, 4, s40
  s_lshl_b32 s40, s36, 5
  s_add_u32 s40, s40, s38
  s_lshl_b32 s40, s40, 14
  s_add_u32 s40, s40, 90177536
  v_lshl_add_u32 v6, v0, 4, s40
  s_xor_b32 s41, s36, s37
  s_lshl_b32 s41, s41, 12
  v_add_u32 v5, s41, v6
  s_lshl_b32 s40, s36, 12
L_ct_102:
  s_cbranch_execz L_ct_103
  v_lshl_add_u32 v7, v0, 4, s40
  s_lshl_b32 s40, s36, 10
  v_lshl_add_u32 v8, v0, 4, s40
  s_lshr_b32 s40, s36, 1
  s_lshl_b32 s40, s40, 16
  s_and_b32 s41, s36, 1
  s_lshl_b32 s41, s41, 5
  s_add_u32 s40, s40, s41
  s_lshl_b32 s41, s38, 6
  s_add_u32 s40, s40, s41
  s_add_u32 s40, s40, 7995392
  v_and_b32 v1, 15, v0
  v_lshl_add_u32 v9, v1, 12, s40
  v_lshrrev_b32 v1, 4, v0
L_ct_103:
  s_cbranch_execz L_ct_104
  v_lshl_add_u32 v9, v1, 3, v9
  s_add_u32 s44, s34, 0
  s_addc_u32 s45, s35, 0
  s_add_u32 s46, s34, 4096
  s_addc_u32 s47, s35, 0
  s_add_u32 s48, s34, 8192
  s_addc_u32 s49, s35, 0
  s_add_u32 s50, s34, 12288
  s_addc_u32 s51, s35, 0
  s_add_u32 s52, s34, 262144
  s_addc_u32 s53, s35, 0
  s_add_u32 s54, s34, 266240
  s_addc_u32 s55, s35, 0
  s_add_u32 s56, s34, 270336
L_ct_104:
  s_cbranch_execz L_ct_105
  s_addc_u32 s57, s35, 0
  s_add_u32 s58, s34, 274432
  s_addc_u32 s59, s35, 0
  s_add_u32 s60, s34, 524288
  s_addc_u32 s61, s35, 0
  s_add_u32 s62, s34, 528384
  s_addc_u32 s63, s35, 0
  s_add_u32 s64, s34, 532480
  s_addc_u32 s65, s35, 0
  s_add_u32 s66, s34, 536576
  s_addc_u32 s67, s35, 0
  v_readfirstlane_b32 s40, v4
  s_and_b32 s41, s38, 7
  s_lshl_b32 s41, s41, 7
L_ct_105:
  s_cbranch_execz L_ct_106
  s_add_u32 s40, s40, s41
  v_and_b32 v1, 15, v0
  v_lshl_add_u32 v10, v1, 10, s40
  s_barrier
  v_mov_b32 v2, 0
  s_mov_b64 exec, 0xffff
  global_load_dword v2, v10, s[44:45] sc1
  s_mov_b64 exec, -1
L_c_tw0:
  s_waitcnt vmcnt(0)
  v_cmp_eq_u32 vcc, -1, v2
  s_cbranch_vccz L_c_tg0
  s_mov_b64 exec, 0xffff
  global_load_dword v2, v10, s[44:45] sc1
  s_mov_b64 exec, -1
L_ct_106:
  s_cbranch_execz L_ct_143
  s_sub_u32 s39, s39, 1
  s_cbranch_scc0 L_c_tw0
  s_endpgm
L_c_tg0:
  global_load_dwordx4 v[40:43], v4, s[44:45] offset:0 sc1
  global_load_dwordx4 v[44:47], v4, s[44:45] offset:1024 sc1
  global_load_dwordx4 v[48:51], v4, s[44:45] offset:2048 sc1
  global_load_dwordx4 v[52:55], v4, s[44:45] offset:3072 sc1
  global_load_dwordx4 v[56:59], v4, s[46:47] offset:0 sc1
  global_load_dwordx4 v[60:63], v4, s[46:47] offset:1024 sc1
  global_load_dwordx4 v[64:67], v4, s[46:47] offset:2048 sc1
  global_load_dwordx4 v[68:71], v4, s[46:47] offset:3072 sc1
  global_load_dwordx4 v[72:75], v4, s[48:49] offset:0 sc1
  global_load_dwordx4 v[76:79], v4, s[48:49] offset:1024 sc1
L_ct_w3:
L_ct_107:
  s_cbranch_execz L_ct_108
  global_load_dwordx4 v[80:83], v4, s[48:49] offset:2048 sc1
  global_load_dwordx4 v[84:87], v4, s[48:49] offset:3072 sc1
  global_load_dwordx4 v[88:91], v4, s[50:51] offset:0 sc1
  global_load_dwordx4 v[92:95], v4, s[50:51] offset:1024 sc1
  global_load_dwordx4 v[96:99], v4, s[50:51] offset:2048 sc1
  global_load_dwordx4 v[100:103], v4, s[50:51] offset:3072 sc1
  s_mov_b64 exec, 0xffff
  global_load_dword v2, v10, s[52:53] sc1
  s_mov_b64 exec, -1
L_c_tw1:
  s_waitcnt vmcnt(0)
  v_cmp_eq_u32 vcc, -1, v2
  s_cbranch_vccz L_c_tg1
  s_mov_b64 exec, 0xffff
  global_load_dword v2, v10, s[52:53] sc1
  s_mov_b64 exec, -1
L_ct_108:
  s_cbranch_execz L_ct_109
  s_sub_u32 s39, s39, 1
  s_cbranch_scc0 L_c_tw1
  s_endpgm
L_c_tg1:
  v_max3_u32 v1, v43, v47, v51
  v_max_u32 v1, v1, v55
  v_cmp_eq_u32 vcc, -1, v1
  s_cbranch_vccnz L_c_t0_0_s
L_c_t0_0:
  v_mfma_f32_16x16x32_bf16 v[168:171], a[192:195], v[40:43], 0
  v_mfma_f32_16x16x32_bf16 v[172:175], a[200:203], v[40:43], 0
  global_load_dwordx4 v[104:107], v4, s[52:53] offset:0 sc1
  v_mfma_f32_16x16x32_bf16 v[176:179], a[192:195], v[44:47], 0
  v_mfma_f32_16x16x32_bf16 v[180:183], a[200:203], v[44:47], 0
L_ct_109:
  s_cbranch_execz L_ct_110
  global_load_dwordx4 v[108:111], v4, s[52:53] offset:1024 sc1
  v_mfma_f32_16x16x32_bf16 v[168:171], a[196:199], v[48:51], v[168:171]
  v_mfma_f32_16x16x32_bf16 v[172:175], a[204:207], v[48:51], v[172:175]
  global_load_dwordx4 v[112:115], v4, s[52:53] offset:2048 sc1
  v_mfma_f32_16x16x32_bf16 v[176:179], a[196:199], v[52:55], v[176:179]
  v_mfma_f32_16x16x32_bf16 v[180:183], a[204:207], v[52:55], v[180:183]
  global_load_dwordx4 v[116:119], v4, s[52:53] offset:3072 sc1
  v_max3_u32 v1, v59, v63, v67
  v_max_u32 v1, v1, v71
  v_cmp_eq_u32 vcc, -1, v1
  s_cbranch_vccnz L_c_t0_1_s
L_c_t0_1:
  v_mfma_f32_16x16x32_bf16 v[168:171], a[208:211], v[56:59], v[168:171]
  v_mfma_f32_16x16x32_bf16 v[172:175], a[216:219], v[56:59], v[172:175]
L_ct_110:
  s_cbranch_execz L_ct_111
  global_load_dwordx4 v[120:123], v4, s[54:55] offset:0 sc1
  v_mfma_f32_16x16x32_bf16 v[176:179], a[208:211], v[60:63], v[176:179]
  v_mfma_f32_16x16x32_bf16 v[180:183], a[216:219], v[60:63], v[180:183]
  global_load_dwordx4 v[124:127], v4, s[54:55] offset:1024 sc1
  v_mfma_f32_16x16x32_bf16 v[168:171], a[212:215], v[64:67], v[168:171]
  v_mfma_f32_16x16x32_bf16 v[172:175], a[220:223], v[64:67], v[172:175]
  global_load_dwordx4 v[128:131], v4, s[54:55] offset:2048 sc1
  v_mfma_f32_16x16x32_bf16 v[176:179], a[212:215], v[68:71], v[176:179]
  v_mfma_f32_16x16x32_bf16 v[180:183], a[220:223], v[68:71], v[180:183]
  global_load_dwordx4 v[132:135], v4, s[54:55] offset:3072 sc1
  v_max3_u32 v1, v75, v79, v83
  v_max_u32 v1, v1, v87
  v_cmp_eq_u32 vcc, -1, v1
  s_cbranch_vccnz L_c_t0_2_s
L_c_t0_2:
L_ct_111:
  s_cbranch_execz L_ct_112
  v_mfma_f32_16x16x32_bf16 v[168:171], a[224:227], v[72:75], v[168:171]
  v_mfma_f32_16x16x32_bf16 v[172:175], a[232:235], v[72:75], v[172:175]
  global_load_dwordx4 v[136:139], v4, s[56:57] offset:0 sc1
  v_mfma_f32_16x16x32_bf16 v[176:179], a[224:227], v[76:79], v[176:179]
  v_mfma_f32_16x16x32_bf16 v[180:183], a[232:235], v[76:79], v[180:183]
  global_load_dwordx4 v[140:143], v4, s[56:57] offset:1024 sc1
  v_mfma_f32_16x16x32_bf16 v[168:171], a[228:231], v[80:83], v[168:171]
  v_mfma_f32_16x16x32_bf16 v[172:175], a[236:239], v[80:83], v[172:175]
  global_load_dwordx4 v[144:147], v4, s[56:57] offset:2048 sc1
  v_mfma_f32_16x16x32_bf16 v[176:179], a[228:231], v[84:87], v[176:179]
  v_mfma_f32_16x16x32_bf16 v[180:183], a[236:239], v[84:87], v[180:183]
  global_load_dwordx4 v[148:151], v4, s[56:57] offset:3072 sc1
  v_max3_u32 v1, v91, v95, v99
  v_max_u32 v1, v1, v103
L_ct_112:
  s_cbranch_execz L_ct_113
  v_cmp_eq_u32 vcc, -1, v1
  s_cbranch_vccnz L_c_t0_3_s
L_c_t0_3:
  v_mfma_f32_16x16x32_bf16 v[168:171], a[240:243], v[88:91], v[168:171]
  v_mfma_f32_16x16x32_bf16 v[172:175], a[248:251], v[88:91], v[172:175]
  global_load_dwordx4 v[152:155], v4, s[58:59] offset:0 sc1
  v_mfma_f32_16x16x32_bf16 v[176:179], a[240:243], v[92:95], v[176:179]
  v_mfma_f32_16x16x32_bf16 v[180:183], a[248:251], v[92:95], v[180:183]
  global_load_dwordx4 v[156:159], v4, s[58:59] offset:1024 sc1
  v_mfma_f32_16x16x32_bf16 v[168:171], a[244:247], v[96:99], v[168:171]
  v_mfma_f32_16x16x32_bf16 v[172:175], a[252:255], v[96:99], v[172:175]
  global_load_dwordx4 v[160:163], v4, s[58:59] offset:2048 sc1
  v_mfma_f32_16x16x32_bf16 v[176:179], a[244:247], v[100:103], v[176:179]
  v_mfma_f32_16x16x32_bf16 v[180:183], a[252:255], v[100:103], v[180:183]
L_ct_113:
  s_cbranch_execz L_ct_114
  global_load_dwordx4 v[164:167], v4, s[58:59] offset:3072 sc1
  s_mov_b64 exec, 0xffff
  global_load_dword v2, v10, s[60:61] sc1
  s_mov_b64 exec, -1
  s_nop 4
  ds_write_b128 v7, v[168:171] offset:32768
  ds_write_b128 v7, v[172:175] offset:33792
  ds_write_b128 v7, v[176:179] offset:34816
  ds_write_b128 v7, v[180:183] offset:35840
  s_waitcnt vmcnt(13)
  v_max3_u32 v1, v107, v111, v115
  v_max_u32 v1, v1, v119
  v_cmp_eq_u32 vcc, -1, v1
  s_cbranch_vccnz L_c_t1_0_s
L_c_t1_0:
L_ct_114:
  s_cbranch_execz L_ct_115
  v_mfma_f32_16x16x32_bf16 v[168:171], a[192:195], v[104:107], 0
  v_mfma_f32_16x16x32_bf16 v[172:175], a[200:203], v[104:107], 0
  v_mfma_f32_16x16x32_bf16 v[176:179], a[192:195], v[108:111], 0
  v_mfma_f32_16x16x32_bf16 v[180:183], a[200:203], v[108:111], 0
  v_mfma_f32_16x16x32_bf16 v[168:171], a[196:199], v[112:115], v[168:171]
  v_mfma_f32_16x16x32_bf16 v[172:175], a[204:207], v[112:115], v[172:175]
  v_mfma_f32_16x16x32_bf16 v[176:179], a[196:199], v[116:119], v[176:179]
  v_mfma_f32_16x16x32_bf16 v[180:183], a[204:207], v[116:119], v[180:183]
  s_waitcnt vmcnt(9)
  v_max3_u32 v1, v123, v127, v131
  v_max_u32 v1, v1, v135
  v_cmp_eq_u32 vcc, -1, v1
  s_cbranch_vccnz L_c_t1_1_s
L_c_t1_1:
L_ct_115:
  s_cbranch_execz L_ct_116
  v_mfma_f32_16x16x32_bf16 v[168:171], a[208:211], v[120:123], v[168:171]
  v_mfma_f32_16x16x32_bf16 v[172:175], a[216:219], v[120:123], v[172:175]
  v_mfma_f32_16x16x32_bf16 v[176:179], a[208:211], v[124:127], v[176:179]
  v_mfma_f32_16x16x32_bf16 v[180:183], a[216:219], v[124:127], v[180:183]
  v_mfma_f32_16x16x32_bf16 v[168:171], a[212:215], v[128:131], v[168:171]
  v_mfma_f32_16x16x32_bf16 v[172:175], a[220:223], v[128:131], v[172:175]
  v_mfma_f32_16x16x32_bf16 v[176:179], a[212:215], v[132:135], v[176:179]
  v_mfma_f32_16x16x32_bf16 v[180:183], a[220:223], v[132:135], v[180:183]
  s_waitcnt vmcnt(5)
  v_max3_u32 v1, v139, v143, v147
  v_max_u32 v1, v1, v151
  v_cmp_eq_u32 vcc, -1, v1
  s_cbranch_vccnz L_c_t1_2_s
L_c_t1_2:
L_ct_116:
  s_cbranch_execz L_ct_117
  v_mfma_f32_16x16x32_bf16 v[168:171], a[224:227], v[136:139], v[168:171]
  v_mfma_f32_16x16x32_bf16 v[172:175], a[232:235], v[136:139], v[172:175]
  v_mfma_f32_16x16x32_bf16 v[176:179], a[224:227], v[140:143], v[176:179]
  v_mfma_f32_16x16x32_bf16 v[180:183], a[232:235], v[140:143], v[180:183]
  v_mfma_f32_16x16x32_bf16 v[168:171], a[228:231], v[144:147], v[168:171]
  v_mfma_f32_16x16x32_bf16 v[172:175], a[236:239], v[144:147], v[172:175]
  v_mfma_f32_16x16x32_bf16 v[176:179], a[228:231], v[148:151], v[176:179]
  v_mfma_f32_16x16x32_bf16 v[180:183], a[236:239], v[148:151], v[180:183]
  s_waitcnt vmcnt(1)
  v_max3_u32 v1, v155, v159, v163
  v_max_u32 v1, v1, v167
  v_cmp_eq_u32 vcc, -1, v1
  s_cbranch_vccnz L_c_t1_3_s
L_c_t1_3:
L_ct_117:
  s_cbranch_execz L_ct_118
  v_mfma_f32_16x16x32_bf16 v[168:171], a[240:243], v[152:155], v[168:171]
  v_mfma_f32_16x16x32_bf16 v[172:175], a[248:251], v[152:155], v[172:175]
  v_mfma_f32_16x16x32_bf16 v[176:179], a[240:243], v[156:159], v[176:179]
  v_mfma_f32_16x16x32_bf16 v[180:183], a[248:251], v[156:159], v[180:183]
  v_mfma_f32_16x16x32_bf16 v[168:171], a[244:247], v[160:163], v[168:171]
  v_mfma_f32_16x16x32_bf16 v[172:175], a[252:255], v[160:163], v[172:175]
  v_mfma_f32_16x16x32_bf16 v[176:179], a[244:247], v[164:167], v[176:179]
  v_mfma_f32_16x16x32_bf16 v[180:183], a[252:255], v[164:167], v[180:183]
  s_nop 4
  ds_write_b128 v7, v[168:171] offset:49152
  ds_write_b128 v7, v[172:175] offset:50176
  ds_write_b128 v7, v[176:179] offset:51200
  ds_write_b128 v7, v[180:183] offset:52224
  s_waitcnt lgkmcnt(0)
L_ct_118:
  s_cbranch_execz L_ct_119
  s_barrier
  ds_read_b128 v[184:187], v8 offset:32768
  ds_read_b128 v[188:191], v8 offset:36864
  ds_read_b128 v[192:195], v8 offset:40960
  ds_read_b128 v[196:199], v8 offset:45056
  s_waitcnt lgkmcnt(0)
  v_pk_add_f32 v[184:185], v[184:185], v[188:189]
  v_pk_add_f32 v[192:193], v[192:193], v[196:197]
  v_pk_add_f32 v[186:187], v[186:187], v[190:191]
  v_pk_add_f32 v[194:195], v[194:195], v[198:199]
  v_pk_add_f32 v[200:201], v[184:185], v[192:193]
  v_pk_add_f32 v[202:203], v[186:187], v[194:195]
  ds_read_b128 v[184:187], v8 offset:49152
  ds_read_b128 v[188:191], v8 offset:53248
L_ct_119:
  s_cbranch_execz L_ct_120
  ds_read_b128 v[192:195], v8 offset:57344
  ds_read_b128 v[196:199], v8 offset:61440
  s_waitcnt lgkmcnt(0)
  v_pk_add_f32 v[184:185], v[184:185], v[188:189]
  v_pk_add_f32 v[192:193], v[192:193], v[196:197]
  v_pk_add_f32 v[186:187], v[186:187], v[190:191]
  v_pk_add_f32 v[194:195], v[194:195], v[198:199]
  v_pk_add_f32 v[204:205], v[184:185], v[192:193]
  v_pk_add_f32 v[206:207], v[186:187], v[194:195]
  s_barrier
L_c_tw2:
  s_waitcnt vmcnt(0)
  v_cmp_eq_u32 vcc, -1, v2
  s_cbranch_vccz L_c_tg2
L_ct_120:
  s_cbranch_execz L_ct_121
  s_mov_b64 exec, 0xffff
  global_load_dword v2, v10, s[60:61] sc1
  s_mov_b64 exec, -1
  s_sub_u32 s39, s39, 1
  s_cbranch_scc0 L_c_tw2
  s_endpgm
L_c_tg2:
  global_load_dwordx4 v[40:43], v4, s[60:61] offset:0 sc1
  global_load_dwordx4 v[44:47], v4, s[60:61] offset:1024 sc1
  global_load_dwordx4 v[48:51], v4, s[60:61] offset:2048 sc1
  global_load_dwordx4 v[52:55], v4, s[60:61] offset:3072 sc1
  global_load_dwordx4 v[56:59], v4, s[62:63] offset:0 sc1
  global_load_dwordx4 v[60:63], v4, s[62:63] offset:1024 sc1
  global_load_dwordx4 v[64:67], v4, s[62:63] offset:2048 sc1
L_ct_121:
  s_cbranch_execz L_ct_122
  global_load_dwordx4 v[68:71], v4, s[62:63] offset:3072 sc1
  s_waitcnt vmcnt(4)
  v_max3_u32 v1, v43, v47, v51
  v_max_u32 v1, v1, v55
  v_cmp_eq_u32 vcc, -1, v1
  s_cbranch_vccnz L_c_t2_0_s
L_c_t2_0:
  v_mfma_f32_16x16x32_bf16 v[168:171], a[192:195], v[40:43], 0
  v_mfma_f32_16x16x32_bf16 v[172:175], a[200:203], v[40:43], 0
  global_load_dwordx4 v[72:75], v4, s[64:65] offset:0 sc1
  v_mfma_f32_16x16x32_bf16 v[176:179], a[192:195], v[44:47], 0
  v_mfma_f32_16x16x32_bf16 v[180:183], a[200:203], v[44:47], 0
  global_load_dwordx4 v[76:79], v4, s[64:65] offset:1024 sc1
  v_mfma_f32_16x16x32_bf16 v[168:171], a[196:199], v[48:51], v[168:171]
L_ct_122:
  s_cbranch_execz L_ct_123
  v_mfma_f32_16x16x32_bf16 v[172:175], a[204:207], v[48:51], v[172:175]
  global_load_dwordx4 v[80:83], v4, s[64:65] offset:2048 sc1
  v_mfma_f32_16x16x32_bf16 v[176:179], a[196:199], v[52:55], v[176:179]
  v_mfma_f32_16x16x32_bf16 v[180:183], a[204:207], v[52:55], v[180:183]
  global_load_dwordx4 v[84:87], v4, s[64:65] offset:3072 sc1
  s_waitcnt vmcnt(4)
  v_max3_u32 v1, v59, v63, v67
  v_max_u32 v1, v1, v71
  v_cmp_eq_u32 vcc, -1, v1
  s_cbranch_vccnz L_c_t2_1_s
L_c_t2_1:
  v_mfma_f32_16x16x32_bf16 v[168:171], a[208:211], v[56:59], v[168:171]
  v_mfma_f32_16x16x32_bf16 v[172:175], a[216:219], v[56:59], v[172:175]
  global_load_dwordx4 v[88:91], v4, s[66:67] offset:0 sc1
L_ct_123:
  s_cbranch_execz L_ct_124
  v_mfma_f32_16x16x32_bf16 v[176:179], a[208:211], v[60:63], v[176:179]
  v_mfma_f32_16x16x32_bf16 v[180:183], a[216:219], v[60:63], v[180:183]
  global_load_dwordx4 v[92:95], v4, s[66:67] offset:1024 sc1
  v_mfma_f32_16x16x32_bf16 v[168:171], a[212:215], v[64:67], v[168:171]
  v_mfma_f32_16x16x32_bf16 v[172:175], a[220:223], v[64:67], v[172:175]
  global_load_dwordx4 v[96:99], v4, s[66:67] offset:2048 sc1
  v_mfma_f32_16x16x32_bf16 v[176:179], a[212:215], v[68:71], v[176:179]
  v_mfma_f32_16x16x32_bf16 v[180:183], a[220:223], v[68:71], v[180:183]
  global_load_dwordx4 v[100:103], v4, s[66:67] offset:3072 sc1
  s_waitcnt vmcnt(4)
  v_max3_u32 v1, v75, v79, v83
  v_max_u32 v1, v1, v87
  v_cmp_eq_u32 vcc, -1, v1
  s_cbranch_vccnz L_c_t2_2_s
L_c_t2_2:
L_ct_124:
  s_cbranch_execz L_ct_125
  v_mfma_f32_16x16x32_bf16 v[168:171], a[224:227], v[72:75], v[168:171]
  v_mfma_f32_16x16x32_bf16 v[172:175], a[232:235], v[72:75], v[172:175]
  v_mfma_f32_16x16x32_bf16 v[176:179], a[224:227], v[76:79], v[176:179]
  v_mfma_f32_16x16x32_bf16 v[180:183], a[232:235], v[76:79], v[180:183]
  v_mfma_f32_16x16x32_bf16 v[168:171], a[228:231], v[80:83], v[168:171]
  v_mfma_f32_16x16x32_bf16 v[172:175], a[236:239], v[80:83], v[172:175]
  v_mfma_f32_16x16x32_bf16 v[176:179], a[228:231], v[84:87], v[176:179]
  v_mfma_f32_16x16x32_bf16 v[180:183], a[236:239], v[84:87], v[180:183]
  s_waitcnt vmcnt(0)
  v_max3_u32 v1, v91, v95, v99
  v_max_u32 v1, v1, v103
  v_cmp_eq_u32 vcc, -1, v1
  s_cbranch_vccnz L_c_t2_3_s
L_c_t2_3:
L_ct_125:
  s_cbranch_execz L_ct_126
  v_mfma_f32_16x16x32_bf16 v[168:171], a[240:243], v[88:91], v[168:171]
  v_mfma_f32_16x16x32_bf16 v[172:175], a[248:251], v[88:91], v[172:175]
  global_store_dwordx4 v5, v[200:203], s[34:35] offset:0 sc1
  v_mfma_f32_16x16x32_bf16 v[176:179], a[240:243], v[92:95], v[176:179]
  v_mfma_f32_16x16x32_bf16 v[180:183], a[248:251], v[92:95], v[180:183]
  global_store_dwordx4 v5, v[204:207], s[34:35] offset:1024 sc1
  v_mfma_f32_16x16x32_bf16 v[168:171], a[244:247], v[96:99], v[168:171]
  v_mfma_f32_16x16x32_bf16 v[172:175], a[252:255], v[96:99], v[172:175]
  v_mfma_f32_16x16x32_bf16 v[176:179], a[244:247], v[100:103], v[176:179]
  v_mfma_f32_16x16x32_bf16 v[180:183], a[252:255], v[100:103], v[180:183]
  s_nop 4
  ds_write_b128 v7, v[168:171] offset:32768
  ds_write_b128 v7, v[172:175] offset:33792
  ds_write_b128 v7, v[176:179] offset:34816
L_ct_126:
  s_cbranch_execz L_ct_127
  ds_write_b128 v7, v[180:183] offset:35840
  s_waitcnt lgkmcnt(0)
  s_barrier
  ds_read_b128 v[184:187], v8 offset:32768
  ds_read_b128 v[188:191], v8 offset:36864
  ds_read_b128 v[192:195], v8 offset:40960
  ds_read_b128 v[196:199], v8 offset:45056
  s_waitcnt lgkmcnt(0)
  v_pk_add_f32 v[184:185], v[184:185], v[188:189]
  v_pk_add_f32 v[192:193], v[192:193], v[196:197]
  v_pk_add_f32 v[186:187], v[186:187], v[190:191]
  v_pk_add_f32 v[194:195], v[194:195], v[198:199]
  v_pk_add_f32 v[208:209], v[184:185], v[192:193]
  v_pk_add_f32 v[210:211], v[186:187], v[194:195]
L_ct_127:
  s_cbranch_execz L_ct_128
  s_cmp_eq_u32 s36, s37
  s_cbranch_scc1 L_c_town
  global_store_dwordx4 v5, v[208:211], s[34:35] offset:2048 sc1
  s_endpgm
L_c_town:
  v_add_u32 v11, 4096, v6
  v_add_u32 v12, 8192, v6
  v_add_u32 v13, 12288, v6
L_c_tp:
  global_load_dwordx4 v[40:43], v11, s[34:35] offset:0 sc1
  global_load_dwordx4 v[44:47], v12, s[34:35] offset:0 sc1
  global_load_dwordx4 v[48:51], v13, s[34:35] offset:0 sc1
  global_load_dwordx4 v[52:55], v11, s[34:35] offset:1024 sc1
  global_load_dwordx4 v[56:59], v12, s[34:35] offset:1024 sc1
L_ct_128:
  s_cbranch_execz L_ct_129
  global_load_dwordx4 v[60:63], v13, s[34:35] offset:1024 sc1
  s_sleep 2
  global_load_dwordx4 v[64:67], v11, s[34:35] offset:2048 sc1
  global_load_dwordx4 v[68:71], v12, s[34:35] offset:2048 sc1
  global_load_dwordx4 v[72:75], v13, s[34:35] offset:2048 sc1
  s_waitcnt vmcnt(0)
  v_pk_add_f32 v[168:169], v[200:201], v[40:41]
  v_pk_add_f32 v[44:45], v[44:45], v[48:49]
  v_pk_add_f32 v[170:171], v[202:203], v[42:43]
  v_pk_add_f32 v[46:47], v[46:47], v[50:51]
  v_pk_add_f32 v[168:169], v[168:169], v[44:45]
  v_pk_add_f32 v[170:171], v[170:171], v[46:47]
  v_pk_add_f32 v[172:173], v[204:205], v[52:53]
  v_pk_add_f32 v[56:57], v[56:57], v[60:61]
L_ct_129:
  s_cbranch_execz L_ct_130
  v_pk_add_f32 v[174:175], v[206:207], v[54:55]
  v_pk_add_f32 v[58:59], v[58:59], v[62:63]
  v_pk_add_f32 v[172:173], v[172:173], v[56:57]
  v_pk_add_f32 v[174:175], v[174:175], v[58:59]
  v_pk_add_f32 v[176:177], v[208:209], v[64:65]
  v_pk_add_f32 v[68:69], v[68:69], v[72:73]
  v_pk_add_f32 v[178:179], v[210:211], v[66:67]
  v_pk_add_f32 v[70:71], v[70:71], v[74:75]
  v_pk_add_f32 v[176:177], v[176:177], v[68:69]
  v_pk_add_f32 v[178:179], v[178:179], v[70:71]
  v_maximum3_f32 v1, v168, v169, v170
  v_maximum3_f32 v1, v1, v171, v172
  v_maximum3_f32 v1, v1, v173, v174
  v_maximum3_f32 v1, v1, v175, v176
L_ct_130:
  s_cbranch_execz L_ct_131
  v_maximum3_f32 v1, v1, v177, v178
  v_cmp_u_f32 vcc, v1, v179
  s_cbranch_vccz L_c_tdone
  s_sub_u32 s39, s39, 1
  s_cbranch_scc0 L_c_tp
  s_endpgm
L_c_tdone:
  v_cvt_pk_bf16_f32 v184, v168, v169
  v_cvt_pk_bf16_f32 v185, v170, v171
  s_add_u32 s44, s30, 0
  s_addc_u32 s45, s31, 0
  global_store_dwordx2 v9, v[184:185], s[44:45]
  v_cvt_pk_bf16_f32 v186, v172, v173
  v_cvt_pk_bf16_f32 v187, v174, v175
L_ct_131:
  s_cbranch_execz L_ct_132
  s_add_u32 s44, s30, 131072
  s_addc_u32 s45, s31, 0
  global_store_dwordx2 v9, v[186:187], s[44:45]
  v_cvt_pk_bf16_f32 v188, v176, v177
  v_cvt_pk_bf16_f32 v189, v178, v179
  s_add_u32 s44, s30, 262144
  s_addc_u32 s45, s31, 0
  global_store_dwordx2 v9, v[188:189], s[44:45]
  s_endpgm
L_c_t0_0_s:
  global_load_dwordx4 v[40:43], v4, s[44:45] offset:0 sc1
  global_load_dwordx4 v[44:47], v4, s[44:45] offset:1024 sc1
  global_load_dwordx4 v[48:51], v4, s[44:45] offset:2048 sc1
  global_load_dwordx4 v[52:55], v4, s[44:45] offset:3072 sc1
L_ct_132:
  s_cbranch_execz L_ct_133
  s_waitcnt vmcnt(0)
  v_max3_u32 v1, v43, v47, v51
  v_max_u32 v1, v1, v55
  v_cmp_eq_u32 vcc, -1, v1
  s_cbranch_vccz L_c_t0_0
  s_sub_u32 s39, s39, 1
  s_cbranch_scc0 L_c_t0_0_s
  s_endpgm
L_c_t0_1_s:
  global_load_dwordx4 v[56:59], v4, s[46:47] offset:0 sc1
  global_load_dwordx4 v[60:63], v4, s[46:47] offset:1024 sc1
  global_load_dwordx4 v[64:67], v4, s[46:47] offset:2048 sc1
  global_load_dwordx4 v[68:71], v4, s[46:47] offset:3072 sc1
  s_waitcnt vmcnt(0)
L_ct_133:
  s_cbranch_execz L_ct_134
  v_max3_u32 v1, v59, v63, v67
  v_max_u32 v1, v1, v71
  v_cmp_eq_u32 vcc, -1, v1
  s_cbranch_vccz L_c_t0_1
  s_sub_u32 s39, s39, 1
  s_cbranch_scc0 L_c_t0_1_s
  s_endpgm
L_c_t0_2_s:
  global_load_dwordx4 v[72:75], v4, s[48:49] offset:0 sc1
  global_load_dwordx4 v[76:79], v4, s[48:49] offset:1024 sc1
  global_load_dwordx4 v[80:83], v4, s[48:49] offset:2048 sc1
  global_load_dwordx4 v[84:87], v4, s[48:49] offset:3072 sc1
  s_waitcnt vmcnt(0)
  v_max3_u32 v1, v75, v79, v83
L_ct_134:
  s_cbranch_execz L_ct_135
  v_max_u32 v1, v1, v87
  v_cmp_eq_u32 vcc, -1, v1
  s_cbranch_vccz L_c_t0_2
  s_sub_u32 s39, s39, 1
  s_cbranch_scc0 L_c_t0_2_s
  s_endpgm
L_c_t0_3_s:
  global_load_dwordx4 v[88:91], v4, s[50:51] offset:0 sc1
  global_load_dwordx4 v[92:95], v4, s[50:51] offset:1024 sc1
  global_load_dwordx4 v[96:99], v4, s[50:51] offset:2048 sc1
  global_load_dwordx4 v[100:103], v4, s[50:51] offset:3072 sc1
  s_waitcnt vmcnt(0)
  v_max3_u32 v1, v91, v95, v99
  v_max_u32 v1, v1, v103
L_ct_135:
  s_cbranch_execz L_ct_136
  v_cmp_eq_u32 vcc, -1, v1
  s_cbranch_vccz L_c_t0_3
  s_sub_u32 s39, s39, 1
  s_cbranch_scc0 L_c_t0_3_s
  s_endpgm
L_c_t1_0_s:
  global_load_dwordx4 v[104:107], v4, s[52:53] offset:0 sc1
  global_load_dwordx4 v[108:111], v4, s[52:53] offset:1024 sc1
  global_load_dwordx4 v[112:115], v4, s[52:53] offset:2048 sc1
  global_load_dwordx4 v[116:119], v4, s[52:53] offset:3072 sc1
  s_waitcnt vmcnt(0)
  v_max3_u32 v1, v107, v111, v115
  v_max_u32 v1, v1, v119
  v_cmp_eq_u32 vcc, -1, v1
L_ct_136:
  s_cbranch_execz L_ct_137
  s_cbranch_vccz L_c_t1_0
  s_sub_u32 s39, s39, 1
  s_cbranch_scc0 L_c_t1_0_s
  s_endpgm
L_c_t1_1_s:
  global_load_dwordx4 v[120:123], v4, s[54:55] offset:0 sc1
  global_load_dwordx4 v[124:127], v4, s[54:55] offset:1024 sc1
  global_load_dwordx4 v[128:131], v4, s[54:55] offset:2048 sc1
  global_load_dwordx4 v[132:135], v4, s[54:55] offset:3072 sc1
  s_waitcnt vmcnt(0)
  v_max3_u32 v1, v123, v127, v131
  v_max_u32 v1, v1, v135
  v_cmp_eq_u32 vcc, -1, v1
  s_cbranch_vccz L_c_t1_1
L_ct_137:
  s_cbranch_execz L_ct_138
  s_sub_u32 s39, s39, 1
  s_cbranch_scc0 L_c_t1_1_s
  s_endpgm
L_c_t1_2_s:
  global_load_dwordx4 v[136:139], v4, s[56:57] offset:0 sc1
  global_load_dwordx4 v[140:143], v4, s[56:57] offset:1024 sc1
  global_load_dwordx4 v[144:147], v4, s[56:57] offset:2048 sc1
  global_load_dwordx4 v[148:151], v4, s[56:57] offset:3072 sc1
  s_waitcnt vmcnt(0)
  v_max3_u32 v1, v139, v143, v147
  v_max_u32 v1, v1, v151
  v_cmp_eq_u32 vcc, -1, v1
  s_cbranch_vccz L_c_t1_2
  s_sub_u32 s39, s39, 1
L_ct_138:
  s_cbranch_execz L_ct_139
  s_cbranch_scc0 L_c_t1_2_s
  s_endpgm
L_c_t1_3_s:
  global_load_dwordx4 v[152:155], v4, s[58:59] offset:0 sc1
  global_load_dwordx4 v[156:159], v4, s[58:59] offset:1024 sc1
  global_load_dwordx4 v[160:163], v4, s[58:59] offset:2048 sc1
  global_load_dwordx4 v[164:167], v4, s[58:59] offset:3072 sc1
  s_waitcnt vmcnt(0)
  v_max3_u32 v1, v155, v159, v163
  v_max_u32 v1, v1, v167
  v_cmp_eq_u32 vcc, -1, v1
  s_cbranch_vccz L_c_t1_3
  s_sub_u32 s39, s39, 1
  s_cbranch_scc0 L_c_t1_3_s
L_ct_139:
  s_cbranch_execz L_ct_140
  s_endpgm
L_c_t2_0_s:
  global_load_dwordx4 v[40:43], v4, s[60:61] offset:0 sc1
  global_load_dwordx4 v[44:47], v4, s[60:61] offset:1024 sc1
  global_load_dwordx4 v[48:51], v4, s[60:61] offset:2048 sc1
  global_load_dwordx4 v[52:55], v4, s[60:61] offset:3072 sc1
  s_waitcnt vmcnt(0)
  v_max3_u32 v1, v43, v47, v51
  v_max_u32 v1, v1, v55
  v_cmp_eq_u32 vcc, -1, v1
  s_cbranch_vccz L_c_t2_0
  s_sub_u32 s39, s39, 1
  s_cbranch_scc0 L_c_t2_0_s
  s_endpgm
L_c_t2_1_s:
L_ct_140:
  s_cbranch_execz L_ct_141
  global_load_dwordx4 v[56:59], v4, s[62:63] offset:0 sc1
  global_load_dwordx4 v[60:63], v4, s[62:63] offset:1024 sc1
  global_load_dwordx4 v[64:67], v4, s[62:63] offset:2048 sc1
  global_load_dwordx4 v[68:71], v4, s[62:63] offset:3072 sc1
  s_waitcnt vmcnt(0)
  v_max3_u32 v1, v59, v63, v67
  v_max_u32 v1, v1, v71
  v_cmp_eq_u32 vcc, -1, v1
  s_cbranch_vccz L_c_t2_1
  s_sub_u32 s39, s39, 1
  s_cbranch_scc0 L_c_t2_1_s
  s_endpgm
L_c_t2_2_s:
  global_load_dwordx4 v[72:75], v4, s[64:65] offset:0 sc1
L_ct_141:
  s_cbranch_execz L_ct_142
  global_load_dwordx4 v[76:79], v4, s[64:65] offset:1024 sc1
  global_load_dwordx4 v[80:83], v4, s[64:65] offset:2048 sc1
  global_load_dwordx4 v[84:87], v4, s[64:65] offset:3072 sc1
  s_waitcnt vmcnt(0)
  v_max3_u32 v1, v75, v79, v83
  v_max_u32 v1, v1, v87
  v_cmp_eq_u32 vcc, -1, v1
  s_cbranch_vccz L_c_t2_2
  s_sub_u32 s39, s39, 1
  s_cbranch_scc0 L_c_t2_2_s
  s_endpgm
L_c_t2_3_s:
  global_load_dwordx4 v[88:91], v4, s[66:67] offset:0 sc1
  global_load_dwordx4 v[92:95], v4, s[66:67] offset:1024 sc1
L_ct_142:
  s_cbranch_execz L_ct_143
  global_load_dwordx4 v[96:99], v4, s[66:67] offset:2048 sc1
  global_load_dwordx4 v[100:103], v4, s[66:67] offset:3072 sc1
  s_waitcnt vmcnt(0)
  v_max3_u32 v1, v91, v95, v99
  v_max_u32 v1, v1, v103
  v_cmp_eq_u32 vcc, -1, v1
  s_cbranch_vccz L_c_t2_3
  s_sub_u32 s39, s39, 1
  s_cbranch_scc0 L_c_t2_3_s
  s_endpgm
L_ct_143:
  s_mov_b64 exec, -1
  s_branch L_ct_done
  .fill (((16 - (. - L_0)) & 31) >> 2), 4, 0xbf800000
L_c_safe_step:
  s_nop 15
  s_nop 3
  global_load_dwordx4 v[40:43], v4, s[44:45] offset:0 sc1
  s_nop 7
  global_load_dwordx4 v[44:47], v4, s[44:45] offset:1024 sc1
  s_nop 7
  global_load_dwordx4 v[48:51], v4, s[44:45] offset:2048 sc1
  s_nop 7
  global_load_dwordx4 v[52:55], v4, s[44:45] offset:3072 sc1
  .fill (((4 - (. - L_0)) & 31) >> 2), 4, 0xbf800000
  s_waitcnt vmcnt(3)
  v_cmp_eq_u32 vcc, -1, v43
  s_cbranch_vccnz L_c_safe_A_f0123
  v_smfmac_f32_16x16x64_bf16 v[56:59], v[40:43], a[0:7], v3
  v_smfmac_f32_16x16x64_bf16 v[60:63], v[40:43], a[8:15], v3
  s_waitcnt vmcnt(2)
  v_cmp_eq_u32 vcc, -1, v47
  v_smfmac_f32_16x16x64_bf16 v[64:67], v[40:43], a[64:71], v3
  v_smfmac_f32_16x16x64_bf16 v[68:71], v[40:43], a[72:79], v3
  s_cbranch_vccnz L_c_safe_A_f123
  v_smfmac_f32_16x16x64_bf16 v[56:59], v[44:47], a[16:23], v3
  v_smfmac_f32_16x16x64_bf16 v[60:63], v[44:47], a[24:31], v3
  s_waitcnt vmcnt(1)
  v_cmp_eq_u32 vcc, -1, v51
  v_smfmac_f32_16x16x64_bf16 v[64:67], v[44:47], a[80:87], v3
  v_smfmac_f32_16x16x64_bf16 v[68:71], v[44:47], a[88:95], v3
  s_cbranch_vccnz L_c_safe_A_f23
  v_smfmac_f32_16x16x64_bf16 v[56:59], v[48:51], a[32:39], v3
  v_smfmac_f32_16x16x64_bf16 v[60:63], v[48:51], a[40:47], v3
  s_waitcnt vmcnt(0)
  v_cmp_eq_u32 vcc, -1, v55
  v_smfmac_f32_16x16x64_bf16 v[64:67], v[48:51], a[96:103], v3
  v_smfmac_f32_16x16x64_bf16 v[68:71], v[48:51], a[104:111], v3
  s_cbranch_vccnz L_c_safe_A_f3
  v_smfmac_f32_16x16x64_bf16 v[56:59], v[52:55], a[48:55], v3
  v_smfmac_f32_16x16x64_bf16 v[60:63], v[52:55], a[56:63], v3
  v_smfmac_f32_16x16x64_bf16 v[64:67], v[52:55], a[112:119], v3
  v_smfmac_f32_16x16x64_bf16 v[68:71], v[52:55], a[120:127], v3
L_c_safe_A_done:
  s_cmp_eq_u32 s36, 0
  s_nop 3
  v_pk_add_f32 v[56:57], v[56:57], v[58:59]
  ds_write2_b32 v19, v56, v57 offset0:0 offset1:16
  v_pk_add_f32 v[60:61], v[60:61], v[62:63]
  ds_write2_b32 v20, v60, v61 offset0:0 offset1:16
  v_pk_add_f32 v[64:65], v[64:65], v[66:67]
  ds_write2_b32 v19, v64, v65 offset0:32 offset1:48
  v_pk_add_f32 v[68:69], v[68:69], v[70:71]
  ds_write2_b32 v20, v68, v69 offset0:32 offset1:48
  s_barrier
  s_cbranch_scc0 L_c_safe_helper
L_c_safe_B2:
  ds_read_b128 v[88:91], v21 offset:0
  ds_read_b128 v[92:95], v21 offset:1152
  ds_read_b128 v[96:99], v21 offset:2304
  ds_read_b128 v[100:103], v21 offset:3456
  ds_read_b128 v[104:107], v21 offset:4608
  ds_read_b128 v[108:111], v21 offset:5760
  ds_read_b128 v[112:115], v21 offset:6912
  ds_read_b128 v[116:119], v21 offset:8064
  s_cmp_eq_u32 s58, s79
  s_waitcnt lgkmcnt(4)
  v_pk_add_f32 v[88:89], v[88:89], v[96:97]
  v_pk_add_f32 v[90:91], v[90:91], v[98:99]
  v_pk_add_f32 v[92:93], v[92:93], v[100:101]
  v_pk_add_f32 v[94:95], v[94:95], v[102:103]
  s_waitcnt lgkmcnt(2)
  v_pk_add_f32 v[88:89], v[88:89], v[104:105]
  v_pk_add_f32 v[90:91], v[90:91], v[106:107]
  v_pk_add_f32 v[92:93], v[92:93], v[108:109]
  v_pk_add_f32 v[94:95], v[94:95], v[110:111]
  s_waitcnt lgkmcnt(1)
  v_pk_add_f32 v[88:89], v[88:89], v[112:113]
  v_pk_add_f32 v[90:91], v[90:91], v[114:115]
  v_cvt_pk_bf16_f32 v120, v88, v89
  v_cvt_pk_bf16_f32 v121, v90, v91
  s_waitcnt lgkmcnt(0)
  v_pk_add_f32 v[92:93], v[92:93], v[116:117]
  v_pk_add_f32 v[94:95], v[94:95], v[118:119]
  v_cvt_pk_bf16_f32 v122, v92, v93
  v_cvt_pk_bf16_f32 v123, v94, v95
  s_cbranch_scc1 L_c_safe_last
L_c_safe_Bret:
  s_nop 0
  v_mfma_f32_16x16x32_bf16 v[148:151], v[124:127], v[120:123], 0
  v_mfma_f32_16x16x32_bf16 v[152:155], v[128:131], v[120:123], 0
  v_mfma_f32_16x16x32_bf16 v[156:159], v[120:123], v[120:123], 0
  s_mov_b64 exec, s[66:67]
  s_nop 4
  global_store_dwordx4 v8, v[148:151], s[44:45] sc1
  global_store_dwordx4 v8, v[152:155], s[44:45] offset:128 sc1
  s_mov_b64 exec, s[62:63]
  global_store_dwordx4 v12, v[156:159], s[44:45] offset:1024 sc1
  s_mov_b64 exec, -1
  v_cmp_u_f32 vcc, v156, v156
  v_mov_b32_dpp v148, v152 row_shr:8 row_mask:0xf bank_mask:0xc
  v_mov_b32_dpp v149, v153 row_shr:8 row_mask:0xf bank_mask:0xc
  v_mov_b32_dpp v150, v154 row_shr:8 row_mask:0xf bank_mask:0xc
  v_mov_b32_dpp v151, v155 row_shr:8 row_mask:0xf bank_mask:0xc
  s_cbranch_vccnz L_c_safe_Bredo
  v_smfmac_f32_16x16x64_bf16 v[72:75], v[40:43], a[128:135], v3
  v_smfmac_f32_16x16x64_bf16 v[76:79], v[40:43], a[136:143], v3
  v_smfmac_f32_16x16x64_bf16 v[72:75], v[44:47], a[144:151], v3
  v_smfmac_f32_16x16x64_bf16 v[76:79], v[44:47], a[152:159], v3
  v_smfmac_f32_16x16x64_bf16 v[72:75], v[48:51], a[160:167], v3
  v_smfmac_f32_16x16x64_bf16 v[76:79], v[48:51], a[168:175], v3
  v_smfmac_f32_16x16x64_bf16 v[72:75], v[52:55], a[176:183], v3
  v_smfmac_f32_16x16x64_bf16 v[76:79], v[52:55], a[184:191], v3
  global_load_dword v176, v13, s[44:45] offset:1024 sc1
  global_load_dword v177, v13, s[44:45] offset:3072 sc1
  global_load_dword v178, v14, s[44:45] offset:1024 sc1
  global_load_dword v179, v14, s[44:45] offset:3072 sc1
  global_load_dwordx4 v[164:167], v9, s[44:45] sc1
  global_load_dwordx4 v[168:171], v10, s[44:45] sc1
  global_load_dwordx4 v[172:175], v11, s[44:45] sc1
  s_barrier
  ds_read_b128 v[92:95], v22 offset:17408
  ds_read_b128 v[96:99], v22 offset:18432
  ds_read_b128 v[100:103], v22 offset:19456
  v_mov_b64 v[132:133], v[212:213]
  v_mov_b64 v[136:137], v[214:215]
  v_mov_b64 v[140:141], v[216:217]
  v_mov_b64 v[144:145], v[218:219]
  v_pk_add_f32 v[72:73], v[72:73], v[74:75]
  v_pk_add_f32 v[74:75], v[76:77], v[78:79]
  s_waitcnt lgkmcnt(0)
  v_pk_add_f32 v[88:89], v[72:73], v[92:93]
  v_pk_add_f32 v[90:91], v[74:75], v[94:95]
  v_pk_add_f32 v[76:77], v[96:97], v[100:101]
  v_pk_add_f32 v[78:79], v[98:99], v[102:103]
  v_pk_add_f32 v[76:77], v[76:77], v[88:89]
  v_pk_add_f32 v[78:79], v[78:79], v[90:91]
  v_cvt_pk_bf16_f32 v134, v76, v77
  v_cvt_pk_bf16_f32 v138, v77, v76
  v_cvt_pk_bf16_f32 v142, v78, v79
  v_cvt_pk_bf16_f32 v146, v79, v78
  global_load_dword v176, v13, s[44:45] offset:1024 sc1
  global_load_dword v177, v13, s[44:45] offset:3072 sc1
  global_load_dword v178, v14, s[44:45] offset:1024 sc1
  global_load_dword v179, v14, s[44:45] offset:3072 sc1
  global_load_dwordx4 v[164:167], v9, s[44:45] sc1
  global_load_dwordx4 v[168:171], v10, s[44:45] sc1
  global_load_dwordx4 v[172:175], v11, s[44:45] sc1
  .fill (((20 - (. - L_0)) & 31) >> 2), 4, 0xbf800000
L_c_safe_Schk:
  s_waitcnt vmcnt(10)
  v_pk_add_f32 v[108:109], v[176:177], v[178:179]
  v_add_f32 v108, v108, v109
  s_waitcnt vmcnt(9)
  v_pk_add_f32 v[104:105], v[148:149], v[164:165]
  v_pk_add_f32 v[106:107], v[150:151], v[166:167]
  s_waitcnt vmcnt(8)
  v_pk_add_f32 v[104:105], v[104:105], v[168:169]
  v_pk_add_f32 v[106:107], v[106:107], v[170:171]
  s_waitcnt vmcnt(7)
  v_pk_add_f32 v[104:105], v[104:105], v[172:173]
  v_pk_add_f32 v[106:107], v[106:107], v[174:175]
  v_maximum3_f32 v204, v104, v105, v108
  v_maximum3_f32 v204, v204, v106, v107
  v_cmp_u_f32 vcc, v204, v204
  v_mul_f32 v116, s64, v108
  v_max_f32_dpp v204, v204, v204 row_ror:8 row_mask:0xf bank_mask:0xf
  v_mov_b32 v206, v204
  v_pk_mul_f32 v[112:113], v[104:105], s[64:65] op_sel_hi:[1,0]
  v_pk_mul_f32 v[114:115], v[106:107], s[64:65] op_sel_hi:[1,0]
  v_permlane16_swap_b32 v206, v204
  v_max_f32 v204, v204, v206
  v_mov_b32 v206, v204
  s_cbranch_vccnz L_c_safe_Sret
  s_nop 0
  v_permlane32_swap_b32 v206, v204
  v_max_f32 v204, v204, v206
  v_fma_f32 v116, -v204, s64, v116
  v_pk_fma_f32 v[112:113], v[204:205], s[64:65], v[112:113] op_sel_hi:[0,0,1] neg_lo:[1,0,0] neg_hi:[1,0,0]
  v_exp_f32 v116, v116
  v_pk_fma_f32 v[114:115], v[204:205], s[64:65], v[114:115] op_sel_hi:[0,0,1] neg_lo:[1,0,0] neg_hi:[1,0,0]
  v_exp_f32 v112, v112
  v_exp_f32 v113, v113
  v_exp_f32 v114, v114
  v_exp_f32 v115, v115
  v_cvt_pk_bf16_f32 v182, v116, v183
  v_cvt_pk_bf16_f32 v180, v112, v113
  v_cvt_pk_bf16_f32 v181, v114, v115
  v_mov_b32_dpp v186, v182 row_ror:8 row_mask:0xf bank_mask:0xf
  v_mov_b32_dpp v184, v180 row_ror:8 row_mask:0xf bank_mask:0xf
  v_mfma_f32_16x16x32_bf16 v[156:159], v[160:163], v[180:183], 0
  v_mov_b32_dpp v185, v181 row_ror:8 row_mask:0xf bank_mask:0xf
  v_mfma_f32_16x16x32_bf16 v[148:151], v[132:135], v[180:183], 0
  v_mfma_f32_16x16x32_bf16 v[152:155], v[140:143], v[180:183], 0
  v_mfma_f32_16x16x32_bf16 v[148:151], v[136:139], v[184:187], v[148:151]
  v_mfma_f32_16x16x32_bf16 v[152:155], v[144:147], v[184:187], v[152:155]
  s_nop 2
  v_add_f32_dpp v206, v156, v156 row_ror:8 row_mask:0xf bank_mask:0xf
  v_rcp_f32 v206, v206
  s_mov_b64 exec, s[66:67]
  s_nop 0
  v_pk_mul_f32 v[148:149], v[148:149], v[206:207] op_sel_hi:[1,0]
  v_pk_mul_f32 v[154:155], v[154:155], v[206:207] op_sel_hi:[1,0]
  v_pk_mul_f32 v[150:151], v[150:151], v[206:207] op_sel_hi:[1,0]
  v_pk_mul_f32 v[152:153], v[152:153], v[206:207] op_sel_hi:[1,0]
  v_cvt_pk_bf16_f32 v211, v154, v155
  v_cvt_pk_bf16_f32 v208, v148, v149
  v_cvt_pk_bf16_f32 v209, v150, v151
  v_cvt_pk_bf16_f32 v210, v152, v153
  v_max_i32 v211, s77, v211
  global_store_dwordx4 v6, v[208:211], s[44:45] sc1
  s_mov_b64 exec, -1
  s_nop 15
  s_nop 15
  s_nop 3
  s_barrier
  global_load_dwordx4 v[40:43], v29, s[44:45] offset:0 sc1
  s_nop 7
  global_load_dwordx4 v[44:47], v29, s[44:45] offset:1024 sc1
  s_nop 7
  global_load_dwordx4 v[48:51], v29, s[44:45] offset:2048 sc1
  s_nop 7
  global_load_dwordx4 v[52:55], v29, s[44:45] offset:3072 sc1
  .fill (((12 - (. - L_0)) & 31) >> 2), 4, 0xbf800000
  s_waitcnt vmcnt(3)
  v_smfmac_f32_16x16x64_bf16 v[80:83], v[40:43], a[192:199], v3
  v_cmp_gt_i32 vcc, s77, v43
  v_smfmac_f32_16x16x64_bf16 v[84:87], v[40:43], a[200:207], v3
  s_cbranch_vccnz L_c_safe_E0_f0123
  s_waitcnt vmcnt(2)
  v_smfmac_f32_16x16x64_bf16 v[80:83], v[44:47], a[208:215], v3
  v_cmp_gt_i32 vcc, s77, v47
  v_smfmac_f32_16x16x64_bf16 v[84:87], v[44:47], a[216:223], v3
  s_cbranch_vccnz L_c_safe_E0_f123
  s_waitcnt vmcnt(1)
  v_smfmac_f32_16x16x64_bf16 v[80:83], v[48:51], a[224:231], v3
  v_cmp_gt_i32 vcc, s77, v51
  v_smfmac_f32_16x16x64_bf16 v[84:87], v[48:51], a[232:239], v3
  s_cbranch_vccnz L_c_safe_E0_f23
  s_waitcnt vmcnt(0)
  v_smfmac_f32_16x16x64_bf16 v[80:83], v[52:55], a[240:247], v3
  v_cmp_gt_i32 vcc, s77, v55
  v_smfmac_f32_16x16x64_bf16 v[84:87], v[52:55], a[248:255], v3
  s_nop 5
  s_cbranch_vccnz L_c_safe_E0_f3
L_c_safe_E0_done:
  s_add_u32 s54, s54, 262144
  s_addc_u32 s55, s55, 0
  global_load_dwordx4 v[124:127], v24, s[54:55] offset:0 sc1
  global_load_dwordx4 v[128:131], v24, s[54:55] offset:1024 sc1
  global_load_dwordx4 v[212:215], v25, s[54:55] offset:0 sc1
  global_load_dwordx4 v[216:219], v25, s[54:55] offset:1024 sc1
  v_pk_add_f32 v[80:81], v[80:81], v[82:83]
  v_pk_add_f32 v[82:83], v[84:85], v[86:87]
  .fill (((8 - (. - L_0)) & 31) >> 2), 4, 0xbf800000
  s_barrier
L_c_safe_F2:
  ds_read_b128 v[92:95], v22 offset:25600
  ds_read_b128 v[96:99], v22 offset:26624
  ds_read_b128 v[100:103], v22 offset:27648
  s_waitcnt lgkmcnt(2)
  v_pk_add_f32 v[188:189], v[80:81], v[92:93]
  v_pk_add_f32 v[190:191], v[82:83], v[94:95]
  s_waitcnt lgkmcnt(1)
  v_pk_add_f32 v[188:189], v[188:189], v[96:97]
  v_pk_add_f32 v[190:191], v[190:191], v[98:99]
  s_waitcnt lgkmcnt(0)
  v_pk_add_f32 v[188:189], v[188:189], v[100:101]
  v_pk_add_f32 v[190:191], v[190:191], v[102:103]
  global_store_dwordx4 v15, v[188:191], s[48:49] sc1
  v_maximum3_f32 v1, v188, v189, v190
  v_cmp_u_f32 vcc, v1, v191
  s_cbranch_vccnz L_c_safe_Fredo
  v_mov_b32 v56, 0
  v_mov_b32 v57, 0
  v_mov_b32 v58, 0
  v_mov_b32 v59, 0
  v_mov_b32 v60, 0
  v_mov_b32 v61, 0
  v_mov_b32 v62, 0
  v_mov_b32 v63, 0
  v_mov_b32 v64, 0
  v_mov_b32 v65, 0
  v_mov_b32 v66, 0
  v_mov_b32 v67, 0
  v_mov_b32 v68, 0
  v_mov_b32 v69, 0
  v_mov_b32 v70, 0
  v_mov_b32 v71, 0
  v_mov_b32 v72, 0
  v_mov_b32 v73, 0
  v_mov_b32 v74, 0
  v_mov_b32 v75, 0
  v_mov_b32 v76, 0
  v_mov_b32 v77, 0
  v_mov_b32 v78, 0
  v_mov_b32 v79, 0
  v_mov_b32 v80, 0
  v_mov_b32 v81, 0
  v_mov_b32 v82, 0
  v_mov_b32 v83, 0
  v_mov_b32 v84, 0
  v_mov_b32 v85, 0
  v_mov_b32 v86, 0
  v_mov_b32 v87, 0
  s_add_u32 s58, s58, 1
  s_mov_b64 s[40:41], s[44:45]
  s_mov_b64 s[44:45], s[46:47]
  s_mov_b64 s[46:47], s[40:41]
  s_nop 15
  s_nop 15
  s_nop 1
  global_load_dwordx4 v[192:195], v16, s[48:49] sc1
  global_load_dwordx4 v[196:199], v17, s[48:49] sc1
  global_load_dwordx4 v[200:203], v18, s[48:49] sc1
  s_mov_b64 exec, s[68:69]
  global_store_dwordx4 v26, v[120:123], s[56:57] sc1
  s_mov_b64 exec, -1
  global_store_dword v27, v134, s[56:57] offset:512 sc1
  global_store_dword v27, v142, s[56:57] offset:768 sc1
  global_store_dwordx4 v15, v[36:39], s[50:51] sc1
  s_add_u32 s56, s56, 131072
  s_addc_u32 s57, s57, 0
  s_mov_b64 s[70:71], s[48:49]
  s_and_b32 s40, s58, 3
  s_lshl_b32 s40, s40, 18
  s_add_u32 s48, s52, s40
  s_addc_u32 s49, s53, 0
  s_xor_b32 s40, s40, 0x80000
  s_add_u32 s50, s52, s40
  s_addc_u32 s51, s53, 0
  .fill (((0 - (. - L_0)) & 31) >> 2), 4, 0xbf800000
  s_waitcnt vmcnt(6)
  v_pk_add_f32 v[88:89], v[188:189], v[192:193]
  v_pk_add_f32 v[90:91], v[190:191], v[194:195]
  s_waitcnt vmcnt(4)
  v_max3_u32 v1, v195, v199, v203
  v_cmp_eq_u32 vcc, -1, v1
  v_pk_add_f32 v[96:97], v[196:197], v[200:201]
  v_pk_add_f32 v[98:99], v[198:199], v[202:203]
  v_pk_add_f32 v[96:97], v[96:97], v[88:89]
  v_pk_add_f32 v[98:99], v[98:99], v[90:91]
  v_cvt_pk_bf16_f32 v208, v96, v98
  v_cvt_pk_bf16_f32 v209, v97, v99
  s_cbranch_vccnz L_c_safe_Gret
  global_store_dword v5, v208, s[44:45] sc1
  global_store_dword v5, v209, s[44:45] offset:16 sc1
  s_barrier
  s_branch L_c_safe_step
  .fill (((0 - (. - L_0)) & 31) >> 2), 4, 0xbf800000
L_c_safe_helper:
  s_cmp_eq_u32 s36, 1
  s_cbranch_scc0 L_c_safe_h1
  global_store_dwordx4 v7, v[32:35], s[46:47] sc1
  global_store_dwordx4 v8, v[36:39], s[46:47] sc1
  s_mov_b64 exec, 0xffff
  global_store_dwordx4 v8, v[36:39], s[46:47] offset:1024 sc1
  s_mov_b64 exec, -1
L_c_safe_h1:
  s_nop 15
  s_nop 15
  s_nop 3
  v_smfmac_f32_16x16x64_bf16 v[72:75], v[40:43], a[128:135], v3
  v_smfmac_f32_16x16x64_bf16 v[76:79], v[40:43], a[136:143], v3
  v_smfmac_f32_16x16x64_bf16 v[72:75], v[44:47], a[144:151], v3
  v_smfmac_f32_16x16x64_bf16 v[76:79], v[44:47], a[152:159], v3
  v_smfmac_f32_16x16x64_bf16 v[72:75], v[48:51], a[160:167], v3
  v_smfmac_f32_16x16x64_bf16 v[76:79], v[48:51], a[168:175], v3
  v_smfmac_f32_16x16x64_bf16 v[72:75], v[52:55], a[176:183], v3
  v_smfmac_f32_16x16x64_bf16 v[76:79], v[52:55], a[184:191], v3
  s_nop 7
  v_pk_add_f32 v[72:73], v[72:73], v[74:75]
  v_pk_add_f32 v[74:75], v[76:77], v[78:79]
  ds_write_b128 v22, v[72:75] offset:16384
  ds_write_b128 v22, v[36:39] offset:24576
  s_cmp_eq_u32 s36, 1
  s_waitcnt vmcnt(0) lgkmcnt(0)
  s_barrier
  s_cbranch_scc0 L_c_safe_h2
  s_min_u32 s40, s58, 1
  s_atomic_add s40, s[34:35], s60
  s_cmp_eq_u32 s58, 63
  s_cbranch_scc0 L_c_safe_join
  s_branch L_c_safe_hend
L_c_safe_h2:
  s_cmp_eq_u32 s58, 63
  s_cbranch_scc1 L_c_safe_hend
  s_add_u32 s42, s58, 2
  s_min_u32 s42, s42, 64
L_kv_7:
  s_cmp_ge_u32 s59, s42
  s_cbranch_scc1 L_kvd_8
  s_load_dword s59, s[34:35], s60 glc
  s_waitcnt lgkmcnt(0)
  s_sub_u32 s39, s39, 1
  s_cbranch_scc0 L_kv_7
  s_endpgm
L_kvd_8:
  .fill (((16 - (. - L_0)) & 31) >> 2), 4, 0xbf800000
L_c_safe_join:
  s_barrier
  global_load_dwordx4 v[40:43], v29, s[44:45] offset:0 sc1
  s_nop 7
  global_load_dwordx4 v[44:47], v29, s[44:45] offset:1024 sc1
  s_nop 7
  global_load_dwordx4 v[48:51], v29, s[44:45] offset:2048 sc1
  s_nop 7
  global_load_dwordx4 v[52:55], v29, s[44:45] offset:3072 sc1
  .fill (((12 - (. - L_0)) & 31) >> 2), 4, 0xbf800000
  s_waitcnt vmcnt(3)
  v_smfmac_f32_16x16x64_bf16 v[80:83], v[40:43], a[192:199], v3
  v_cmp_gt_i32 vcc, s77, v43
  v_smfmac_f32_16x16x64_bf16 v[84:87], v[40:43], a[200:207], v3
  s_cbranch_vccnz L_c_safe_EH_f0123
  s_waitcnt vmcnt(2)
  v_smfmac_f32_16x16x64_bf16 v[80:83], v[44:47], a[208:215], v3
  v_cmp_gt_i32 vcc, s77, v47
  v_smfmac_f32_16x16x64_bf16 v[84:87], v[44:47], a[216:223], v3
  s_cbranch_vccnz L_c_safe_EH_f123
  s_waitcnt vmcnt(1)
  v_smfmac_f32_16x16x64_bf16 v[80:83], v[48:51], a[224:231], v3
  v_cmp_gt_i32 vcc, s77, v51
  v_smfmac_f32_16x16x64_bf16 v[84:87], v[48:51], a[232:239], v3
  s_cbranch_vccnz L_c_safe_EH_f23
  s_waitcnt vmcnt(0)
  v_smfmac_f32_16x16x64_bf16 v[80:83], v[52:55], a[240:247], v3
  v_cmp_gt_i32 vcc, s77, v55
  v_smfmac_f32_16x16x64_bf16 v[84:87], v[52:55], a[248:255], v3
  s_nop 5
  s_cbranch_vccnz L_c_safe_EH_f3
L_c_safe_EH_done:
  v_pk_add_f32 v[80:81], v[80:81], v[82:83]
  v_pk_add_f32 v[82:83], v[84:85], v[86:87]
  ds_write_b128 v22, v[80:83] offset:24576
  s_barrier
  s_nop 15
  s_nop 7
  ds_write2_b32 v19, v36, v36 offset0:0 offset1:16
  ds_write2_b32 v20, v36, v36 offset0:0 offset1:16
  ds_write2_b32 v19, v36, v36 offset0:32 offset1:48
  ds_write2_b32 v20, v36, v36 offset0:32 offset1:48
  s_waitcnt lgkmcnt(0)
  v_mov_b32 v56, 0
  v_mov_b32 v57, 0
  v_mov_b32 v58, 0
  v_mov_b32 v59, 0
  v_mov_b32 v60, 0
  v_mov_b32 v61, 0
  v_mov_b32 v62, 0
  v_mov_b32 v63, 0
  v_mov_b32 v64, 0
  v_mov_b32 v65, 0
  v_mov_b32 v66, 0
  v_mov_b32 v67, 0
  v_mov_b32 v68, 0
  v_mov_b32 v69, 0
  v_mov_b32 v70, 0
  v_mov_b32 v71, 0
  v_mov_b32 v72, 0
  v_mov_b32 v73, 0
  v_mov_b32 v74, 0
  v_mov_b32 v75, 0
  v_mov_b32 v76, 0
  v_mov_b32 v77, 0
  v_mov_b32 v78, 0
  v_mov_b32 v79, 0
  v_mov_b32 v80, 0
  v_mov_b32 v81, 0
  v_mov_b32 v82, 0
  v_mov_b32 v83, 0
  v_mov_b32 v84, 0
  v_mov_b32 v85, 0
  v_mov_b32 v86, 0
  v_mov_b32 v87, 0
  s_add_u32 s58, s58, 1
  s_mov_b64 s[40:41], s[44:45]
  s_mov_b64 s[44:45], s[46:47]
  s_mov_b64 s[46:47], s[40:41]
  s_add_u32 s54, s54, 262144
  s_addc_u32 s55, s55, 0
  s_cmp_lt_u32 s59, 64
  s_cbranch_scc0 L_c_safe_asy
  s_load_dword s59, s[34:35], s60 glc
L_c_safe_asy:
  s_barrier
  s_branch L_c_safe_step
L_c_safe_hend:
  s_branch L_c_tail
L_c_safe_last:
  s_cmp_eq_u32 s58, 0
  s_cbranch_scc0 L_c_safe_last2
  s_mov_b32 s79, 63
  s_sub_u32 s42, s60, 8
L_c_safe_first:
  s_load_dwordx2 s[40:41], s[34:35], s42 glc
  s_waitcnt lgkmcnt(0)
  s_min_u32 s40, s40, s41
  s_cmp_ge_u32 s40, 1
  s_cbranch_scc1 L_c_safe_first2
  s_sub_u32 s39, s39, 1
  s_cbranch_scc0 L_c_safe_first
  s_endpgm
L_c_safe_first2:
  global_load_dwordx4 v[124:127], v24, s[54:55] offset:0 sc1
  global_load_dwordx4 v[128:131], v24, s[54:55] offset:1024 sc1
  global_load_dwordx4 v[212:215], v25, s[54:55] offset:0 sc1
  global_load_dwordx4 v[216:219], v25, s[54:55] offset:1024 sc1
  s_waitcnt vmcnt(0)
  s_branch L_c_safe_Bret
L_c_safe_last2:
  v_maximum3_f32 v1, v88, v89, v90
  v_maximum3_f32 v1, v1, v91, v92
  v_maximum3_f32 v1, v1, v93, v94
  v_cmp_u_f32 vcc, v1, v95
  s_cbranch_vccnz L_c_safe_Bredo
  v_smfmac_f32_16x16x64_bf16 v[72:75], v[40:43], a[128:135], v3
  v_smfmac_f32_16x16x64_bf16 v[76:79], v[40:43], a[136:143], v3
  v_smfmac_f32_16x16x64_bf16 v[72:75], v[44:47], a[144:151], v3
  v_smfmac_f32_16x16x64_bf16 v[76:79], v[44:47], a[152:159], v3
  v_smfmac_f32_16x16x64_bf16 v[72:75], v[48:51], a[160:167], v3
  v_smfmac_f32_16x16x64_bf16 v[76:79], v[48:51], a[168:175], v3
  v_smfmac_f32_16x16x64_bf16 v[72:75], v[52:55], a[176:183], v3
  v_smfmac_f32_16x16x64_bf16 v[76:79], v[52:55], a[184:191], v3
  s_barrier
  ds_read_b128 v[92:95], v22 offset:17408
  ds_read_b128 v[96:99], v22 offset:18432
  ds_read_b128 v[100:103], v22 offset:19456
  s_nop 3
  v_pk_add_f32 v[72:73], v[72:73], v[74:75]
  v_pk_add_f32 v[74:75], v[76:77], v[78:79]
  s_waitcnt lgkmcnt(0)
  v_pk_add_f32 v[88:89], v[72:73], v[92:93]
  v_pk_add_f32 v[90:91], v[74:75], v[94:95]
  v_pk_add_f32 v[76:77], v[96:97], v[100:101]
  v_pk_add_f32 v[78:79], v[98:99], v[102:103]
  v_pk_add_f32 v[76:77], v[76:77], v[88:89]
  v_pk_add_f32 v[78:79], v[78:79], v[90:91]
  v_cvt_pk_bf16_f32 v134, v76, v77
  v_cvt_pk_bf16_f32 v138, v77, v76
  v_cvt_pk_bf16_f32 v142, v78, v79
  v_cvt_pk_bf16_f32 v146, v79, v78
  s_mov_b64 exec, s[68:69]
  global_store_dwordx4 v26, v[120:123], s[56:57] sc1
  s_mov_b64 exec, -1
  global_store_dword v27, v134, s[56:57] offset:512 sc1
  global_store_dword v27, v142, s[56:57] offset:768 sc1
  s_branch L_c_tail
  .fill (((0 - (. - L_0)) & 31) >> 2), 4, 0xbf800000
L_c_safe_A_f0123:
  s_mov_b64 exec, vcc
  global_load_dwordx4 v[40:43], v4, s[44:45] offset:0 sc1
  s_mov_b64 exec, -1
  s_sub_u32 s39, s39, 1
  s_cbranch_scc1 L_c_safe_bail
  s_waitcnt vmcnt(3)
  v_cmp_eq_u32 vcc, -1, v47
  s_cbranch_vccnz L_c_safe_A_f1230
  v_smfmac_f32_16x16x64_bf16 v[56:59], v[44:47], a[16:23], v3
  v_smfmac_f32_16x16x64_bf16 v[60:63], v[44:47], a[24:31], v3
  s_waitcnt vmcnt(2)
  v_cmp_eq_u32 vcc, -1, v51
  v_smfmac_f32_16x16x64_bf16 v[64:67], v[44:47], a[80:87], v3
  v_smfmac_f32_16x16x64_bf16 v[68:71], v[44:47], a[88:95], v3
  s_cbranch_vccnz L_c_safe_A_f230
  v_smfmac_f32_16x16x64_bf16 v[56:59], v[48:51], a[32:39], v3
  v_smfmac_f32_16x16x64_bf16 v[60:63], v[48:51], a[40:47], v3
  s_waitcnt vmcnt(1)
  v_cmp_eq_u32 vcc, -1, v55
  v_smfmac_f32_16x16x64_bf16 v[64:67], v[48:51], a[96:103], v3
  v_smfmac_f32_16x16x64_bf16 v[68:71], v[48:51], a[104:111], v3
  s_cbranch_vccnz L_c_safe_A_f30
  v_smfmac_f32_16x16x64_bf16 v[56:59], v[52:55], a[48:55], v3
  v_smfmac_f32_16x16x64_bf16 v[60:63], v[52:55], a[56:63], v3
  s_waitcnt vmcnt(0)
  v_cmp_eq_u32 vcc, -1, v43
  v_smfmac_f32_16x16x64_bf16 v[64:67], v[52:55], a[112:119], v3
  v_smfmac_f32_16x16x64_bf16 v[68:71], v[52:55], a[120:127], v3
  s_cbranch_vccnz L_c_safe_A_f0
  v_smfmac_f32_16x16x64_bf16 v[56:59], v[40:43], a[0:7], v3
  v_smfmac_f32_16x16x64_bf16 v[60:63], v[40:43], a[8:15], v3
  v_smfmac_f32_16x16x64_bf16 v[64:67], v[40:43], a[64:71], v3
  v_smfmac_f32_16x16x64_bf16 v[68:71], v[40:43], a[72:79], v3
  s_branch L_c_safe_A_done
  .fill (((0 - (. - L_0)) & 31) >> 2), 4, 0xbf800000
L_c_safe_A_f123:
  s_mov_b64 exec, vcc
  global_load_dwordx4 v[44:47], v4, s[44:45] offset:1024 sc1
  s_mov_b64 exec, -1
  s_sub_u32 s39, s39, 1
  s_cbranch_scc1 L_c_safe_bail
  s_waitcnt vmcnt(2)
  v_cmp_eq_u32 vcc, -1, v51
  s_cbranch_vccnz L_c_safe_A_f231
  v_smfmac_f32_16x16x64_bf16 v[56:59], v[48:51], a[32:39], v3
  v_smfmac_f32_16x16x64_bf16 v[60:63], v[48:51], a[40:47], v3
  s_waitcnt vmcnt(1)
  v_cmp_eq_u32 vcc, -1, v55
  v_smfmac_f32_16x16x64_bf16 v[64:67], v[48:51], a[96:103], v3
  v_smfmac_f32_16x16x64_bf16 v[68:71], v[48:51], a[104:111], v3
  s_cbranch_vccnz L_c_safe_A_f31
  v_smfmac_f32_16x16x64_bf16 v[56:59], v[52:55], a[48:55], v3
  v_smfmac_f32_16x16x64_bf16 v[60:63], v[52:55], a[56:63], v3
  s_waitcnt vmcnt(0)
  v_cmp_eq_u32 vcc, -1, v47
  v_smfmac_f32_16x16x64_bf16 v[64:67], v[52:55], a[112:119], v3
  v_smfmac_f32_16x16x64_bf16 v[68:71], v[52:55], a[120:127], v3
  s_cbranch_vccnz L_c_safe_A_f1
  v_smfmac_f32_16x16x64_bf16 v[56:59], v[44:47], a[16:23], v3
  v_smfmac_f32_16x16x64_bf16 v[60:63], v[44:47], a[24:31], v3
  v_smfmac_f32_16x16x64_bf16 v[64:67], v[44:47], a[80:87], v3
  v_smfmac_f32_16x16x64_bf16 v[68:71], v[44:47], a[88:95], v3
  s_branch L_c_safe_A_done
  .fill (((0 - (. - L_0)) & 31) >> 2), 4, 0xbf800000
L_c_safe_A_f23:
  s_mov_b64 exec, vcc
  global_load_dwordx4 v[48:51], v4, s[44:45] offset:2048 sc1
  s_mov_b64 exec, -1
  s_sub_u32 s39, s39, 1
  s_cbranch_scc1 L_c_safe_bail
  s_waitcnt vmcnt(1)
  v_cmp_eq_u32 vcc, -1, v55
  s_cbranch_vccnz L_c_safe_A_f32
  v_smfmac_f32_16x16x64_bf16 v[56:59], v[52:55], a[48:55], v3
  v_smfmac_f32_16x16x64_bf16 v[60:63], v[52:55], a[56:63], v3
  s_waitcnt vmcnt(0)
  v_cmp_eq_u32 vcc, -1, v51
  v_smfmac_f32_16x16x64_bf16 v[64:67], v[52:55], a[112:119], v3
  v_smfmac_f32_16x16x64_bf16 v[68:71], v[52:55], a[120:127], v3
  s_cbranch_vccnz L_c_safe_A_f2
  v_smfmac_f32_16x16x64_bf16 v[56:59], v[48:51], a[32:39], v3
  v_smfmac_f32_16x16x64_bf16 v[60:63], v[48:51], a[40:47], v3
  v_smfmac_f32_16x16x64_bf16 v[64:67], v[48:51], a[96:103], v3
  v_smfmac_f32_16x16x64_bf16 v[68:71], v[48:51], a[104:111], v3
  s_branch L_c_safe_A_done
  .fill (((0 - (. - L_0)) & 31) >> 2), 4, 0xbf800000
L_c_safe_A_f3:
  s_mov_b64 exec, vcc
  global_load_dwordx4 v[52:55], v4, s[44:45] offset:3072 sc1
  s_mov_b64 exec, -1
  s_sub_u32 s39, s39, 1
  s_cbranch_scc1 L_c_safe_bail
  s_waitcnt vmcnt(0)
  v_cmp_eq_u32 vcc, -1, v55
  s_cbranch_vccnz L_c_safe_A_f3
  v_smfmac_f32_16x16x64_bf16 v[56:59], v[52:55], a[48:55], v3
  v_smfmac_f32_16x16x64_bf16 v[60:63], v[52:55], a[56:63], v3
  v_smfmac_f32_16x16x64_bf16 v[64:67], v[52:55], a[112:119], v3
  v_smfmac_f32_16x16x64_bf16 v[68:71], v[52:55], a[120:127], v3
  s_branch L_c_safe_A_done
  .fill (((0 - (. - L_0)) & 31) >> 2), 4, 0xbf800000
L_c_safe_A_f1230:
  s_mov_b64 exec, vcc
  global_load_dwordx4 v[44:47], v4, s[44:45] offset:1024 sc1
  s_mov_b64 exec, -1
  s_sub_u32 s39, s39, 1
  s_cbranch_scc1 L_c_safe_bail
  s_waitcnt vmcnt(3)
  v_cmp_eq_u32 vcc, -1, v51
  s_cbranch_vccnz L_c_safe_A_f2301
  v_smfmac_f32_16x16x64_bf16 v[56:59], v[48:51], a[32:39], v3
  v_smfmac_f32_16x16x64_bf16 v[60:63], v[48:51], a[40:47], v3
  s_waitcnt vmcnt(2)
  v_cmp_eq_u32 vcc, -1, v55
  v_smfmac_f32_16x16x64_bf16 v[64:67], v[48:51], a[96:103], v3
  v_smfmac_f32_16x16x64_bf16 v[68:71], v[48:51], a[104:111], v3
  s_cbranch_vccnz L_c_safe_A_f301
  v_smfmac_f32_16x16x64_bf16 v[56:59], v[52:55], a[48:55], v3
  v_smfmac_f32_16x16x64_bf16 v[60:63], v[52:55], a[56:63], v3
  s_waitcnt vmcnt(1)
  v_cmp_eq_u32 vcc, -1, v43
  v_smfmac_f32_16x16x64_bf16 v[64:67], v[52:55], a[112:119], v3
  v_smfmac_f32_16x16x64_bf16 v[68:71], v[52:55], a[120:127], v3
  s_cbranch_vccnz L_c_safe_A_f01
  v_smfmac_f32_16x16x64_bf16 v[56:59], v[40:43], a[0:7], v3
  v_smfmac_f32_16x16x64_bf16 v[60:63], v[40:43], a[8:15], v3
  s_waitcnt vmcnt(0)
  v_cmp_eq_u32 vcc, -1, v47
  v_smfmac_f32_16x16x64_bf16 v[64:67], v[40:43], a[64:71], v3
  v_smfmac_f32_16x16x64_bf16 v[68:71], v[40:43], a[72:79], v3
  s_cbranch_vccnz L_c_safe_A_f1
  v_smfmac_f32_16x16x64_bf16 v[56:59], v[44:47], a[16:23], v3
  v_smfmac_f32_16x16x64_bf16 v[60:63], v[44:47], a[24:31], v3
  v_smfmac_f32_16x16x64_bf16 v[64:67], v[44:47], a[80:87], v3
  v_smfmac_f32_16x16x64_bf16 v[68:71], v[44:47], a[88:95], v3
  s_branch L_c_safe_A_done
  .fill (((0 - (. - L_0)) & 31) >> 2), 4, 0xbf800000
L_c_safe_A_f230:
  s_mov_b64 exec, vcc
  global_load_dwordx4 v[48:51], v4, s[44:45] offset:2048 sc1
  s_mov_b64 exec, -1
  s_sub_u32 s39, s39, 1
  s_cbranch_scc1 L_c_safe_bail
  s_waitcnt vmcnt(2)
  v_cmp_eq_u32 vcc, -1, v55
  s_cbranch_vccnz L_c_safe_A_f302
  v_smfmac_f32_16x16x64_bf16 v[56:59], v[52:55], a[48:55], v3
  v_smfmac_f32_16x16x64_bf16 v[60:63], v[52:55], a[56:63], v3
  s_waitcnt vmcnt(1)
  v_cmp_eq_u32 vcc, -1, v43
  v_smfmac_f32_16x16x64_bf16 v[64:67], v[52:55], a[112:119], v3
  v_smfmac_f32_16x16x64_bf16 v[68:71], v[52:55], a[120:127], v3
  s_cbranch_vccnz L_c_safe_A_f02
  v_smfmac_f32_16x16x64_bf16 v[56:59], v[40:43], a[0:7], v3
  v_smfmac_f32_16x16x64_bf16 v[60:63], v[40:43], a[8:15], v3
  s_waitcnt vmcnt(0)
  v_cmp_eq_u32 vcc, -1, v51
  v_smfmac_f32_16x16x64_bf16 v[64:67], v[40:43], a[64:71], v3
  v_smfmac_f32_16x16x64_bf16 v[68:71], v[40:43], a[72:79], v3
  s_cbranch_vccnz L_c_safe_A_f2
  v_smfmac_f32_16x16x64_bf16 v[56:59], v[48:51], a[32:39], v3
  v_smfmac_f32_16x16x64_bf16 v[60:63], v[48:51], a[40:47], v3
  v_smfmac_f32_16x16x64_bf16 v[64:67], v[48:51], a[96:103], v3
  v_smfmac_f32_16x16x64_bf16 v[68:71], v[48:51], a[104:111], v3
  s_branch L_c_safe_A_done
  .fill (((0 - (. - L_0)) & 31) >> 2), 4, 0xbf800000
L_c_safe_A_f30:
  s_mov_b64 exec, vcc
  global_load_dwordx4 v[52:55], v4, s[44:45] offset:3072 sc1
  s_mov_b64 exec, -1
  s_sub_u32 s39, s39, 1
  s_cbranch_scc1 L_c_safe_bail
  s_waitcnt vmcnt(1)
  v_cmp_eq_u32 vcc, -1, v43
  s_cbranch_vccnz L_c_safe_A_f03
  v_smfmac_f32_16x16x64_bf16 v[56:59], v[40:43], a[0:7], v3
  v_smfmac_f32_16x16x64_bf16 v[60:63], v[40:43], a[8:15], v3
  s_waitcnt vmcnt(0)
  v_cmp_eq_u32 vcc, -1, v55
  v_smfmac_f32_16x16x64_bf16 v[64:67], v[40:43], a[64:71], v3
  v_smfmac_f32_16x16x64_bf16 v[68:71], v[40:43], a[72:79], v3
  s_cbranch_vccnz L_c_safe_A_f3
  v_smfmac_f32_16x16x64_bf16 v[56:59], v[52:55], a[48:55], v3
  v_smfmac_f32_16x16x64_bf16 v[60:63], v[52:55], a[56:63], v3
  v_smfmac_f32_16x16x64_bf16 v[64:67], v[52:55], a[112:119], v3
  v_smfmac_f32_16x16x64_bf16 v[68:71], v[52:55], a[120:127], v3
  s_branch L_c_safe_A_done
  .fill (((0 - (. - L_0)) & 31) >> 2), 4, 0xbf800000
L_c_safe_A_f0:
  s_mov_b64 exec, vcc
  global_load_dwordx4 v[40:43], v4, s[44:45] offset:0 sc1
  s_mov_b64 exec, -1
  s_sub_u32 s39, s39, 1
  s_cbranch_scc1 L_c_safe_bail
  s_waitcnt vmcnt(0)
  v_cmp_eq_u32 vcc, -1, v43
  s_cbranch_vccnz L_c_safe_A_f0
  v_smfmac_f32_16x16x64_bf16 v[56:59], v[40:43], a[0:7], v3
  v_smfmac_f32_16x16x64_bf16 v[60:63], v[40:43], a[8:15], v3
  v_smfmac_f32_16x16x64_bf16 v[64:67], v[40:43], a[64:71], v3
  v_smfmac_f32_16x16x64_bf16 v[68:71], v[40:43], a[72:79], v3
  s_branch L_c_safe_A_done
  .fill (((0 - (. - L_0)) & 31) >> 2), 4, 0xbf800000
L_c_safe_A_f231:
  s_mov_b64 exec, vcc
  global_load_dwordx4 v[48:51], v4, s[44:45] offset:2048 sc1
  s_mov_b64 exec, -1
  s_sub_u32 s39, s39, 1
  s_cbranch_scc1 L_c_safe_bail
  s_waitcnt vmcnt(2)
  v_cmp_eq_u32 vcc, -1, v55
  s_cbranch_vccnz L_c_safe_A_f312
  v_smfmac_f32_16x16x64_bf16 v[56:59], v[52:55], a[48:55], v3
  v_smfmac_f32_16x16x64_bf16 v[60:63], v[52:55], a[56:63], v3
  s_waitcnt vmcnt(1)
  v_cmp_eq_u32 vcc, -1, v47
  v_smfmac_f32_16x16x64_bf16 v[64:67], v[52:55], a[112:119], v3
  v_smfmac_f32_16x16x64_bf16 v[68:71], v[52:55], a[120:127], v3
  s_cbranch_vccnz L_c_safe_A_f12
  v_smfmac_f32_16x16x64_bf16 v[56:59], v[44:47], a[16:23], v3
  v_smfmac_f32_16x16x64_bf16 v[60:63], v[44:47], a[24:31], v3
  s_waitcnt vmcnt(0)
  v_cmp_eq_u32 vcc, -1, v51
  v_smfmac_f32_16x16x64_bf16 v[64:67], v[44:47], a[80:87], v3
  v_smfmac_f32_16x16x64_bf16 v[68:71], v[44:47], a[88:95], v3
  s_cbranch_vccnz L_c_safe_A_f2
  v_smfmac_f32_16x16x64_bf16 v[56:59], v[48:51], a[32:39], v3
  v_smfmac_f32_16x16x64_bf16 v[60:63], v[48:51], a[40:47], v3
  v_smfmac_f32_16x16x64_bf16 v[64:67], v[48:51], a[96:103], v3
  v_smfmac_f32_16x16x64_bf16 v[68:71], v[48:51], a[104:111], v3
  s_branch L_c_safe_A_done
  .fill (((0 - (. - L_0)) & 31) >> 2), 4, 0xbf800000
L_c_safe_A_f31:
  s_mov_b64 exec, vcc
  global_load_dwordx4 v[52:55], v4, s[44:45] offset:3072 sc1
  s_mov_b64 exec, -1
  s_sub_u32 s39, s39, 1
  s_cbranch_scc1 L_c_safe_bail
  s_waitcnt vmcnt(1)
  v_cmp_eq_u32 vcc, -1, v47
  s_cbranch_vccnz L_c_safe_A_f13
  v_smfmac_f32_16x16x64_bf16 v[56:59], v[44:47], a[16:23], v3
  v_smfmac_f32_16x16x64_bf16 v[60:63], v[44:47], a[24:31], v3
  s_waitcnt vmcnt(0)
  v_cmp_eq_u32 vcc, -1, v55
  v_smfmac_f32_16x16x64_bf16 v[64:67], v[44:47], a[80:87], v3
  v_smfmac_f32_16x16x64_bf16 v[68:71], v[44:47], a[88:95], v3
  s_cbranch_vccnz L_c_safe_A_f3
  v_smfmac_f32_16x16x64_bf16 v[56:59], v[52:55], a[48:55], v3
  v_smfmac_f32_16x16x64_bf16 v[60:63], v[52:55], a[56:63], v3
  v_smfmac_f32_16x16x64_bf16 v[64:67], v[52:55], a[112:119], v3
  v_smfmac_f32_16x16x64_bf16 v[68:71], v[52:55], a[120:127], v3
  s_branch L_c_safe_A_done
  .fill (((0 - (. - L_0)) & 31) >> 2), 4, 0xbf800000
L_c_safe_A_f1:
  s_mov_b64 exec, vcc
  global_load_dwordx4 v[44:47], v4, s[44:45] offset:1024 sc1
  s_mov_b64 exec, -1
  s_sub_u32 s39, s39, 1
  s_cbranch_scc1 L_c_safe_bail
  s_waitcnt vmcnt(0)
  v_cmp_eq_u32 vcc, -1, v47
  s_cbranch_vccnz L_c_safe_A_f1
  v_smfmac_f32_16x16x64_bf16 v[56:59], v[44:47], a[16:23], v3
  v_smfmac_f32_16x16x64_bf16 v[60:63], v[44:47], a[24:31], v3
  v_smfmac_f32_16x16x64_bf16 v[64:67], v[44:47], a[80:87], v3
  v_smfmac_f32_16x16x64_bf16 v[68:71], v[44:47], a[88:95], v3
  s_branch L_c_safe_A_done
  .fill (((0 - (. - L_0)) & 31) >> 2), 4, 0xbf800000
L_c_safe_A_f32:
  s_mov_b64 exec, vcc
  global_load_dwordx4 v[52:55], v4, s[44:45] offset:3072 sc1
  s_mov_b64 exec, -1
  s_sub_u32 s39, s39, 1
  s_cbranch_scc1 L_c_safe_bail
  s_waitcnt vmcnt(1)
  v_cmp_eq_u32 vcc, -1, v51
  s_cbranch_vccnz L_c_safe_A_f23
  v_smfmac_f32_16x16x64_bf16 v[56:59], v[48:51], a[32:39], v3
  v_smfmac_f32_16x16x64_bf16 v[60:63], v[48:51], a[40:47], v3
  s_waitcnt vmcnt(0)
  v_cmp_eq_u32 vcc, -1, v55
  v_smfmac_f32_16x16x64_bf16 v[64:67], v[48:51], a[96:103], v3
  v_smfmac_f32_16x16x64_bf16 v[68:71], v[48:51], a[104:111], v3
  s_cbranch_vccnz L_c_safe_A_f3
  v_smfmac_f32_16x16x64_bf16 v[56:59], v[52:55], a[48:55], v3
  v_smfmac_f32_16x16x64_bf16 v[60:63], v[52:55], a[56:63], v3
  v_smfmac_f32_16x16x64_bf16 v[64:67], v[52:55], a[112:119], v3
  v_smfmac_f32_16x16x64_bf16 v[68:71], v[52:55], a[120:127], v3
  s_branch L_c_safe_A_done
  .fill (((0 - (. - L_0)) & 31) >> 2), 4, 0xbf800000
L_c_safe_A_f2:
  s_mov_b64 exec, vcc
  global_load_dwordx4 v[48:51], v4, s[44:45] offset:2048 sc1
  s_mov_b64 exec, -1
  s_sub_u32 s39, s39, 1
  s_cbranch_scc1 L_c_safe_bail
  s_waitcnt vmcnt(0)
  v_cmp_eq_u32 vcc, -1, v51
  s_cbranch_vccnz L_c_safe_A_f2
  v_smfmac_f32_16x16x64_bf16 v[56:59], v[48:51], a[32:39], v3
  v_smfmac_f32_16x16x64_bf16 v[60:63], v[48:51], a[40:47], v3
  v_smfmac_f32_16x16x64_bf16 v[64:67], v[48:51], a[96:103], v3
  v_smfmac_f32_16x16x64_bf16 v[68:71], v[48:51], a[104:111], v3
  s_branch L_c_safe_A_done
  .fill (((0 - (. - L_0)) & 31) >> 2), 4, 0xbf800000
L_c_safe_A_f2301:
  s_mov_b64 exec, vcc
  global_load_dwordx4 v[48:51], v4, s[44:45] offset:2048 sc1
  s_mov_b64 exec, -1
  s_sub_u32 s39, s39, 1
  s_cbranch_scc1 L_c_safe_bail
  s_waitcnt vmcnt(3)
  v_cmp_eq_u32 vcc, -1, v55
  s_cbranch_vccnz L_c_safe_A_f3012
  v_smfmac_f32_16x16x64_bf16 v[56:59], v[52:55], a[48:55], v3
  v_smfmac_f32_16x16x64_bf16 v[60:63], v[52:55], a[56:63], v3
  s_waitcnt vmcnt(2)
  v_cmp_eq_u32 vcc, -1, v43
  v_smfmac_f32_16x16x64_bf16 v[64:67], v[52:55], a[112:119], v3
  v_smfmac_f32_16x16x64_bf16 v[68:71], v[52:55], a[120:127], v3
  s_cbranch_vccnz L_c_safe_A_f012
  v_smfmac_f32_16x16x64_bf16 v[56:59], v[40:43], a[0:7], v3
  v_smfmac_f32_16x16x64_bf16 v[60:63], v[40:43], a[8:15], v3
  s_waitcnt vmcnt(1)
  v_cmp_eq_u32 vcc, -1, v47
  v_smfmac_f32_16x16x64_bf16 v[64:67], v[40:43], a[64:71], v3
  v_smfmac_f32_16x16x64_bf16 v[68:71], v[40:43], a[72:79], v3
  s_cbranch_vccnz L_c_safe_A_f12
  v_smfmac_f32_16x16x64_bf16 v[56:59], v[44:47], a[16:23], v3
  v_smfmac_f32_16x16x64_bf16 v[60:63], v[44:47], a[24:31], v3
  s_waitcnt vmcnt(0)
  v_cmp_eq_u32 vcc, -1, v51
  v_smfmac_f32_16x16x64_bf16 v[64:67], v[44:47], a[80:87], v3
  v_smfmac_f32_16x16x64_bf16 v[68:71], v[44:47], a[88:95], v3
  s_cbranch_vccnz L_c_safe_A_f2
  v_smfmac_f32_16x16x64_bf16 v[56:59], v[48:51], a[32:39], v3
  v_smfmac_f32_16x16x64_bf16 v[60:63], v[48:51], a[40:47], v3
  v_smfmac_f32_16x16x64_bf16 v[64:67], v[48:51], a[96:103], v3
  v_smfmac_f32_16x16x64_bf16 v[68:71], v[48:51], a[104:111], v3
  s_branch L_c_safe_A_done
  .fill (((0 - (. - L_0)) & 31) >> 2), 4, 0xbf800000
L_c_safe_A_f301:
  s_mov_b64 exec, vcc
  global_load_dwordx4 v[52:55], v4, s[44:45] offset:3072 sc1
  s_mov_b64 exec, -1
  s_sub_u32 s39, s39, 1
  s_cbranch_scc1 L_c_safe_bail
  s_waitcnt vmcnt(2)
  v_cmp_eq_u32 vcc, -1, v43
  s_cbranch_vccnz L_c_safe_A_f013
  v_smfmac_f32_16x16x64_bf16 v[56:59], v[40:43], a[0:7], v3
  v_smfmac_f32_16x16x64_bf16 v[60:63], v[40:43], a[8:15], v3
  s_waitcnt vmcnt(1)
  v_cmp_eq_u32 vcc, -1, v47
  v_smfmac_f32_16x16x64_bf16 v[64:67], v[40:43], a[64:71], v3
  v_smfmac_f32_16x16x64_bf16 v[68:71], v[40:43], a[72:79], v3
  s_cbranch_vccnz L_c_safe_A_f13
  v_smfmac_f32_16x16x64_bf16 v[56:59], v[44:47], a[16:23], v3
  v_smfmac_f32_16x16x64_bf16 v[60:63], v[44:47], a[24:31], v3
  s_waitcnt vmcnt(0)
  v_cmp_eq_u32 vcc, -1, v55
  v_smfmac_f32_16x16x64_bf16 v[64:67], v[44:47], a[80:87], v3
  v_smfmac_f32_16x16x64_bf16 v[68:71], v[44:47], a[88:95], v3
  s_cbranch_vccnz L_c_safe_A_f3
  v_smfmac_f32_16x16x64_bf16 v[56:59], v[52:55], a[48:55], v3
  v_smfmac_f32_16x16x64_bf16 v[60:63], v[52:55], a[56:63], v3
  v_smfmac_f32_16x16x64_bf16 v[64:67], v[52:55], a[112:119], v3
  v_smfmac_f32_16x16x64_bf16 v[68:71], v[52:55], a[120:127], v3
  s_branch L_c_safe_A_done
  .fill (((0 - (. - L_0)) & 31) >> 2), 4, 0xbf800000
L_c_safe_A_f01:
  s_mov_b64 exec, vcc
  global_load_dwordx4 v[40:43], v4, s[44:45] offset:0 sc1
  s_mov_b64 exec, -1
  s_sub_u32 s39, s39, 1
  s_cbranch_scc1 L_c_safe_bail
  s_waitcnt vmcnt(1)
  v_cmp_eq_u32 vcc, -1, v47
  s_cbranch_vccnz L_c_safe_A_f10
  v_smfmac_f32_16x16x64_bf16 v[56:59], v[44:47], a[16:23], v3
  v_smfmac_f32_16x16x64_bf16 v[60:63], v[44:47], a[24:31], v3
  s_waitcnt vmcnt(0)
  v_cmp_eq_u32 vcc, -1, v43
  v_smfmac_f32_16x16x64_bf16 v[64:67], v[44:47], a[80:87], v3
  v_smfmac_f32_16x16x64_bf16 v[68:71], v[44:47], a[88:95], v3
  s_cbranch_vccnz L_c_safe_A_f0
  v_smfmac_f32_16x16x64_bf16 v[56:59], v[40:43], a[0:7], v3
  v_smfmac_f32_16x16x64_bf16 v[60:63], v[40:43], a[8:15], v3
  v_smfmac_f32_16x16x64_bf16 v[64:67], v[40:43], a[64:71], v3
  v_smfmac_f32_16x16x64_bf16 v[68:71], v[40:43], a[72:79], v3
  s_branch L_c_safe_A_done
  .fill (((0 - (. - L_0)) & 31) >> 2), 4, 0xbf800000
L_c_safe_A_f302:
  s_mov_b64 exec, vcc
  global_load_dwordx4 v[52:55], v4, s[44:45] offset:3072 sc1
  s_mov_b64 exec, -1
  s_sub_u32 s39, s39, 1
  s_cbranch_scc1 L_c_safe_bail
  s_waitcnt vmcnt(2)
  v_cmp_eq_u32 vcc, -1, v43
  s_cbranch_vccnz L_c_safe_A_f023
  v_smfmac_f32_16x16x64_bf16 v[56:59], v[40:43], a[0:7], v3
  v_smfmac_f32_16x16x64_bf16 v[60:63], v[40:43], a[8:15], v3
  s_waitcnt vmcnt(1)
  v_cmp_eq_u32 vcc, -1, v51
  v_smfmac_f32_16x16x64_bf16 v[64:67], v[40:43], a[64:71], v3
  v_smfmac_f32_16x16x64_bf16 v[68:71], v[40:43], a[72:79], v3
  s_cbranch_vccnz L_c_safe_A_f23
  v_smfmac_f32_16x16x64_bf16 v[56:59], v[48:51], a[32:39], v3
  v_smfmac_f32_16x16x64_bf16 v[60:63], v[48:51], a[40:47], v3
  s_waitcnt vmcnt(0)
  v_cmp_eq_u32 vcc, -1, v55
  v_smfmac_f32_16x16x64_bf16 v[64:67], v[48:51], a[96:103], v3
  v_smfmac_f32_16x16x64_bf16 v[68:71], v[48:51], a[104:111], v3
  s_cbranch_vccnz L_c_safe_A_f3
  v_smfmac_f32_16x16x64_bf16 v[56:59], v[52:55], a[48:55], v3
  v_smfmac_f32_16x16x64_bf16 v[60:63], v[52:55], a[56:63], v3
  v_smfmac_f32_16x16x64_bf16 v[64:67], v[52:55], a[112:119], v3
  v_smfmac_f32_16x16x64_bf16 v[68:71], v[52:55], a[120:127], v3
  s_branch L_c_safe_A_done
  .fill (((0 - (. - L_0)) & 31) >> 2), 4, 0xbf800000
L_c_safe_A_f02:
  s_mov_b64 exec, vcc
  global_load_dwordx4 v[40:43], v4, s[44:45] offset:0 sc1
  s_mov_b64 exec, -1
  s_sub_u32 s39, s39, 1
  s_cbranch_scc1 L_c_safe_bail
  s_waitcnt vmcnt(1)
  v_cmp_eq_u32 vcc, -1, v51
  s_cbranch_vccnz L_c_safe_A_f20
  v_smfmac_f32_16x16x64_bf16 v[56:59], v[48:51], a[32:39], v3
  v_smfmac_f32_16x16x64_bf16 v[60:63], v[48:51], a[40:47], v3
  s_waitcnt vmcnt(0)
  v_cmp_eq_u32 vcc, -1, v43
  v_smfmac_f32_16x16x64_bf16 v[64:67], v[48:51], a[96:103], v3
  v_smfmac_f32_16x16x64_bf16 v[68:71], v[48:51], a[104:111], v3
  s_cbranch_vccnz L_c_safe_A_f0
  v_smfmac_f32_16x16x64_bf16 v[56:59], v[40:43], a[0:7], v3
  v_smfmac_f32_16x16x64_bf16 v[60:63], v[40:43], a[8:15], v3
  v_smfmac_f32_16x16x64_bf16 v[64:67], v[40:43], a[64:71], v3
  v_smfmac_f32_16x16x64_bf16 v[68:71], v[40:43], a[72:79], v3
  s_branch L_c_safe_A_done
  .fill (((0 - (. - L_0)) & 31) >> 2), 4, 0xbf800000
L_c_safe_A_f03:
  s_mov_b64 exec, vcc
  global_load_dwordx4 v[40:43], v4, s[44:45] offset:0 sc1
  s_mov_b64 exec, -1
  s_sub_u32 s39, s39, 1
  s_cbranch_scc1 L_c_safe_bail
  s_waitcnt vmcnt(1)
  v_cmp_eq_u32 vcc, -1, v55
  s_cbranch_vccnz L_c_safe_A_f30
  v_smfmac_f32_16x16x64_bf16 v[56:59], v[52:55], a[48:55], v3
  v_smfmac_f32_16x16x64_bf16 v[60:63], v[52:55], a[56:63], v3
  s_waitcnt vmcnt(0)
  v_cmp_eq_u32 vcc, -1, v43
  v_smfmac_f32_16x16x64_bf16 v[64:67], v[52:55], a[112:119], v3
  v_smfmac_f32_16x16x64_bf16 v[68:71], v[52:55], a[120:127], v3
  s_cbranch_vccnz L_c_safe_A_f0
  v_smfmac_f32_16x16x64_bf16 v[56:59], v[40:43], a[0:7], v3
  v_smfmac_f32_16x16x64_bf16 v[60:63], v[40:43], a[8:15], v3
  v_smfmac_f32_16x16x64_bf16 v[64:67], v[40:43], a[64:71], v3
  v_smfmac_f32_16x16x64_bf16 v[68:71], v[40:43], a[72:79], v3
  s_branch L_c_safe_A_done
  .fill (((0 - (. - L_0)) & 31) >> 2), 4, 0xbf800000
L_c_safe_A_f312:
  s_mov_b64 exec, vcc
  global_load_dwordx4 v[52:55], v4, s[44:45] offset:3072 sc1
  s_mov_b64 exec, -1
  s_sub_u32 s39, s39, 1
  s_cbranch_scc1 L_c_safe_bail
  s_waitcnt vmcnt(2)
  v_cmp_eq_u32 vcc, -1, v47
  s_cbranch_vccnz L_c_safe_A_f123
  v_smfmac_f32_16x16x64_bf16 v[56:59], v[44:47], a[16:23], v3
  v_smfmac_f32_16x16x64_bf16 v[60:63], v[44:47], a[24:31], v3
  s_waitcnt vmcnt(1)
  v_cmp_eq_u32 vcc, -1, v51
  v_smfmac_f32_16x16x64_bf16 v[64:67], v[44:47], a[80:87], v3
  v_smfmac_f32_16x16x64_bf16 v[68:71], v[44:47], a[88:95], v3
  s_cbranch_vccnz L_c_safe_A_f23
  v_smfmac_f32_16x16x64_bf16 v[56:59], v[48:51], a[32:39], v3
  v_smfmac_f32_16x16x64_bf16 v[60:63], v[48:51], a[40:47], v3
  s_waitcnt vmcnt(0)
  v_cmp_eq_u32 vcc, -1, v55
  v_smfmac_f32_16x16x64_bf16 v[64:67], v[48:51], a[96:103], v3
  v_smfmac_f32_16x16x64_bf16 v[68:71], v[48:51], a[104:111], v3
  s_cbranch_vccnz L_c_safe_A_f3
  v_smfmac_f32_16x16x64_bf16 v[56:59], v[52:55], a[48:55], v3
  v_smfmac_f32_16x16x64_bf16 v[60:63], v[52:55], a[56:63], v3
  v_smfmac_f32_16x16x64_bf16 v[64:67], v[52:55], a[112:119], v3
  v_smfmac_f32_16x16x64_bf16 v[68:71], v[52:55], a[120:127], v3
  s_branch L_c_safe_A_done
  .fill (((0 - (. - L_0)) & 31) >> 2), 4, 0xbf800000
L_c_safe_A_f12:
  s_mov_b64 exec, vcc
  global_load_dwordx4 v[44:47], v4, s[44:45] offset:1024 sc1
  s_mov_b64 exec, -1
  s_sub_u32 s39, s39, 1
  s_cbranch_scc1 L_c_safe_bail
  s_waitcnt vmcnt(1)
  v_cmp_eq_u32 vcc, -1, v51
  s_cbranch_vccnz L_c_safe_A_f21
  v_smfmac_f32_16x16x64_bf16 v[56:59], v[48:51], a[32:39], v3
  v_smfmac_f32_16x16x64_bf16 v[60:63], v[48:51], a[40:47], v3
  s_waitcnt vmcnt(0)
  v_cmp_eq_u32 vcc, -1, v47
  v_smfmac_f32_16x16x64_bf16 v[64:67], v[48:51], a[96:103], v3
  v_smfmac_f32_16x16x64_bf16 v[68:71], v[48:51], a[104:111], v3
  s_cbranch_vccnz L_c_safe_A_f1
  v_smfmac_f32_16x16x64_bf16 v[56:59], v[44:47], a[16:23], v3
  v_smfmac_f32_16x16x64_bf16 v[60:63], v[44:47], a[24:31], v3
  v_smfmac_f32_16x16x64_bf16 v[64:67], v[44:47], a[80:87], v3
  v_smfmac_f32_16x16x64_bf16 v[68:71], v[44:47], a[88:95], v3
  s_branch L_c_safe_A_done
  .fill (((0 - (. - L_0)) & 31) >> 2), 4, 0xbf800000
L_c_safe_A_f13:
  s_mov_b64 exec, vcc
  global_load_dwordx4 v[44:47], v4, s[44:45] offset:1024 sc1
  s_mov_b64 exec, -1
  s_sub_u32 s39, s39, 1
  s_cbranch_scc1 L_c_safe_bail
  s_waitcnt vmcnt(1)
  v_cmp_eq_u32 vcc, -1, v55
  s_cbranch_vccnz L_c_safe_A_f31
  v_smfmac_f32_16x16x64_bf16 v[56:59], v[52:55], a[48:55], v3
  v_smfmac_f32_16x16x64_bf16 v[60:63], v[52:55], a[56:63], v3
  s_waitcnt vmcnt(0)
  v_cmp_eq_u32 vcc, -1, v47
  v_smfmac_f32_16x16x64_bf16 v[64:67], v[52:55], a[112:119], v3
  v_smfmac_f32_16x16x64_bf16 v[68:71], v[52:55], a[120:127], v3
  s_cbranch_vccnz L_c_safe_A_f1
  v_smfmac_f32_16x16x64_bf16 v[56:59], v[44:47], a[16:23], v3
  v_smfmac_f32_16x16x64_bf16 v[60:63], v[44:47], a[24:31], v3
  v_smfmac_f32_16x16x64_bf16 v[64:67], v[44:47], a[80:87], v3
  v_smfmac_f32_16x16x64_bf16 v[68:71], v[44:47], a[88:95], v3
  s_branch L_c_safe_A_done
  .fill (((0 - (. - L_0)) & 31) >> 2), 4, 0xbf800000
L_c_safe_A_f3012:
  s_mov_b64 exec, vcc
  global_load_dwordx4 v[52:55], v4, s[44:45] offset:3072 sc1
  s_mov_b64 exec, -1
  s_sub_u32 s39, s39, 1
  s_cbranch_scc1 L_c_safe_bail
  s_waitcnt vmcnt(3)
  v_cmp_eq_u32 vcc, -1, v43
  s_cbranch_vccnz L_c_safe_A_f0123
  v_smfmac_f32_16x16x64_bf16 v[56:59], v[40:43], a[0:7], v3
  v_smfmac_f32_16x16x64_bf16 v[60:63], v[40:43], a[8:15], v3
  s_waitcnt vmcnt(2)
  v_cmp_eq_u32 vcc, -1, v47
  v_smfmac_f32_16x16x64_bf16 v[64:67], v[40:43], a[64:71], v3
  v_smfmac_f32_16x16x64_bf16 v[68:71], v[40:43], a[72:79], v3
  s_cbranch_vccnz L_c_safe_A_f123
  v_smfmac_f32_16x16x64_bf16 v[56:59], v[44:47], a[16:23], v3
  v_smfmac_f32_16x16x64_bf16 v[60:63], v[44:47], a[24:31], v3
  s_waitcnt vmcnt(1)
  v_cmp_eq_u32 vcc, -1, v51
  v_smfmac_f32_16x16x64_bf16 v[64:67], v[44:47], a[80:87], v3
  v_smfmac_f32_16x16x64_bf16 v[68:71], v[44:47], a[88:95], v3
  s_cbranch_vccnz L_c_safe_A_f23
  v_smfmac_f32_16x16x64_bf16 v[56:59], v[48:51], a[32:39], v3
  v_smfmac_f32_16x16x64_bf16 v[60:63], v[48:51], a[40:47], v3
  s_waitcnt vmcnt(0)
  v_cmp_eq_u32 vcc, -1, v55
  v_smfmac_f32_16x16x64_bf16 v[64:67], v[48:51], a[96:103], v3
  v_smfmac_f32_16x16x64_bf16 v[68:71], v[48:51], a[104:111], v3
  s_cbranch_vccnz L_c_safe_A_f3
  v_smfmac_f32_16x16x64_bf16 v[56:59], v[52:55], a[48:55], v3
  v_smfmac_f32_16x16x64_bf16 v[60:63], v[52:55], a[56:63], v3
  v_smfmac_f32_16x16x64_bf16 v[64:67], v[52:55], a[112:119], v3
  v_smfmac_f32_16x16x64_bf16 v[68:71], v[52:55], a[120:127], v3
  s_branch L_c_safe_A_done
  .fill (((0 - (. - L_0)) & 31) >> 2), 4, 0xbf800000
L_c_safe_A_f012:
  s_mov_b64 exec, vcc
  global_load_dwordx4 v[40:43], v4, s[44:45] offset:0 sc1
  s_mov_b64 exec, -1
  s_sub_u32 s39, s39, 1
  s_cbranch_scc1 L_c_safe_bail
  s_waitcnt vmcnt(2)
  v_cmp_eq_u32 vcc, -1, v47
  s_cbranch_vccnz L_c_safe_A_f120
  v_smfmac_f32_16x16x64_bf16 v[56:59], v[44:47], a[16:23], v3
  v_smfmac_f32_16x16x64_bf16 v[60:63], v[44:47], a[24:31], v3
  s_waitcnt vmcnt(1)
  v_cmp_eq_u32 vcc, -1, v51
  v_smfmac_f32_16x16x64_bf16 v[64:67], v[44:47], a[80:87], v3
  v_smfmac_f32_16x16x64_bf16 v[68:71], v[44:47], a[88:95], v3
  s_cbranch_vccnz L_c_safe_A_f20
  v_smfmac_f32_16x16x64_bf16 v[56:59], v[48:51], a[32:39], v3
  v_smfmac_f32_16x16x64_bf16 v[60:63], v[48:51], a[40:47], v3
  s_waitcnt vmcnt(0)
  v_cmp_eq_u32 vcc, -1, v43
  v_smfmac_f32_16x16x64_bf16 v[64:67], v[48:51], a[96:103], v3
  v_smfmac_f32_16x16x64_bf16 v[68:71], v[48:51], a[104:111], v3
  s_cbranch_vccnz L_c_safe_A_f0
  v_smfmac_f32_16x16x64_bf16 v[56:59], v[40:43], a[0:7], v3
  v_smfmac_f32_16x16x64_bf16 v[60:63], v[40:43], a[8:15], v3
  v_smfmac_f32_16x16x64_bf16 v[64:67], v[40:43], a[64:71], v3
  v_smfmac_f32_16x16x64_bf16 v[68:71], v[40:43], a[72:79], v3
  s_branch L_c_safe_A_done
  .fill (((0 - (. - L_0)) & 31) >> 2), 4, 0xbf800000
L_c_safe_A_f013:
  s_mov_b64 exec, vcc
  global_load_dwordx4 v[40:43], v4, s[44:45] offset:0 sc1
  s_mov_b64 exec, -1
  s_sub_u32 s39, s39, 1
  s_cbranch_scc1 L_c_safe_bail
  s_waitcnt vmcnt(2)
  v_cmp_eq_u32 vcc, -1, v47
  s_cbranch_vccnz L_c_safe_A_f130
  v_smfmac_f32_16x16x64_bf16 v[56:59], v[44:47], a[16:23], v3
  v_smfmac_f32_16x16x64_bf16 v[60:63], v[44:47], a[24:31], v3
  s_waitcnt vmcnt(1)
  v_cmp_eq_u32 vcc, -1, v55
  v_smfmac_f32_16x16x64_bf16 v[64:67], v[44:47], a[80:87], v3
  v_smfmac_f32_16x16x64_bf16 v[68:71], v[44:47], a[88:95], v3
  s_cbranch_vccnz L_c_safe_A_f30
  v_smfmac_f32_16x16x64_bf16 v[56:59], v[52:55], a[48:55], v3
  v_smfmac_f32_16x16x64_bf16 v[60:63], v[52:55], a[56:63], v3
  s_waitcnt vmcnt(0)
  v_cmp_eq_u32 vcc, -1, v43
  v_smfmac_f32_16x16x64_bf16 v[64:67], v[52:55], a[112:119], v3
  v_smfmac_f32_16x16x64_bf16 v[68:71], v[52:55], a[120:127], v3
  s_cbranch_vccnz L_c_safe_A_f0
  v_smfmac_f32_16x16x64_bf16 v[56:59], v[40:43], a[0:7], v3
  v_smfmac_f32_16x16x64_bf16 v[60:63], v[40:43], a[8:15], v3
  v_smfmac_f32_16x16x64_bf16 v[64:67], v[40:43], a[64:71], v3
  v_smfmac_f32_16x16x64_bf16 v[68:71], v[40:43], a[72:79], v3
  s_branch L_c_safe_A_done
  .fill (((0 - (. - L_0)) & 31) >> 2), 4, 0xbf800000
L_c_safe_A_f10:
  s_mov_b64 exec, vcc
  global_load_dwordx4 v[44:47], v4, s[44:45] offset:1024 sc1
  s_mov_b64 exec, -1
  s_sub_u32 s39, s39, 1
  s_cbranch_scc1 L_c_safe_bail
  s_waitcnt vmcnt(1)
  v_cmp_eq_u32 vcc, -1, v43
  s_cbranch_vccnz L_c_safe_A_f01
  v_smfmac_f32_16x16x64_bf16 v[56:59], v[40:43], a[0:7], v3
  v_smfmac_f32_16x16x64_bf16 v[60:63], v[40:43], a[8:15], v3
  s_waitcnt vmcnt(0)
  v_cmp_eq_u32 vcc, -1, v47
  v_smfmac_f32_16x16x64_bf16 v[64:67], v[40:43], a[64:71], v3
  v_smfmac_f32_16x16x64_bf16 v[68:71], v[40:43], a[72:79], v3
  s_cbranch_vccnz L_c_safe_A_f1
  v_smfmac_f32_16x16x64_bf16 v[56:59], v[44:47], a[16:23], v3
  v_smfmac_f32_16x16x64_bf16 v[60:63], v[44:47], a[24:31], v3
  v_smfmac_f32_16x16x64_bf16 v[64:67], v[44:47], a[80:87], v3
  v_smfmac_f32_16x16x64_bf16 v[68:71], v[44:47], a[88:95], v3
  s_branch L_c_safe_A_done
  .fill (((0 - (. - L_0)) & 31) >> 2), 4, 0xbf800000
L_c_safe_A_f023:
  s_mov_b64 exec, vcc
  global_load_dwordx4 v[40:43], v4, s[44:45] offset:0 sc1
  s_mov_b64 exec, -1
  s_sub_u32 s39, s39, 1
  s_cbranch_scc1 L_c_safe_bail
  s_waitcnt vmcnt(2)
  v_cmp_eq_u32 vcc, -1, v51
  s_cbranch_vccnz L_c_safe_A_f230
  v_smfmac_f32_16x16x64_bf16 v[56:59], v[48:51], a[32:39], v3
  v_smfmac_f32_16x16x64_bf16 v[60:63], v[48:51], a[40:47], v3
  s_waitcnt vmcnt(1)
  v_cmp_eq_u32 vcc, -1, v55
  v_smfmac_f32_16x16x64_bf16 v[64:67], v[48:51], a[96:103], v3
  v_smfmac_f32_16x16x64_bf16 v[68:71], v[48:51], a[104:111], v3
  s_cbranch_vccnz L_c_safe_A_f30
  v_smfmac_f32_16x16x64_bf16 v[56:59], v[52:55], a[48:55], v3
  v_smfmac_f32_16x16x64_bf16 v[60:63], v[52:55], a[56:63], v3
  s_waitcnt vmcnt(0)
  v_cmp_eq_u32 vcc, -1, v43
  v_smfmac_f32_16x16x64_bf16 v[64:67], v[52:55], a[112:119], v3
  v_smfmac_f32_16x16x64_bf16 v[68:71], v[52:55], a[120:127], v3
  s_cbranch_vccnz L_c_safe_A_f0
  v_smfmac_f32_16x16x64_bf16 v[56:59], v[40:43], a[0:7], v3
  v_smfmac_f32_16x16x64_bf16 v[60:63], v[40:43], a[8:15], v3
  v_smfmac_f32_16x16x64_bf16 v[64:67], v[40:43], a[64:71], v3
  v_smfmac_f32_16x16x64_bf16 v[68:71], v[40:43], a[72:79], v3
  s_branch L_c_safe_A_done
  .fill (((0 - (. - L_0)) & 31) >> 2), 4, 0xbf800000
L_c_safe_A_f20:
  s_mov_b64 exec, vcc
  global_load_dwordx4 v[48:51], v4, s[44:45] offset:2048 sc1
  s_mov_b64 exec, -1
  s_sub_u32 s39, s39, 1
  s_cbranch_scc1 L_c_safe_bail
  s_waitcnt vmcnt(1)
  v_cmp_eq_u32 vcc, -1, v43
  s_cbranch_vccnz L_c_safe_A_f02
  v_smfmac_f32_16x16x64_bf16 v[56:59], v[40:43], a[0:7], v3
  v_smfmac_f32_16x16x64_bf16 v[60:63], v[40:43], a[8:15], v3
  s_waitcnt vmcnt(0)
  v_cmp_eq_u32 vcc, -1, v51
  v_smfmac_f32_16x16x64_bf16 v[64:67], v[40:43], a[64:71], v3
  v_smfmac_f32_16x16x64_bf16 v[68:71], v[40:43], a[72:79], v3
  s_cbranch_vccnz L_c_safe_A_f2
  v_smfmac_f32_16x16x64_bf16 v[56:59], v[48:51], a[32:39], v3
  v_smfmac_f32_16x16x64_bf16 v[60:63], v[48:51], a[40:47], v3
  v_smfmac_f32_16x16x64_bf16 v[64:67], v[48:51], a[96:103], v3
  v_smfmac_f32_16x16x64_bf16 v[68:71], v[48:51], a[104:111], v3
  s_branch L_c_safe_A_done
  .fill (((0 - (. - L_0)) & 31) >> 2), 4, 0xbf800000
L_c_safe_A_f21:
  s_mov_b64 exec, vcc
  global_load_dwordx4 v[48:51], v4, s[44:45] offset:2048 sc1
  s_mov_b64 exec, -1
  s_sub_u32 s39, s39, 1
  s_cbranch_scc1 L_c_safe_bail
  s_waitcnt vmcnt(1)
  v_cmp_eq_u32 vcc, -1, v47
  s_cbranch_vccnz L_c_safe_A_f12
  v_smfmac_f32_16x16x64_bf16 v[56:59], v[44:47], a[16:23], v3
  v_smfmac_f32_16x16x64_bf16 v[60:63], v[44:47], a[24:31], v3
  s_waitcnt vmcnt(0)
  v_cmp_eq_u32 vcc, -1, v51
  v_smfmac_f32_16x16x64_bf16 v[64:67], v[44:47], a[80:87], v3
  v_smfmac_f32_16x16x64_bf16 v[68:71], v[44:47], a[88:95], v3
  s_cbranch_vccnz L_c_safe_A_f2
  v_smfmac_f32_16x16x64_bf16 v[56:59], v[48:51], a[32:39], v3
  v_smfmac_f32_16x16x64_bf16 v[60:63], v[48:51], a[40:47], v3
  v_smfmac_f32_16x16x64_bf16 v[64:67], v[48:51], a[96:103], v3
  v_smfmac_f32_16x16x64_bf16 v[68:71], v[48:51], a[104:111], v3
  s_branch L_c_safe_A_done
  .fill (((0 - (. - L_0)) & 31) >> 2), 4, 0xbf800000
L_c_safe_A_f120:
  s_mov_b64 exec, vcc
  global_load_dwordx4 v[44:47], v4, s[44:45] offset:1024 sc1
  s_mov_b64 exec, -1
  s_sub_u32 s39, s39, 1
  s_cbranch_scc1 L_c_safe_bail
  s_waitcnt vmcnt(2)
  v_cmp_eq_u32 vcc, -1, v51
  s_cbranch_vccnz L_c_safe_A_f201
  v_smfmac_f32_16x16x64_bf16 v[56:59], v[48:51], a[32:39], v3
  v_smfmac_f32_16x16x64_bf16 v[60:63], v[48:51], a[40:47], v3
  s_waitcnt vmcnt(1)
  v_cmp_eq_u32 vcc, -1, v43
  v_smfmac_f32_16x16x64_bf16 v[64:67], v[48:51], a[96:103], v3
  v_smfmac_f32_16x16x64_bf16 v[68:71], v[48:51], a[104:111], v3
  s_cbranch_vccnz L_c_safe_A_f01
  v_smfmac_f32_16x16x64_bf16 v[56:59], v[40:43], a[0:7], v3
  v_smfmac_f32_16x16x64_bf16 v[60:63], v[40:43], a[8:15], v3
  s_waitcnt vmcnt(0)
  v_cmp_eq_u32 vcc, -1, v47
  v_smfmac_f32_16x16x64_bf16 v[64:67], v[40:43], a[64:71], v3
  v_smfmac_f32_16x16x64_bf16 v[68:71], v[40:43], a[72:79], v3
  s_cbranch_vccnz L_c_safe_A_f1
  v_smfmac_f32_16x16x64_bf16 v[56:59], v[44:47], a[16:23], v3
  v_smfmac_f32_16x16x64_bf16 v[60:63], v[44:47], a[24:31], v3
  v_smfmac_f32_16x16x64_bf16 v[64:67], v[44:47], a[80:87], v3
  v_smfmac_f32_16x16x64_bf16 v[68:71], v[44:47], a[88:95], v3
  s_branch L_c_safe_A_done
  .fill (((0 - (. - L_0)) & 31) >> 2), 4, 0xbf800000
L_c_safe_A_f130:
  s_mov_b64 exec, vcc
  global_load_dwordx4 v[44:47], v4, s[44:45] offset:1024 sc1
  s_mov_b64 exec, -1
  s_sub_u32 s39, s39, 1
  s_cbranch_scc1 L_c_safe_bail
  s_waitcnt vmcnt(2)
  v_cmp_eq_u32 vcc, -1, v55
  s_cbranch_vccnz L_c_safe_A_f301
  v_smfmac_f32_16x16x64_bf16 v[56:59], v[52:55], a[48:55], v3
  v_smfmac_f32_16x16x64_bf16 v[60:63], v[52:55], a[56:63], v3
  s_waitcnt vmcnt(1)
  v_cmp_eq_u32 vcc, -1, v43
  v_smfmac_f32_16x16x64_bf16 v[64:67], v[52:55], a[112:119], v3
  v_smfmac_f32_16x16x64_bf16 v[68:71], v[52:55], a[120:127], v3
  s_cbranch_vccnz L_c_safe_A_f01
  v_smfmac_f32_16x16x64_bf16 v[56:59], v[40:43], a[0:7], v3
  v_smfmac_f32_16x16x64_bf16 v[60:63], v[40:43], a[8:15], v3
  s_waitcnt vmcnt(0)
  v_cmp_eq_u32 vcc, -1, v47
  v_smfmac_f32_16x16x64_bf16 v[64:67], v[40:43], a[64:71], v3
  v_smfmac_f32_16x16x64_bf16 v[68:71], v[40:43], a[72:79], v3
  s_cbranch_vccnz L_c_safe_A_f1
  v_smfmac_f32_16x16x64_bf16 v[56:59], v[44:47], a[16:23], v3
  v_smfmac_f32_16x16x64_bf16 v[60:63], v[44:47], a[24:31], v3
  v_smfmac_f32_16x16x64_bf16 v[64:67], v[44:47], a[80:87], v3
  v_smfmac_f32_16x16x64_bf16 v[68:71], v[44:47], a[88:95], v3
  s_branch L_c_safe_A_done
  .fill (((0 - (. - L_0)) & 31) >> 2), 4, 0xbf800000
L_c_safe_A_f201:
  s_mov_b64 exec, vcc
  global_load_dwordx4 v[48:51], v4, s[44:45] offset:2048 sc1
  s_mov_b64 exec, -1
  s_sub_u32 s39, s39, 1
  s_cbranch_scc1 L_c_safe_bail
  s_waitcnt vmcnt(2)
  v_cmp_eq_u32 vcc, -1, v43
  s_cbranch_vccnz L_c_safe_A_f012
  v_smfmac_f32_16x16x64_bf16 v[56:59], v[40:43], a[0:7], v3
  v_smfmac_f32_16x16x64_bf16 v[60:63], v[40:43], a[8:15], v3
  s_waitcnt vmcnt(1)
  v_cmp_eq_u32 vcc, -1, v47
  v_smfmac_f32_16x16x64_bf16 v[64:67], v[40:43], a[64:71], v3
  v_smfmac_f32_16x16x64_bf16 v[68:71], v[40:43], a[72:79], v3
  s_cbranch_vccnz L_c_safe_A_f12
  v_smfmac_f32_16x16x64_bf16 v[56:59], v[44:47], a[16:23], v3
  v_smfmac_f32_16x16x64_bf16 v[60:63], v[44:47], a[24:31], v3
  s_waitcnt vmcnt(0)
  v_cmp_eq_u32 vcc, -1, v51
  v_smfmac_f32_16x16x64_bf16 v[64:67], v[44:47], a[80:87], v3
  v_smfmac_f32_16x16x64_bf16 v[68:71], v[44:47], a[88:95], v3
  s_cbranch_vccnz L_c_safe_A_f2
  v_smfmac_f32_16x16x64_bf16 v[56:59], v[48:51], a[32:39], v3
  v_smfmac_f32_16x16x64_bf16 v[60:63], v[48:51], a[40:47], v3
  v_smfmac_f32_16x16x64_bf16 v[64:67], v[48:51], a[96:103], v3
  v_smfmac_f32_16x16x64_bf16 v[68:71], v[48:51], a[104:111], v3
  s_branch L_c_safe_A_done
  .fill (((0 - (. - L_0)) & 31) >> 2), 4, 0xbf800000
L_c_safe_Sret:
  global_load_dword v176, v13, s[44:45] offset:1024 sc1
  global_load_dword v177, v13, s[44:45] offset:3072 sc1
  global_load_dword v178, v14, s[44:45] offset:1024 sc1
  global_load_dword v179, v14, s[44:45] offset:3072 sc1
  global_load_dwordx4 v[164:167], v9, s[44:45] sc1
  global_load_dwordx4 v[168:171], v10, s[44:45] sc1
  global_load_dwordx4 v[172:175], v11, s[44:45] sc1
  s_sub_u32 s39, s39, 1
  s_cbranch_scc0 L_c_safe_Schk
  s_endpgm
  .fill (((0 - (. - L_0)) & 31) >> 2), 4, 0xbf800000
L_c_safe_E0_f0123:
  s_mov_b64 exec, vcc
  global_load_dwordx4 v[40:43], v29, s[44:45] offset:0 sc1
  s_not_b64 exec, vcc
  v_mov_b64 v[40:41], 0
  v_mov_b64 v[42:43], 0
  s_mov_b64 exec, -1
  s_sub_u32 s39, s39, 1
  s_cbranch_scc1 L_c_safe_bail
  s_waitcnt vmcnt(3)
  v_smfmac_f32_16x16x64_bf16 v[80:83], v[44:47], a[208:215], v3
  v_cmp_gt_i32 vcc, s77, v47
  v_smfmac_f32_16x16x64_bf16 v[84:87], v[44:47], a[216:223], v3
  s_cbranch_vccnz L_c_safe_E0_f1230
  s_waitcnt vmcnt(2)
  v_smfmac_f32_16x16x64_bf16 v[80:83], v[48:51], a[224:231], v3
  v_cmp_gt_i32 vcc, s77, v51
  v_smfmac_f32_16x16x64_bf16 v[84:87], v[48:51], a[232:239], v3
  s_cbranch_vccnz L_c_safe_E0_f230
  s_waitcnt vmcnt(1)
  v_smfmac_f32_16x16x64_bf16 v[80:83], v[52:55], a[240:247], v3
  v_cmp_gt_i32 vcc, s77, v55
  v_smfmac_f32_16x16x64_bf16 v[84:87], v[52:55], a[248:255], v3
  s_cbranch_vccnz L_c_safe_E0_f30
  s_waitcnt vmcnt(0)
  v_smfmac_f32_16x16x64_bf16 v[80:83], v[40:43], a[192:199], v3
  v_cmp_gt_i32 vcc, s77, v43
  v_smfmac_f32_16x16x64_bf16 v[84:87], v[40:43], a[200:207], v3
  s_nop 5
  s_cbranch_vccnz L_c_safe_E0_f0
  s_branch L_c_safe_E0_done
  .fill (((0 - (. - L_0)) & 31) >> 2), 4, 0xbf800000
L_c_safe_E0_f123:
  s_mov_b64 exec, vcc
  global_load_dwordx4 v[44:47], v29, s[44:45] offset:1024 sc1
  s_not_b64 exec, vcc
  v_mov_b64 v[44:45], 0
  v_mov_b64 v[46:47], 0
  s_mov_b64 exec, -1
  s_sub_u32 s39, s39, 1
  s_cbranch_scc1 L_c_safe_bail
  s_waitcnt vmcnt(2)
  v_smfmac_f32_16x16x64_bf16 v[80:83], v[48:51], a[224:231], v3
  v_cmp_gt_i32 vcc, s77, v51
  v_smfmac_f32_16x16x64_bf16 v[84:87], v[48:51], a[232:239], v3
  s_cbranch_vccnz L_c_safe_E0_f231
  s_waitcnt vmcnt(1)
  v_smfmac_f32_16x16x64_bf16 v[80:83], v[52:55], a[240:247], v3
  v_cmp_gt_i32 vcc, s77, v55
  v_smfmac_f32_16x16x64_bf16 v[84:87], v[52:55], a[248:255], v3
  s_cbranch_vccnz L_c_safe_E0_f31
  s_waitcnt vmcnt(0)
  v_smfmac_f32_16x16x64_bf16 v[80:83], v[44:47], a[208:215], v3
  v_cmp_gt_i32 vcc, s77, v47
  v_smfmac_f32_16x16x64_bf16 v[84:87], v[44:47], a[216:223], v3
  s_nop 5
  s_cbranch_vccnz L_c_safe_E0_f1
  s_branch L_c_safe_E0_done
  .fill (((0 - (. - L_0)) & 31) >> 2), 4, 0xbf800000
L_c_safe_E0_f23:
  s_mov_b64 exec, vcc
  global_load_dwordx4 v[48:51], v29, s[44:45] offset:2048 sc1
  s_not_b64 exec, vcc
  v_mov_b64 v[48:49], 0
  v_mov_b64 v[50:51], 0
  s_mov_b64 exec, -1
  s_sub_u32 s39, s39, 1
  s_cbranch_scc1 L_c_safe_bail
  s_waitcnt vmcnt(1)
  v_smfmac_f32_16x16x64_bf16 v[80:83], v[52:55], a[240:247], v3
  v_cmp_gt_i32 vcc, s77, v55
  v_smfmac_f32_16x16x64_bf16 v[84:87], v[52:55], a[248:255], v3
  s_cbranch_vccnz L_c_safe_E0_f32
  s_waitcnt vmcnt(0)
  v_smfmac_f32_16x16x64_bf16 v[80:83], v[48:51], a[224:231], v3
  v_cmp_gt_i32 vcc, s77, v51
  v_smfmac_f32_16x16x64_bf16 v[84:87], v[48:51], a[232:239], v3
  s_nop 5
  s_cbranch_vccnz L_c_safe_E0_f2
  s_branch L_c_safe_E0_done
  .fill (((0 - (. - L_0)) & 31) >> 2), 4, 0xbf800000
L_c_safe_E0_f3:
  s_mov_b64 exec, vcc
  global_load_dwordx4 v[52:55], v29, s[44:45] offset:3072 sc1
  s_not_b64 exec, vcc
  v_mov_b64 v[52:53], 0
  v_mov_b64 v[54:55], 0
  s_mov_b64 exec, -1
  s_sub_u32 s39, s39, 1
  s_cbranch_scc1 L_c_safe_bail
  s_waitcnt vmcnt(0)
  v_smfmac_f32_16x16x64_bf16 v[80:83], v[52:55], a[240:247], v3
  v_cmp_gt_i32 vcc, s77, v55
  v_smfmac_f32_16x16x64_bf16 v[84:87], v[52:55], a[248:255], v3
  s_nop 5
  s_cbranch_vccnz L_c_safe_E0_f3
  s_branch L_c_safe_E0_done
  .fill (((0 - (. - L_0)) & 31) >> 2), 4, 0xbf800000
L_c_safe_E0_f1230:
  s_mov_b64 exec, vcc
  global_load_dwordx4 v[44:47], v29, s[44:45] offset:1024 sc1
  s_not_b64 exec, vcc
  v_mov_b64 v[44:45], 0
  v_mov_b64 v[46:47], 0
  s_mov_b64 exec, -1
  s_sub_u32 s39, s39, 1
  s_cbranch_scc1 L_c_safe_bail
  s_waitcnt vmcnt(3)
  v_smfmac_f32_16x16x64_bf16 v[80:83], v[48:51], a[224:231], v3
  v_cmp_gt_i32 vcc, s77, v51
  v_smfmac_f32_16x16x64_bf16 v[84:87], v[48:51], a[232:239], v3
  s_cbranch_vccnz L_c_safe_E0_f2301
  s_waitcnt vmcnt(2)
  v_smfmac_f32_16x16x64_bf16 v[80:83], v[52:55], a[240:247], v3
  v_cmp_gt_i32 vcc, s77, v55
  v_smfmac_f32_16x16x64_bf16 v[84:87], v[52:55], a[248:255], v3
  s_cbranch_vccnz L_c_safe_E0_f301
  s_waitcnt vmcnt(1)
  v_smfmac_f32_16x16x64_bf16 v[80:83], v[40:43], a[192:199], v3
  v_cmp_gt_i32 vcc, s77, v43
  v_smfmac_f32_16x16x64_bf16 v[84:87], v[40:43], a[200:207], v3
  s_cbranch_vccnz L_c_safe_E0_f01
  s_waitcnt vmcnt(0)
  v_smfmac_f32_16x16x64_bf16 v[80:83], v[44:47], a[208:215], v3
  v_cmp_gt_i32 vcc, s77, v47
  v_smfmac_f32_16x16x64_bf16 v[84:87], v[44:47], a[216:223], v3
  s_nop 5
  s_cbranch_vccnz L_c_safe_E0_f1
  s_branch L_c_safe_E0_done
  .fill (((0 - (. - L_0)) & 31) >> 2), 4, 0xbf800000
L_c_safe_E0_f230:
  s_mov_b64 exec, vcc
  global_load_dwordx4 v[48:51], v29, s[44:45] offset:2048 sc1
  s_not_b64 exec, vcc
  v_mov_b64 v[48:49], 0
  v_mov_b64 v[50:51], 0
  s_mov_b64 exec, -1
  s_sub_u32 s39, s39, 1
  s_cbranch_scc1 L_c_safe_bail
  s_waitcnt vmcnt(2)
  v_smfmac_f32_16x16x64_bf16 v[80:83], v[52:55], a[240:247], v3
  v_cmp_gt_i32 vcc, s77, v55
  v_smfmac_f32_16x16x64_bf16 v[84:87], v[52:55], a[248:255], v3
  s_cbranch_vccnz L_c_safe_E0_f302
  s_waitcnt vmcnt(1)
  v_smfmac_f32_16x16x64_bf16 v[80:83], v[40:43], a[192:199], v3
  v_cmp_gt_i32 vcc, s77, v43
  v_smfmac_f32_16x16x64_bf16 v[84:87], v[40:43], a[200:207], v3
  s_cbranch_vccnz L_c_safe_E0_f02
  s_waitcnt vmcnt(0)
  v_smfmac_f32_16x16x64_bf16 v[80:83], v[48:51], a[224:231], v3
  v_cmp_gt_i32 vcc, s77, v51
  v_smfmac_f32_16x16x64_bf16 v[84:87], v[48:51], a[232:239], v3
  s_nop 5
  s_cbranch_vccnz L_c_safe_E0_f2
  s_branch L_c_safe_E0_done
  .fill (((0 - (. - L_0)) & 31) >> 2), 4, 0xbf800000
L_c_safe_E0_f30:
  s_mov_b64 exec, vcc
  global_load_dwordx4 v[52:55], v29, s[44:45] offset:3072 sc1
  s_not_b64 exec, vcc
  v_mov_b64 v[52:53], 0
  v_mov_b64 v[54:55], 0
  s_mov_b64 exec, -1
  s_sub_u32 s39, s39, 1
  s_cbranch_scc1 L_c_safe_bail
  s_waitcnt vmcnt(1)
  v_smfmac_f32_16x16x64_bf16 v[80:83], v[40:43], a[192:199], v3
  v_cmp_gt_i32 vcc, s77, v43
  v_smfmac_f32_16x16x64_bf16 v[84:87], v[40:43], a[200:207], v3
  s_cbranch_vccnz L_c_safe_E0_f03
  s_waitcnt vmcnt(0)
  v_smfmac_f32_16x16x64_bf16 v[80:83], v[52:55], a[240:247], v3
  v_cmp_gt_i32 vcc, s77, v55
  v_smfmac_f32_16x16x64_bf16 v[84:87], v[52:55], a[248:255], v3
  s_nop 5
  s_cbranch_vccnz L_c_safe_E0_f3
  s_branch L_c_safe_E0_done
  .fill (((0 - (. - L_0)) & 31) >> 2), 4, 0xbf800000
L_c_safe_E0_f0:
  s_mov_b64 exec, vcc
  global_load_dwordx4 v[40:43], v29, s[44:45] offset:0 sc1
  s_not_b64 exec, vcc
  v_mov_b64 v[40:41], 0
  v_mov_b64 v[42:43], 0
  s_mov_b64 exec, -1
  s_sub_u32 s39, s39, 1
  s_cbranch_scc1 L_c_safe_bail
  s_waitcnt vmcnt(0)
  v_smfmac_f32_16x16x64_bf16 v[80:83], v[40:43], a[192:199], v3
  v_cmp_gt_i32 vcc, s77, v43
  v_smfmac_f32_16x16x64_bf16 v[84:87], v[40:43], a[200:207], v3
  s_nop 5
  s_cbranch_vccnz L_c_safe_E0_f0
  s_branch L_c_safe_E0_done
  .fill (((0 - (. - L_0)) & 31) >> 2), 4, 0xbf800000
L_c_safe_E0_f231:
  s_mov_b64 exec, vcc
  global_load_dwordx4 v[48:51], v29, s[44:45] offset:2048 sc1
  s_not_b64 exec, vcc
  v_mov_b64 v[48:49], 0
  v_mov_b64 v[50:51], 0
  s_mov_b64 exec, -1
  s_sub_u32 s39, s39, 1
  s_cbranch_scc1 L_c_safe_bail
  s_waitcnt vmcnt(2)
  v_smfmac_f32_16x16x64_bf16 v[80:83], v[52:55], a[240:247], v3
  v_cmp_gt_i32 vcc, s77, v55
  v_smfmac_f32_16x16x64_bf16 v[84:87], v[52:55], a[248:255], v3
  s_cbranch_vccnz L_c_safe_E0_f312
  s_waitcnt vmcnt(1)
  v_smfmac_f32_16x16x64_bf16 v[80:83], v[44:47], a[208:215], v3
  v_cmp_gt_i32 vcc, s77, v47
  v_smfmac_f32_16x16x64_bf16 v[84:87], v[44:47], a[216:223], v3
  s_cbranch_vccnz L_c_safe_E0_f12
  s_waitcnt vmcnt(0)
  v_smfmac_f32_16x16x64_bf16 v[80:83], v[48:51], a[224:231], v3
  v_cmp_gt_i32 vcc, s77, v51
  v_smfmac_f32_16x16x64_bf16 v[84:87], v[48:51], a[232:239], v3
  s_nop 5
  s_cbranch_vccnz L_c_safe_E0_f2
  s_branch L_c_safe_E0_done
  .fill (((0 - (. - L_0)) & 31) >> 2), 4, 0xbf800000
L_c_safe_E0_f31:
  s_mov_b64 exec, vcc
  global_load_dwordx4 v[52:55], v29, s[44:45] offset:3072 sc1
  s_not_b64 exec, vcc
  v_mov_b64 v[52:53], 0
  v_mov_b64 v[54:55], 0
  s_mov_b64 exec, -1
  s_sub_u32 s39, s39, 1
  s_cbranch_scc1 L_c_safe_bail
  s_waitcnt vmcnt(1)
  v_smfmac_f32_16x16x64_bf16 v[80:83], v[44:47], a[208:215], v3
  v_cmp_gt_i32 vcc, s77, v47
  v_smfmac_f32_16x16x64_bf16 v[84:87], v[44:47], a[216:223], v3
  s_cbranch_vccnz L_c_safe_E0_f13
  s_waitcnt vmcnt(0)
  v_smfmac_f32_16x16x64_bf16 v[80:83], v[52:55], a[240:247], v3
  v_cmp_gt_i32 vcc, s77, v55
  v_smfmac_f32_16x16x64_bf16 v[84:87], v[52:55], a[248:255], v3
  s_nop 5
  s_cbranch_vccnz L_c_safe_E0_f3
  s_branch L_c_safe_E0_done
  .fill (((0 - (. - L_0)) & 31) >> 2), 4, 0xbf800000
L_c_safe_E0_f1:
  s_mov_b64 exec, vcc
  global_load_dwordx4 v[44:47], v29, s[44:45] offset:1024 sc1
  s_not_b64 exec, vcc
  v_mov_b64 v[44:45], 0
  v_mov_b64 v[46:47], 0
  s_mov_b64 exec, -1
  s_sub_u32 s39, s39, 1
  s_cbranch_scc1 L_c_safe_bail
  s_waitcnt vmcnt(0)
  v_smfmac_f32_16x16x64_bf16 v[80:83], v[44:47], a[208:215], v3
  v_cmp_gt_i32 vcc, s77, v47
  v_smfmac_f32_16x16x64_bf16 v[84:87], v[44:47], a[216:223], v3
  s_nop 5
  s_cbranch_vccnz L_c_safe_E0_f1
  s_branch L_c_safe_E0_done
  .fill (((0 - (. - L_0)) & 31) >> 2), 4, 0xbf800000
L_c_safe_E0_f32:
  s_mov_b64 exec, vcc
  global_load_dwordx4 v[52:55], v29, s[44:45] offset:3072 sc1
  s_not_b64 exec, vcc
  v_mov_b64 v[52:53], 0
  v_mov_b64 v[54:55], 0
  s_mov_b64 exec, -1
  s_sub_u32 s39, s39, 1
  s_cbranch_scc1 L_c_safe_bail
  s_waitcnt vmcnt(1)
  v_smfmac_f32_16x16x64_bf16 v[80:83], v[48:51], a[224:231], v3
  v_cmp_gt_i32 vcc, s77, v51
  v_smfmac_f32_16x16x64_bf16 v[84:87], v[48:51], a[232:239], v3
  s_cbranch_vccnz L_c_safe_E0_f23
  s_waitcnt vmcnt(0)
  v_smfmac_f32_16x16x64_bf16 v[80:83], v[52:55], a[240:247], v3
  v_cmp_gt_i32 vcc, s77, v55
  v_smfmac_f32_16x16x64_bf16 v[84:87], v[52:55], a[248:255], v3
  s_nop 5
  s_cbranch_vccnz L_c_safe_E0_f3
  s_branch L_c_safe_E0_done
  .fill (((0 - (. - L_0)) & 31) >> 2), 4, 0xbf800000
L_c_safe_E0_f2:
  s_mov_b64 exec, vcc
  global_load_dwordx4 v[48:51], v29, s[44:45] offset:2048 sc1
  s_not_b64 exec, vcc
  v_mov_b64 v[48:49], 0
  v_mov_b64 v[50:51], 0
  s_mov_b64 exec, -1
  s_sub_u32 s39, s39, 1
  s_cbranch_scc1 L_c_safe_bail
  s_waitcnt vmcnt(0)
  v_smfmac_f32_16x16x64_bf16 v[80:83], v[48:51], a[224:231], v3
  v_cmp_gt_i32 vcc, s77, v51
  v_smfmac_f32_16x16x64_bf16 v[84:87], v[48:51], a[232:239], v3
  s_nop 5
  s_cbranch_vccnz L_c_safe_E0_f2
  s_branch L_c_safe_E0_done
  .fill (((0 - (. - L_0)) & 31) >> 2), 4, 0xbf800000
L_c_safe_E0_f2301:
  s_mov_b64 exec, vcc
  global_load_dwordx4 v[48:51], v29, s[44:45] offset:2048 sc1
  s_not_b64 exec, vcc
  v_mov_b64 v[48:49], 0
  v_mov_b64 v[50:51], 0
  s_mov_b64 exec, -1
  s_sub_u32 s39, s39, 1
  s_cbranch_scc1 L_c_safe_bail
  s_waitcnt vmcnt(3)
  v_smfmac_f32_16x16x64_bf16 v[80:83], v[52:55], a[240:247], v3
  v_cmp_gt_i32 vcc, s77, v55
  v_smfmac_f32_16x16x64_bf16 v[84:87], v[52:55], a[248:255], v3
  s_cbranch_vccnz L_c_safe_E0_f3012
  s_waitcnt vmcnt(2)
  v_smfmac_f32_16x16x64_bf16 v[80:83], v[40:43], a[192:199], v3
  v_cmp_gt_i32 vcc, s77, v43
  v_smfmac_f32_16x16x64_bf16 v[84:87], v[40:43], a[200:207], v3
  s_cbranch_vccnz L_c_safe_E0_f012
  s_waitcnt vmcnt(1)
  v_smfmac_f32_16x16x64_bf16 v[80:83], v[44:47], a[208:215], v3
  v_cmp_gt_i32 vcc, s77, v47
  v_smfmac_f32_16x16x64_bf16 v[84:87], v[44:47], a[216:223], v3
  s_cbranch_vccnz L_c_safe_E0_f12
  s_waitcnt vmcnt(0)
  v_smfmac_f32_16x16x64_bf16 v[80:83], v[48:51], a[224:231], v3
  v_cmp_gt_i32 vcc, s77, v51
  v_smfmac_f32_16x16x64_bf16 v[84:87], v[48:51], a[232:239], v3
  s_nop 5
  s_cbranch_vccnz L_c_safe_E0_f2
  s_branch L_c_safe_E0_done
  .fill (((0 - (. - L_0)) & 31) >> 2), 4, 0xbf800000
L_c_safe_E0_f301:
  s_mov_b64 exec, vcc
  global_load_dwordx4 v[52:55], v29, s[44:45] offset:3072 sc1
  s_not_b64 exec, vcc
  v_mov_b64 v[52:53], 0
  v_mov_b64 v[54:55], 0
  s_mov_b64 exec, -1
  s_sub_u32 s39, s39, 1
  s_cbranch_scc1 L_c_safe_bail
  s_waitcnt vmcnt(2)
  v_smfmac_f32_16x16x64_bf16 v[80:83], v[40:43], a[192:199], v3
  v_cmp_gt_i32 vcc, s77, v43
  v_smfmac_f32_16x16x64_bf16 v[84:87], v[40:43], a[200:207], v3
  s_cbranch_vccnz L_c_safe_E0_f013
  s_waitcnt vmcnt(1)
  v_smfmac_f32_16x16x64_bf16 v[80:83], v[44:47], a[208:215], v3
  v_cmp_gt_i32 vcc, s77, v47
  v_smfmac_f32_16x16x64_bf16 v[84:87], v[44:47], a[216:223], v3
  s_cbranch_vccnz L_c_safe_E0_f13
  s_waitcnt vmcnt(0)
  v_smfmac_f32_16x16x64_bf16 v[80:83], v[52:55], a[240:247], v3
  v_cmp_gt_i32 vcc, s77, v55
  v_smfmac_f32_16x16x64_bf16 v[84:87], v[52:55], a[248:255], v3
  s_nop 5
  s_cbranch_vccnz L_c_safe_E0_f3
  s_branch L_c_safe_E0_done
  .fill (((0 - (. - L_0)) & 31) >> 2), 4, 0xbf800000
L_c_safe_E0_f01:
  s_mov_b64 exec, vcc
  global_load_dwordx4 v[40:43], v29, s[44:45] offset:0 sc1
  s_not_b64 exec, vcc
  v_mov_b64 v[40:41], 0
  v_mov_b64 v[42:43], 0
  s_mov_b64 exec, -1
  s_sub_u32 s39, s39, 1
  s_cbranch_scc1 L_c_safe_bail
  s_waitcnt vmcnt(1)
  v_smfmac_f32_16x16x64_bf16 v[80:83], v[44:47], a[208:215], v3
  v_cmp_gt_i32 vcc, s77, v47
  v_smfmac_f32_16x16x64_bf16 v[84:87], v[44:47], a[216:223], v3
  s_cbranch_vccnz L_c_safe_E0_f10
  s_waitcnt vmcnt(0)
  v_smfmac_f32_16x16x64_bf16 v[80:83], v[40:43], a[192:199], v3
  v_cmp_gt_i32 vcc, s77, v43
  v_smfmac_f32_16x16x64_bf16 v[84:87], v[40:43], a[200:207], v3
  s_nop 5
  s_cbranch_vccnz L_c_safe_E0_f0
  s_branch L_c_safe_E0_done
  .fill (((0 - (. - L_0)) & 31) >> 2), 4, 0xbf800000
L_c_safe_E0_f302:
  s_mov_b64 exec, vcc
  global_load_dwordx4 v[52:55], v29, s[44:45] offset:3072 sc1
  s_not_b64 exec, vcc
  v_mov_b64 v[52:53], 0
  v_mov_b64 v[54:55], 0
  s_mov_b64 exec, -1
  s_sub_u32 s39, s39, 1
  s_cbranch_scc1 L_c_safe_bail
  s_waitcnt vmcnt(2)
  v_smfmac_f32_16x16x64_bf16 v[80:83], v[40:43], a[192:199], v3
  v_cmp_gt_i32 vcc, s77, v43
  v_smfmac_f32_16x16x64_bf16 v[84:87], v[40:43], a[200:207], v3
  s_cbranch_vccnz L_c_safe_E0_f023
  s_waitcnt vmcnt(1)
  v_smfmac_f32_16x16x64_bf16 v[80:83], v[48:51], a[224:231], v3
  v_cmp_gt_i32 vcc, s77, v51
  v_smfmac_f32_16x16x64_bf16 v[84:87], v[48:51], a[232:239], v3
  s_cbranch_vccnz L_c_safe_E0_f23
  s_waitcnt vmcnt(0)
  v_smfmac_f32_16x16x64_bf16 v[80:83], v[52:55], a[240:247], v3
  v_cmp_gt_i32 vcc, s77, v55
  v_smfmac_f32_16x16x64_bf16 v[84:87], v[52:55], a[248:255], v3
  s_nop 5
  s_cbranch_vccnz L_c_safe_E0_f3
  s_branch L_c_safe_E0_done
  .fill (((0 - (. - L_0)) & 31) >> 2), 4, 0xbf800000
L_c_safe_E0_f02:
  s_mov_b64 exec, vcc
  global_load_dwordx4 v[40:43], v29, s[44:45] offset:0 sc1
  s_not_b64 exec, vcc
  v_mov_b64 v[40:41], 0
  v_mov_b64 v[42:43], 0
  s_mov_b64 exec, -1
  s_sub_u32 s39, s39, 1
  s_cbranch_scc1 L_c_safe_bail
  s_waitcnt vmcnt(1)
  v_smfmac_f32_16x16x64_bf16 v[80:83], v[48:51], a[224:231], v3
  v_cmp_gt_i32 vcc, s77, v51
  v_smfmac_f32_16x16x64_bf16 v[84:87], v[48:51], a[232:239], v3
  s_cbranch_vccnz L_c_safe_E0_f20
  s_waitcnt vmcnt(0)
  v_smfmac_f32_16x16x64_bf16 v[80:83], v[40:43], a[192:199], v3
  v_cmp_gt_i32 vcc, s77, v43
  v_smfmac_f32_16x16x64_bf16 v[84:87], v[40:43], a[200:207], v3
  s_nop 5
  s_cbranch_vccnz L_c_safe_E0_f0
  s_branch L_c_safe_E0_done
  .fill (((0 - (. - L_0)) & 31) >> 2), 4, 0xbf800000
L_c_safe_E0_f03:
  s_mov_b64 exec, vcc
  global_load_dwordx4 v[40:43], v29, s[44:45] offset:0 sc1
  s_not_b64 exec, vcc
  v_mov_b64 v[40:41], 0
  v_mov_b64 v[42:43], 0
  s_mov_b64 exec, -1
  s_sub_u32 s39, s39, 1
  s_cbranch_scc1 L_c_safe_bail
  s_waitcnt vmcnt(1)
  v_smfmac_f32_16x16x64_bf16 v[80:83], v[52:55], a[240:247], v3
  v_cmp_gt_i32 vcc, s77, v55
  v_smfmac_f32_16x16x64_bf16 v[84:87], v[52:55], a[248:255], v3
  s_cbranch_vccnz L_c_safe_E0_f30
  s_waitcnt vmcnt(0)
  v_smfmac_f32_16x16x64_bf16 v[80:83], v[40:43], a[192:199], v3
  v_cmp_gt_i32 vcc, s77, v43
  v_smfmac_f32_16x16x64_bf16 v[84:87], v[40:43], a[200:207], v3
  s_nop 5
  s_cbranch_vccnz L_c_safe_E0_f0
  s_branch L_c_safe_E0_done
  .fill (((0 - (. - L_0)) & 31) >> 2), 4, 0xbf800000
L_c_safe_E0_f312:
  s_mov_b64 exec, vcc
  global_load_dwordx4 v[52:55], v29, s[44:45] offset:3072 sc1
  s_not_b64 exec, vcc
  v_mov_b64 v[52:53], 0
  v_mov_b64 v[54:55], 0
  s_mov_b64 exec, -1
  s_sub_u32 s39, s39, 1
  s_cbranch_scc1 L_c_safe_bail
  s_waitcnt vmcnt(2)
  v_smfmac_f32_16x16x64_bf16 v[80:83], v[44:47], a[208:215], v3
  v_cmp_gt_i32 vcc, s77, v47
  v_smfmac_f32_16x16x64_bf16 v[84:87], v[44:47], a[216:223], v3
  s_cbranch_vccnz L_c_safe_E0_f123
  s_waitcnt vmcnt(1)
  v_smfmac_f32_16x16x64_bf16 v[80:83], v[48:51], a[224:231], v3
  v_cmp_gt_i32 vcc, s77, v51
  v_smfmac_f32_16x16x64_bf16 v[84:87], v[48:51], a[232:239], v3
  s_cbranch_vccnz L_c_safe_E0_f23
  s_waitcnt vmcnt(0)
  v_smfmac_f32_16x16x64_bf16 v[80:83], v[52:55], a[240:247], v3
  v_cmp_gt_i32 vcc, s77, v55
  v_smfmac_f32_16x16x64_bf16 v[84:87], v[52:55], a[248:255], v3
  s_nop 5
  s_cbranch_vccnz L_c_safe_E0_f3
  s_branch L_c_safe_E0_done
  .fill (((0 - (. - L_0)) & 31) >> 2), 4, 0xbf800000
L_c_safe_E0_f12:
  s_mov_b64 exec, vcc
  global_load_dwordx4 v[44:47], v29, s[44:45] offset:1024 sc1
  s_not_b64 exec, vcc
  v_mov_b64 v[44:45], 0
  v_mov_b64 v[46:47], 0
  s_mov_b64 exec, -1
  s_sub_u32 s39, s39, 1
  s_cbranch_scc1 L_c_safe_bail
  s_waitcnt vmcnt(1)
  v_smfmac_f32_16x16x64_bf16 v[80:83], v[48:51], a[224:231], v3
  v_cmp_gt_i32 vcc, s77, v51
  v_smfmac_f32_16x16x64_bf16 v[84:87], v[48:51], a[232:239], v3
  s_cbranch_vccnz L_c_safe_E0_f21
  s_waitcnt vmcnt(0)
  v_smfmac_f32_16x16x64_bf16 v[80:83], v[44:47], a[208:215], v3
  v_cmp_gt_i32 vcc, s77, v47
  v_smfmac_f32_16x16x64_bf16 v[84:87], v[44:47], a[216:223], v3
  s_nop 5
  s_cbranch_vccnz L_c_safe_E0_f1
  s_branch L_c_safe_E0_done
  .fill (((0 - (. - L_0)) & 31) >> 2), 4, 0xbf800000
L_c_safe_E0_f13:
  s_mov_b64 exec, vcc
  global_load_dwordx4 v[44:47], v29, s[44:45] offset:1024 sc1
  s_not_b64 exec, vcc
  v_mov_b64 v[44:45], 0
  v_mov_b64 v[46:47], 0
  s_mov_b64 exec, -1
  s_sub_u32 s39, s39, 1
  s_cbranch_scc1 L_c_safe_bail
  s_waitcnt vmcnt(1)
  v_smfmac_f32_16x16x64_bf16 v[80:83], v[52:55], a[240:247], v3
  v_cmp_gt_i32 vcc, s77, v55
  v_smfmac_f32_16x16x64_bf16 v[84:87], v[52:55], a[248:255], v3
  s_cbranch_vccnz L_c_safe_E0_f31
  s_waitcnt vmcnt(0)
  v_smfmac_f32_16x16x64_bf16 v[80:83], v[44:47], a[208:215], v3
  v_cmp_gt_i32 vcc, s77, v47
  v_smfmac_f32_16x16x64_bf16 v[84:87], v[44:47], a[216:223], v3
  s_nop 5
  s_cbranch_vccnz L_c_safe_E0_f1
  s_branch L_c_safe_E0_done
  .fill (((0 - (. - L_0)) & 31) >> 2), 4, 0xbf800000
L_c_safe_E0_f3012:
  s_mov_b64 exec, vcc
  global_load_dwordx4 v[52:55], v29, s[44:45] offset:3072 sc1
  s_not_b64 exec, vcc
  v_mov_b64 v[52:53], 0
  v_mov_b64 v[54:55], 0
  s_mov_b64 exec, -1
  s_sub_u32 s39, s39, 1
  s_cbranch_scc1 L_c_safe_bail
  s_waitcnt vmcnt(3)
  v_smfmac_f32_16x16x64_bf16 v[80:83], v[40:43], a[192:199], v3
  v_cmp_gt_i32 vcc, s77, v43
  v_smfmac_f32_16x16x64_bf16 v[84:87], v[40:43], a[200:207], v3
  s_cbranch_vccnz L_c_safe_E0_f0123
  s_waitcnt vmcnt(2)
  v_smfmac_f32_16x16x64_bf16 v[80:83], v[44:47], a[208:215], v3
  v_cmp_gt_i32 vcc, s77, v47
  v_smfmac_f32_16x16x64_bf16 v[84:87], v[44:47], a[216:223], v3
  s_cbranch_vccnz L_c_safe_E0_f123
  s_waitcnt vmcnt(1)
  v_smfmac_f32_16x16x64_bf16 v[80:83], v[48:51], a[224:231], v3
  v_cmp_gt_i32 vcc, s77, v51
  v_smfmac_f32_16x16x64_bf16 v[84:87], v[48:51], a[232:239], v3
  s_cbranch_vccnz L_c_safe_E0_f23
  s_waitcnt vmcnt(0)
  v_smfmac_f32_16x16x64_bf16 v[80:83], v[52:55], a[240:247], v3
  v_cmp_gt_i32 vcc, s77, v55
  v_smfmac_f32_16x16x64_bf16 v[84:87], v[52:55], a[248:255], v3
  s_nop 5
  s_cbranch_vccnz L_c_safe_E0_f3
  s_branch L_c_safe_E0_done
  .fill (((0 - (. - L_0)) & 31) >> 2), 4, 0xbf800000
L_c_safe_E0_f012:
  s_mov_b64 exec, vcc
  global_load_dwordx4 v[40:43], v29, s[44:45] offset:0 sc1
  s_not_b64 exec, vcc
  v_mov_b64 v[40:41], 0
  v_mov_b64 v[42:43], 0
  s_mov_b64 exec, -1
  s_sub_u32 s39, s39, 1
  s_cbranch_scc1 L_c_safe_bail
  s_waitcnt vmcnt(2)
  v_smfmac_f32_16x16x64_bf16 v[80:83], v[44:47], a[208:215], v3
  v_cmp_gt_i32 vcc, s77, v47
  v_smfmac_f32_16x16x64_bf16 v[84:87], v[44:47], a[216:223], v3
  s_cbranch_vccnz L_c_safe_E0_f120
  s_waitcnt vmcnt(1)
  v_smfmac_f32_16x16x64_bf16 v[80:83], v[48:51], a[224:231], v3
  v_cmp_gt_i32 vcc, s77, v51
  v_smfmac_f32_16x16x64_bf16 v[84:87], v[48:51], a[232:239], v3
  s_cbranch_vccnz L_c_safe_E0_f20
  s_waitcnt vmcnt(0)
  v_smfmac_f32_16x16x64_bf16 v[80:83], v[40:43], a[192:199], v3
  v_cmp_gt_i32 vcc, s77, v43
  v_smfmac_f32_16x16x64_bf16 v[84:87], v[40:43], a[200:207], v3
  s_nop 5
  s_cbranch_vccnz L_c_safe_E0_f0
  s_branch L_c_safe_E0_done
  .fill (((0 - (. - L_0)) & 31) >> 2), 4, 0xbf800000
L_c_safe_E0_f013:
  s_mov_b64 exec, vcc
  global_load_dwordx4 v[40:43], v29, s[44:45] offset:0 sc1
  s_not_b64 exec, vcc
  v_mov_b64 v[40:41], 0
  v_mov_b64 v[42:43], 0
  s_mov_b64 exec, -1
  s_sub_u32 s39, s39, 1
  s_cbranch_scc1 L_c_safe_bail
  s_waitcnt vmcnt(2)
  v_smfmac_f32_16x16x64_bf16 v[80:83], v[44:47], a[208:215], v3
  v_cmp_gt_i32 vcc, s77, v47
  v_smfmac_f32_16x16x64_bf16 v[84:87], v[44:47], a[216:223], v3
  s_cbranch_vccnz L_c_safe_E0_f130
  s_waitcnt vmcnt(1)
  v_smfmac_f32_16x16x64_bf16 v[80:83], v[52:55], a[240:247], v3
  v_cmp_gt_i32 vcc, s77, v55
  v_smfmac_f32_16x16x64_bf16 v[84:87], v[52:55], a[248:255], v3
  s_cbranch_vccnz L_c_safe_E0_f30
  s_waitcnt vmcnt(0)
  v_smfmac_f32_16x16x64_bf16 v[80:83], v[40:43], a[192:199], v3
  v_cmp_gt_i32 vcc, s77, v43
  v_smfmac_f32_16x16x64_bf16 v[84:87], v[40:43], a[200:207], v3
  s_nop 5
  s_cbranch_vccnz L_c_safe_E0_f0
  s_branch L_c_safe_E0_done
  .fill (((0 - (. - L_0)) & 31) >> 2), 4, 0xbf800000
L_c_safe_E0_f10:
  s_mov_b64 exec, vcc
  global_load_dwordx4 v[44:47], v29, s[44:45] offset:1024 sc1
  s_not_b64 exec, vcc
  v_mov_b64 v[44:45], 0
  v_mov_b64 v[46:47], 0
  s_mov_b64 exec, -1
  s_sub_u32 s39, s39, 1
  s_cbranch_scc1 L_c_safe_bail
  s_waitcnt vmcnt(1)
  v_smfmac_f32_16x16x64_bf16 v[80:83], v[40:43], a[192:199], v3
  v_cmp_gt_i32 vcc, s77, v43
  v_smfmac_f32_16x16x64_bf16 v[84:87], v[40:43], a[200:207], v3
  s_cbranch_vccnz L_c_safe_E0_f01
  s_waitcnt vmcnt(0)
  v_smfmac_f32_16x16x64_bf16 v[80:83], v[44:47], a[208:215], v3
  v_cmp_gt_i32 vcc, s77, v47
  v_smfmac_f32_16x16x64_bf16 v[84:87], v[44:47], a[216:223], v3
  s_nop 5
  s_cbranch_vccnz L_c_safe_E0_f1
  s_branch L_c_safe_E0_done
  .fill (((0 - (. - L_0)) & 31) >> 2), 4, 0xbf800000
L_c_safe_E0_f023:
  s_mov_b64 exec, vcc
  global_load_dwordx4 v[40:43], v29, s[44:45] offset:0 sc1
  s_not_b64 exec, vcc
  v_mov_b64 v[40:41], 0
  v_mov_b64 v[42:43], 0
  s_mov_b64 exec, -1
  s_sub_u32 s39, s39, 1
  s_cbranch_scc1 L_c_safe_bail
  s_waitcnt vmcnt(2)
  v_smfmac_f32_16x16x64_bf16 v[80:83], v[48:51], a[224:231], v3
  v_cmp_gt_i32 vcc, s77, v51
  v_smfmac_f32_16x16x64_bf16 v[84:87], v[48:51], a[232:239], v3
  s_cbranch_vccnz L_c_safe_E0_f230
  s_waitcnt vmcnt(1)
  v_smfmac_f32_16x16x64_bf16 v[80:83], v[52:55], a[240:247], v3
  v_cmp_gt_i32 vcc, s77, v55
  v_smfmac_f32_16x16x64_bf16 v[84:87], v[52:55], a[248:255], v3
  s_cbranch_vccnz L_c_safe_E0_f30
  s_waitcnt vmcnt(0)
  v_smfmac_f32_16x16x64_bf16 v[80:83], v[40:43], a[192:199], v3
  v_cmp_gt_i32 vcc, s77, v43
  v_smfmac_f32_16x16x64_bf16 v[84:87], v[40:43], a[200:207], v3
  s_nop 5
  s_cbranch_vccnz L_c_safe_E0_f0
  s_branch L_c_safe_E0_done
  .fill (((0 - (. - L_0)) & 31) >> 2), 4, 0xbf800000
L_c_safe_E0_f20:
  s_mov_b64 exec, vcc
  global_load_dwordx4 v[48:51], v29, s[44:45] offset:2048 sc1
  s_not_b64 exec, vcc
  v_mov_b64 v[48:49], 0
  v_mov_b64 v[50:51], 0
  s_mov_b64 exec, -1
  s_sub_u32 s39, s39, 1
  s_cbranch_scc1 L_c_safe_bail
  s_waitcnt vmcnt(1)
  v_smfmac_f32_16x16x64_bf16 v[80:83], v[40:43], a[192:199], v3
  v_cmp_gt_i32 vcc, s77, v43
  v_smfmac_f32_16x16x64_bf16 v[84:87], v[40:43], a[200:207], v3
  s_cbranch_vccnz L_c_safe_E0_f02
  s_waitcnt vmcnt(0)
  v_smfmac_f32_16x16x64_bf16 v[80:83], v[48:51], a[224:231], v3
  v_cmp_gt_i32 vcc, s77, v51
  v_smfmac_f32_16x16x64_bf16 v[84:87], v[48:51], a[232:239], v3
  s_nop 5
  s_cbranch_vccnz L_c_safe_E0_f2
  s_branch L_c_safe_E0_done
  .fill (((0 - (. - L_0)) & 31) >> 2), 4, 0xbf800000
L_c_safe_E0_f21:
  s_mov_b64 exec, vcc
  global_load_dwordx4 v[48:51], v29, s[44:45] offset:2048 sc1
  s_not_b64 exec, vcc
  v_mov_b64 v[48:49], 0
  v_mov_b64 v[50:51], 0
  s_mov_b64 exec, -1
  s_sub_u32 s39, s39, 1
  s_cbranch_scc1 L_c_safe_bail
  s_waitcnt vmcnt(1)
  v_smfmac_f32_16x16x64_bf16 v[80:83], v[44:47], a[208:215], v3
  v_cmp_gt_i32 vcc, s77, v47
  v_smfmac_f32_16x16x64_bf16 v[84:87], v[44:47], a[216:223], v3
  s_cbranch_vccnz L_c_safe_E0_f12
  s_waitcnt vmcnt(0)
  v_smfmac_f32_16x16x64_bf16 v[80:83], v[48:51], a[224:231], v3
  v_cmp_gt_i32 vcc, s77, v51
  v_smfmac_f32_16x16x64_bf16 v[84:87], v[48:51], a[232:239], v3
  s_nop 5
  s_cbranch_vccnz L_c_safe_E0_f2
  s_branch L_c_safe_E0_done
  .fill (((0 - (. - L_0)) & 31) >> 2), 4, 0xbf800000
L_c_safe_E0_f120:
  s_mov_b64 exec, vcc
  global_load_dwordx4 v[44:47], v29, s[44:45] offset:1024 sc1
  s_not_b64 exec, vcc
  v_mov_b64 v[44:45], 0
  v_mov_b64 v[46:47], 0
  s_mov_b64 exec, -1
  s_sub_u32 s39, s39, 1
  s_cbranch_scc1 L_c_safe_bail
  s_waitcnt vmcnt(2)
  v_smfmac_f32_16x16x64_bf16 v[80:83], v[48:51], a[224:231], v3
  v_cmp_gt_i32 vcc, s77, v51
  v_smfmac_f32_16x16x64_bf16 v[84:87], v[48:51], a[232:239], v3
  s_cbranch_vccnz L_c_safe_E0_f201
  s_waitcnt vmcnt(1)
  v_smfmac_f32_16x16x64_bf16 v[80:83], v[40:43], a[192:199], v3
  v_cmp_gt_i32 vcc, s77, v43
  v_smfmac_f32_16x16x64_bf16 v[84:87], v[40:43], a[200:207], v3
  s_cbranch_vccnz L_c_safe_E0_f01
  s_waitcnt vmcnt(0)
  v_smfmac_f32_16x16x64_bf16 v[80:83], v[44:47], a[208:215], v3
  v_cmp_gt_i32 vcc, s77, v47
  v_smfmac_f32_16x16x64_bf16 v[84:87], v[44:47], a[216:223], v3
  s_nop 5
  s_cbranch_vccnz L_c_safe_E0_f1
  s_branch L_c_safe_E0_done
  .fill (((0 - (. - L_0)) & 31) >> 2), 4, 0xbf800000
L_c_safe_E0_f130:
  s_mov_b64 exec, vcc
  global_load_dwordx4 v[44:47], v29, s[44:45] offset:1024 sc1
  s_not_b64 exec, vcc
  v_mov_b64 v[44:45], 0
  v_mov_b64 v[46:47], 0
  s_mov_b64 exec, -1
  s_sub_u32 s39, s39, 1
  s_cbranch_scc1 L_c_safe_bail
  s_waitcnt vmcnt(2)
  v_smfmac_f32_16x16x64_bf16 v[80:83], v[52:55], a[240:247], v3
  v_cmp_gt_i32 vcc, s77, v55
  v_smfmac_f32_16x16x64_bf16 v[84:87], v[52:55], a[248:255], v3
  s_cbranch_vccnz L_c_safe_E0_f301
  s_waitcnt vmcnt(1)
  v_smfmac_f32_16x16x64_bf16 v[80:83], v[40:43], a[192:199], v3
  v_cmp_gt_i32 vcc, s77, v43
  v_smfmac_f32_16x16x64_bf16 v[84:87], v[40:43], a[200:207], v3
  s_cbranch_vccnz L_c_safe_E0_f01
  s_waitcnt vmcnt(0)
  v_smfmac_f32_16x16x64_bf16 v[80:83], v[44:47], a[208:215], v3
  v_cmp_gt_i32 vcc, s77, v47
  v_smfmac_f32_16x16x64_bf16 v[84:87], v[44:47], a[216:223], v3
  s_nop 5
  s_cbranch_vccnz L_c_safe_E0_f1
  s_branch L_c_safe_E0_done
  .fill (((0 - (. - L_0)) & 31) >> 2), 4, 0xbf800000
L_c_safe_E0_f201:
  s_mov_b64 exec, vcc
  global_load_dwordx4 v[48:51], v29, s[44:45] offset:2048 sc1
  s_not_b64 exec, vcc
  v_mov_b64 v[48:49], 0
  v_mov_b64 v[50:51], 0
  s_mov_b64 exec, -1
  s_sub_u32 s39, s39, 1
  s_cbranch_scc1 L_c_safe_bail
  s_waitcnt vmcnt(2)
  v_smfmac_f32_16x16x64_bf16 v[80:83], v[40:43], a[192:199], v3
  v_cmp_gt_i32 vcc, s77, v43
  v_smfmac_f32_16x16x64_bf16 v[84:87], v[40:43], a[200:207], v3
  s_cbranch_vccnz L_c_safe_E0_f012
  s_waitcnt vmcnt(1)
  v_smfmac_f32_16x16x64_bf16 v[80:83], v[44:47], a[208:215], v3
  v_cmp_gt_i32 vcc, s77, v47
  v_smfmac_f32_16x16x64_bf16 v[84:87], v[44:47], a[216:223], v3
  s_cbranch_vccnz L_c_safe_E0_f12
  s_waitcnt vmcnt(0)
  v_smfmac_f32_16x16x64_bf16 v[80:83], v[48:51], a[224:231], v3
  v_cmp_gt_i32 vcc, s77, v51
  v_smfmac_f32_16x16x64_bf16 v[84:87], v[48:51], a[232:239], v3
  s_nop 5
  s_cbranch_vccnz L_c_safe_E0_f2
  s_branch L_c_safe_E0_done
L_c_safe_Gret:
  global_load_dwordx4 v[192:195], v16, s[70:71] sc1
  global_load_dwordx4 v[196:199], v17, s[70:71] sc1
  global_load_dwordx4 v[200:203], v18, s[70:71] sc1
  s_sub_u32 s39, s39, 1
  s_cbranch_scc1 L_c_safe_bail
  s_waitcnt vmcnt(2)
  v_pk_add_f32 v[88:89], v[188:189], v[192:193]
  v_pk_add_f32 v[90:91], v[190:191], v[194:195]
  s_waitcnt vmcnt(0)
  v_max3_u32 v1, v195, v199, v203
  v_cmp_eq_u32 vcc, -1, v1
  v_pk_add_f32 v[96:97], v[196:197], v[200:201]
  v_pk_add_f32 v[98:99], v[198:199], v[202:203]
  v_pk_add_f32 v[96:97], v[96:97], v[88:89]
  v_pk_add_f32 v[98:99], v[98:99], v[90:91]
  v_cvt_pk_bf16_f32 v208, v96, v98
  v_cvt_pk_bf16_f32 v209, v97, v99
  s_cbranch_vccnz L_c_safe_Gret
  global_store_dword v5, v208, s[44:45] sc1
  global_store_dword v5, v209, s[44:45] offset:16 sc1
  s_barrier
  s_branch L_c_safe_step
  .fill (((0 - (. - L_0)) & 31) >> 2), 4, 0xbf800000
L_c_safe_EH_f0123:
  s_mov_b64 exec, vcc
  global_load_dwordx4 v[40:43], v29, s[44:45] offset:0 sc1
  s_not_b64 exec, vcc
  v_mov_b64 v[40:41], 0
  v_mov_b64 v[42:43], 0
  s_mov_b64 exec, -1
  s_sub_u32 s39, s39, 1
  s_cbranch_scc1 L_c_safe_bail
  s_waitcnt vmcnt(3)
  v_smfmac_f32_16x16x64_bf16 v[80:83], v[44:47], a[208:215], v3
  v_cmp_gt_i32 vcc, s77, v47
  v_smfmac_f32_16x16x64_bf16 v[84:87], v[44:47], a[216:223], v3
  s_cbranch_vccnz L_c_safe_EH_f1230
  s_waitcnt vmcnt(2)
  v_smfmac_f32_16x16x64_bf16 v[80:83], v[48:51], a[224:231], v3
  v_cmp_gt_i32 vcc, s77, v51
  v_smfmac_f32_16x16x64_bf16 v[84:87], v[48:51], a[232:239], v3
  s_cbranch_vccnz L_c_safe_EH_f230
  s_waitcnt vmcnt(1)
  v_smfmac_f32_16x16x64_bf16 v[80:83], v[52:55], a[240:247], v3
  v_cmp_gt_i32 vcc, s77, v55
  v_smfmac_f32_16x16x64_bf16 v[84:87], v[52:55], a[248:255], v3
  s_cbranch_vccnz L_c_safe_EH_f30
  s_waitcnt vmcnt(0)
  v_smfmac_f32_16x16x64_bf16 v[80:83], v[40:43], a[192:199], v3
  v_cmp_gt_i32 vcc, s77, v43
  v_smfmac_f32_16x16x64_bf16 v[84:87], v[40:43], a[200:207], v3
  s_nop 5
  s_cbranch_vccnz L_c_safe_EH_f0
  s_branch L_c_safe_EH_done
  .fill (((0 - (. - L_0)) & 31) >> 2), 4, 0xbf800000
L_c_safe_EH_f123:
  s_mov_b64 exec, vcc
  global_load_dwordx4 v[44:47], v29, s[44:45] offset:1024 sc1
  s_not_b64 exec, vcc
  v_mov_b64 v[44:45], 0
  v_mov_b64 v[46:47], 0
  s_mov_b64 exec, -1
  s_sub_u32 s39, s39, 1
  s_cbranch_scc1 L_c_safe_bail
  s_waitcnt vmcnt(2)
  v_smfmac_f32_16x16x64_bf16 v[80:83], v[48:51], a[224:231], v3
  v_cmp_gt_i32 vcc, s77, v51
  v_smfmac_f32_16x16x64_bf16 v[84:87], v[48:51], a[232:239], v3
  s_cbranch_vccnz L_c_safe_EH_f231
  s_waitcnt vmcnt(1)
  v_smfmac_f32_16x16x64_bf16 v[80:83], v[52:55], a[240:247], v3
  v_cmp_gt_i32 vcc, s77, v55
  v_smfmac_f32_16x16x64_bf16 v[84:87], v[52:55], a[248:255], v3
  s_cbranch_vccnz L_c_safe_EH_f31
  s_waitcnt vmcnt(0)
  v_smfmac_f32_16x16x64_bf16 v[80:83], v[44:47], a[208:215], v3
  v_cmp_gt_i32 vcc, s77, v47
  v_smfmac_f32_16x16x64_bf16 v[84:87], v[44:47], a[216:223], v3
  s_nop 5
  s_cbranch_vccnz L_c_safe_EH_f1
  s_branch L_c_safe_EH_done
  .fill (((0 - (. - L_0)) & 31) >> 2), 4, 0xbf800000
L_c_safe_EH_f23:
  s_mov_b64 exec, vcc
  global_load_dwordx4 v[48:51], v29, s[44:45] offset:2048 sc1
  s_not_b64 exec, vcc
  v_mov_b64 v[48:49], 0
  v_mov_b64 v[50:51], 0
  s_mov_b64 exec, -1
  s_sub_u32 s39, s39, 1
  s_cbranch_scc1 L_c_safe_bail
  s_waitcnt vmcnt(1)
  v_smfmac_f32_16x16x64_bf16 v[80:83], v[52:55], a[240:247], v3
  v_cmp_gt_i32 vcc, s77, v55
  v_smfmac_f32_16x16x64_bf16 v[84:87], v[52:55], a[248:255], v3
  s_cbranch_vccnz L_c_safe_EH_f32
  s_waitcnt vmcnt(0)
  v_smfmac_f32_16x16x64_bf16 v[80:83], v[48:51], a[224:231], v3
  v_cmp_gt_i32 vcc, s77, v51
  v_smfmac_f32_16x16x64_bf16 v[84:87], v[48:51], a[232:239], v3
  s_nop 5
  s_cbranch_vccnz L_c_safe_EH_f2
  s_branch L_c_safe_EH_done
  .fill (((0 - (. - L_0)) & 31) >> 2), 4, 0xbf800000
L_c_safe_EH_f3:
  s_mov_b64 exec, vcc
  global_load_dwordx4 v[52:55], v29, s[44:45] offset:3072 sc1
  s_not_b64 exec, vcc
  v_mov_b64 v[52:53], 0
  v_mov_b64 v[54:55], 0
  s_mov_b64 exec, -1
  s_sub_u32 s39, s39, 1
  s_cbranch_scc1 L_c_safe_bail
  s_waitcnt vmcnt(0)
  v_smfmac_f32_16x16x64_bf16 v[80:83], v[52:55], a[240:247], v3
  v_cmp_gt_i32 vcc, s77, v55
  v_smfmac_f32_16x16x64_bf16 v[84:87], v[52:55], a[248:255], v3
  s_nop 5
  s_cbranch_vccnz L_c_safe_EH_f3
  s_branch L_c_safe_EH_done
  .fill (((0 - (. - L_0)) & 31) >> 2), 4, 0xbf800000
L_c_safe_EH_f1230:
  s_mov_b64 exec, vcc
  global_load_dwordx4 v[44:47], v29, s[44:45] offset:1024 sc1
  s_not_b64 exec, vcc
  v_mov_b64 v[44:45], 0
  v_mov_b64 v[46:47], 0
  s_mov_b64 exec, -1
  s_sub_u32 s39, s39, 1
  s_cbranch_scc1 L_c_safe_bail
  s_waitcnt vmcnt(3)
  v_smfmac_f32_16x16x64_bf16 v[80:83], v[48:51], a[224:231], v3
  v_cmp_gt_i32 vcc, s77, v51
  v_smfmac_f32_16x16x64_bf16 v[84:87], v[48:51], a[232:239], v3
  s_cbranch_vccnz L_c_safe_EH_f2301
  s_waitcnt vmcnt(2)
  v_smfmac_f32_16x16x64_bf16 v[80:83], v[52:55], a[240:247], v3
  v_cmp_gt_i32 vcc, s77, v55
  v_smfmac_f32_16x16x64_bf16 v[84:87], v[52:55], a[248:255], v3
  s_cbranch_vccnz L_c_safe_EH_f301
  s_waitcnt vmcnt(1)
  v_smfmac_f32_16x16x64_bf16 v[80:83], v[40:43], a[192:199], v3
  v_cmp_gt_i32 vcc, s77, v43
  v_smfmac_f32_16x16x64_bf16 v[84:87], v[40:43], a[200:207], v3
  s_cbranch_vccnz L_c_safe_EH_f01
  s_waitcnt vmcnt(0)
  v_smfmac_f32_16x16x64_bf16 v[80:83], v[44:47], a[208:215], v3
  v_cmp_gt_i32 vcc, s77, v47
  v_smfmac_f32_16x16x64_bf16 v[84:87], v[44:47], a[216:223], v3
  s_nop 5
  s_cbranch_vccnz L_c_safe_EH_f1
  s_branch L_c_safe_EH_done
  .fill (((0 - (. - L_0)) & 31) >> 2), 4, 0xbf800000
L_c_safe_EH_f230:
  s_mov_b64 exec, vcc
  global_load_dwordx4 v[48:51], v29, s[44:45] offset:2048 sc1
  s_not_b64 exec, vcc
  v_mov_b64 v[48:49], 0
  v_mov_b64 v[50:51], 0
  s_mov_b64 exec, -1
  s_sub_u32 s39, s39, 1
  s_cbranch_scc1 L_c_safe_bail
  s_waitcnt vmcnt(2)
  v_smfmac_f32_16x16x64_bf16 v[80:83], v[52:55], a[240:247], v3
  v_cmp_gt_i32 vcc, s77, v55
  v_smfmac_f32_16x16x64_bf16 v[84:87], v[52:55], a[248:255], v3
  s_cbranch_vccnz L_c_safe_EH_f302
  s_waitcnt vmcnt(1)
  v_smfmac_f32_16x16x64_bf16 v[80:83], v[40:43], a[192:199], v3
  v_cmp_gt_i32 vcc, s77, v43
  v_smfmac_f32_16x16x64_bf16 v[84:87], v[40:43], a[200:207], v3
  s_cbranch_vccnz L_c_safe_EH_f02
  s_waitcnt vmcnt(0)
  v_smfmac_f32_16x16x64_bf16 v[80:83], v[48:51], a[224:231], v3
  v_cmp_gt_i32 vcc, s77, v51
  v_smfmac_f32_16x16x64_bf16 v[84:87], v[48:51], a[232:239], v3
  s_nop 5
  s_cbranch_vccnz L_c_safe_EH_f2
  s_branch L_c_safe_EH_done
  .fill (((0 - (. - L_0)) & 31) >> 2), 4, 0xbf800000
L_c_safe_EH_f30:
  s_mov_b64 exec, vcc
  global_load_dwordx4 v[52:55], v29, s[44:45] offset:3072 sc1
  s_not_b64 exec, vcc
  v_mov_b64 v[52:53], 0
  v_mov_b64 v[54:55], 0
  s_mov_b64 exec, -1
  s_sub_u32 s39, s39, 1
  s_cbranch_scc1 L_c_safe_bail
  s_waitcnt vmcnt(1)
  v_smfmac_f32_16x16x64_bf16 v[80:83], v[40:43], a[192:199], v3
  v_cmp_gt_i32 vcc, s77, v43
  v_smfmac_f32_16x16x64_bf16 v[84:87], v[40:43], a[200:207], v3
  s_cbranch_vccnz L_c_safe_EH_f03
  s_waitcnt vmcnt(0)
  v_smfmac_f32_16x16x64_bf16 v[80:83], v[52:55], a[240:247], v3
  v_cmp_gt_i32 vcc, s77, v55
  v_smfmac_f32_16x16x64_bf16 v[84:87], v[52:55], a[248:255], v3
  s_nop 5
  s_cbranch_vccnz L_c_safe_EH_f3
  s_branch L_c_safe_EH_done
  .fill (((0 - (. - L_0)) & 31) >> 2), 4, 0xbf800000
L_c_safe_EH_f0:
  s_mov_b64 exec, vcc
  global_load_dwordx4 v[40:43], v29, s[44:45] offset:0 sc1
  s_not_b64 exec, vcc
  v_mov_b64 v[40:41], 0
  v_mov_b64 v[42:43], 0
  s_mov_b64 exec, -1
  s_sub_u32 s39, s39, 1
  s_cbranch_scc1 L_c_safe_bail
  s_waitcnt vmcnt(0)
  v_smfmac_f32_16x16x64_bf16 v[80:83], v[40:43], a[192:199], v3
  v_cmp_gt_i32 vcc, s77, v43
  v_smfmac_f32_16x16x64_bf16 v[84:87], v[40:43], a[200:207], v3
  s_nop 5
  s_cbranch_vccnz L_c_safe_EH_f0
  s_branch L_c_safe_EH_done
  .fill (((0 - (. - L_0)) & 31) >> 2), 4, 0xbf800000
L_c_safe_EH_f231:
  s_mov_b64 exec, vcc
  global_load_dwordx4 v[48:51], v29, s[44:45] offset:2048 sc1
  s_not_b64 exec, vcc
  v_mov_b64 v[48:49], 0
  v_mov_b64 v[50:51], 0
  s_mov_b64 exec, -1
  s_sub_u32 s39, s39, 1
  s_cbranch_scc1 L_c_safe_bail
  s_waitcnt vmcnt(2)
  v_smfmac_f32_16x16x64_bf16 v[80:83], v[52:55], a[240:247], v3
  v_cmp_gt_i32 vcc, s77, v55
  v_smfmac_f32_16x16x64_bf16 v[84:87], v[52:55], a[248:255], v3
  s_cbranch_vccnz L_c_safe_EH_f312
  s_waitcnt vmcnt(1)
  v_smfmac_f32_16x16x64_bf16 v[80:83], v[44:47], a[208:215], v3
  v_cmp_gt_i32 vcc, s77, v47
  v_smfmac_f32_16x16x64_bf16 v[84:87], v[44:47], a[216:223], v3
  s_cbranch_vccnz L_c_safe_EH_f12
  s_waitcnt vmcnt(0)
  v_smfmac_f32_16x16x64_bf16 v[80:83], v[48:51], a[224:231], v3
  v_cmp_gt_i32 vcc, s77, v51
  v_smfmac_f32_16x16x64_bf16 v[84:87], v[48:51], a[232:239], v3
  s_nop 5
  s_cbranch_vccnz L_c_safe_EH_f2
  s_branch L_c_safe_EH_done
  .fill (((0 - (. - L_0)) & 31) >> 2), 4, 0xbf800000
L_c_safe_EH_f31:
  s_mov_b64 exec, vcc
  global_load_dwordx4 v[52:55], v29, s[44:45] offset:3072 sc1
  s_not_b64 exec, vcc
  v_mov_b64 v[52:53], 0
  v_mov_b64 v[54:55], 0
  s_mov_b64 exec, -1
  s_sub_u32 s39, s39, 1
  s_cbranch_scc1 L_c_safe_bail
  s_waitcnt vmcnt(1)
  v_smfmac_f32_16x16x64_bf16 v[80:83], v[44:47], a[208:215], v3
  v_cmp_gt_i32 vcc, s77, v47
  v_smfmac_f32_16x16x64_bf16 v[84:87], v[44:47], a[216:223], v3
  s_cbranch_vccnz L_c_safe_EH_f13
  s_waitcnt vmcnt(0)
  v_smfmac_f32_16x16x64_bf16 v[80:83], v[52:55], a[240:247], v3
  v_cmp_gt_i32 vcc, s77, v55
  v_smfmac_f32_16x16x64_bf16 v[84:87], v[52:55], a[248:255], v3
  s_nop 5
  s_cbranch_vccnz L_c_safe_EH_f3
  s_branch L_c_safe_EH_done
  .fill (((0 - (. - L_0)) & 31) >> 2), 4, 0xbf800000
L_c_safe_EH_f1:
  s_mov_b64 exec, vcc
  global_load_dwordx4 v[44:47], v29, s[44:45] offset:1024 sc1
  s_not_b64 exec, vcc
  v_mov_b64 v[44:45], 0
  v_mov_b64 v[46:47], 0
  s_mov_b64 exec, -1
  s_sub_u32 s39, s39, 1
  s_cbranch_scc1 L_c_safe_bail
  s_waitcnt vmcnt(0)
  v_smfmac_f32_16x16x64_bf16 v[80:83], v[44:47], a[208:215], v3
  v_cmp_gt_i32 vcc, s77, v47
  v_smfmac_f32_16x16x64_bf16 v[84:87], v[44:47], a[216:223], v3
  s_nop 5
  s_cbranch_vccnz L_c_safe_EH_f1
  s_branch L_c_safe_EH_done
  .fill (((0 - (. - L_0)) & 31) >> 2), 4, 0xbf800000
L_c_safe_EH_f32:
  s_mov_b64 exec, vcc
  global_load_dwordx4 v[52:55], v29, s[44:45] offset:3072 sc1
  s_not_b64 exec, vcc
  v_mov_b64 v[52:53], 0
  v_mov_b64 v[54:55], 0
  s_mov_b64 exec, -1
  s_sub_u32 s39, s39, 1
  s_cbranch_scc1 L_c_safe_bail
  s_waitcnt vmcnt(1)
  v_smfmac_f32_16x16x64_bf16 v[80:83], v[48:51], a[224:231], v3
  v_cmp_gt_i32 vcc, s77, v51
  v_smfmac_f32_16x16x64_bf16 v[84:87], v[48:51], a[232:239], v3
  s_cbranch_vccnz L_c_safe_EH_f23
  s_waitcnt vmcnt(0)
  v_smfmac_f32_16x16x64_bf16 v[80:83], v[52:55], a[240:247], v3
  v_cmp_gt_i32 vcc, s77, v55
  v_smfmac_f32_16x16x64_bf16 v[84:87], v[52:55], a[248:255], v3
  s_nop 5
  s_cbranch_vccnz L_c_safe_EH_f3
  s_branch L_c_safe_EH_done
  .fill (((0 - (. - L_0)) & 31) >> 2), 4, 0xbf800000
L_c_safe_EH_f2:
  s_mov_b64 exec, vcc
  global_load_dwordx4 v[48:51], v29, s[44:45] offset:2048 sc1
  s_not_b64 exec, vcc
  v_mov_b64 v[48:49], 0
  v_mov_b64 v[50:51], 0
  s_mov_b64 exec, -1
  s_sub_u32 s39, s39, 1
  s_cbranch_scc1 L_c_safe_bail
  s_waitcnt vmcnt(0)
  v_smfmac_f32_16x16x64_bf16 v[80:83], v[48:51], a[224:231], v3
  v_cmp_gt_i32 vcc, s77, v51
  v_smfmac_f32_16x16x64_bf16 v[84:87], v[48:51], a[232:239], v3
  s_nop 5
  s_cbranch_vccnz L_c_safe_EH_f2
  s_branch L_c_safe_EH_done
  .fill (((0 - (. - L_0)) & 31) >> 2), 4, 0xbf800000
L_c_safe_EH_f2301:
  s_mov_b64 exec, vcc
  global_load_dwordx4 v[48:51], v29, s[44:45] offset:2048 sc1
  s_not_b64 exec, vcc
  v_mov_b64 v[48:49], 0
  v_mov_b64 v[50:51], 0
  s_mov_b64 exec, -1
  s_sub_u32 s39, s39, 1
  s_cbranch_scc1 L_c_safe_bail
  s_waitcnt vmcnt(3)
  v_smfmac_f32_16x16x64_bf16 v[80:83], v[52:55], a[240:247], v3
  v_cmp_gt_i32 vcc, s77, v55
  v_smfmac_f32_16x16x64_bf16 v[84:87], v[52:55], a[248:255], v3
  s_cbranch_vccnz L_c_safe_EH_f3012
  s_waitcnt vmcnt(2)
  v_smfmac_f32_16x16x64_bf16 v[80:83], v[40:43], a[192:199], v3
  v_cmp_gt_i32 vcc, s77, v43
  v_smfmac_f32_16x16x64_bf16 v[84:87], v[40:43], a[200:207], v3
  s_cbranch_vccnz L_c_safe_EH_f012
  s_waitcnt vmcnt(1)
  v_smfmac_f32_16x16x64_bf16 v[80:83], v[44:47], a[208:215], v3
  v_cmp_gt_i32 vcc, s77, v47
  v_smfmac_f32_16x16x64_bf16 v[84:87], v[44:47], a[216:223], v3
  s_cbranch_vccnz L_c_safe_EH_f12
  s_waitcnt vmcnt(0)
  v_smfmac_f32_16x16x64_bf16 v[80:83], v[48:51], a[224:231], v3
  v_cmp_gt_i32 vcc, s77, v51
  v_smfmac_f32_16x16x64_bf16 v[84:87], v[48:51], a[232:239], v3
  s_nop 5
  s_cbranch_vccnz L_c_safe_EH_f2
  s_branch L_c_safe_EH_done
  .fill (((0 - (. - L_0)) & 31) >> 2), 4, 0xbf800000
L_c_safe_EH_f301:
  s_mov_b64 exec, vcc
  global_load_dwordx4 v[52:55], v29, s[44:45] offset:3072 sc1
  s_not_b64 exec, vcc
  v_mov_b64 v[52:53], 0
  v_mov_b64 v[54:55], 0
  s_mov_b64 exec, -1
  s_sub_u32 s39, s39, 1
  s_cbranch_scc1 L_c_safe_bail
  s_waitcnt vmcnt(2)
  v_smfmac_f32_16x16x64_bf16 v[80:83], v[40:43], a[192:199], v3
  v_cmp_gt_i32 vcc, s77, v43
  v_smfmac_f32_16x16x64_bf16 v[84:87], v[40:43], a[200:207], v3
  s_cbranch_vccnz L_c_safe_EH_f013
  s_waitcnt vmcnt(1)
  v_smfmac_f32_16x16x64_bf16 v[80:83], v[44:47], a[208:215], v3
  v_cmp_gt_i32 vcc, s77, v47
  v_smfmac_f32_16x16x64_bf16 v[84:87], v[44:47], a[216:223], v3
  s_cbranch_vccnz L_c_safe_EH_f13
  s_waitcnt vmcnt(0)
  v_smfmac_f32_16x16x64_bf16 v[80:83], v[52:55], a[240:247], v3
  v_cmp_gt_i32 vcc, s77, v55
  v_smfmac_f32_16x16x64_bf16 v[84:87], v[52:55], a[248:255], v3
  s_nop 5
  s_cbranch_vccnz L_c_safe_EH_f3
  s_branch L_c_safe_EH_done
  .fill (((0 - (. - L_0)) & 31) >> 2), 4, 0xbf800000
L_c_safe_EH_f01:
  s_mov_b64 exec, vcc
  global_load_dwordx4 v[40:43], v29, s[44:45] offset:0 sc1
  s_not_b64 exec, vcc
  v_mov_b64 v[40:41], 0
  v_mov_b64 v[42:43], 0
  s_mov_b64 exec, -1
  s_sub_u32 s39, s39, 1
  s_cbranch_scc1 L_c_safe_bail
  s_waitcnt vmcnt(1)
  v_smfmac_f32_16x16x64_bf16 v[80:83], v[44:47], a[208:215], v3
  v_cmp_gt_i32 vcc, s77, v47
  v_smfmac_f32_16x16x64_bf16 v[84:87], v[44:47], a[216:223], v3
  s_cbranch_vccnz L_c_safe_EH_f10
  s_waitcnt vmcnt(0)
  v_smfmac_f32_16x16x64_bf16 v[80:83], v[40:43], a[192:199], v3
  v_cmp_gt_i32 vcc, s77, v43
  v_smfmac_f32_16x16x64_bf16 v[84:87], v[40:43], a[200:207], v3
  s_nop 5
  s_cbranch_vccnz L_c_safe_EH_f0
  s_branch L_c_safe_EH_done
  .fill (((0 - (. - L_0)) & 31) >> 2), 4, 0xbf800000
L_c_safe_EH_f302:
  s_mov_b64 exec, vcc
  global_load_dwordx4 v[52:55], v29, s[44:45] offset:3072 sc1
  s_not_b64 exec, vcc
  v_mov_b64 v[52:53], 0
  v_mov_b64 v[54:55], 0
  s_mov_b64 exec, -1
  s_sub_u32 s39, s39, 1
  s_cbranch_scc1 L_c_safe_bail
  s_waitcnt vmcnt(2)
  v_smfmac_f32_16x16x64_bf16 v[80:83], v[40:43], a[192:199], v3
  v_cmp_gt_i32 vcc, s77, v43
  v_smfmac_f32_16x16x64_bf16 v[84:87], v[40:43], a[200:207], v3
  s_cbranch_vccnz L_c_safe_EH_f023
  s_waitcnt vmcnt(1)
  v_smfmac_f32_16x16x64_bf16 v[80:83], v[48:51], a[224:231], v3
  v_cmp_gt_i32 vcc, s77, v51
  v_smfmac_f32_16x16x64_bf16 v[84:87], v[48:51], a[232:239], v3
  s_cbranch_vccnz L_c_safe_EH_f23
  s_waitcnt vmcnt(0)
  v_smfmac_f32_16x16x64_bf16 v[80:83], v[52:55], a[240:247], v3
  v_cmp_gt_i32 vcc, s77, v55
  v_smfmac_f32_16x16x64_bf16 v[84:87], v[52:55], a[248:255], v3
  s_nop 5
  s_cbranch_vccnz L_c_safe_EH_f3
  s_branch L_c_safe_EH_done
  .fill (((0 - (. - L_0)) & 31) >> 2), 4, 0xbf800000
L_c_safe_EH_f02:
  s_mov_b64 exec, vcc
  global_load_dwordx4 v[40:43], v29, s[44:45] offset:0 sc1
  s_not_b64 exec, vcc
  v_mov_b64 v[40:41], 0
  v_mov_b64 v[42:43], 0
  s_mov_b64 exec, -1
  s_sub_u32 s39, s39, 1
  s_cbranch_scc1 L_c_safe_bail
  s_waitcnt vmcnt(1)
  v_smfmac_f32_16x16x64_bf16 v[80:83], v[48:51], a[224:231], v3
  v_cmp_gt_i32 vcc, s77, v51
  v_smfmac_f32_16x16x64_bf16 v[84:87], v[48:51], a[232:239], v3
  s_cbranch_vccnz L_c_safe_EH_f20
  s_waitcnt vmcnt(0)
  v_smfmac_f32_16x16x64_bf16 v[80:83], v[40:43], a[192:199], v3
  v_cmp_gt_i32 vcc, s77, v43
  v_smfmac_f32_16x16x64_bf16 v[84:87], v[40:43], a[200:207], v3
  s_nop 5
  s_cbranch_vccnz L_c_safe_EH_f0
  s_branch L_c_safe_EH_done
  .fill (((0 - (. - L_0)) & 31) >> 2), 4, 0xbf800000
L_c_safe_EH_f03:
  s_mov_b64 exec, vcc
  global_load_dwordx4 v[40:43], v29, s[44:45] offset:0 sc1
  s_not_b64 exec, vcc
  v_mov_b64 v[40:41], 0
  v_mov_b64 v[42:43], 0
  s_mov_b64 exec, -1
  s_sub_u32 s39, s39, 1
  s_cbranch_scc1 L_c_safe_bail
  s_waitcnt vmcnt(1)
  v_smfmac_f32_16x16x64_bf16 v[80:83], v[52:55], a[240:247], v3
  v_cmp_gt_i32 vcc, s77, v55
  v_smfmac_f32_16x16x64_bf16 v[84:87], v[52:55], a[248:255], v3
  s_cbranch_vccnz L_c_safe_EH_f30
  s_waitcnt vmcnt(0)
  v_smfmac_f32_16x16x64_bf16 v[80:83], v[40:43], a[192:199], v3
  v_cmp_gt_i32 vcc, s77, v43
  v_smfmac_f32_16x16x64_bf16 v[84:87], v[40:43], a[200:207], v3
  s_nop 5
  s_cbranch_vccnz L_c_safe_EH_f0
  s_branch L_c_safe_EH_done
  .fill (((0 - (. - L_0)) & 31) >> 2), 4, 0xbf800000
L_c_safe_EH_f312:
  s_mov_b64 exec, vcc
  global_load_dwordx4 v[52:55], v29, s[44:45] offset:3072 sc1
  s_not_b64 exec, vcc
  v_mov_b64 v[52:53], 0
  v_mov_b64 v[54:55], 0
  s_mov_b64 exec, -1
  s_sub_u32 s39, s39, 1
  s_cbranch_scc1 L_c_safe_bail
  s_waitcnt vmcnt(2)
  v_smfmac_f32_16x16x64_bf16 v[80:83], v[44:47], a[208:215], v3
  v_cmp_gt_i32 vcc, s77, v47
  v_smfmac_f32_16x16x64_bf16 v[84:87], v[44:47], a[216:223], v3
  s_cbranch_vccnz L_c_safe_EH_f123
  s_waitcnt vmcnt(1)
  v_smfmac_f32_16x16x64_bf16 v[80:83], v[48:51], a[224:231], v3
  v_cmp_gt_i32 vcc, s77, v51
  v_smfmac_f32_16x16x64_bf16 v[84:87], v[48:51], a[232:239], v3
  s_cbranch_vccnz L_c_safe_EH_f23
  s_waitcnt vmcnt(0)
  v_smfmac_f32_16x16x64_bf16 v[80:83], v[52:55], a[240:247], v3
  v_cmp_gt_i32 vcc, s77, v55
  v_smfmac_f32_16x16x64_bf16 v[84:87], v[52:55], a[248:255], v3
  s_nop 5
  s_cbranch_vccnz L_c_safe_EH_f3
  s_branch L_c_safe_EH_done
  .fill (((0 - (. - L_0)) & 31) >> 2), 4, 0xbf800000
L_c_safe_EH_f12:
  s_mov_b64 exec, vcc
  global_load_dwordx4 v[44:47], v29, s[44:45] offset:1024 sc1
  s_not_b64 exec, vcc
  v_mov_b64 v[44:45], 0
  v_mov_b64 v[46:47], 0
  s_mov_b64 exec, -1
  s_sub_u32 s39, s39, 1
  s_cbranch_scc1 L_c_safe_bail
  s_waitcnt vmcnt(1)
  v_smfmac_f32_16x16x64_bf16 v[80:83], v[48:51], a[224:231], v3
  v_cmp_gt_i32 vcc, s77, v51
  v_smfmac_f32_16x16x64_bf16 v[84:87], v[48:51], a[232:239], v3
  s_cbranch_vccnz L_c_safe_EH_f21
  s_waitcnt vmcnt(0)
  v_smfmac_f32_16x16x64_bf16 v[80:83], v[44:47], a[208:215], v3
  v_cmp_gt_i32 vcc, s77, v47
  v_smfmac_f32_16x16x64_bf16 v[84:87], v[44:47], a[216:223], v3
  s_nop 5
  s_cbranch_vccnz L_c_safe_EH_f1
  s_branch L_c_safe_EH_done
  .fill (((0 - (. - L_0)) & 31) >> 2), 4, 0xbf800000
L_c_safe_EH_f13:
  s_mov_b64 exec, vcc
  global_load_dwordx4 v[44:47], v29, s[44:45] offset:1024 sc1
  s_not_b64 exec, vcc
  v_mov_b64 v[44:45], 0
  v_mov_b64 v[46:47], 0
  s_mov_b64 exec, -1
  s_sub_u32 s39, s39, 1
  s_cbranch_scc1 L_c_safe_bail
  s_waitcnt vmcnt(1)
  v_smfmac_f32_16x16x64_bf16 v[80:83], v[52:55], a[240:247], v3
  v_cmp_gt_i32 vcc, s77, v55
  v_smfmac_f32_16x16x64_bf16 v[84:87], v[52:55], a[248:255], v3
  s_cbranch_vccnz L_c_safe_EH_f31
  s_waitcnt vmcnt(0)
  v_smfmac_f32_16x16x64_bf16 v[80:83], v[44:47], a[208:215], v3
  v_cmp_gt_i32 vcc, s77, v47
  v_smfmac_f32_16x16x64_bf16 v[84:87], v[44:47], a[216:223], v3
  s_nop 5
  s_cbranch_vccnz L_c_safe_EH_f1
  s_branch L_c_safe_EH_done
  .fill (((0 - (. - L_0)) & 31) >> 2), 4, 0xbf800000
L_c_safe_EH_f3012:
  s_mov_b64 exec, vcc
  global_load_dwordx4 v[52:55], v29, s[44:45] offset:3072 sc1
  s_not_b64 exec, vcc
  v_mov_b64 v[52:53], 0
  v_mov_b64 v[54:55], 0
  s_mov_b64 exec, -1
  s_sub_u32 s39, s39, 1
  s_cbranch_scc1 L_c_safe_bail
  s_waitcnt vmcnt(3)
  v_smfmac_f32_16x16x64_bf16 v[80:83], v[40:43], a[192:199], v3
  v_cmp_gt_i32 vcc, s77, v43
  v_smfmac_f32_16x16x64_bf16 v[84:87], v[40:43], a[200:207], v3
  s_cbranch_vccnz L_c_safe_EH_f0123
  s_waitcnt vmcnt(2)
  v_smfmac_f32_16x16x64_bf16 v[80:83], v[44:47], a[208:215], v3
  v_cmp_gt_i32 vcc, s77, v47
  v_smfmac_f32_16x16x64_bf16 v[84:87], v[44:47], a[216:223], v3
  s_cbranch_vccnz L_c_safe_EH_f123
  s_waitcnt vmcnt(1)
  v_smfmac_f32_16x16x64_bf16 v[80:83], v[48:51], a[224:231], v3
  v_cmp_gt_i32 vcc, s77, v51
  v_smfmac_f32_16x16x64_bf16 v[84:87], v[48:51], a[232:239], v3
  s_cbranch_vccnz L_c_safe_EH_f23
  s_waitcnt vmcnt(0)
  v_smfmac_f32_16x16x64_bf16 v[80:83], v[52:55], a[240:247], v3
  v_cmp_gt_i32 vcc, s77, v55
  v_smfmac_f32_16x16x64_bf16 v[84:87], v[52:55], a[248:255], v3
  s_nop 5
  s_cbranch_vccnz L_c_safe_EH_f3
  s_branch L_c_safe_EH_done
  .fill (((0 - (. - L_0)) & 31) >> 2), 4, 0xbf800000
L_c_safe_EH_f012:
  s_mov_b64 exec, vcc
  global_load_dwordx4 v[40:43], v29, s[44:45] offset:0 sc1
  s_not_b64 exec, vcc
  v_mov_b64 v[40:41], 0
  v_mov_b64 v[42:43], 0
  s_mov_b64 exec, -1
  s_sub_u32 s39, s39, 1
  s_cbranch_scc1 L_c_safe_bail
  s_waitcnt vmcnt(2)
  v_smfmac_f32_16x16x64_bf16 v[80:83], v[44:47], a[208:215], v3
  v_cmp_gt_i32 vcc, s77, v47
  v_smfmac_f32_16x16x64_bf16 v[84:87], v[44:47], a[216:223], v3
  s_cbranch_vccnz L_c_safe_EH_f120
  s_waitcnt vmcnt(1)
  v_smfmac_f32_16x16x64_bf16 v[80:83], v[48:51], a[224:231], v3
  v_cmp_gt_i32 vcc, s77, v51
  v_smfmac_f32_16x16x64_bf16 v[84:87], v[48:51], a[232:239], v3
  s_cbranch_vccnz L_c_safe_EH_f20
  s_waitcnt vmcnt(0)
  v_smfmac_f32_16x16x64_bf16 v[80:83], v[40:43], a[192:199], v3
  v_cmp_gt_i32 vcc, s77, v43
  v_smfmac_f32_16x16x64_bf16 v[84:87], v[40:43], a[200:207], v3
  s_nop 5
  s_cbranch_vccnz L_c_safe_EH_f0
  s_branch L_c_safe_EH_done
  .fill (((0 - (. - L_0)) & 31) >> 2), 4, 0xbf800000
L_c_safe_EH_f013:
  s_mov_b64 exec, vcc
  global_load_dwordx4 v[40:43], v29, s[44:45] offset:0 sc1
  s_not_b64 exec, vcc
  v_mov_b64 v[40:41], 0
  v_mov_b64 v[42:43], 0
  s_mov_b64 exec, -1
  s_sub_u32 s39, s39, 1
  s_cbranch_scc1 L_c_safe_bail
  s_waitcnt vmcnt(2)
  v_smfmac_f32_16x16x64_bf16 v[80:83], v[44:47], a[208:215], v3
  v_cmp_gt_i32 vcc, s77, v47
  v_smfmac_f32_16x16x64_bf16 v[84:87], v[44:47], a[216:223], v3
  s_cbranch_vccnz L_c_safe_EH_f130
  s_waitcnt vmcnt(1)
  v_smfmac_f32_16x16x64_bf16 v[80:83], v[52:55], a[240:247], v3
  v_cmp_gt_i32 vcc, s77, v55
  v_smfmac_f32_16x16x64_bf16 v[84:87], v[52:55], a[248:255], v3
  s_cbranch_vccnz L_c_safe_EH_f30
  s_waitcnt vmcnt(0)
  v_smfmac_f32_16x16x64_bf16 v[80:83], v[40:43], a[192:199], v3
  v_cmp_gt_i32 vcc, s77, v43
  v_smfmac_f32_16x16x64_bf16 v[84:87], v[40:43], a[200:207], v3
  s_nop 5
  s_cbranch_vccnz L_c_safe_EH_f0
  s_branch L_c_safe_EH_done
  .fill (((0 - (. - L_0)) & 31) >> 2), 4, 0xbf800000
L_c_safe_EH_f10:
  s_mov_b64 exec, vcc
  global_load_dwordx4 v[44:47], v29, s[44:45] offset:1024 sc1
  s_not_b64 exec, vcc
  v_mov_b64 v[44:45], 0
  v_mov_b64 v[46:47], 0
  s_mov_b64 exec, -1
  s_sub_u32 s39, s39, 1
  s_cbranch_scc1 L_c_safe_bail
  s_waitcnt vmcnt(1)
  v_smfmac_f32_16x16x64_bf16 v[80:83], v[40:43], a[192:199], v3
  v_cmp_gt_i32 vcc, s77, v43
  v_smfmac_f32_16x16x64_bf16 v[84:87], v[40:43], a[200:207], v3
  s_cbranch_vccnz L_c_safe_EH_f01
  s_waitcnt vmcnt(0)
  v_smfmac_f32_16x16x64_bf16 v[80:83], v[44:47], a[208:215], v3
  v_cmp_gt_i32 vcc, s77, v47
  v_smfmac_f32_16x16x64_bf16 v[84:87], v[44:47], a[216:223], v3
  s_nop 5
  s_cbranch_vccnz L_c_safe_EH_f1
  s_branch L_c_safe_EH_done
  .fill (((0 - (. - L_0)) & 31) >> 2), 4, 0xbf800000
L_c_safe_EH_f023:
  s_mov_b64 exec, vcc
  global_load_dwordx4 v[40:43], v29, s[44:45] offset:0 sc1
  s_not_b64 exec, vcc
  v_mov_b64 v[40:41], 0
  v_mov_b64 v[42:43], 0
  s_mov_b64 exec, -1
  s_sub_u32 s39, s39, 1
  s_cbranch_scc1 L_c_safe_bail
  s_waitcnt vmcnt(2)
  v_smfmac_f32_16x16x64_bf16 v[80:83], v[48:51], a[224:231], v3
  v_cmp_gt_i32 vcc, s77, v51
  v_smfmac_f32_16x16x64_bf16 v[84:87], v[48:51], a[232:239], v3
  s_cbranch_vccnz L_c_safe_EH_f230
  s_waitcnt vmcnt(1)
  v_smfmac_f32_16x16x64_bf16 v[80:83], v[52:55], a[240:247], v3
  v_cmp_gt_i32 vcc, s77, v55
  v_smfmac_f32_16x16x64_bf16 v[84:87], v[52:55], a[248:255], v3
  s_cbranch_vccnz L_c_safe_EH_f30
  s_waitcnt vmcnt(0)
  v_smfmac_f32_16x16x64_bf16 v[80:83], v[40:43], a[192:199], v3
  v_cmp_gt_i32 vcc, s77, v43
  v_smfmac_f32_16x16x64_bf16 v[84:87], v[40:43], a[200:207], v3
  s_nop 5
  s_cbranch_vccnz L_c_safe_EH_f0
  s_branch L_c_safe_EH_done
  .fill (((0 - (. - L_0)) & 31) >> 2), 4, 0xbf800000
L_c_safe_EH_f20:
  s_mov_b64 exec, vcc
  global_load_dwordx4 v[48:51], v29, s[44:45] offset:2048 sc1
  s_not_b64 exec, vcc
  v_mov_b64 v[48:49], 0
  v_mov_b64 v[50:51], 0
  s_mov_b64 exec, -1
  s_sub_u32 s39, s39, 1
  s_cbranch_scc1 L_c_safe_bail
  s_waitcnt vmcnt(1)
  v_smfmac_f32_16x16x64_bf16 v[80:83], v[40:43], a[192:199], v3
  v_cmp_gt_i32 vcc, s77, v43
  v_smfmac_f32_16x16x64_bf16 v[84:87], v[40:43], a[200:207], v3
  s_cbranch_vccnz L_c_safe_EH_f02
  s_waitcnt vmcnt(0)
  v_smfmac_f32_16x16x64_bf16 v[80:83], v[48:51], a[224:231], v3
  v_cmp_gt_i32 vcc, s77, v51
  v_smfmac_f32_16x16x64_bf16 v[84:87], v[48:51], a[232:239], v3
  s_nop 5
  s_cbranch_vccnz L_c_safe_EH_f2
  s_branch L_c_safe_EH_done
  .fill (((0 - (. - L_0)) & 31) >> 2), 4, 0xbf800000
L_c_safe_EH_f21:
  s_mov_b64 exec, vcc
  global_load_dwordx4 v[48:51], v29, s[44:45] offset:2048 sc1
  s_not_b64 exec, vcc
  v_mov_b64 v[48:49], 0
  v_mov_b64 v[50:51], 0
  s_mov_b64 exec, -1
  s_sub_u32 s39, s39, 1
  s_cbranch_scc1 L_c_safe_bail
  s_waitcnt vmcnt(1)
  v_smfmac_f32_16x16x64_bf16 v[80:83], v[44:47], a[208:215], v3
  v_cmp_gt_i32 vcc, s77, v47
  v_smfmac_f32_16x16x64_bf16 v[84:87], v[44:47], a[216:223], v3
  s_cbranch_vccnz L_c_safe_EH_f12
  s_waitcnt vmcnt(0)
  v_smfmac_f32_16x16x64_bf16 v[80:83], v[48:51], a[224:231], v3
  v_cmp_gt_i32 vcc, s77, v51
  v_smfmac_f32_16x16x64_bf16 v[84:87], v[48:51], a[232:239], v3
  s_nop 5
  s_cbranch_vccnz L_c_safe_EH_f2
  s_branch L_c_safe_EH_done
  .fill (((0 - (. - L_0)) & 31) >> 2), 4, 0xbf800000
L_c_safe_EH_f120:
  s_mov_b64 exec, vcc
  global_load_dwordx4 v[44:47], v29, s[44:45] offset:1024 sc1
  s_not_b64 exec, vcc
  v_mov_b64 v[44:45], 0
  v_mov_b64 v[46:47], 0
  s_mov_b64 exec, -1
  s_sub_u32 s39, s39, 1
  s_cbranch_scc1 L_c_safe_bail
  s_waitcnt vmcnt(2)
  v_smfmac_f32_16x16x64_bf16 v[80:83], v[48:51], a[224:231], v3
  v_cmp_gt_i32 vcc, s77, v51
  v_smfmac_f32_16x16x64_bf16 v[84:87], v[48:51], a[232:239], v3
  s_cbranch_vccnz L_c_safe_EH_f201
  s_waitcnt vmcnt(1)
  v_smfmac_f32_16x16x64_bf16 v[80:83], v[40:43], a[192:199], v3
  v_cmp_gt_i32 vcc, s77, v43
  v_smfmac_f32_16x16x64_bf16 v[84:87], v[40:43], a[200:207], v3
  s_cbranch_vccnz L_c_safe_EH_f01
  s_waitcnt vmcnt(0)
  v_smfmac_f32_16x16x64_bf16 v[80:83], v[44:47], a[208:215], v3
  v_cmp_gt_i32 vcc, s77, v47
  v_smfmac_f32_16x16x64_bf16 v[84:87], v[44:47], a[216:223], v3
  s_nop 5
  s_cbranch_vccnz L_c_safe_EH_f1
  s_branch L_c_safe_EH_done
  .fill (((0 - (. - L_0)) & 31) >> 2), 4, 0xbf800000
L_c_safe_EH_f130:
  s_mov_b64 exec, vcc
  global_load_dwordx4 v[44:47], v29, s[44:45] offset:1024 sc1
  s_not_b64 exec, vcc
  v_mov_b64 v[44:45], 0
  v_mov_b64 v[46:47], 0
  s_mov_b64 exec, -1
  s_sub_u32 s39, s39, 1
  s_cbranch_scc1 L_c_safe_bail
  s_waitcnt vmcnt(2)
  v_smfmac_f32_16x16x64_bf16 v[80:83], v[52:55], a[240:247], v3
  v_cmp_gt_i32 vcc, s77, v55
  v_smfmac_f32_16x16x64_bf16 v[84:87], v[52:55], a[248:255], v3
  s_cbranch_vccnz L_c_safe_EH_f301
  s_waitcnt vmcnt(1)
  v_smfmac_f32_16x16x64_bf16 v[80:83], v[40:43], a[192:199], v3
  v_cmp_gt_i32 vcc, s77, v43
  v_smfmac_f32_16x16x64_bf16 v[84:87], v[40:43], a[200:207], v3
  s_cbranch_vccnz L_c_safe_EH_f01
  s_waitcnt vmcnt(0)
  v_smfmac_f32_16x16x64_bf16 v[80:83], v[44:47], a[208:215], v3
  v_cmp_gt_i32 vcc, s77, v47
  v_smfmac_f32_16x16x64_bf16 v[84:87], v[44:47], a[216:223], v3
  s_nop 5
  s_cbranch_vccnz L_c_safe_EH_f1
  s_branch L_c_safe_EH_done
  .fill (((0 - (. - L_0)) & 31) >> 2), 4, 0xbf800000
L_c_safe_EH_f201:
  s_mov_b64 exec, vcc
  global_load_dwordx4 v[48:51], v29, s[44:45] offset:2048 sc1
  s_not_b64 exec, vcc
  v_mov_b64 v[48:49], 0
  v_mov_b64 v[50:51], 0
  s_mov_b64 exec, -1
  s_sub_u32 s39, s39, 1
  s_cbranch_scc1 L_c_safe_bail
  s_waitcnt vmcnt(2)
  v_smfmac_f32_16x16x64_bf16 v[80:83], v[40:43], a[192:199], v3
  v_cmp_gt_i32 vcc, s77, v43
  v_smfmac_f32_16x16x64_bf16 v[84:87], v[40:43], a[200:207], v3
  s_cbranch_vccnz L_c_safe_EH_f012
  s_waitcnt vmcnt(1)
  v_smfmac_f32_16x16x64_bf16 v[80:83], v[44:47], a[208:215], v3
  v_cmp_gt_i32 vcc, s77, v47
  v_smfmac_f32_16x16x64_bf16 v[84:87], v[44:47], a[216:223], v3
  s_cbranch_vccnz L_c_safe_EH_f12
  s_waitcnt vmcnt(0)
  v_smfmac_f32_16x16x64_bf16 v[80:83], v[48:51], a[224:231], v3
  v_cmp_gt_i32 vcc, s77, v51
  v_smfmac_f32_16x16x64_bf16 v[84:87], v[48:51], a[232:239], v3
  s_nop 5
  s_cbranch_vccnz L_c_safe_EH_f2
  s_branch L_c_safe_EH_done
L_c_safe_Bredo:
  s_sub_u32 s39, s39, 1
  s_cbranch_scc0 L_c_safe_B2
  s_endpgm
L_c_safe_Fredo:
  s_sub_u32 s39, s39, 1
  s_cbranch_scc0 L_c_safe_F2
  s_endpgm
L_c_safe_bail:
  s_endpgm
L_xrole:
  s_mov_b32 s52, s34
  s_and_b32 s53, s35, 0xffff
  s_mov_b32 s54, 0x6000000
  s_mov_b32 s55, 0x20000
  s_lshl_b32 s56, s36, 15
  s_add_u32 s56, s56, 32768
  s_lshl_b32 s61, s36, 10
  v_mov_b32 v7, 0
  s_mov_b32 s44, s14
  s_and_b32 s45, s15, 0xffff
  s_mov_b32 s46, 0x800000
  s_mov_b32 s47, 0x20000
  s_mov_b32 s68, s30
  s_and_b32 s69, s31, 0xffff
  s_mov_b32 s70, 0x800000
  s_mov_b32 s71, 0x20000
  s_lshr_b32 s72, s38, 3
  s_and_b32 s43, s38, 7
  v_lshrrev_b32 v2, 2, v0
  v_lshlrev_b32 v2, 11, v2
  s_and_b32 s40, s72, 1
  s_lshl_b32 s40, s40, 1
  v_xor_b32 v1, s40, v0
  v_and_b32 v1, 3, v1
  v_lshl_add_u32 v2, v1, 4, v2
  s_lshl_b32 s63, s43, 1
  s_lshl_b32 s62, s72, 21
  s_lshl_b32 s40, s63, 17
  s_add_u32 s62, s62, s40
  s_lshl_b32 s40, s43, 8
  s_lshl_b32 s41, s36, 6
  s_add_u32 s40, s40, s41
  s_add_u32 s62, s62, s40
  s_lshl_b32 s63, s63, 12
  s_and_b32 s41, s72, 1
  s_lshl_b32 s41, s41, 5
  s_add_u32 s40, s40, s41
  s_lshr_b32 s41, s72, 1
  s_lshl_b32 s42, s41, 16
  s_add_u32 s40, s40, s42
  v_and_b32 v1, 15, v0
  v_lshl_add_u32 v108, v1, 12, s40
  v_lshrrev_b32 v1, 4, v0
  v_lshl_add_u32 v108, v1, 3, v108
  s_lshl_b32 s41, s41, 10
  s_add_u32 s63, s63, s41
  s_lshl_b32 s41, s36, 11
  s_lshl_b32 s40, s72, 16
  s_add_u32 s40, s40, s41
  s_add_u32 s40, s40, 50331648
  v_lshl_add_u32 v4, v0, 4, s40
  v_lshlrev_b32 v8, 4, v0
  v_add_u32 v9, 0x10000, v8
  s_lshl_b32 s40, s43, 16
  s_lshl_b32 s41, s72, 14
  s_add_u32 s40, s40, s41
  s_lshl_b32 s41, s36, 12
  s_add_u32 s40, s40, s41
  s_add_u32 s40, s40, 88080384
  v_lshl_add_u32 v107, v0, 4, s40
  s_lshl_b32 s40, s72, 10
  s_lshl_b32 s41, s36, 8
  s_add_u32 s40, s40, s41
  s_add_u32 s83, s40, 76554240
  s_lshl_b32 s61, s36, 11
  v_xor_b32 v104, 16384, v107
  v_xor_b32 v105, 32768, v107
  v_xor_b32 v106, 49152, v107
  v_mov_b32 v80, -1
  v_mov_b32 v81, -1
  v_mov_b32 v82, -1
  v_mov_b32 v83, -1
  v_mov_b32 v32, 0
  v_mov_b32 v33, 0
  v_mov_b32 v34, 0
  v_mov_b32 v35, 0
  v_mov_b32 v36, 0
  v_mov_b32 v37, 0
  v_mov_b32 v38, 0
  v_mov_b32 v39, 0
  v_mov_b32 v40, 0
  v_mov_b32 v41, 0
  v_mov_b32 v42, 0
  v_mov_b32 v43, 0
  v_mov_b32 v44, 0
  v_mov_b32 v45, 0
  v_mov_b32 v46, 0
  v_mov_b32 v47, 0
  v_lshrrev_b32 v3, 4, v0
  v_lshlrev_b32 v3, 2, v3
  v_bfe_u32 v1, v0, 2, 2
  v_add_u32 v3, v1, v3
  v_lshlrev_b32 v3, 6, v3
  v_and_b32 v1, 3, v0
  v_lshl_add_u32 v3, v1, 3, v3
  v_add_u32 v3, s56, v3
  s_mov_b32 s67, 0
  buffer_store_dwordx4 v[80:83], v107, s[52:55], s67 offen offset:1024 sc1
  buffer_store_dwordx4 v[80:83], v107, s[52:55], s67 offen offset:2048 sc1
  buffer_store_dwordx4 v[80:83], v107, s[52:55], s67 offen offset:3072 sc1
  s_mov_b32 s67, 524288
  buffer_store_dwordx4 v[80:83], v107, s[52:55], s67 offen offset:1024 sc1
  buffer_store_dwordx4 v[80:83], v107, s[52:55], s67 offen offset:2048 sc1
  buffer_store_dwordx4 v[80:83], v107, s[52:55], s67 offen offset:3072 sc1
  s_mov_b32 s67, 1048576
  buffer_store_dwordx4 v[80:83], v107, s[52:55], s67 offen offset:1024 sc1
  buffer_store_dwordx4 v[80:83], v107, s[52:55], s67 offen offset:2048 sc1
  buffer_store_dwordx4 v[80:83], v107, s[52:55], s67 offen offset:3072 sc1
  s_mov_b32 s67, 1572864
  buffer_store_dwordx4 v[80:83], v107, s[52:55], s67 offen offset:1024 sc1
  buffer_store_dwordx4 v[80:83], v107, s[52:55], s67 offen offset:2048 sc1
  buffer_store_dwordx4 v[80:83], v107, s[52:55], s67 offen offset:3072 sc1
  s_waitcnt vmcnt(0)
  s_barrier
  s_cmp_eq_u32 s36, 0
  s_cbranch_scc0 L_arr_9
  s_mov_b32 s41, 0x10000
  s_atomic_add s41, s[32:33], 4 glc
  s_waitcnt lgkmcnt(0)
  s_lshr_b32 s40, s41, 16
  s_cmp_eq_u32 s40, 255
  s_cbranch_scc0 L_arr_9
  s_mov_b32 s84, 0
  s_atomic_add s84, s[32:33], 0 glc
  s_mov_b32 s85, 0
  s_atomic_add s85, s[32:33], 32 glc
  s_mov_b32 s86, 0
  s_atomic_add s86, s[32:33], 64 glc
  s_mov_b32 s87, 0
  s_atomic_add s87, s[32:33], 96 glc
  s_mov_b32 s88, 0
  s_atomic_add s88, s[32:33], 128 glc
  s_mov_b32 s89, 0
  s_atomic_add s89, s[32:33], 160 glc
  s_mov_b32 s90, 0
  s_atomic_add s90, s[32:33], 192 glc
  s_mov_b32 s91, 0
  s_atomic_add s91, s[32:33], 224 glc
  s_and_b32 s41, s41, 0xffff
  s_cmp_ge_u32 s41, 64
  s_cselect_b32 s41, 3, 1
  s_mov_b32 s40, 4
  s_waitcnt lgkmcnt(0)
  s_cmp_eq_u32 s84, 32
  s_cselect_b32 s40, s40, 0
  s_cmp_eq_u32 s85, 32
  s_cselect_b32 s40, s40, 0
  s_cmp_eq_u32 s86, 32
  s_cselect_b32 s40, s40, 0
  s_cmp_eq_u32 s87, 32
  s_cselect_b32 s40, s40, 0
  s_cmp_eq_u32 s88, 32
  s_cselect_b32 s40, s40, 0
  s_cmp_eq_u32 s89, 32
  s_cselect_b32 s40, s40, 0
  s_cmp_eq_u32 s90, 32
  s_cselect_b32 s40, s40, 0
  s_cmp_eq_u32 s91, 32
  s_cselect_b32 s40, s40, 0
  s_add_u32 s41, s41, s40
  s_atomic_add s41, s[32:33], 252
L_arr_9:
  v_mov_b32 v1, 252
  s_cmp_eq_u32 s36, 0
  s_cbranch_scc0 L_wib_12
L_wi_10:
  global_load_dword v110, v1, s[32:33] sc1
  s_waitcnt vmcnt(0)
  v_cmp_ne_u32 vcc, 0, v110
  s_cbranch_vccnz L_wid_11
  s_sleep 2
  s_sub_u32 s39, s39, 1
  s_cbranch_scc0 L_wi_10
  s_endpgm
L_wid_11:
  ds_write_b32 v1, v110 offset:0
  s_waitcnt lgkmcnt(0)
L_wib_12:
  s_barrier
  ds_read_b32 v110, v1 offset:0
  s_waitcnt lgkmcnt(0)
  s_lshl_b32 s41, s38, 8
  s_lshl_b32 s40, s36, 6
  s_add_u32 s41, s41, s40
  s_add_u32 s41, s41, 76546048
L_o_wk:
  s_load_dword s40, s[34:35], s41 glc
  s_waitcnt lgkmcnt(0)
  s_cmp_lg_u32 s40, 0
  s_cbranch_scc1 L_o_wkd
  s_sleep 8
  s_sub_u32 s39, s39, 1
  s_cbranch_scc0 L_o_wk
  s_endpgm
L_o_wkd:
  s_xor_b32 m0, s56, 0
  s_xor_b32 s57, s62, 0
  buffer_load_dwordx4 v2, s[44:47], s57 offen lds
  s_xor_b32 m0, s56, 1024
  s_xor_b32 s57, s62, 32768
  buffer_load_dwordx4 v2, s[44:47], s57 offen lds
  s_xor_b32 m0, s56, 2048
  s_xor_b32 s57, s62, 65536
  buffer_load_dwordx4 v2, s[44:47], s57 offen lds
  s_xor_b32 m0, s56, 3072
  s_xor_b32 s57, s62, 98304
  buffer_load_dwordx4 v2, s[44:47], s57 offen lds
  s_xor_b32 m0, s56, 4096
  s_xor_b32 s57, s62, 131072
  buffer_load_dwordx4 v2, s[44:47], s57 offen lds
  s_xor_b32 m0, s56, 5120
  s_xor_b32 s57, s62, 163840
  buffer_load_dwordx4 v2, s[44:47], s57 offen lds
  s_xor_b32 m0, s56, 6144
  s_xor_b32 s57, s62, 196608
  buffer_load_dwordx4 v2, s[44:47], s57 offen lds
  s_xor_b32 m0, s56, 7168
  s_xor_b32 s57, s62, 229376
  buffer_load_dwordx4 v2, s[44:47], s57 offen lds
  s_xor_b32 m0, s56, 8192
  s_xor_b32 s57, s62, 262144
  buffer_load_dwordx4 v2, s[44:47], s57 offen lds
  s_xor_b32 m0, s56, 9216
  s_xor_b32 s57, s62, 294912
  buffer_load_dwordx4 v2, s[44:47], s57 offen lds
  s_xor_b32 m0, s56, 10240
  s_xor_b32 s57, s62, 327680
  buffer_load_dwordx4 v2, s[44:47], s57 offen lds
  s_xor_b32 m0, s56, 11264
  s_xor_b32 s57, s62, 360448
  buffer_load_dwordx4 v2, s[44:47], s57 offen lds
  s_xor_b32 m0, s56, 12288
  s_xor_b32 s57, s62, 393216
  buffer_load_dwordx4 v2, s[44:47], s57 offen lds
  s_xor_b32 m0, s56, 13312
  s_xor_b32 s57, s62, 425984
  buffer_load_dwordx4 v2, s[44:47], s57 offen lds
  s_xor_b32 m0, s56, 14336
  s_xor_b32 s57, s62, 458752
  buffer_load_dwordx4 v2, s[44:47], s57 offen lds
  s_xor_b32 m0, s56, 15360
  s_xor_b32 s57, s62, 491520
  buffer_load_dwordx4 v2, s[44:47], s57 offen lds
  s_xor_b32 m0, s56, 16384
  s_xor_b32 s57, s62, 524288
  buffer_load_dwordx4 v2, s[44:47], s57 offen lds
  s_xor_b32 m0, s56, 17408
  s_xor_b32 s57, s62, 557056
  buffer_load_dwordx4 v2, s[44:47], s57 offen lds
  s_xor_b32 m0, s56, 18432
  s_xor_b32 s57, s62, 589824
  buffer_load_dwordx4 v2, s[44:47], s57 offen lds
  s_xor_b32 m0, s56, 19456
  s_xor_b32 s57, s62, 622592
  buffer_load_dwordx4 v2, s[44:47], s57 offen lds
  s_xor_b32 m0, s56, 20480
  s_xor_b32 s57, s62, 655360
  buffer_load_dwordx4 v2, s[44:47], s57 offen lds
  s_xor_b32 m0, s56, 21504
  s_xor_b32 s57, s62, 688128
  buffer_load_dwordx4 v2, s[44:47], s57 offen lds
  s_xor_b32 m0, s56, 22528
  s_xor_b32 s57, s62, 720896
  buffer_load_dwordx4 v2, s[44:47], s57 offen lds
  s_waitcnt vmcnt(7)
  ds_read_b64_tr_b16 a[0:1], v3 offset:0
  ds_read_b64_tr_b16 a[2:3], v3 offset:1024
  ds_read_b64_tr_b16 a[4:5], v3 offset:32
  ds_read_b64_tr_b16 a[6:7], v3 offset:1056
  s_xor_b32 m0, s56, 23552
  s_xor_b32 s57, s62, 753664
  buffer_load_dwordx4 v2, s[44:47], s57 offen lds
  ds_read_b64_tr_b16 a[8:9], v3 offset:2048
  ds_read_b64_tr_b16 a[10:11], v3 offset:3072
  ds_read_b64_tr_b16 a[12:13], v3 offset:2080
  ds_read_b64_tr_b16 a[14:15], v3 offset:3104
  s_xor_b32 m0, s56, 24576
  s_xor_b32 s57, s62, 786432
  buffer_load_dwordx4 v2, s[44:47], s57 offen lds
  ds_read_b64_tr_b16 a[16:17], v3 offset:4096
  ds_read_b64_tr_b16 a[18:19], v3 offset:5120
  ds_read_b64_tr_b16 a[20:21], v3 offset:4128
  ds_read_b64_tr_b16 a[22:23], v3 offset:5152
  s_xor_b32 m0, s56, 25600
  s_xor_b32 s57, s62, 819200
  buffer_load_dwordx4 v2, s[44:47], s57 offen lds
  ds_read_b64_tr_b16 a[24:25], v3 offset:6144
  ds_read_b64_tr_b16 a[26:27], v3 offset:7168
  ds_read_b64_tr_b16 a[28:29], v3 offset:6176
  ds_read_b64_tr_b16 a[30:31], v3 offset:7200
  s_xor_b32 m0, s56, 26624
  s_xor_b32 s57, s62, 851968
  buffer_load_dwordx4 v2, s[44:47], s57 offen lds
  ds_read_b64_tr_b16 a[32:33], v3 offset:8192
  ds_read_b64_tr_b16 a[34:35], v3 offset:9216
  ds_read_b64_tr_b16 a[36:37], v3 offset:8224
  ds_read_b64_tr_b16 a[38:39], v3 offset:9248
  s_xor_b32 m0, s56, 27648
  s_xor_b32 s57, s62, 884736
  buffer_load_dwordx4 v2, s[44:47], s57 offen lds
  ds_read_b64_tr_b16 a[40:41], v3 offset:10240
  ds_read_b64_tr_b16 a[42:43], v3 offset:11264
  ds_read_b64_tr_b16 a[44:45], v3 offset:10272
  ds_read_b64_tr_b16 a[46:47], v3 offset:11296
  s_xor_b32 m0, s56, 28672
  s_xor_b32 s57, s62, 917504
  buffer_load_dwordx4 v2, s[44:47], s57 offen lds
  ds_read_b64_tr_b16 a[48:49], v3 offset:12288
  ds_read_b64_tr_b16 a[50:51], v3 offset:13312
  ds_read_b64_tr_b16 a[52:53], v3 offset:12320
  ds_read_b64_tr_b16 a[54:55], v3 offset:13344
  s_xor_b32 m0, s56, 29696
  s_xor_b32 s57, s62, 950272
  buffer_load_dwordx4 v2, s[44:47], s57 offen lds
  ds_read_b64_tr_b16 a[56:57], v3 offset:14336
  ds_read_b64_tr_b16 a[58:59], v3 offset:15360
  ds_read_b64_tr_b16 a[60:61], v3 offset:14368
  ds_read_b64_tr_b16 a[62:63], v3 offset:15392
  s_xor_b32 m0, s56, 30720
  s_xor_b32 s57, s62, 983040
  buffer_load_dwordx4 v2, s[44:47], s57 offen lds
  s_xor_b32 m0, s56, 31744
  s_xor_b32 s57, s62, 1015808
  buffer_load_dwordx4 v2, s[44:47], s57 offen lds
  s_waitcnt lgkmcnt(0)
  s_xor_b32 m0, s56, 0
  s_xor_b32 s57, s62, 1048576
  buffer_load_dwordx4 v2, s[44:47], s57 offen lds
  s_xor_b32 m0, s56, 1024
  s_xor_b32 s57, s62, 1081344
  buffer_load_dwordx4 v2, s[44:47], s57 offen lds
  s_xor_b32 m0, s56, 2048
  s_xor_b32 s57, s62, 1114112
  buffer_load_dwordx4 v2, s[44:47], s57 offen lds
  s_xor_b32 m0, s56, 3072
  s_xor_b32 s57, s62, 1146880
  buffer_load_dwordx4 v2, s[44:47], s57 offen lds
  s_xor_b32 m0, s56, 4096
  s_xor_b32 s57, s62, 1179648
  buffer_load_dwordx4 v2, s[44:47], s57 offen lds
  s_xor_b32 m0, s56, 5120
  s_xor_b32 s57, s62, 1212416
  buffer_load_dwordx4 v2, s[44:47], s57 offen lds
  s_xor_b32 m0, s56, 6144
  s_xor_b32 s57, s62, 1245184
  buffer_load_dwordx4 v2, s[44:47], s57 offen lds
  s_waitcnt vmcnt(7)
  ds_read_b64_tr_b16 a[64:65], v3 offset:16384
  ds_read_b64_tr_b16 a[66:67], v3 offset:17408
  ds_read_b64_tr_b16 a[68:69], v3 offset:16416
  ds_read_b64_tr_b16 a[70:71], v3 offset:17440
  s_xor_b32 m0, s56, 7168
  s_xor_b32 s57, s62, 1277952
  buffer_load_dwordx4 v2, s[44:47], s57 offen lds
  ds_read_b64_tr_b16 a[72:73], v3 offset:18432
  ds_read_b64_tr_b16 a[74:75], v3 offset:19456
  ds_read_b64_tr_b16 a[76:77], v3 offset:18464
  ds_read_b64_tr_b16 a[78:79], v3 offset:19488
  s_xor_b32 m0, s56, 8192
  s_xor_b32 s57, s62, 1310720
  buffer_load_dwordx4 v2, s[44:47], s57 offen lds
  ds_read_b64_tr_b16 a[80:81], v3 offset:20480
  ds_read_b64_tr_b16 a[82:83], v3 offset:21504
  ds_read_b64_tr_b16 a[84:85], v3 offset:20512
  ds_read_b64_tr_b16 a[86:87], v3 offset:21536
  s_xor_b32 m0, s56, 9216
  s_xor_b32 s57, s62, 1343488
  buffer_load_dwordx4 v2, s[44:47], s57 offen lds
  ds_read_b64_tr_b16 a[88:89], v3 offset:22528
  ds_read_b64_tr_b16 a[90:91], v3 offset:23552
  ds_read_b64_tr_b16 a[92:93], v3 offset:22560
  ds_read_b64_tr_b16 a[94:95], v3 offset:23584
  s_xor_b32 m0, s56, 10240
  s_xor_b32 s57, s62, 1376256
  buffer_load_dwordx4 v2, s[44:47], s57 offen lds
  ds_read_b64_tr_b16 a[96:97], v3 offset:24576
  ds_read_b64_tr_b16 a[98:99], v3 offset:25600
  ds_read_b64_tr_b16 a[100:101], v3 offset:24608
  ds_read_b64_tr_b16 a[102:103], v3 offset:25632
  s_xor_b32 m0, s56, 11264
  s_xor_b32 s57, s62, 1409024
  buffer_load_dwordx4 v2, s[44:47], s57 offen lds
  ds_read_b64_tr_b16 a[104:105], v3 offset:26624
  ds_read_b64_tr_b16 a[106:107], v3 offset:27648
  ds_read_b64_tr_b16 a[108:109], v3 offset:26656
  ds_read_b64_tr_b16 a[110:111], v3 offset:27680
  s_xor_b32 m0, s56, 12288
  s_xor_b32 s57, s62, 1441792
  buffer_load_dwordx4 v2, s[44:47], s57 offen lds
  ds_read_b64_tr_b16 a[112:113], v3 offset:28672
  ds_read_b64_tr_b16 a[114:115], v3 offset:29696
  ds_read_b64_tr_b16 a[116:117], v3 offset:28704
  ds_read_b64_tr_b16 a[118:119], v3 offset:29728
  s_xor_b32 m0, s56, 13312
  s_xor_b32 s57, s62, 1474560
  buffer_load_dwordx4 v2, s[44:47], s57 offen lds
  ds_read_b64_tr_b16 a[120:121], v3 offset:30720
  ds_read_b64_tr_b16 a[122:123], v3 offset:31744
  ds_read_b64_tr_b16 a[124:125], v3 offset:30752
  ds_read_b64_tr_b16 a[126:127], v3 offset:31776
  s_xor_b32 m0, s56, 14336
  s_xor_b32 s57, s62, 1507328
  buffer_load_dwordx4 v2, s[44:47], s57 offen lds
  s_xor_b32 m0, s56, 15360
  s_xor_b32 s57, s62, 1540096
  buffer_load_dwordx4 v2, s[44:47], s57 offen lds
  s_waitcnt lgkmcnt(0)
  s_xor_b32 m0, s56, 16384
  s_xor_b32 s57, s62, 1572864
  buffer_load_dwordx4 v2, s[44:47], s57 offen lds
  s_xor_b32 m0, s56, 17408
  s_xor_b32 s57, s62, 1605632
  buffer_load_dwordx4 v2, s[44:47], s57 offen lds
  s_xor_b32 m0, s56, 18432
  s_xor_b32 s57, s62, 1638400
  buffer_load_dwordx4 v2, s[44:47], s57 offen lds
  s_xor_b32 m0, s56, 19456
  s_xor_b32 s57, s62, 1671168
  buffer_load_dwordx4 v2, s[44:47], s57 offen lds
  s_xor_b32 m0, s56, 20480
  s_xor_b32 s57, s62, 1703936
  buffer_load_dwordx4 v2, s[44:47], s57 offen lds
  s_xor_b32 m0, s56, 21504
  s_xor_b32 s57, s62, 1736704
  buffer_load_dwordx4 v2, s[44:47], s57 offen lds
  s_xor_b32 m0, s56, 22528
  s_xor_b32 s57, s62, 1769472
  buffer_load_dwordx4 v2, s[44:47], s57 offen lds
  s_waitcnt vmcnt(7)
  ds_read_b64_tr_b16 a[128:129], v3 offset:0
  ds_read_b64_tr_b16 a[130:131], v3 offset:1024
  ds_read_b64_tr_b16 a[132:133], v3 offset:32
  ds_read_b64_tr_b16 a[134:135], v3 offset:1056
  s_xor_b32 m0, s56, 23552
  s_xor_b32 s57, s62, 1802240
  buffer_load_dwordx4 v2, s[44:47], s57 offen lds
  ds_read_b64_tr_b16 a[136:137], v3 offset:2048
  ds_read_b64_tr_b16 a[138:139], v3 offset:3072
  ds_read_b64_tr_b16 a[140:141], v3 offset:2080
  ds_read_b64_tr_b16 a[142:143], v3 offset:3104
  s_xor_b32 m0, s56, 24576
  s_xor_b32 s57, s62, 1835008
  buffer_load_dwordx4 v2, s[44:47], s57 offen lds
  ds_read_b64_tr_b16 a[144:145], v3 offset:4096
  ds_read_b64_tr_b16 a[146:147], v3 offset:5120
  ds_read_b64_tr_b16 a[148:149], v3 offset:4128
  ds_read_b64_tr_b16 a[150:151], v3 offset:5152
  s_xor_b32 m0, s56, 25600
  s_xor_b32 s57, s62, 1867776
  buffer_load_dwordx4 v2, s[44:47], s57 offen lds
  ds_read_b64_tr_b16 a[152:153], v3 offset:6144
  ds_read_b64_tr_b16 a[154:155], v3 offset:7168
  ds_read_b64_tr_b16 a[156:157], v3 offset:6176
  ds_read_b64_tr_b16 a[158:159], v3 offset:7200
  s_xor_b32 m0, s56, 26624
  s_xor_b32 s57, s62, 1900544
  buffer_load_dwordx4 v2, s[44:47], s57 offen lds
  ds_read_b64_tr_b16 a[160:161], v3 offset:8192
  ds_read_b64_tr_b16 a[162:163], v3 offset:9216
  ds_read_b64_tr_b16 a[164:165], v3 offset:8224
  ds_read_b64_tr_b16 a[166:167], v3 offset:9248
  s_xor_b32 m0, s56, 27648
  s_xor_b32 s57, s62, 1933312
  buffer_load_dwordx4 v2, s[44:47], s57 offen lds
  ds_read_b64_tr_b16 a[168:169], v3 offset:10240
  ds_read_b64_tr_b16 a[170:171], v3 offset:11264
  ds_read_b64_tr_b16 a[172:173], v3 offset:10272
  ds_read_b64_tr_b16 a[174:175], v3 offset:11296
  s_xor_b32 m0, s56, 28672
  s_xor_b32 s57, s62, 1966080
  buffer_load_dwordx4 v2, s[44:47], s57 offen lds
  ds_read_b64_tr_b16 a[176:177], v3 offset:12288
  ds_read_b64_tr_b16 a[178:179], v3 offset:13312
  ds_read_b64_tr_b16 a[180:181], v3 offset:12320
  ds_read_b64_tr_b16 a[182:183], v3 offset:13344
  s_xor_b32 m0, s56, 29696
  s_xor_b32 s57, s62, 1998848
  buffer_load_dwordx4 v2, s[44:47], s57 offen lds
  ds_read_b64_tr_b16 a[184:185], v3 offset:14336
  ds_read_b64_tr_b16 a[186:187], v3 offset:15360
  ds_read_b64_tr_b16 a[188:189], v3 offset:14368
  ds_read_b64_tr_b16 a[190:191], v3 offset:15392
  s_xor_b32 m0, s56, 30720
  s_xor_b32 s57, s62, 2031616
  buffer_load_dwordx4 v2, s[44:47], s57 offen lds
  s_xor_b32 m0, s56, 31744
  s_xor_b32 s57, s62, 2064384
  buffer_load_dwordx4 v2, s[44:47], s57 offen lds
  s_waitcnt lgkmcnt(0)
  s_waitcnt vmcnt(0)
  ds_read_b64_tr_b16 a[192:193], v3 offset:16384
  ds_read_b64_tr_b16 a[194:195], v3 offset:17408
  ds_read_b64_tr_b16 a[196:197], v3 offset:16416
  ds_read_b64_tr_b16 a[198:199], v3 offset:17440
  ds_read_b64_tr_b16 a[200:201], v3 offset:18432
  ds_read_b64_tr_b16 a[202:203], v3 offset:19456
  ds_read_b64_tr_b16 a[204:205], v3 offset:18464
  ds_read_b64_tr_b16 a[206:207], v3 offset:19488
  ds_read_b64_tr_b16 a[208:209], v3 offset:20480
  ds_read_b64_tr_b16 a[210:211], v3 offset:21504
  ds_read_b64_tr_b16 a[212:213], v3 offset:20512
  ds_read_b64_tr_b16 a[214:215], v3 offset:21536
  ds_read_b64_tr_b16 a[216:217], v3 offset:22528
  ds_read_b64_tr_b16 a[218:219], v3 offset:23552
  ds_read_b64_tr_b16 a[220:221], v3 offset:22560
  ds_read_b64_tr_b16 a[222:223], v3 offset:23584
  ds_read_b64_tr_b16 a[224:225], v3 offset:24576
  ds_read_b64_tr_b16 a[226:227], v3 offset:25600
  ds_read_b64_tr_b16 a[228:229], v3 offset:24608
  ds_read_b64_tr_b16 a[230:231], v3 offset:25632
  ds_read_b64_tr_b16 a[232:233], v3 offset:26624
  ds_read_b64_tr_b16 a[234:235], v3 offset:27648
  ds_read_b64_tr_b16 a[236:237], v3 offset:26656
  ds_read_b64_tr_b16 a[238:239], v3 offset:27680
  ds_read_b64_tr_b16 a[240:241], v3 offset:28672
  ds_read_b64_tr_b16 a[242:243], v3 offset:29696
  ds_read_b64_tr_b16 a[244:245], v3 offset:28704
  ds_read_b64_tr_b16 a[246:247], v3 offset:29728
  ds_read_b64_tr_b16 a[248:249], v3 offset:30720
  ds_read_b64_tr_b16 a[250:251], v3 offset:31744
  ds_read_b64_tr_b16 a[252:253], v3 offset:30752
  ds_read_b64_tr_b16 a[254:255], v3 offset:31776
  s_waitcnt lgkmcnt(0)
  s_barrier
  s_mov_b32 s58, 0
  s_mov_b32 s66, 0
  v_mov_b32 v111, 0
  v_mov_b32 v122, 0
  s_mov_b32 s59, 0x80000000
  s_mov_b32 s67, 0x80000000
  s_mov_b32 s74, 0x80000000
  s_mov_b32 s75, 0x80000000
  s_mov_b32 s84, 0
  s_mov_b32 s85, 0
  s_mov_b32 s86, 0
  s_mov_b32 s87, 0
  s_mov_b32 s88, 0
  s_mov_b32 s89, 0
  s_mov_b32 s90, 0
  s_mov_b32 s91, 0
  v_bfe_u32 v1, v0, 3, 2
  v_mov_b32 v128, s20
  v_mov_b32 v129, s21
  v_cmp_eq_u32 vcc, 1, v1
  s_mov_b64 exec, vcc
  v_mov_b32 v128, s22
  v_mov_b32 v129, s23
  s_mov_b64 exec, -1
  v_cmp_eq_u32 vcc, 2, v1
  s_mov_b64 exec, vcc
  v_mov_b32 v128, s26
  v_mov_b32 v129, s27
  s_mov_b64 exec, -1
  v_cmp_eq_u32 vcc, 3, v1
  s_mov_b64 exec, vcc
  v_mov_b32 v128, s18
  v_mov_b32 v129, s19
  s_mov_b64 exec, -1
  s_lshl_b32 s40, s38, 12
  s_lshl_b32 s41, s36, 10
  s_add_u32 s40, s40, s41
  v_and_b32 v1, 7, v0
  v_lshl_add_u32 v130, v1, 7, s40
  v_mov_b32 v131, 0
  v_lshl_add_u64 v[128:129], v[130:131], 0, v[128:129]
  v_mov_b32 v130, 131072
  s_mov_b32 s76, 0
  s_add_u32 s40, s38, s36
  s_cmp_eq_u32 s40, 0
  s_cselect_b32 s77, 0, -1
  s_mov_b64 exec, 0
  s_cmp_eq_u32 s36, 0
  s_cbranch_scc1 L_ot_w0
  s_cmp_eq_u32 s36, 1
  s_cbranch_scc1 L_ot_w1
  s_cmp_eq_u32 s36, 2
  s_cbranch_scc1 L_ot_w2
  s_branch L_ot_w3
L_ot_done:
L_o_loop:
  s_cmp_eq_u32 s66, 0
  s_cbranch_scc1 L_oh_13_s
L_oh_13:
  s_waitcnt vmcnt(8)
  s_barrier
  ds_read_b128 v[48:51], v8 offset:0
  ds_read_b128 v[52:55], v8 offset:1024
  ds_read_b128 v[56:59], v8 offset:2048
  ds_read_b128 v[60:63], v8 offset:3072
  ds_read_b128 v[64:67], v8 offset:4096
  ds_read_b128 v[68:71], v8 offset:5120
  s_waitcnt lgkmcnt(4)
  v_mfma_f32_16x16x32_bf16 v[16:19], a[0:3], v[48:51], 0
  ds_read_b128 v[72:75], v8 offset:6144
  v_mfma_f32_16x16x32_bf16 v[20:23], a[4:7], v[48:51], 0
  v_mfma_f32_16x16x32_bf16 v[24:27], a[0:3], v[52:55], 0
  ds_read_b128 v[76:79], v8 offset:7168
  v_mfma_f32_16x16x32_bf16 v[28:31], a[4:7], v[52:55], 0
  s_waitcnt lgkmcnt(4)
  v_mfma_f32_16x16x32_bf16 v[16:19], a[8:11], v[56:59], v[16:19]
  ds_read_b128 v[48:51], v8 offset:8192
  s_load_dwordx8 s[84:91], s[34:35], s83 glc
  v_mfma_f32_16x16x32_bf16 v[20:23], a[12:15], v[56:59], v[20:23]
  buffer_load_dwordx4 v[92:95], v107, s[52:55], s74 offen offset:1024 sc1
  v_mfma_f32_16x16x32_bf16 v[24:27], a[8:11], v[60:63], v[24:27]
  ds_read_b128 v[52:55], v8 offset:9216
  v_bfi_b32 v80, 1, v111, v36
  v_mfma_f32_16x16x32_bf16 v[28:31], a[12:15], v[60:63], v[28:31]
  v_bfi_b32 v81, 1, v111, v37
  s_waitcnt lgkmcnt(4)
  v_mfma_f32_16x16x32_bf16 v[16:19], a[16:19], v[64:67], v[16:19]
  ds_read_b128 v[56:59], v8 offset:10240
  v_bfi_b32 v82, 1, v111, v38
  v_mfma_f32_16x16x32_bf16 v[20:23], a[20:23], v[64:67], v[20:23]
  v_bfi_b32 v83, 1, v111, v39
  buffer_load_dwordx4 v[96:99], v107, s[52:55], s74 offen offset:2048 sc1
  v_mfma_f32_16x16x32_bf16 v[24:27], a[16:19], v[68:71], v[24:27]
  ds_read_b128 v[60:63], v8 offset:11264
  v_bfi_b32 v84, 1, v111, v40
  v_mfma_f32_16x16x32_bf16 v[28:31], a[20:23], v[68:71], v[28:31]
  v_bfi_b32 v85, 1, v111, v41
  s_waitcnt lgkmcnt(4)
  v_mfma_f32_16x16x32_bf16 v[16:19], a[24:27], v[72:75], v[16:19]
  ds_read_b128 v[64:67], v8 offset:12288
  v_bfi_b32 v86, 1, v111, v42
  v_mfma_f32_16x16x32_bf16 v[20:23], a[28:31], v[72:75], v[20:23]
  v_bfi_b32 v87, 1, v111, v43
  buffer_load_dwordx4 v[100:103], v107, s[52:55], s74 offen offset:3072 sc1
  v_mfma_f32_16x16x32_bf16 v[24:27], a[24:27], v[76:79], v[24:27]
  ds_read_b128 v[68:71], v8 offset:13312
  v_bfi_b32 v88, 1, v111, v44
  v_mfma_f32_16x16x32_bf16 v[28:31], a[28:31], v[76:79], v[28:31]
  v_bfi_b32 v89, 1, v111, v45
  s_waitcnt lgkmcnt(4)
  v_mfma_f32_16x16x32_bf16 v[16:19], a[32:35], v[48:51], v[16:19]
  ds_read_b128 v[72:75], v8 offset:14336
  v_bfi_b32 v90, 1, v111, v46
  v_mfma_f32_16x16x32_bf16 v[20:23], a[36:39], v[48:51], v[20:23]
  v_bfi_b32 v91, 1, v111, v47
  v_mfma_f32_16x16x32_bf16 v[24:27], a[32:35], v[52:55], v[24:27]
  ds_read_b128 v[76:79], v8 offset:15360
  v_mfma_f32_16x16x32_bf16 v[28:31], a[36:39], v[52:55], v[28:31]
  s_waitcnt lgkmcnt(4)
  v_mfma_f32_16x16x32_bf16 v[16:19], a[40:43], v[56:59], v[16:19]
  ds_read_b128 v[48:51], v8 offset:16384
  v_mfma_f32_16x16x32_bf16 v[20:23], a[44:47], v[56:59], v[20:23]
  buffer_store_dwordx4 v[80:83], v104, s[52:55], s67 offen offset:1024 sc1
  v_mfma_f32_16x16x32_bf16 v[24:27], a[40:43], v[60:63], v[24:27]
  ds_read_b128 v[52:55], v8 offset:17408
  v_mfma_f32_16x16x32_bf16 v[28:31], a[44:47], v[60:63], v[28:31]
  s_waitcnt lgkmcnt(4)
  v_mfma_f32_16x16x32_bf16 v[16:19], a[48:51], v[64:67], v[16:19]
  ds_read_b128 v[56:59], v8 offset:18432
  v_mfma_f32_16x16x32_bf16 v[20:23], a[52:55], v[64:67], v[20:23]
  buffer_store_dwordx4 v[84:87], v105, s[52:55], s67 offen offset:2048 sc1
  v_mfma_f32_16x16x32_bf16 v[24:27], a[48:51], v[68:71], v[24:27]
  ds_read_b128 v[60:63], v8 offset:19456
  v_mfma_f32_16x16x32_bf16 v[28:31], a[52:55], v[68:71], v[28:31]
  s_waitcnt lgkmcnt(4)
  v_mfma_f32_16x16x32_bf16 v[16:19], a[56:59], v[72:75], v[16:19]
  ds_read_b128 v[64:67], v8 offset:20480
  v_mfma_f32_16x16x32_bf16 v[20:23], a[60:63], v[72:75], v[20:23]
  buffer_store_dwordx4 v[88:91], v106, s[52:55], s67 offen offset:3072 sc1
  v_mfma_f32_16x16x32_bf16 v[24:27], a[56:59], v[76:79], v[24:27]
  ds_read_b128 v[68:71], v8 offset:21504
  v_mfma_f32_16x16x32_bf16 v[28:31], a[60:63], v[76:79], v[28:31]
  s_waitcnt vmcnt(10)
  s_barrier
  s_waitcnt lgkmcnt(4)
  v_mfma_f32_16x16x32_bf16 v[16:19], a[64:67], v[48:51], v[16:19]
  ds_read_b128 v[72:75], v8 offset:22528
  v_mfma_f32_16x16x32_bf16 v[20:23], a[68:71], v[48:51], v[20:23]
  v_mfma_f32_16x16x32_bf16 v[24:27], a[64:67], v[52:55], v[24:27]
  ds_read_b128 v[76:79], v8 offset:23552
  v_mfma_f32_16x16x32_bf16 v[28:31], a[68:71], v[52:55], v[28:31]
  s_waitcnt lgkmcnt(4)
  v_mfma_f32_16x16x32_bf16 v[16:19], a[72:75], v[56:59], v[16:19]
  ds_read_b128 v[48:51], v8 offset:24576
  v_mfma_f32_16x16x32_bf16 v[20:23], a[76:79], v[56:59], v[20:23]
  v_mfma_f32_16x16x32_bf16 v[24:27], a[72:75], v[60:63], v[24:27]
  ds_read_b128 v[52:55], v8 offset:25600
  v_mfma_f32_16x16x32_bf16 v[28:31], a[76:79], v[60:63], v[28:31]
  s_waitcnt lgkmcnt(4)
  v_mfma_f32_16x16x32_bf16 v[16:19], a[80:83], v[64:67], v[16:19]
  ds_read_b128 v[56:59], v8 offset:26624
  v_mfma_f32_16x16x32_bf16 v[20:23], a[84:87], v[64:67], v[20:23]
  s_min_u32 s40, s84, s85
  s_min_u32 s41, s86, s87
  v_mfma_f32_16x16x32_bf16 v[24:27], a[80:83], v[68:71], v[24:27]
  ds_read_b128 v[60:63], v8 offset:27648
  s_min_u32 s42, s88, s89
  s_min_u32 s43, s90, s91
  v_mfma_f32_16x16x32_bf16 v[28:31], a[84:87], v[68:71], v[28:31]
  s_min_u32 s40, s40, s41
  s_min_u32 s42, s42, s43
  s_waitcnt lgkmcnt(4)
  v_mfma_f32_16x16x32_bf16 v[16:19], a[88:91], v[72:75], v[16:19]
  ds_read_b128 v[64:67], v8 offset:28672
  s_min_u32 s40, s40, s42
  v_mfma_f32_16x16x32_bf16 v[20:23], a[92:95], v[72:75], v[20:23]
  s_add_u32 s73, s58, 1
  s_lshl_b32 s57, s73, 18
  v_mfma_f32_16x16x32_bf16 v[24:27], a[88:91], v[76:79], v[24:27]
  ds_read_b128 v[68:71], v8 offset:29696
  s_add_u32 s57, s57, s63
  s_cmp_gt_u32 s40, s73
  s_cselect_b32 s66, 1, 0
  s_cselect_b32 s57, s57, 0x80000000
  v_mfma_f32_16x16x32_bf16 v[28:31], a[92:95], v[76:79], v[28:31]
  s_waitcnt lgkmcnt(4)
  v_mfma_f32_16x16x32_bf16 v[16:19], a[96:99], v[48:51], v[16:19]
  ds_read_b128 v[72:75], v8 offset:30720
  s_add_u32 m0, s61, 65536
  s_xor_b32 s64, s57, 0
  v_mfma_f32_16x16x32_bf16 v[20:23], a[100:103], v[48:51], v[20:23]
  buffer_load_dwordx4 v4, s[52:55], s64 offen sc1 lds
  v_mfma_f32_16x16x32_bf16 v[24:27], a[96:99], v[52:55], v[24:27]
  ds_read_b128 v[76:79], v8 offset:31744
  v_mfma_f32_16x16x32_bf16 v[28:31], a[100:103], v[52:55], v[28:31]
  s_waitcnt lgkmcnt(4)
  v_mfma_f32_16x16x32_bf16 v[16:19], a[104:107], v[56:59], v[16:19]
  ds_read_b128 v[48:51], v8 offset:32768
  v_mfma_f32_16x16x32_bf16 v[20:23], a[108:111], v[56:59], v[20:23]
  s_add_u32 m0, s61, 66560
  s_xor_b32 s64, s57, 1024
  v_mfma_f32_16x16x32_bf16 v[24:27], a[104:107], v[60:63], v[24:27]
  ds_read_b128 v[52:55], v8 offset:33792
  buffer_load_dwordx4 v4, s[52:55], s64 offen sc1 lds
  v_mfma_f32_16x16x32_bf16 v[28:31], a[108:111], v[60:63], v[28:31]
  s_waitcnt lgkmcnt(4)
  v_mfma_f32_16x16x32_bf16 v[16:19], a[112:115], v[64:67], v[16:19]
  ds_read_b128 v[56:59], v8 offset:34816
  s_waitcnt vmcnt(5)
  v_mfma_f32_16x16x32_bf16 v[20:23], a[116:119], v[64:67], v[20:23]
  v_xor_b32 v1, v122, v92
  v_mfma_f32_16x16x32_bf16 v[24:27], a[112:115], v[68:71], v[24:27]
  ds_read_b128 v[60:63], v8 offset:35840
  s_add_u32 m0, s61, 73728
  s_xor_b32 s64, s57, 8192
  v_mfma_f32_16x16x32_bf16 v[28:31], a[116:119], v[68:71], v[28:31]
  buffer_load_dwordx4 v4, s[52:55], s64 offen sc1 lds
  v_bitop3_b32 v1, v1, v122, v93 bitop3:0xf6
  s_waitcnt lgkmcnt(4)
  v_mfma_f32_16x16x32_bf16 v[16:19], a[120:123], v[72:75], v[16:19]
  ds_read_b128 v[64:67], v8 offset:36864
  v_bitop3_b32 v1, v1, v122, v94 bitop3:0xf6
  v_mfma_f32_16x16x32_bf16 v[20:23], a[124:127], v[72:75], v[20:23]
  v_mfma_f32_16x16x32_bf16 v[24:27], a[120:123], v[76:79], v[24:27]
  ds_read_b128 v[68:71], v8 offset:37888
  v_bitop3_b32 v1, v1, v122, v95 bitop3:0xf6
  v_mfma_f32_16x16x32_bf16 v[28:31], a[124:127], v[76:79], v[28:31]
  s_add_u32 m0, s61, 74752
  s_xor_b32 s64, s57, 9216
  v_bitop3_b32 v1, v1, v122, v96 bitop3:0xf6
  s_barrier
  s_waitcnt lgkmcnt(4)
  v_mfma_f32_16x16x32_bf16 v[16:19], a[128:131], v[48:51], v[16:19]
  ds_read_b128 v[72:75], v8 offset:38912
  buffer_load_dwordx4 v4, s[52:55], s64 offen sc1 lds
  v_mfma_f32_16x16x32_bf16 v[20:23], a[132:135], v[48:51], v[20:23]
  v_bitop3_b32 v1, v1, v122, v97 bitop3:0xf6
  v_mfma_f32_16x16x32_bf16 v[24:27], a[128:131], v[52:55], v[24:27]
  ds_read_b128 v[76:79], v8 offset:39936
  v_bitop3_b32 v1, v1, v122, v98 bitop3:0xf6
  v_mfma_f32_16x16x32_bf16 v[28:31], a[132:135], v[52:55], v[28:31]
  s_waitcnt lgkmcnt(4)
  v_mfma_f32_16x16x32_bf16 v[16:19], a[136:139], v[56:59], v[16:19]
  ds_read_b128 v[48:51], v8 offset:40960
  s_add_u32 m0, s61, 81920
  s_xor_b32 s64, s57, 16384
  v_bitop3_b32 v1, v1, v122, v99 bitop3:0xf6
  v_mfma_f32_16x16x32_bf16 v[20:23], a[140:143], v[56:59], v[20:23]
  buffer_load_dwordx4 v4, s[52:55], s64 offen sc1 lds
  v_bitop3_b32 v1, v1, v122, v100 bitop3:0xf6
  v_mfma_f32_16x16x32_bf16 v[24:27], a[136:139], v[60:63], v[24:27]
  ds_read_b128 v[52:55], v8 offset:41984
  v_mfma_f32_16x16x32_bf16 v[28:31], a[140:143], v[60:63], v[28:31]
  v_bitop3_b32 v1, v1, v122, v101 bitop3:0xf6
  s_waitcnt lgkmcnt(4)
  v_mfma_f32_16x16x32_bf16 v[16:19], a[144:147], v[64:67], v[16:19]
  ds_read_b128 v[56:59], v8 offset:43008
  v_bitop3_b32 v1, v1, v122, v102 bitop3:0xf6
  v_mfma_f32_16x16x32_bf16 v[20:23], a[148:151], v[64:67], v[20:23]
  s_add_u32 m0, s61, 82944
  s_xor_b32 s64, s57, 17408
  v_mfma_f32_16x16x32_bf16 v[24:27], a[144:147], v[68:71], v[24:27]
  ds_read_b128 v[60:63], v8 offset:44032
  buffer_load_dwordx4 v4, s[52:55], s64 offen sc1 lds
  v_bitop3_b32 v1, v1, v122, v103 bitop3:0xf6
  v_mfma_f32_16x16x32_bf16 v[28:31], a[148:151], v[68:71], v[28:31]
  v_and_b32 v1, 1, v1
  s_waitcnt lgkmcnt(4)
  v_mfma_f32_16x16x32_bf16 v[16:19], a[152:155], v[72:75], v[16:19]
  ds_read_b128 v[64:67], v8 offset:45056
  v_mfma_f32_16x16x32_bf16 v[20:23], a[156:159], v[72:75], v[20:23]
  v_cmp_ne_u32 vcc, 0, v1
  v_mfma_f32_16x16x32_bf16 v[24:27], a[152:155], v[76:79], v[24:27]
  ds_read_b128 v[68:71], v8 offset:46080
  s_add_u32 m0, s61, 90112
  s_xor_b32 s64, s57, 24576
  v_mfma_f32_16x16x32_bf16 v[28:31], a[156:159], v[76:79], v[28:31]
  buffer_load_dwordx4 v4, s[52:55], s64 offen sc1 lds
  s_waitcnt lgkmcnt(4)
  v_mfma_f32_16x16x32_bf16 v[16:19], a[160:163], v[48:51], v[16:19]
  ds_read_b128 v[72:75], v8 offset:47104
  v_mfma_f32_16x16x32_bf16 v[20:23], a[164:167], v[48:51], v[20:23]
  s_cbranch_vccnz L_of_14_s
L_of_14:
  v_mfma_f32_16x16x32_bf16 v[24:27], a[160:163], v[52:55], v[24:27]
  ds_read_b128 v[76:79], v8 offset:48128
  v_mfma_f32_16x16x32_bf16 v[28:31], a[164:167], v[52:55], v[28:31]
  s_add_u32 m0, s61, 91136
  s_xor_b32 s64, s57, 25600
  v_add_f32 v112, v124, v92
  s_waitcnt lgkmcnt(4)
  v_mfma_f32_16x16x32_bf16 v[16:19], a[168:171], v[56:59], v[16:19]
  ds_read_b128 v[48:51], v8 offset:49152
  buffer_load_dwordx4 v4, s[52:55], s64 offen sc1 lds
  v_add_f32 v113, v125, v93
  v_mfma_f32_16x16x32_bf16 v[20:23], a[172:175], v[56:59], v[20:23]
  v_mfma_f32_16x16x32_bf16 v[24:27], a[168:171], v[60:63], v[24:27]
  ds_read_b128 v[52:55], v8 offset:50176
  v_add_f32 v114, v126, v94
  v_mfma_f32_16x16x32_bf16 v[28:31], a[172:175], v[60:63], v[28:31]
  v_add_f32 v115, v127, v95
  s_waitcnt lgkmcnt(4)
  v_mfma_f32_16x16x32_bf16 v[16:19], a[176:179], v[64:67], v[16:19]
  ds_read_b128 v[56:59], v8 offset:51200
  s_add_u32 m0, s61, 98304
  s_xor_b32 s64, s57, 32768
  v_mfma_f32_16x16x32_bf16 v[20:23], a[180:183], v[64:67], v[20:23]
  buffer_load_dwordx4 v4, s[52:55], s64 offen sc1 lds
  v_add_f32 v116, v96, v100
  v_mfma_f32_16x16x32_bf16 v[24:27], a[176:179], v[68:71], v[24:27]
  ds_read_b128 v[60:63], v8 offset:52224
  v_add_f32 v117, v97, v101
  s_load_dwordx8 s[84:91], s[34:35], s83 glc
  v_mfma_f32_16x16x32_bf16 v[28:31], a[180:183], v[68:71], v[28:31]
  s_waitcnt lgkmcnt(4)
  v_mfma_f32_16x16x32_bf16 v[16:19], a[184:187], v[72:75], v[16:19]
  ds_read_b128 v[64:67], v8 offset:53248
  v_add_f32 v118, v98, v102
  v_mfma_f32_16x16x32_bf16 v[20:23], a[188:191], v[72:75], v[20:23]
  s_add_u32 m0, s61, 99328
  s_xor_b32 s64, s57, 33792
  v_add_f32 v119, v99, v103
  v_mfma_f32_16x16x32_bf16 v[24:27], a[184:187], v[76:79], v[24:27]
  ds_read_b128 v[68:71], v8 offset:54272
  buffer_load_dwordx4 v4, s[52:55], s64 offen sc1 lds
  v_mfma_f32_16x16x32_bf16 v[28:31], a[188:191], v[76:79], v[28:31]
  v_add_f32 v112, v112, v116
  s_waitcnt lgkmcnt(4)
  v_mfma_f32_16x16x32_bf16 v[16:19], a[192:195], v[48:51], v[16:19]
  ds_read_b128 v[72:75], v8 offset:55296
  v_add_f32 v113, v113, v117
  v_mfma_f32_16x16x32_bf16 v[20:23], a[196:199], v[48:51], v[20:23]
  v_mfma_f32_16x16x32_bf16 v[24:27], a[192:195], v[52:55], v[24:27]
  ds_read_b128 v[76:79], v8 offset:56320
  s_add_u32 m0, s61, 106496
  s_xor_b32 s64, s57, 40960
  v_add_f32 v114, v114, v118
  v_mfma_f32_16x16x32_bf16 v[28:31], a[196:199], v[52:55], v[28:31]
  buffer_load_dwordx4 v4, s[52:55], s64 offen sc1 lds
  v_add_f32 v115, v115, v119
  s_waitcnt lgkmcnt(4)
  v_mfma_f32_16x16x32_bf16 v[16:19], a[200:203], v[56:59], v[16:19]
  ds_read_b128 v[48:51], v8 offset:57344
  v_mfma_f32_16x16x32_bf16 v[20:23], a[204:207], v[56:59], v[20:23]
  v_cvt_pk_bf16_f32 v120, v112, v113
  v_mfma_f32_16x16x32_bf16 v[24:27], a[200:203], v[60:63], v[24:27]
  ds_read_b128 v[52:55], v8 offset:58368
  v_cvt_pk_bf16_f32 v121, v114, v115
  v_mfma_f32_16x16x32_bf16 v[28:31], a[204:207], v[60:63], v[28:31]
  s_add_u32 m0, s61, 107520
  s_xor_b32 s64, s57, 41984
  s_waitcnt lgkmcnt(4)
  v_mfma_f32_16x16x32_bf16 v[16:19], a[208:211], v[64:67], v[16:19]
  ds_read_b128 v[56:59], v8 offset:59392
  buffer_load_dwordx4 v4, s[52:55], s64 offen sc1 lds
  buffer_store_dwordx2 v[120:121], v108, s[68:71], s75 offen
  v_mfma_f32_16x16x32_bf16 v[20:23], a[212:215], v[64:67], v[20:23]
  v_mfma_f32_16x16x32_bf16 v[24:27], a[208:211], v[68:71], v[24:27]
  ds_read_b128 v[60:63], v8 offset:60416
  v_mfma_f32_16x16x32_bf16 v[28:31], a[212:215], v[68:71], v[28:31]
  s_waitcnt lgkmcnt(4)
  v_mfma_f32_16x16x32_bf16 v[16:19], a[216:219], v[72:75], v[16:19]
  ds_read_b128 v[64:67], v8 offset:61440
  s_add_u32 m0, s61, 114688
  s_xor_b32 s64, s57, 49152
  v_mfma_f32_16x16x32_bf16 v[20:23], a[220:223], v[72:75], v[20:23]
  buffer_load_dwordx4 v4, s[52:55], s64 offen sc1 lds
  v_mfma_f32_16x16x32_bf16 v[24:27], a[216:219], v[76:79], v[24:27]
  ds_read_b128 v[68:71], v8 offset:62464
  v_mfma_f32_16x16x32_bf16 v[28:31], a[220:223], v[76:79], v[28:31]
  s_waitcnt lgkmcnt(4)
  v_mfma_f32_16x16x32_bf16 v[16:19], a[224:227], v[48:51], v[16:19]
  ds_read_b128 v[72:75], v8 offset:63488
  v_mov_b32 v124, v32
  v_mfma_f32_16x16x32_bf16 v[20:23], a[228:231], v[48:51], v[20:23]
  s_add_u32 m0, s61, 115712
  s_xor_b32 s64, s57, 50176
  v_mov_b32 v125, v33
  v_mfma_f32_16x16x32_bf16 v[24:27], a[224:227], v[52:55], v[24:27]
  ds_read_b128 v[76:79], v8 offset:64512
  buffer_load_dwordx4 v4, s[52:55], s64 offen sc1 lds
  v_mov_b32 v126, v34
  v_mfma_f32_16x16x32_bf16 v[28:31], a[228:231], v[52:55], v[28:31]
  s_waitcnt lgkmcnt(4)
  v_mfma_f32_16x16x32_bf16 v[16:19], a[232:235], v[56:59], v[16:19]
  v_mov_b32 v127, v35
  v_mfma_f32_16x16x32_bf16 v[20:23], a[236:239], v[56:59], v[20:23]
  v_mov_b32 v122, v111
  s_mov_b32 s74, s67
  v_mfma_f32_16x16x32_bf16 v[24:27], a[232:235], v[60:63], v[24:27]
  s_add_u32 m0, s61, 122880
  s_xor_b32 s64, s57, 57344
  s_mov_b32 s75, s59
  v_mfma_f32_16x16x32_bf16 v[28:31], a[236:239], v[60:63], v[28:31]
  buffer_load_dwordx4 v4, s[52:55], s64 offen sc1 lds
  s_waitcnt lgkmcnt(2)
  v_mfma_f32_16x16x32_bf16 v[16:19], a[240:243], v[64:67], v[16:19]
  s_lshl_b32 s59, s58, 17
  s_and_b32 s67, s58, 3
  v_mfma_f32_16x16x32_bf16 v[20:23], a[244:247], v[64:67], v[20:23]
  s_lshl_b32 s67, s67, 19
  s_bfe_u32 s40, s58, 0x10002
  v_mfma_f32_16x16x32_bf16 v[24:27], a[240:243], v[68:71], v[24:27]
  v_mov_b32 v111, s40
  s_add_u32 s58, s58, 1
  v_mfma_f32_16x16x32_bf16 v[28:31], a[244:247], v[68:71], v[28:31]
  s_add_u32 m0, s61, 123904
  s_xor_b32 s64, s57, 58368
  s_waitcnt lgkmcnt(0)
  v_mfma_f32_16x16x32_bf16 v[16:19], a[248:251], v[72:75], v[16:19]
  buffer_load_dwordx4 v4, s[52:55], s64 offen sc1 lds
  v_mfma_f32_16x16x32_bf16 v[20:23], a[252:255], v[72:75], v[20:23]
  v_mfma_f32_16x16x32_bf16 v[24:27], a[248:251], v[76:79], v[24:27]
  v_mfma_f32_16x16x32_bf16 v[28:31], a[252:255], v[76:79], v[28:31]
  s_cmp_eq_u32 s58, 61
  s_cbranch_scc1 L_o_end
  s_cmp_eq_u32 s66, 0
  s_cbranch_scc1 L_oh_15_s
L_oh_15:
  s_waitcnt vmcnt(8)
  s_barrier
  ds_read_b128 v[48:51], v9 offset:0
  ds_read_b128 v[52:55], v9 offset:1024
  ds_read_b128 v[56:59], v9 offset:2048
  ds_read_b128 v[60:63], v9 offset:3072
  ds_read_b128 v[64:67], v9 offset:4096
  ds_read_b128 v[68:71], v9 offset:5120
  s_waitcnt lgkmcnt(4)
  v_mfma_f32_16x16x32_bf16 v[32:35], a[0:3], v[48:51], 0
  ds_read_b128 v[72:75], v9 offset:6144
  v_mfma_f32_16x16x32_bf16 v[36:39], a[4:7], v[48:51], 0
  v_mfma_f32_16x16x32_bf16 v[40:43], a[0:3], v[52:55], 0
  ds_read_b128 v[76:79], v9 offset:7168
  v_mfma_f32_16x16x32_bf16 v[44:47], a[4:7], v[52:55], 0
  s_waitcnt lgkmcnt(4)
  v_mfma_f32_16x16x32_bf16 v[32:35], a[8:11], v[56:59], v[32:35]
  ds_read_b128 v[48:51], v9 offset:8192
  s_load_dwordx8 s[84:91], s[34:35], s83 glc
  v_mfma_f32_16x16x32_bf16 v[36:39], a[12:15], v[56:59], v[36:39]
  buffer_load_dwordx4 v[92:95], v107, s[52:55], s74 offen offset:1024 sc1
  v_mfma_f32_16x16x32_bf16 v[40:43], a[8:11], v[60:63], v[40:43]
  ds_read_b128 v[52:55], v9 offset:9216
  v_bfi_b32 v80, 1, v111, v20
  v_mfma_f32_16x16x32_bf16 v[44:47], a[12:15], v[60:63], v[44:47]
  v_bfi_b32 v81, 1, v111, v21
  s_waitcnt lgkmcnt(4)
  v_mfma_f32_16x16x32_bf16 v[32:35], a[16:19], v[64:67], v[32:35]
  ds_read_b128 v[56:59], v9 offset:10240
  v_bfi_b32 v82, 1, v111, v22
  v_mfma_f32_16x16x32_bf16 v[36:39], a[20:23], v[64:67], v[36:39]
  v_bfi_b32 v83, 1, v111, v23
  buffer_load_dwordx4 v[96:99], v107, s[52:55], s74 offen offset:2048 sc1
  v_mfma_f32_16x16x32_bf16 v[40:43], a[16:19], v[68:71], v[40:43]
  ds_read_b128 v[60:63], v9 offset:11264
  v_bfi_b32 v84, 1, v111, v24
  v_mfma_f32_16x16x32_bf16 v[44:47], a[20:23], v[68:71], v[44:47]
  v_bfi_b32 v85, 1, v111, v25
  s_waitcnt lgkmcnt(4)
  v_mfma_f32_16x16x32_bf16 v[32:35], a[24:27], v[72:75], v[32:35]
  ds_read_b128 v[64:67], v9 offset:12288
  v_bfi_b32 v86, 1, v111, v26
  v_mfma_f32_16x16x32_bf16 v[36:39], a[28:31], v[72:75], v[36:39]
  v_bfi_b32 v87, 1, v111, v27
  buffer_load_dwordx4 v[100:103], v107, s[52:55], s74 offen offset:3072 sc1
  v_mfma_f32_16x16x32_bf16 v[40:43], a[24:27], v[76:79], v[40:43]
  ds_read_b128 v[68:71], v9 offset:13312
  v_bfi_b32 v88, 1, v111, v28
  v_mfma_f32_16x16x32_bf16 v[44:47], a[28:31], v[76:79], v[44:47]
  v_bfi_b32 v89, 1, v111, v29
  s_waitcnt lgkmcnt(4)
  v_mfma_f32_16x16x32_bf16 v[32:35], a[32:35], v[48:51], v[32:35]
  ds_read_b128 v[72:75], v9 offset:14336
  v_bfi_b32 v90, 1, v111, v30
  v_mfma_f32_16x16x32_bf16 v[36:39], a[36:39], v[48:51], v[36:39]
  v_bfi_b32 v91, 1, v111, v31
  v_mfma_f32_16x16x32_bf16 v[40:43], a[32:35], v[52:55], v[40:43]
  ds_read_b128 v[76:79], v9 offset:15360
  v_mfma_f32_16x16x32_bf16 v[44:47], a[36:39], v[52:55], v[44:47]
  s_waitcnt lgkmcnt(4)
  v_mfma_f32_16x16x32_bf16 v[32:35], a[40:43], v[56:59], v[32:35]
  ds_read_b128 v[48:51], v9 offset:16384
  v_mfma_f32_16x16x32_bf16 v[36:39], a[44:47], v[56:59], v[36:39]
  buffer_store_dwordx4 v[80:83], v104, s[52:55], s67 offen offset:1024 sc1
  v_mfma_f32_16x16x32_bf16 v[40:43], a[40:43], v[60:63], v[40:43]
  ds_read_b128 v[52:55], v9 offset:17408
  v_mfma_f32_16x16x32_bf16 v[44:47], a[44:47], v[60:63], v[44:47]
  s_waitcnt lgkmcnt(4)
  v_mfma_f32_16x16x32_bf16 v[32:35], a[48:51], v[64:67], v[32:35]
  ds_read_b128 v[56:59], v9 offset:18432
  v_mfma_f32_16x16x32_bf16 v[36:39], a[52:55], v[64:67], v[36:39]
  buffer_store_dwordx4 v[84:87], v105, s[52:55], s67 offen offset:2048 sc1
  v_mfma_f32_16x16x32_bf16 v[40:43], a[48:51], v[68:71], v[40:43]
  ds_read_b128 v[60:63], v9 offset:19456
  v_mfma_f32_16x16x32_bf16 v[44:47], a[52:55], v[68:71], v[44:47]
  s_waitcnt lgkmcnt(4)
  v_mfma_f32_16x16x32_bf16 v[32:35], a[56:59], v[72:75], v[32:35]
  ds_read_b128 v[64:67], v9 offset:20480
  v_mfma_f32_16x16x32_bf16 v[36:39], a[60:63], v[72:75], v[36:39]
  buffer_store_dwordx4 v[88:91], v106, s[52:55], s67 offen offset:3072 sc1
  v_mfma_f32_16x16x32_bf16 v[40:43], a[56:59], v[76:79], v[40:43]
  ds_read_b128 v[68:71], v9 offset:21504
  v_mfma_f32_16x16x32_bf16 v[44:47], a[60:63], v[76:79], v[44:47]
  s_waitcnt vmcnt(10)
  s_barrier
  s_waitcnt lgkmcnt(4)
  v_mfma_f32_16x16x32_bf16 v[32:35], a[64:67], v[48:51], v[32:35]
  ds_read_b128 v[72:75], v9 offset:22528
  v_mfma_f32_16x16x32_bf16 v[36:39], a[68:71], v[48:51], v[36:39]
  v_mfma_f32_16x16x32_bf16 v[40:43], a[64:67], v[52:55], v[40:43]
  ds_read_b128 v[76:79], v9 offset:23552
  v_mfma_f32_16x16x32_bf16 v[44:47], a[68:71], v[52:55], v[44:47]
  s_waitcnt lgkmcnt(4)
  v_mfma_f32_16x16x32_bf16 v[32:35], a[72:75], v[56:59], v[32:35]
  ds_read_b128 v[48:51], v9 offset:24576
  v_mfma_f32_16x16x32_bf16 v[36:39], a[76:79], v[56:59], v[36:39]
  v_mfma_f32_16x16x32_bf16 v[40:43], a[72:75], v[60:63], v[40:43]
  ds_read_b128 v[52:55], v9 offset:25600
  v_mfma_f32_16x16x32_bf16 v[44:47], a[76:79], v[60:63], v[44:47]
  s_waitcnt lgkmcnt(4)
  v_mfma_f32_16x16x32_bf16 v[32:35], a[80:83], v[64:67], v[32:35]
  ds_read_b128 v[56:59], v9 offset:26624
  v_mfma_f32_16x16x32_bf16 v[36:39], a[84:87], v[64:67], v[36:39]
  s_min_u32 s40, s84, s85
  s_min_u32 s41, s86, s87
  v_mfma_f32_16x16x32_bf16 v[40:43], a[80:83], v[68:71], v[40:43]
  ds_read_b128 v[60:63], v9 offset:27648
  s_min_u32 s42, s88, s89
  s_min_u32 s43, s90, s91
  v_mfma_f32_16x16x32_bf16 v[44:47], a[84:87], v[68:71], v[44:47]
  s_min_u32 s40, s40, s41
  s_min_u32 s42, s42, s43
  s_waitcnt lgkmcnt(4)
  v_mfma_f32_16x16x32_bf16 v[32:35], a[88:91], v[72:75], v[32:35]
  ds_read_b128 v[64:67], v9 offset:28672
  s_min_u32 s40, s40, s42
  v_mfma_f32_16x16x32_bf16 v[36:39], a[92:95], v[72:75], v[36:39]
  s_add_u32 s73, s58, 1
  s_lshl_b32 s57, s73, 18
  v_mfma_f32_16x16x32_bf16 v[40:43], a[88:91], v[76:79], v[40:43]
  ds_read_b128 v[68:71], v9 offset:29696
  s_add_u32 s57, s57, s63
  s_cmp_gt_u32 s40, s73
  s_cselect_b32 s66, 1, 0
  s_cselect_b32 s57, s57, 0x80000000
  v_mfma_f32_16x16x32_bf16 v[44:47], a[92:95], v[76:79], v[44:47]
  s_waitcnt lgkmcnt(4)
  v_mfma_f32_16x16x32_bf16 v[32:35], a[96:99], v[48:51], v[32:35]
  ds_read_b128 v[72:75], v9 offset:30720
  s_add_u32 m0, s61, 0
  s_xor_b32 s64, s57, 0
  v_mfma_f32_16x16x32_bf16 v[36:39], a[100:103], v[48:51], v[36:39]
  buffer_load_dwordx4 v4, s[52:55], s64 offen sc1 lds
  v_mfma_f32_16x16x32_bf16 v[40:43], a[96:99], v[52:55], v[40:43]
  ds_read_b128 v[76:79], v9 offset:31744
  v_mfma_f32_16x16x32_bf16 v[44:47], a[100:103], v[52:55], v[44:47]
  s_waitcnt lgkmcnt(4)
  v_mfma_f32_16x16x32_bf16 v[32:35], a[104:107], v[56:59], v[32:35]
  ds_read_b128 v[48:51], v9 offset:32768
  v_mfma_f32_16x16x32_bf16 v[36:39], a[108:111], v[56:59], v[36:39]
  s_add_u32 m0, s61, 1024
  s_xor_b32 s64, s57, 1024
  v_mfma_f32_16x16x32_bf16 v[40:43], a[104:107], v[60:63], v[40:43]
  ds_read_b128 v[52:55], v9 offset:33792
  buffer_load_dwordx4 v4, s[52:55], s64 offen sc1 lds
  v_mfma_f32_16x16x32_bf16 v[44:47], a[108:111], v[60:63], v[44:47]
  s_waitcnt lgkmcnt(4)
  v_mfma_f32_16x16x32_bf16 v[32:35], a[112:115], v[64:67], v[32:35]
  ds_read_b128 v[56:59], v9 offset:34816
  s_waitcnt vmcnt(5)
  v_mfma_f32_16x16x32_bf16 v[36:39], a[116:119], v[64:67], v[36:39]
  v_xor_b32 v1, v122, v92
  v_mfma_f32_16x16x32_bf16 v[40:43], a[112:115], v[68:71], v[40:43]
  ds_read_b128 v[60:63], v9 offset:35840
  s_add_u32 m0, s61, 8192
  s_xor_b32 s64, s57, 8192
  v_mfma_f32_16x16x32_bf16 v[44:47], a[116:119], v[68:71], v[44:47]
  buffer_load_dwordx4 v4, s[52:55], s64 offen sc1 lds
  v_bitop3_b32 v1, v1, v122, v93 bitop3:0xf6
  s_waitcnt lgkmcnt(4)
  v_mfma_f32_16x16x32_bf16 v[32:35], a[120:123], v[72:75], v[32:35]
  ds_read_b128 v[64:67], v9 offset:36864
  v_bitop3_b32 v1, v1, v122, v94 bitop3:0xf6
  v_mfma_f32_16x16x32_bf16 v[36:39], a[124:127], v[72:75], v[36:39]
  v_mfma_f32_16x16x32_bf16 v[40:43], a[120:123], v[76:79], v[40:43]
  ds_read_b128 v[68:71], v9 offset:37888
  v_bitop3_b32 v1, v1, v122, v95 bitop3:0xf6
  v_mfma_f32_16x16x32_bf16 v[44:47], a[124:127], v[76:79], v[44:47]
  s_add_u32 m0, s61, 9216
  s_xor_b32 s64, s57, 9216
  v_bitop3_b32 v1, v1, v122, v96 bitop3:0xf6
  s_barrier
  s_waitcnt lgkmcnt(4)
  v_mfma_f32_16x16x32_bf16 v[32:35], a[128:131], v[48:51], v[32:35]
  ds_read_b128 v[72:75], v9 offset:38912
  buffer_load_dwordx4 v4, s[52:55], s64 offen sc1 lds
  v_mfma_f32_16x16x32_bf16 v[36:39], a[132:135], v[48:51], v[36:39]
  v_bitop3_b32 v1, v1, v122, v97 bitop3:0xf6
  v_mfma_f32_16x16x32_bf16 v[40:43], a[128:131], v[52:55], v[40:43]
  ds_read_b128 v[76:79], v9 offset:39936
  v_bitop3_b32 v1, v1, v122, v98 bitop3:0xf6
  v_mfma_f32_16x16x32_bf16 v[44:47], a[132:135], v[52:55], v[44:47]
  s_waitcnt lgkmcnt(4)
  v_mfma_f32_16x16x32_bf16 v[32:35], a[136:139], v[56:59], v[32:35]
  ds_read_b128 v[48:51], v9 offset:40960
  s_add_u32 m0, s61, 16384
  s_xor_b32 s64, s57, 16384
  v_bitop3_b32 v1, v1, v122, v99 bitop3:0xf6
  v_mfma_f32_16x16x32_bf16 v[36:39], a[140:143], v[56:59], v[36:39]
  buffer_load_dwordx4 v4, s[52:55], s64 offen sc1 lds
  v_bitop3_b32 v1, v1, v122, v100 bitop3:0xf6
  v_mfma_f32_16x16x32_bf16 v[40:43], a[136:139], v[60:63], v[40:43]
  ds_read_b128 v[52:55], v9 offset:41984
  v_mfma_f32_16x16x32_bf16 v[44:47], a[140:143], v[60:63], v[44:47]
  v_bitop3_b32 v1, v1, v122, v101 bitop3:0xf6
  s_waitcnt lgkmcnt(4)
  v_mfma_f32_16x16x32_bf16 v[32:35], a[144:147], v[64:67], v[32:35]
  ds_read_b128 v[56:59], v9 offset:43008
  v_bitop3_b32 v1, v1, v122, v102 bitop3:0xf6
  v_mfma_f32_16x16x32_bf16 v[36:39], a[148:151], v[64:67], v[36:39]
  s_add_u32 m0, s61, 17408
  s_xor_b32 s64, s57, 17408
  v_mfma_f32_16x16x32_bf16 v[40:43], a[144:147], v[68:71], v[40:43]
  ds_read_b128 v[60:63], v9 offset:44032
  buffer_load_dwordx4 v4, s[52:55], s64 offen sc1 lds
  v_bitop3_b32 v1, v1, v122, v103 bitop3:0xf6
  v_mfma_f32_16x16x32_bf16 v[44:47], a[148:151], v[68:71], v[44:47]
  v_and_b32 v1, 1, v1
  s_waitcnt lgkmcnt(4)
  v_mfma_f32_16x16x32_bf16 v[32:35], a[152:155], v[72:75], v[32:35]
  ds_read_b128 v[64:67], v9 offset:45056
  v_mfma_f32_16x16x32_bf16 v[36:39], a[156:159], v[72:75], v[36:39]
  v_cmp_ne_u32 vcc, 0, v1
  v_mfma_f32_16x16x32_bf16 v[40:43], a[152:155], v[76:79], v[40:43]
  ds_read_b128 v[68:71], v9 offset:46080
  s_add_u32 m0, s61, 24576
  s_xor_b32 s64, s57, 24576
  v_mfma_f32_16x16x32_bf16 v[44:47], a[156:159], v[76:79], v[44:47]
  buffer_load_dwordx4 v4, s[52:55], s64 offen sc1 lds
  s_waitcnt lgkmcnt(4)
  v_mfma_f32_16x16x32_bf16 v[32:35], a[160:163], v[48:51], v[32:35]
  ds_read_b128 v[72:75], v9 offset:47104
  v_mfma_f32_16x16x32_bf16 v[36:39], a[164:167], v[48:51], v[36:39]
  s_cbranch_vccnz L_of_16_s
L_of_16:
  v_mfma_f32_16x16x32_bf16 v[40:43], a[160:163], v[52:55], v[40:43]
  ds_read_b128 v[76:79], v9 offset:48128
  v_mfma_f32_16x16x32_bf16 v[44:47], a[164:167], v[52:55], v[44:47]
  s_add_u32 m0, s61, 25600
  s_xor_b32 s64, s57, 25600
  v_add_f32 v112, v124, v92
  s_waitcnt lgkmcnt(4)
  v_mfma_f32_16x16x32_bf16 v[32:35], a[168:171], v[56:59], v[32:35]
  ds_read_b128 v[48:51], v9 offset:49152
  buffer_load_dwordx4 v4, s[52:55], s64 offen sc1 lds
  v_add_f32 v113, v125, v93
  v_mfma_f32_16x16x32_bf16 v[36:39], a[172:175], v[56:59], v[36:39]
  v_mfma_f32_16x16x32_bf16 v[40:43], a[168:171], v[60:63], v[40:43]
  ds_read_b128 v[52:55], v9 offset:50176
  v_add_f32 v114, v126, v94
  v_mfma_f32_16x16x32_bf16 v[44:47], a[172:175], v[60:63], v[44:47]
  v_add_f32 v115, v127, v95
  s_waitcnt lgkmcnt(4)
  v_mfma_f32_16x16x32_bf16 v[32:35], a[176:179], v[64:67], v[32:35]
  ds_read_b128 v[56:59], v9 offset:51200
  s_add_u32 m0, s61, 32768
  s_xor_b32 s64, s57, 32768
  v_mfma_f32_16x16x32_bf16 v[36:39], a[180:183], v[64:67], v[36:39]
  buffer_load_dwordx4 v4, s[52:55], s64 offen sc1 lds
  v_add_f32 v116, v96, v100
  v_mfma_f32_16x16x32_bf16 v[40:43], a[176:179], v[68:71], v[40:43]
  ds_read_b128 v[60:63], v9 offset:52224
  v_add_f32 v117, v97, v101
  s_load_dwordx8 s[84:91], s[34:35], s83 glc
  v_mfma_f32_16x16x32_bf16 v[44:47], a[180:183], v[68:71], v[44:47]
  s_waitcnt lgkmcnt(4)
  v_mfma_f32_16x16x32_bf16 v[32:35], a[184:187], v[72:75], v[32:35]
  ds_read_b128 v[64:67], v9 offset:53248
  v_add_f32 v118, v98, v102
  v_mfma_f32_16x16x32_bf16 v[36:39], a[188:191], v[72:75], v[36:39]
  s_add_u32 m0, s61, 33792
  s_xor_b32 s64, s57, 33792
  v_add_f32 v119, v99, v103
  v_mfma_f32_16x16x32_bf16 v[40:43], a[184:187], v[76:79], v[40:43]
  ds_read_b128 v[68:71], v9 offset:54272
  buffer_load_dwordx4 v4, s[52:55], s64 offen sc1 lds
  v_mfma_f32_16x16x32_bf16 v[44:47], a[188:191], v[76:79], v[44:47]
  v_add_f32 v112, v112, v116
  s_waitcnt lgkmcnt(4)
  v_mfma_f32_16x16x32_bf16 v[32:35], a[192:195], v[48:51], v[32:35]
  ds_read_b128 v[72:75], v9 offset:55296
  v_add_f32 v113, v113, v117
  v_mfma_f32_16x16x32_bf16 v[36:39], a[196:199], v[48:51], v[36:39]
  v_mfma_f32_16x16x32_bf16 v[40:43], a[192:195], v[52:55], v[40:43]
  ds_read_b128 v[76:79], v9 offset:56320
  s_add_u32 m0, s61, 40960
  s_xor_b32 s64, s57, 40960
  v_add_f32 v114, v114, v118
  v_mfma_f32_16x16x32_bf16 v[44:47], a[196:199], v[52:55], v[44:47]
  buffer_load_dwordx4 v4, s[52:55], s64 offen sc1 lds
  v_add_f32 v115, v115, v119
  s_waitcnt lgkmcnt(4)
  v_mfma_f32_16x16x32_bf16 v[32:35], a[200:203], v[56:59], v[32:35]
  ds_read_b128 v[48:51], v9 offset:57344
  v_mfma_f32_16x16x32_bf16 v[36:39], a[204:207], v[56:59], v[36:39]
  v_cvt_pk_bf16_f32 v120, v112, v113
  v_mfma_f32_16x16x32_bf16 v[40:43], a[200:203], v[60:63], v[40:43]
  ds_read_b128 v[52:55], v9 offset:58368
  v_cvt_pk_bf16_f32 v121, v114, v115
  v_mfma_f32_16x16x32_bf16 v[44:47], a[204:207], v[60:63], v[44:47]
  s_add_u32 m0, s61, 41984
  s_xor_b32 s64, s57, 41984
  s_waitcnt lgkmcnt(4)
  v_mfma_f32_16x16x32_bf16 v[32:35], a[208:211], v[64:67], v[32:35]
  ds_read_b128 v[56:59], v9 offset:59392
  buffer_load_dwordx4 v4, s[52:55], s64 offen sc1 lds
  buffer_store_dwordx2 v[120:121], v108, s[68:71], s75 offen
  v_mfma_f32_16x16x32_bf16 v[36:39], a[212:215], v[64:67], v[36:39]
  v_mfma_f32_16x16x32_bf16 v[40:43], a[208:211], v[68:71], v[40:43]
  ds_read_b128 v[60:63], v9 offset:60416
  v_mfma_f32_16x16x32_bf16 v[44:47], a[212:215], v[68:71], v[44:47]
  s_waitcnt lgkmcnt(4)
  v_mfma_f32_16x16x32_bf16 v[32:35], a[216:219], v[72:75], v[32:35]
  ds_read_b128 v[64:67], v9 offset:61440
  s_add_u32 m0, s61, 49152
  s_xor_b32 s64, s57, 49152
  v_mfma_f32_16x16x32_bf16 v[36:39], a[220:223], v[72:75], v[36:39]
  buffer_load_dwordx4 v4, s[52:55], s64 offen sc1 lds
  v_mfma_f32_16x16x32_bf16 v[40:43], a[216:219], v[76:79], v[40:43]
  ds_read_b128 v[68:71], v9 offset:62464
  v_mfma_f32_16x16x32_bf16 v[44:47], a[220:223], v[76:79], v[44:47]
  s_waitcnt lgkmcnt(4)
  v_mfma_f32_16x16x32_bf16 v[32:35], a[224:227], v[48:51], v[32:35]
  ds_read_b128 v[72:75], v9 offset:63488
  v_mov_b32 v124, v16
  v_mfma_f32_16x16x32_bf16 v[36:39], a[228:231], v[48:51], v[36:39]
  s_add_u32 m0, s61, 50176
  s_xor_b32 s64, s57, 50176
  v_mov_b32 v125, v17
  v_mfma_f32_16x16x32_bf16 v[40:43], a[224:227], v[52:55], v[40:43]
  ds_read_b128 v[76:79], v9 offset:64512
  buffer_load_dwordx4 v4, s[52:55], s64 offen sc1 lds
  v_mov_b32 v126, v18
  v_mfma_f32_16x16x32_bf16 v[44:47], a[228:231], v[52:55], v[44:47]
  s_waitcnt lgkmcnt(4)
  v_mfma_f32_16x16x32_bf16 v[32:35], a[232:235], v[56:59], v[32:35]
  v_mov_b32 v127, v19
  v_mfma_f32_16x16x32_bf16 v[36:39], a[236:239], v[56:59], v[36:39]
  v_mov_b32 v122, v111
  s_mov_b32 s74, s67
  v_mfma_f32_16x16x32_bf16 v[40:43], a[232:235], v[60:63], v[40:43]
  s_add_u32 m0, s61, 57344
  s_xor_b32 s64, s57, 57344
  s_mov_b32 s75, s59
  v_mfma_f32_16x16x32_bf16 v[44:47], a[236:239], v[60:63], v[44:47]
  buffer_load_dwordx4 v4, s[52:55], s64 offen sc1 lds
  s_waitcnt lgkmcnt(2)
  v_mfma_f32_16x16x32_bf16 v[32:35], a[240:243], v[64:67], v[32:35]
  s_lshl_b32 s59, s58, 17
  s_and_b32 s67, s58, 3
  v_mfma_f32_16x16x32_bf16 v[36:39], a[244:247], v[64:67], v[36:39]
  s_lshl_b32 s67, s67, 19
  s_bfe_u32 s40, s58, 0x10002
  v_mfma_f32_16x16x32_bf16 v[40:43], a[240:243], v[68:71], v[40:43]
  v_mov_b32 v111, s40
  s_add_u32 s58, s58, 1
  v_mfma_f32_16x16x32_bf16 v[44:47], a[244:247], v[68:71], v[44:47]
  s_add_u32 m0, s61, 58368
  s_xor_b32 s64, s57, 58368
  s_waitcnt lgkmcnt(0)
  v_mfma_f32_16x16x32_bf16 v[32:35], a[248:251], v[72:75], v[32:35]
  buffer_load_dwordx4 v4, s[52:55], s64 offen sc1 lds
  v_mfma_f32_16x16x32_bf16 v[36:39], a[252:255], v[72:75], v[36:39]
  v_mfma_f32_16x16x32_bf16 v[40:43], a[248:251], v[76:79], v[40:43]
  v_mfma_f32_16x16x32_bf16 v[44:47], a[252:255], v[76:79], v[44:47]
  s_branch L_o_loop
L_o_end:
L_ot_w0:
L_ot_0:
  s_cbranch_execz L_ot_1
  s_nop 7
  buffer_load_dwordx4 v[92:95], v107, s[52:55], s74 offen offset:1024 sc1
  buffer_load_dwordx4 v[96:99], v107, s[52:55], s74 offen offset:2048 sc1
  buffer_load_dwordx4 v[100:103], v107, s[52:55], s74 offen offset:3072 sc1
  v_bfi_b32 v80, 1, v111, v20
  v_bfi_b32 v81, 1, v111, v21
  v_bfi_b32 v82, 1, v111, v22
  v_bfi_b32 v83, 1, v111, v23
  buffer_store_dwordx4 v[80:83], v104, s[52:55], s67 offen offset:1024 sc1
  v_bfi_b32 v84, 1, v111, v24
  v_bfi_b32 v85, 1, v111, v25
  v_bfi_b32 v86, 1, v111, v26
  v_bfi_b32 v87, 1, v111, v27
  buffer_store_dwordx4 v[84:87], v105, s[52:55], s67 offen offset:2048 sc1
L_ot_1:
  s_cbranch_execz L_ot_2
  v_bfi_b32 v88, 1, v111, v28
  v_bfi_b32 v89, 1, v111, v29
  v_bfi_b32 v90, 1, v111, v30
  v_bfi_b32 v91, 1, v111, v31
  buffer_store_dwordx4 v[88:91], v106, s[52:55], s67 offen offset:3072 sc1
  s_waitcnt vmcnt(3)
  v_xor_b32 v1, v122, v92
  v_bitop3_b32 v1, v1, v122, v93 bitop3:0xf6
  v_bitop3_b32 v1, v1, v122, v94 bitop3:0xf6
  v_bitop3_b32 v1, v1, v122, v95 bitop3:0xf6
  v_bitop3_b32 v1, v1, v122, v96 bitop3:0xf6
  v_bitop3_b32 v1, v1, v122, v97 bitop3:0xf6
  v_bitop3_b32 v1, v1, v122, v98 bitop3:0xf6
  v_bitop3_b32 v1, v1, v122, v99 bitop3:0xf6
L_ot_2:
  s_cbranch_execz L_ot_3
  v_bitop3_b32 v1, v1, v122, v100 bitop3:0xf6
  v_bitop3_b32 v1, v1, v122, v101 bitop3:0xf6
  v_bitop3_b32 v1, v1, v122, v102 bitop3:0xf6
  v_bitop3_b32 v1, v1, v122, v103 bitop3:0xf6
  v_and_b32 v1, 1, v1
  v_cmp_ne_u32 vcc, 0, v1
  s_cbranch_vccnz L_of_17_s
L_of_17:
  v_add_f32 v112, v124, v92
  v_add_f32 v113, v125, v93
  v_add_f32 v114, v126, v94
  v_add_f32 v115, v127, v95
  v_add_f32 v116, v96, v100
  v_add_f32 v117, v97, v101
L_ot_3:
  s_cbranch_execz L_ot_4
  v_add_f32 v118, v98, v102
  v_add_f32 v119, v99, v103
  v_add_f32 v112, v112, v116
  v_add_f32 v113, v113, v117
  v_add_f32 v114, v114, v118
  v_add_f32 v115, v115, v119
  v_cvt_pk_bf16_f32 v120, v112, v113
  v_cvt_pk_bf16_f32 v121, v114, v115
  buffer_store_dwordx2 v[120:121], v108, s[68:71], s75 offen
  v_mov_b32 v124, v16
  v_mov_b32 v125, v17
  v_mov_b32 v126, v18
  v_mov_b32 v127, v19
  v_mov_b32 v122, v111
L_ot_4:
  s_cbranch_execz L_ot_5
  s_mov_b32 s74, s67
  s_mov_b32 s75, s59
  buffer_load_dwordx4 v[92:95], v107, s[52:55], s74 offen offset:1024 sc1
  buffer_load_dwordx4 v[96:99], v107, s[52:55], s74 offen offset:2048 sc1
  buffer_load_dwordx4 v[100:103], v107, s[52:55], s74 offen offset:3072 sc1
  s_waitcnt vmcnt(0)
  v_xor_b32 v1, v122, v92
  v_bitop3_b32 v1, v1, v122, v93 bitop3:0xf6
  v_bitop3_b32 v1, v1, v122, v94 bitop3:0xf6
  v_bitop3_b32 v1, v1, v122, v95 bitop3:0xf6
  v_bitop3_b32 v1, v1, v122, v96 bitop3:0xf6
  v_bitop3_b32 v1, v1, v122, v97 bitop3:0xf6
  v_bitop3_b32 v1, v1, v122, v98 bitop3:0xf6
  v_bitop3_b32 v1, v1, v122, v99 bitop3:0xf6
L_ot_5:
  s_cbranch_execz L_ot_24
  v_bitop3_b32 v1, v1, v122, v100 bitop3:0xf6
  v_bitop3_b32 v1, v1, v122, v101 bitop3:0xf6
  v_bitop3_b32 v1, v1, v122, v102 bitop3:0xf6
  v_bitop3_b32 v1, v1, v122, v103 bitop3:0xf6
  v_and_b32 v1, 1, v1
  v_cmp_ne_u32 vcc, 0, v1
  s_cbranch_vccnz L_of_18_s
L_of_18:
  v_add_f32 v112, v124, v92
  v_add_f32 v113, v125, v93
  v_add_f32 v114, v126, v94
  v_add_f32 v115, v127, v95
  v_add_f32 v116, v96, v100
  v_add_f32 v117, v97, v101
L_ot_w1:
L_ot_6:
  s_cbranch_execz L_ot_7
  v_add_f32 v118, v98, v102
  v_add_f32 v119, v99, v103
  v_add_f32 v112, v112, v116
  v_add_f32 v113, v113, v117
  v_add_f32 v114, v114, v118
  v_add_f32 v115, v115, v119
  v_cvt_pk_bf16_f32 v120, v112, v113
  v_cvt_pk_bf16_f32 v121, v114, v115
  buffer_store_dwordx2 v[120:121], v108, s[68:71], s75 offen
  s_endpgm
L_oh_13_s:
  s_cmp_eq_u32 s76, 0
  s_cbranch_scc1 L_oh_13_p
  s_sub_u32 s76, s76, 1
L_ot_7:
  s_cbranch_execz L_ot_8
  s_mov_b32 exec_hi, 0
  global_load_dword v132, v[128:129], off
  v_lshl_add_u64 v[128:129], v[130:131], 0, v[128:129]
  s_mov_b32 exec_hi, -1
L_oh_13_p:
  s_min_u32 s40, s84, s85
  s_min_u32 s41, s86, s87
  s_min_u32 s42, s88, s89
  s_min_u32 s43, s90, s91
  s_min_u32 s40, s40, s41
  s_min_u32 s42, s42, s43
  s_min_u32 s40, s40, s42
  s_cmp_gt_u32 s40, s58
  s_cbranch_scc1 L_oh_13_g
L_ot_8:
  s_cbranch_execz L_ot_9
  s_load_dwordx8 s[84:91], s[34:35], s83 glc
  s_waitcnt lgkmcnt(0)
  s_sub_u32 s39, s39, 1
  s_cbranch_scc0 L_oh_13_p
  s_endpgm
L_oh_13_g:
  s_lshl_b32 s57, s58, 18
  s_add_u32 s57, s57, s63
  s_add_u32 m0, s61, 0
  s_xor_b32 s64, s57, 0
  buffer_load_dwordx4 v4, s[52:55], s64 offen sc1 lds
  s_add_u32 m0, s61, 1024
  s_xor_b32 s64, s57, 1024
  buffer_load_dwordx4 v4, s[52:55], s64 offen sc1 lds
L_ot_9:
  s_cbranch_execz L_ot_10
  s_add_u32 m0, s61, 8192
  s_xor_b32 s64, s57, 8192
  buffer_load_dwordx4 v4, s[52:55], s64 offen sc1 lds
  s_add_u32 m0, s61, 9216
  s_xor_b32 s64, s57, 9216
  buffer_load_dwordx4 v4, s[52:55], s64 offen sc1 lds
  s_add_u32 m0, s61, 16384
  s_xor_b32 s64, s57, 16384
  buffer_load_dwordx4 v4, s[52:55], s64 offen sc1 lds
  s_add_u32 m0, s61, 17408
  s_xor_b32 s64, s57, 17408
  buffer_load_dwordx4 v4, s[52:55], s64 offen sc1 lds
  s_add_u32 m0, s61, 24576
  s_xor_b32 s64, s57, 24576
L_ot_10:
  s_cbranch_execz L_ot_11
  buffer_load_dwordx4 v4, s[52:55], s64 offen sc1 lds
  s_add_u32 m0, s61, 25600
  s_xor_b32 s64, s57, 25600
  buffer_load_dwordx4 v4, s[52:55], s64 offen sc1 lds
  s_add_u32 m0, s61, 32768
  s_xor_b32 s64, s57, 32768
  buffer_load_dwordx4 v4, s[52:55], s64 offen sc1 lds
  s_add_u32 m0, s61, 33792
  s_xor_b32 s64, s57, 33792
  buffer_load_dwordx4 v4, s[52:55], s64 offen sc1 lds
  s_add_u32 m0, s61, 40960
  s_xor_b32 s64, s57, 40960
  buffer_load_dwordx4 v4, s[52:55], s64 offen sc1 lds
  s_add_u32 m0, s61, 41984
L_ot_11:
  s_cbranch_execz L_ot_24
  s_xor_b32 s64, s57, 41984
  buffer_load_dwordx4 v4, s[52:55], s64 offen sc1 lds
  s_add_u32 m0, s61, 49152
  s_xor_b32 s64, s57, 49152
  buffer_load_dwordx4 v4, s[52:55], s64 offen sc1 lds
  s_add_u32 m0, s61, 50176
  s_xor_b32 s64, s57, 50176
  buffer_load_dwordx4 v4, s[52:55], s64 offen sc1 lds
  s_add_u32 m0, s61, 57344
  s_xor_b32 s64, s57, 57344
  buffer_load_dwordx4 v4, s[52:55], s64 offen sc1 lds
  s_add_u32 m0, s61, 58368
  s_xor_b32 s64, s57, 58368
  buffer_load_dwordx4 v4, s[52:55], s64 offen sc1 lds
L_ot_w2:
L_ot_12:
  s_cbranch_execz L_ot_13
  s_branch L_oh_13
L_of_14_s:
  buffer_load_dwordx4 v[92:95], v107, s[52:55], s74 offen offset:1024 sc1
  buffer_load_dwordx4 v[96:99], v107, s[52:55], s74 offen offset:2048 sc1
  buffer_load_dwordx4 v[100:103], v107, s[52:55], s74 offen offset:3072 sc1
  s_waitcnt vmcnt(0)
  v_xor_b32 v1, v122, v92
  v_bitop3_b32 v1, v1, v122, v93 bitop3:0xf6
  v_bitop3_b32 v1, v1, v122, v94 bitop3:0xf6
  v_bitop3_b32 v1, v1, v122, v95 bitop3:0xf6
  v_bitop3_b32 v1, v1, v122, v96 bitop3:0xf6
  v_bitop3_b32 v1, v1, v122, v97 bitop3:0xf6
  v_bitop3_b32 v1, v1, v122, v98 bitop3:0xf6
  v_bitop3_b32 v1, v1, v122, v99 bitop3:0xf6
L_ot_13:
  s_cbranch_execz L_ot_14
  v_bitop3_b32 v1, v1, v122, v100 bitop3:0xf6
  v_bitop3_b32 v1, v1, v122, v101 bitop3:0xf6
  v_bitop3_b32 v1, v1, v122, v102 bitop3:0xf6
  v_bitop3_b32 v1, v1, v122, v103 bitop3:0xf6
  v_and_b32 v1, 1, v1
  v_cmp_ne_u32 vcc, 0, v1
  s_cbranch_vccz L_of_14
  s_sub_u32 s39, s39, 1
  s_cbranch_scc0 L_of_14_s
  s_endpgm
L_oh_15_s:
  s_cmp_eq_u32 s76, 0
  s_cbranch_scc1 L_oh_15_p
  s_sub_u32 s76, s76, 1
L_ot_14:
  s_cbranch_execz L_ot_15
  s_mov_b32 exec_hi, 0
  global_load_dword v132, v[128:129], off
  v_lshl_add_u64 v[128:129], v[130:131], 0, v[128:129]
  s_mov_b32 exec_hi, -1
L_oh_15_p:
  s_min_u32 s40, s84, s85
  s_min_u32 s41, s86, s87
  s_min_u32 s42, s88, s89
  s_min_u32 s43, s90, s91
  s_min_u32 s40, s40, s41
  s_min_u32 s42, s42, s43
  s_min_u32 s40, s40, s42
  s_cmp_gt_u32 s40, s58
  s_cbranch_scc1 L_oh_15_g
L_ot_15:
  s_cbranch_execz L_ot_16
  s_load_dwordx8 s[84:91], s[34:35], s83 glc
  s_waitcnt lgkmcnt(0)
  s_sub_u32 s39, s39, 1
  s_cbranch_scc0 L_oh_15_p
  s_endpgm
L_oh_15_g:
  s_lshl_b32 s57, s58, 18
  s_add_u32 s57, s57, s63
  s_add_u32 m0, s61, 65536
  s_xor_b32 s64, s57, 0
  buffer_load_dwordx4 v4, s[52:55], s64 offen sc1 lds
  s_add_u32 m0, s61, 66560
  s_xor_b32 s64, s57, 1024
  buffer_load_dwordx4 v4, s[52:55], s64 offen sc1 lds
L_ot_16:
  s_cbranch_execz L_ot_17
  s_add_u32 m0, s61, 73728
  s_xor_b32 s64, s57, 8192
  buffer_load_dwordx4 v4, s[52:55], s64 offen sc1 lds
  s_add_u32 m0, s61, 74752
  s_xor_b32 s64, s57, 9216
  buffer_load_dwordx4 v4, s[52:55], s64 offen sc1 lds
  s_add_u32 m0, s61, 81920
  s_xor_b32 s64, s57, 16384
  buffer_load_dwordx4 v4, s[52:55], s64 offen sc1 lds
  s_add_u32 m0, s61, 82944
  s_xor_b32 s64, s57, 17408
  buffer_load_dwordx4 v4, s[52:55], s64 offen sc1 lds
  s_add_u32 m0, s61, 90112
  s_xor_b32 s64, s57, 24576
L_ot_17:
  s_cbranch_execz L_ot_24
  buffer_load_dwordx4 v4, s[52:55], s64 offen sc1 lds
  s_add_u32 m0, s61, 91136
  s_xor_b32 s64, s57, 25600
  buffer_load_dwordx4 v4, s[52:55], s64 offen sc1 lds
  s_add_u32 m0, s61, 98304
  s_xor_b32 s64, s57, 32768
  buffer_load_dwordx4 v4, s[52:55], s64 offen sc1 lds
  s_add_u32 m0, s61, 99328
  s_xor_b32 s64, s57, 33792
  buffer_load_dwordx4 v4, s[52:55], s64 offen sc1 lds
  s_add_u32 m0, s61, 106496
  s_xor_b32 s64, s57, 40960
  buffer_load_dwordx4 v4, s[52:55], s64 offen sc1 lds
  s_add_u32 m0, s61, 107520
L_ot_w3:
L_ot_18:
  s_cbranch_execz L_ot_19
  s_xor_b32 s64, s57, 41984
  buffer_load_dwordx4 v4, s[52:55], s64 offen sc1 lds
  s_add_u32 m0, s61, 114688
  s_xor_b32 s64, s57, 49152
  buffer_load_dwordx4 v4, s[52:55], s64 offen sc1 lds
  s_add_u32 m0, s61, 115712
  s_xor_b32 s64, s57, 50176
  buffer_load_dwordx4 v4, s[52:55], s64 offen sc1 lds
  s_add_u32 m0, s61, 122880
  s_xor_b32 s64, s57, 57344
  buffer_load_dwordx4 v4, s[52:55], s64 offen sc1 lds
  s_add_u32 m0, s61, 123904
  s_xor_b32 s64, s57, 58368
  buffer_load_dwordx4 v4, s[52:55], s64 offen sc1 lds
L_ot_19:
  s_cbranch_execz L_ot_20
  s_branch L_oh_15
L_of_16_s:
  buffer_load_dwordx4 v[92:95], v107, s[52:55], s74 offen offset:1024 sc1
  buffer_load_dwordx4 v[96:99], v107, s[52:55], s74 offen offset:2048 sc1
  buffer_load_dwordx4 v[100:103], v107, s[52:55], s74 offen offset:3072 sc1
  s_waitcnt vmcnt(0)
  v_xor_b32 v1, v122, v92
  v_bitop3_b32 v1, v1, v122, v93 bitop3:0xf6
  v_bitop3_b32 v1, v1, v122, v94 bitop3:0xf6
  v_bitop3_b32 v1, v1, v122, v95 bitop3:0xf6
  v_bitop3_b32 v1, v1, v122, v96 bitop3:0xf6
  v_bitop3_b32 v1, v1, v122, v97 bitop3:0xf6
  v_bitop3_b32 v1, v1, v122, v98 bitop3:0xf6
  v_bitop3_b32 v1, v1, v122, v99 bitop3:0xf6
L_ot_20:
  s_cbranch_execz L_ot_21
  v_bitop3_b32 v1, v1, v122, v100 bitop3:0xf6
  v_bitop3_b32 v1, v1, v122, v101 bitop3:0xf6
  v_bitop3_b32 v1, v1, v122, v102 bitop3:0xf6
  v_bitop3_b32 v1, v1, v122, v103 bitop3:0xf6
  v_and_b32 v1, 1, v1
  v_cmp_ne_u32 vcc, 0, v1
  s_cbranch_vccz L_of_16
  s_sub_u32 s39, s39, 1
  s_cbranch_scc0 L_of_16_s
  s_endpgm
L_of_17_s:
  buffer_load_dwordx4 v[92:95], v107, s[52:55], s74 offen offset:1024 sc1
  buffer_load_dwordx4 v[96:99], v107, s[52:55], s74 offen offset:2048 sc1
  buffer_load_dwordx4 v[100:103], v107, s[52:55], s74 offen offset:3072 sc1
L_ot_21:
  s_cbranch_execz L_ot_22
  s_waitcnt vmcnt(0)
  v_xor_b32 v1, v122, v92
  v_bitop3_b32 v1, v1, v122, v93 bitop3:0xf6
  v_bitop3_b32 v1, v1, v122, v94 bitop3:0xf6
  v_bitop3_b32 v1, v1, v122, v95 bitop3:0xf6
  v_bitop3_b32 v1, v1, v122, v96 bitop3:0xf6
  v_bitop3_b32 v1, v1, v122, v97 bitop3:0xf6
  v_bitop3_b32 v1, v1, v122, v98 bitop3:0xf6
  v_bitop3_b32 v1, v1, v122, v99 bitop3:0xf6
  v_bitop3_b32 v1, v1, v122, v100 bitop3:0xf6
  v_bitop3_b32 v1, v1, v122, v101 bitop3:0xf6
  v_bitop3_b32 v1, v1, v122, v102 bitop3:0xf6
  v_bitop3_b32 v1, v1, v122, v103 bitop3:0xf6
  v_and_b32 v1, 1, v1
L_ot_22:
  s_cbranch_execz L_ot_23
  v_cmp_ne_u32 vcc, 0, v1
  s_cbranch_vccz L_of_17
  s_sub_u32 s39, s39, 1
  s_cbranch_scc0 L_of_17_s
  s_endpgm
L_of_18_s:
  buffer_load_dwordx4 v[92:95], v107, s[52:55], s74 offen offset:1024 sc1
  buffer_load_dwordx4 v[96:99], v107, s[52:55], s74 offen offset:2048 sc1
  buffer_load_dwordx4 v[100:103], v107, s[52:55], s74 offen offset:3072 sc1
  s_waitcnt vmcnt(0)
  v_xor_b32 v1, v122, v92
  v_bitop3_b32 v1, v1, v122, v93 bitop3:0xf6
  v_bitop3_b32 v1, v1, v122, v94 bitop3:0xf6
  v_bitop3_b32 v1, v1, v122, v95 bitop3:0xf6
L_ot_23:
  s_cbranch_execz L_ot_24
  v_bitop3_b32 v1, v1, v122, v96 bitop3:0xf6
  v_bitop3_b32 v1, v1, v122, v97 bitop3:0xf6
  v_bitop3_b32 v1, v1, v122, v98 bitop3:0xf6
  v_bitop3_b32 v1, v1, v122, v99 bitop3:0xf6
  v_bitop3_b32 v1, v1, v122, v100 bitop3:0xf6
  v_bitop3_b32 v1, v1, v122, v101 bitop3:0xf6
  v_bitop3_b32 v1, v1, v122, v102 bitop3:0xf6
  v_bitop3_b32 v1, v1, v122, v103 bitop3:0xf6
  v_and_b32 v1, 1, v1
  v_cmp_ne_u32 vcc, 0, v1
  s_cbranch_vccz L_of_18
  s_sub_u32 s39, s39, 1
  s_cbranch_scc0 L_of_18_s
  s_endpgm
L_ot_24:
  s_mov_b64 exec, -1
  s_branch L_ot_done
L_proj:
  s_mov_b32 s52, s34
  s_and_b32 s53, s35, 0xffff
  s_mov_b32 s54, 0x6000000
  s_mov_b32 s55, 0x20000
  s_lshl_b32 s56, s36, 15
  s_add_u32 s56, s56, 32768
  s_lshl_b32 s61, s36, 10
  v_mov_b32 v7, 0
  s_cmp_eq_u32 s37, 4
  s_cselect_b32 s44, s10, s8
  s_cselect_b32 s45, s11, s9
  s_cmp_eq_u32 s37, 6
  s_cselect_b32 s44, s12, s44
  s_cselect_b32 s45, s13, s45
  s_and_b32 s45, s45, 0xffff
  s_mov_b32 s46, 0x800000
  s_mov_b32 s47, 0x20000
  s_mov_b32 s48, s4
  s_and_b32 s49, s5, 0xffff
  s_mov_b32 s50, 0x400000
  s_mov_b32 s51, 0x20000
  v_lshrrev_b32 v2, 2, v0
  v_lshlrev_b32 v2, 13, v2
  v_and_b32 v1, 3, v0
  v_lshl_add_u32 v2, v1, 4, v2
  s_lshl_b32 s40, s38, 8
  s_lshl_b32 s41, s36, 6
  s_add_u32 s62, s40, s41
  s_mov_b32 s60, 0
  v_lshrrev_b32 v3, 4, v0
  v_lshlrev_b32 v3, 3, v3
  v_bfe_u32 v1, v0, 2, 2
  v_add_u32 v3, v1, v3
  v_lshlrev_b32 v3, 6, v3
  v_and_b32 v1, 3, v0
  v_lshl_add_u32 v3, v1, 3, v3
  v_add_u32 v3, s56, v3
  s_lshl_b32 s40, s36, 3
  v_lshrrev_b32 v4, 3, v0
  v_add_u32 v4, s40, v4
  v_bfe_u32 v1, v4, 1, 3
  v_xor_b32 v1, v1, v0
  v_and_b32 v1, 7, v1
  v_lshlrev_b32 v4, 11, v4
  v_lshl_add_u32 v4, v1, 4, v4
  v_lshrrev_b32 v1, 4, v0
  v_add_u32 v1, 0, v1
  v_bfe_u32 v8, v0, 1, 3
  v_xor_b32 v1, v1, v8
  v_and_b32 v8, 15, v0
  v_lshlrev_b32 v8, 7, v8
  v_lshl_add_u32 v8, v1, 4, v8
  v_add_u32 v10, 0x10000, v8
  v_lshrrev_b32 v1, 4, v0
  v_add_u32 v1, 4, v1
  v_bfe_u32 v9, v0, 1, 3
  v_xor_b32 v1, v1, v9
  v_and_b32 v9, 15, v0
  v_lshlrev_b32 v9, 7, v9
  v_lshl_add_u32 v9, v1, 4, v9
  v_add_u32 v11, 0x10000, v9
  s_lshl_b32 s41, s38, 13
  s_lshl_b32 s42, s36, 11
  s_add_u32 s41, s41, s42
  v_lshl_add_u32 v5, v0, 4, s41
  s_lshl_b32 s40, s38, 8
  s_and_b32 s41, s37, 2
  s_lshl_b32 s41, s41, 1
  s_add_u32 s40, s40, s41
  s_add_u32 s40, s40, 76546048
  s_lshr_b32 s41, s38, 3
  s_mul_i32 s41, s41, 992
  s_lshl_b32 s42, s38, 2
  s_add_u32 s41, s41, s42
  s_add_u32 s41, s41, 76554240
  s_cmp_eq_u32 s37, 5
  s_cselect_b32 s40, s41, s40
  s_cselect_b32 s41, 256, 64
  s_mul_i32 s83, s36, s41
  s_add_u32 s83, s83, s40
  s_lshl_b32 s42, s38, 11
  s_lshl_b32 s43, s36, 9
  s_add_u32 s42, s42, s43
  s_add_u32 s42, s42, 0x30000
  v_and_b32 v6, 3, v0
  v_lshl_add_u32 v6, v6, 7, s42
  v_and_b32 v1, 3, v0
  v_mul_lo_u32 v1, v1, s41
  v_add_u32 v1, s40, v1
  s_cmp_eq_u32 s36, 0
  s_cbranch_scc0 L_p_ini
  s_mov_b64 exec, 15
  buffer_store_dword v7, v1, s[52:55], 0 offen sc1
  s_mov_b64 exec, -1
L_p_ini:
  s_and_b32 s40, s38, 3
  s_lshl_b32 s40, s40, 2
  s_add_u32 s40, s40, s36
  s_lshl_b32 s40, s40, 17
  s_and_b32 s41, s38, 28
  s_lshl_b32 s42, s41, 8
  s_add_u32 s40, s40, s42
  s_add_u32 s40, s40, 384
  v_and_b32 v80, 15, v0
  v_lshl_add_u32 v80, v80, 13, s40
  v_bfe_u32 v81, v0, 4, 1
  v_lshl_add_u32 v80, v81, 9, v80
  s_mov_b32 s65, 0
  v_bfe_u32 v82, v0, 2, 2
  v_lshlrev_b32 v82, 16, v82
  v_sub_u32 v82, v6, v82
  buffer_load_dword v81, v82, s[48:51], 0 offen
  s_lshl_b32 s40, s36, 14
  s_add_u32 s40, s40, 98304
  s_sub_u32 s41, s40, s56
  s_mov_b32 s56, s40
  v_add_u32 v3, s41, v3
  s_cmp_eq_u32 s37, 5
  s_cselect_b32 s59, 0x80000000, 0
  s_cselect_b32 s92, 0, 1
  s_mov_b32 s64, 0x10000
  s_cmp_eq_u32 s37, 6
  s_cselect_b32 s40, 16777216, 0
  v_add_u32 v5, s40, v5
  s_cbranch_scc1 L_p_startV
L_p_startK:
  s_mov_b32 s57, 0
  s_mov_b32 exec_hi, 0
  buffer_load_dword v81, v80, s[44:47], s57 offen
  s_mov_b64 exec, -1
  s_mov_b32 s57, 2097152
  s_mov_b32 exec_hi, 0
  buffer_load_dword v81, v80, s[44:47], s57 offen
  s_mov_b64 exec, -1
  s_add_u32 m0, s56, 0
  s_add_u32 s57, s62, 0
  buffer_load_dwordx4 v2, s[44:47], s57 offen lds
  s_add_u32 m0, s56, 1024
  s_add_u32 s57, s62, 131072
  buffer_load_dwordx4 v2, s[44:47], s57 offen lds
  s_add_u32 m0, s56, 2048
  s_add_u32 s57, s62, 262144
  buffer_load_dwordx4 v2, s[44:47], s57 offen lds
  s_add_u32 m0, s56, 3072
  s_add_u32 s57, s62, 393216
  buffer_load_dwordx4 v2, s[44:47], s57 offen lds
  s_add_u32 m0, s56, 4096
  s_add_u32 s57, s62, 524288
  buffer_load_dwordx4 v2, s[44:47], s57 offen lds
  s_add_u32 m0, s56, 5120
  s_add_u32 s57, s62, 655360
  buffer_load_dwordx4 v2, s[44:47], s57 offen lds
  s_add_u32 m0, s56, 6144
  s_add_u32 s57, s62, 786432
  buffer_load_dwordx4 v2, s[44:47], s57 offen lds
  s_add_u32 m0, s56, 7168
  s_add_u32 s57, s62, 917504
  buffer_load_dwordx4 v2, s[44:47], s57 offen lds
  s_waitcnt lgkmcnt(0)
  s_add_u32 m0, s56, 8192
  s_add_u32 s57, s62, 1048576
  buffer_load_dwordx4 v2, s[44:47], s57 offen lds
  s_add_u32 m0, s56, 9216
  s_add_u32 s57, s62, 1179648
  buffer_load_dwordx4 v2, s[44:47], s57 offen lds
  s_add_u32 m0, s56, 10240
  s_add_u32 s57, s62, 1310720
  buffer_load_dwordx4 v2, s[44:47], s57 offen lds
  s_add_u32 m0, s56, 11264
  s_add_u32 s57, s62, 1441792
  buffer_load_dwordx4 v2, s[44:47], s57 offen lds
  s_add_u32 m0, s56, 12288
  s_add_u32 s57, s62, 1572864
  buffer_load_dwordx4 v2, s[44:47], s57 offen lds
  s_add_u32 m0, s56, 13312
  s_add_u32 s57, s62, 1703936
  buffer_load_dwordx4 v2, s[44:47], s57 offen lds
  s_waitcnt vmcnt(6)
  ds_read_b64_tr_b16 a[0:1], v3 offset:0
  ds_read_b64_tr_b16 a[2:3], v3 offset:256
  ds_read_b64_tr_b16 a[4:5], v3 offset:32
  ds_read_b64_tr_b16 a[6:7], v3 offset:288
  ds_read_b64_tr_b16 a[8:9], v3 offset:2048
  ds_read_b64_tr_b16 a[10:11], v3 offset:2304
  ds_read_b64_tr_b16 a[12:13], v3 offset:2080
  ds_read_b64_tr_b16 a[14:15], v3 offset:2336
  s_add_u32 m0, s56, 14336
  s_add_u32 s57, s62, 1835008
  buffer_load_dwordx4 v2, s[44:47], s57 offen lds
  ds_read_b64_tr_b16 a[16:17], v3 offset:4096
  ds_read_b64_tr_b16 a[18:19], v3 offset:4352
  ds_read_b64_tr_b16 a[20:21], v3 offset:4128
  ds_read_b64_tr_b16 a[22:23], v3 offset:4384
  ds_read_b64_tr_b16 a[24:25], v3 offset:6144
  ds_read_b64_tr_b16 a[26:27], v3 offset:6400
  ds_read_b64_tr_b16 a[28:29], v3 offset:6176
  ds_read_b64_tr_b16 a[30:31], v3 offset:6432
  s_add_u32 m0, s56, 15360
  s_add_u32 s57, s62, 1966080
  buffer_load_dwordx4 v2, s[44:47], s57 offen lds
  s_waitcnt lgkmcnt(0)
  s_cmp_eq_u32 s36, 0
  s_cbranch_scc0 L_arr_19
  s_mov_b32 s41, 0x10000
  s_atomic_add s41, s[32:33], 4 glc
  s_waitcnt lgkmcnt(0)
  s_lshr_b32 s40, s41, 16
  s_cmp_eq_u32 s40, 255
  s_cbranch_scc0 L_arr_19
  s_mov_b32 s84, 0
  s_atomic_add s84, s[32:33], 0 glc
  s_mov_b32 s85, 0
  s_atomic_add s85, s[32:33], 32 glc
  s_mov_b32 s86, 0
  s_atomic_add s86, s[32:33], 64 glc
  s_mov_b32 s87, 0
  s_atomic_add s87, s[32:33], 96 glc
  s_mov_b32 s88, 0
  s_atomic_add s88, s[32:33], 128 glc
  s_mov_b32 s89, 0
  s_atomic_add s89, s[32:33], 160 glc
  s_mov_b32 s90, 0
  s_atomic_add s90, s[32:33], 192 glc
  s_mov_b32 s91, 0
  s_atomic_add s91, s[32:33], 224 glc
  s_and_b32 s41, s41, 0xffff
  s_cmp_ge_u32 s41, 64
  s_cselect_b32 s41, 3, 1
  s_mov_b32 s40, 4
  s_waitcnt lgkmcnt(0)
  s_cmp_eq_u32 s84, 32
  s_cselect_b32 s40, s40, 0
  s_cmp_eq_u32 s85, 32
  s_cselect_b32 s40, s40, 0
  s_cmp_eq_u32 s86, 32
  s_cselect_b32 s40, s40, 0
  s_cmp_eq_u32 s87, 32
  s_cselect_b32 s40, s40, 0
  s_cmp_eq_u32 s88, 32
  s_cselect_b32 s40, s40, 0
  s_cmp_eq_u32 s89, 32
  s_cselect_b32 s40, s40, 0
  s_cmp_eq_u32 s90, 32
  s_cselect_b32 s40, s40, 0
  s_cmp_eq_u32 s91, 32
  s_cselect_b32 s40, s40, 0
  s_add_u32 s41, s41, s40
  s_atomic_add s41, s[32:33], 252
L_arr_19:
  s_add_u32 m0, s61, 0
  s_nop 0
  buffer_load_dwordx4 v4, s[48:51], s60 offen offset:0 lds
  s_add_u32 m0, s61, 3968
  s_nop 0
  buffer_load_dwordx4 v4, s[48:51], s60 offen offset:128 lds
  s_add_u32 m0, s61, 7936
  s_nop 0
  buffer_load_dwordx4 v4, s[48:51], s60 offen offset:256 lds
  s_add_u32 m0, s61, 11904
  s_nop 0
  buffer_load_dwordx4 v4, s[48:51], s60 offen offset:384 lds
  s_add_u32 m0, s61, 15872
  s_nop 0
  buffer_load_dwordx4 v4, s[48:51], s60 offen offset:512 lds
  s_add_u32 m0, s61, 19840
  s_nop 0
  buffer_load_dwordx4 v4, s[48:51], s60 offen offset:640 lds
  s_add_u32 m0, s61, 23808
  s_nop 0
  buffer_load_dwordx4 v4, s[48:51], s60 offen offset:768 lds
  s_add_u32 m0, s61, 27776
  s_nop 0
  buffer_load_dwordx4 v4, s[48:51], s60 offen offset:896 lds
  s_add_u32 m0, s61, 31744
  s_nop 0
  buffer_load_dwordx4 v4, s[48:51], s60 offen offset:1024 lds
  s_add_u32 m0, s61, 35712
  s_nop 0
  buffer_load_dwordx4 v4, s[48:51], s60 offen offset:1152 lds
  s_add_u32 m0, s61, 39680
  s_nop 0
  buffer_load_dwordx4 v4, s[48:51], s60 offen offset:1280 lds
  s_add_u32 m0, s61, 43648
  s_nop 0
  buffer_load_dwordx4 v4, s[48:51], s60 offen offset:1408 lds
  s_add_u32 m0, s61, 47616
  s_nop 0
  buffer_load_dwordx4 v4, s[48:51], s60 offen offset:1536 lds
  s_add_u32 m0, s61, 51584
  s_nop 0
  buffer_load_dwordx4 v4, s[48:51], s60 offen offset:1664 lds
  s_add_u32 m0, s61, 55552
  s_nop 0
  buffer_load_dwordx4 v4, s[48:51], s60 offen offset:1792 lds
  s_add_u32 m0, s61, 59520
  s_nop 0
  buffer_load_dwordx4 v4, s[48:51], s60 offen offset:1920 lds
  s_add_u32 m0, s61, 65536
  s_nop 0
  buffer_load_dwordx4 v4, s[48:51], s64 offen offset:0 lds
  s_add_u32 m0, s61, 69504
  s_nop 0
  buffer_load_dwordx4 v4, s[48:51], s64 offen offset:128 lds
  s_add_u32 m0, s61, 73472
  s_nop 0
  buffer_load_dwordx4 v4, s[48:51], s64 offen offset:256 lds
  s_add_u32 m0, s61, 77440
  s_nop 0
  buffer_load_dwordx4 v4, s[48:51], s64 offen offset:384 lds
  s_add_u32 m0, s61, 81408
  s_nop 0
  buffer_load_dwordx4 v4, s[48:51], s64 offen offset:512 lds
  s_add_u32 m0, s61, 85376
  s_nop 0
  buffer_load_dwordx4 v4, s[48:51], s64 offen offset:640 lds
  s_add_u32 m0, s61, 89344
  s_nop 0
  buffer_load_dwordx4 v4, s[48:51], s64 offen offset:768 lds
  s_add_u32 m0, s61, 93312
  s_nop 0
  buffer_load_dwordx4 v4, s[48:51], s64 offen offset:896 lds
  s_mov_b32 s57, 4194304
  s_mov_b32 exec_hi, 0
  buffer_load_dword v81, v80, s[44:47], s57 offen
  s_mov_b64 exec, -1
  s_add_u32 m0, s56, 0
  s_add_u32 s57, s62, 2097152
  buffer_load_dwordx4 v2, s[44:47], s57 offen lds
  s_add_u32 m0, s56, 1024
  s_add_u32 s57, s62, 2228224
  buffer_load_dwordx4 v2, s[44:47], s57 offen lds
  s_add_u32 m0, s56, 2048
  s_add_u32 s57, s62, 2359296
  buffer_load_dwordx4 v2, s[44:47], s57 offen lds
  s_add_u32 m0, s56, 3072
  s_add_u32 s57, s62, 2490368
  buffer_load_dwordx4 v2, s[44:47], s57 offen lds
  s_add_u32 m0, s56, 4096
  s_add_u32 s57, s62, 2621440
  buffer_load_dwordx4 v2, s[44:47], s57 offen lds
  s_add_u32 m0, s56, 5120
  s_add_u32 s57, s62, 2752512
  buffer_load_dwordx4 v2, s[44:47], s57 offen lds
  s_waitcnt vmcnt(31)
  ds_read_b64_tr_b16 a[32:33], v3 offset:8192
  ds_read_b64_tr_b16 a[34:35], v3 offset:8448
  ds_read_b64_tr_b16 a[36:37], v3 offset:8224
  ds_read_b64_tr_b16 a[38:39], v3 offset:8480
  ds_read_b64_tr_b16 a[40:41], v3 offset:10240
  ds_read_b64_tr_b16 a[42:43], v3 offset:10496
  ds_read_b64_tr_b16 a[44:45], v3 offset:10272
  ds_read_b64_tr_b16 a[46:47], v3 offset:10528
  s_add_u32 m0, s56, 6144
  s_add_u32 s57, s62, 2883584
  buffer_load_dwordx4 v2, s[44:47], s57 offen lds
  ds_read_b64_tr_b16 a[48:49], v3 offset:12288
  ds_read_b64_tr_b16 a[50:51], v3 offset:12544
  ds_read_b64_tr_b16 a[52:53], v3 offset:12320
  ds_read_b64_tr_b16 a[54:55], v3 offset:12576
  ds_read_b64_tr_b16 a[56:57], v3 offset:14336
  ds_read_b64_tr_b16 a[58:59], v3 offset:14592
  ds_read_b64_tr_b16 a[60:61], v3 offset:14368
  ds_read_b64_tr_b16 a[62:63], v3 offset:14624
  s_add_u32 m0, s56, 7168
  s_add_u32 s57, s62, 3014656
  buffer_load_dwordx4 v2, s[44:47], s57 offen lds
  s_waitcnt lgkmcnt(0)
  s_waitcnt vmcnt(9)
  s_barrier
  s_add_u32 m0, s56, 8192
  s_add_u32 s57, s62, 3145728
  buffer_load_dwordx4 v2, s[44:47], s57 offen lds
  ds_read_b128 v[48:51], v8 offset:0
  ds_read_b128 v[52:55], v8 offset:2048
  ds_read_b128 v[56:59], v9 offset:0
  ds_read_b128 v[60:63], v9 offset:2048
  ds_read_b128 v[64:67], v8 offset:4096
  ds_read_b128 v[68:71], v8 offset:6144
  ds_read_b128 v[72:75], v9 offset:4096
  ds_read_b128 v[76:79], v9 offset:6144
  s_waitcnt lgkmcnt(6)
  v_mfma_f32_16x16x32_bf16 v[16:19], a[0:3], v[48:51], 0
  v_mfma_f32_16x16x32_bf16 v[20:23], a[4:7], v[48:51], 0
  s_add_u32 m0, s56, 9216
  s_add_u32 s57, s62, 3276800
  buffer_load_dwordx4 v2, s[44:47], s57 offen lds
  v_mfma_f32_16x16x32_bf16 v[24:27], a[0:3], v[52:55], 0
  v_mfma_f32_16x16x32_bf16 v[28:31], a[4:7], v[52:55], 0
  s_waitcnt lgkmcnt(4)
  v_mfma_f32_16x16x32_bf16 v[16:19], a[8:11], v[56:59], v[16:19]
  v_mfma_f32_16x16x32_bf16 v[20:23], a[12:15], v[56:59], v[20:23]
  v_mfma_f32_16x16x32_bf16 v[24:27], a[8:11], v[60:63], v[24:27]
  v_mfma_f32_16x16x32_bf16 v[28:31], a[12:15], v[60:63], v[28:31]
  s_waitcnt lgkmcnt(2)
  v_mfma_f32_16x16x32_bf16 v[16:19], a[16:19], v[64:67], v[16:19]
  v_mfma_f32_16x16x32_bf16 v[20:23], a[20:23], v[64:67], v[20:23]
  v_mfma_f32_16x16x32_bf16 v[24:27], a[16:19], v[68:71], v[24:27]
  s_add_u32 m0, s56, 10240
  s_add_u32 s57, s62, 3407872
  buffer_load_dwordx4 v2, s[44:47], s57 offen lds
  v_mfma_f32_16x16x32_bf16 v[28:31], a[20:23], v[68:71], v[28:31]
  s_waitcnt lgkmcnt(0)
  v_mfma_f32_16x16x32_bf16 v[16:19], a[24:27], v[72:75], v[16:19]
  v_mfma_f32_16x16x32_bf16 v[20:23], a[28:31], v[72:75], v[20:23]
  v_mfma_f32_16x16x32_bf16 v[24:27], a[24:27], v[76:79], v[24:27]
  v_mfma_f32_16x16x32_bf16 v[28:31], a[28:31], v[76:79], v[28:31]
  ds_read_b128 v[48:51], v8 offset:8192
  ds_read_b128 v[52:55], v8 offset:10240
  ds_read_b128 v[56:59], v9 offset:8192
  ds_read_b128 v[60:63], v9 offset:10240
  ds_read_b128 v[64:67], v8 offset:12288
  s_add_u32 m0, s56, 11264
  s_add_u32 s57, s62, 3538944
  buffer_load_dwordx4 v2, s[44:47], s57 offen lds
  ds_read_b128 v[68:71], v8 offset:14336
  ds_read_b128 v[72:75], v9 offset:12288
  ds_read_b128 v[76:79], v9 offset:14336
  s_waitcnt lgkmcnt(6)
  v_mfma_f32_16x16x32_bf16 v[16:19], a[32:35], v[48:51], v[16:19]
  v_mfma_f32_16x16x32_bf16 v[20:23], a[36:39], v[48:51], v[20:23]
  v_mfma_f32_16x16x32_bf16 v[24:27], a[32:35], v[52:55], v[24:27]
  v_mfma_f32_16x16x32_bf16 v[28:31], a[36:39], v[52:55], v[28:31]
  s_waitcnt lgkmcnt(4)
  v_mfma_f32_16x16x32_bf16 v[16:19], a[40:43], v[56:59], v[16:19]
  v_mfma_f32_16x16x32_bf16 v[20:23], a[44:47], v[56:59], v[20:23]
  s_add_u32 m0, s56, 12288
  s_add_u32 s57, s62, 3670016
  buffer_load_dwordx4 v2, s[44:47], s57 offen lds
  v_mfma_f32_16x16x32_bf16 v[24:27], a[40:43], v[60:63], v[24:27]
  v_mfma_f32_16x16x32_bf16 v[28:31], a[44:47], v[60:63], v[28:31]
  s_waitcnt lgkmcnt(2)
  v_mfma_f32_16x16x32_bf16 v[16:19], a[48:51], v[64:67], v[16:19]
  v_mfma_f32_16x16x32_bf16 v[20:23], a[52:55], v[64:67], v[20:23]
  v_mfma_f32_16x16x32_bf16 v[24:27], a[48:51], v[68:71], v[24:27]
  v_mfma_f32_16x16x32_bf16 v[28:31], a[52:55], v[68:71], v[28:31]
  s_waitcnt lgkmcnt(0)
  v_mfma_f32_16x16x32_bf16 v[16:19], a[56:59], v[72:75], v[16:19]
  v_mfma_f32_16x16x32_bf16 v[20:23], a[60:63], v[72:75], v[20:23]
  v_mfma_f32_16x16x32_bf16 v[24:27], a[56:59], v[76:79], v[24:27]
  v_mfma_f32_16x16x32_bf16 v[28:31], a[60:63], v[76:79], v[28:31]
  s_add_u32 m0, s56, 13312
  s_add_u32 s57, s62, 3801088
  buffer_load_dwordx4 v2, s[44:47], s57 offen lds
  s_waitcnt vmcnt(6)
  ds_read_b64_tr_b16 a[64:65], v3 offset:0
  ds_read_b64_tr_b16 a[66:67], v3 offset:256
  ds_read_b64_tr_b16 a[68:69], v3 offset:32
  ds_read_b64_tr_b16 a[70:71], v3 offset:288
  ds_read_b64_tr_b16 a[72:73], v3 offset:2048
  ds_read_b64_tr_b16 a[74:75], v3 offset:2304
  ds_read_b64_tr_b16 a[76:77], v3 offset:2080
  ds_read_b64_tr_b16 a[78:79], v3 offset:2336
  s_add_u32 m0, s56, 14336
  s_add_u32 s57, s62, 3932160
  buffer_load_dwordx4 v2, s[44:47], s57 offen lds
  ds_read_b64_tr_b16 a[80:81], v3 offset:4096
  ds_read_b64_tr_b16 a[82:83], v3 offset:4352
  ds_read_b64_tr_b16 a[84:85], v3 offset:4128
  ds_read_b64_tr_b16 a[86:87], v3 offset:4384
  ds_read_b64_tr_b16 a[88:89], v3 offset:6144
  ds_read_b64_tr_b16 a[90:91], v3 offset:6400
  ds_read_b64_tr_b16 a[92:93], v3 offset:6176
  ds_read_b64_tr_b16 a[94:95], v3 offset:6432
  s_add_u32 m0, s56, 15360
  s_add_u32 s57, s62, 4063232
  buffer_load_dwordx4 v2, s[44:47], s57 offen lds
  s_waitcnt lgkmcnt(0)
  s_mov_b32 s57, 6291456
  s_mov_b32 exec_hi, 0
  buffer_load_dword v81, v80, s[44:47], s57 offen
  s_mov_b64 exec, -1
  s_add_u32 m0, s56, 0
  s_add_u32 s57, s62, 4194304
  buffer_load_dwordx4 v2, s[44:47], s57 offen lds
  ds_read_b128 v[48:51], v8 offset:16384
  ds_read_b128 v[52:55], v8 offset:18432
  ds_read_b128 v[56:59], v9 offset:16384
  ds_read_b128 v[60:63], v9 offset:18432
  ds_read_b128 v[64:67], v8 offset:20480
  ds_read_b128 v[68:71], v8 offset:22528
  ds_read_b128 v[72:75], v9 offset:20480
  ds_read_b128 v[76:79], v9 offset:22528
  s_waitcnt lgkmcnt(6)
  v_mfma_f32_16x16x32_bf16 v[16:19], a[64:67], v[48:51], v[16:19]
  v_mfma_f32_16x16x32_bf16 v[20:23], a[68:71], v[48:51], v[20:23]
  s_add_u32 m0, s56, 1024
  s_add_u32 s57, s62, 4325376
  buffer_load_dwordx4 v2, s[44:47], s57 offen lds
  v_mfma_f32_16x16x32_bf16 v[24:27], a[64:67], v[52:55], v[24:27]
  v_mfma_f32_16x16x32_bf16 v[28:31], a[68:71], v[52:55], v[28:31]
  s_waitcnt lgkmcnt(4)
  v_mfma_f32_16x16x32_bf16 v[16:19], a[72:75], v[56:59], v[16:19]
  v_mfma_f32_16x16x32_bf16 v[20:23], a[76:79], v[56:59], v[20:23]
  v_mfma_f32_16x16x32_bf16 v[24:27], a[72:75], v[60:63], v[24:27]
  v_mfma_f32_16x16x32_bf16 v[28:31], a[76:79], v[60:63], v[28:31]
  s_waitcnt lgkmcnt(2)
  v_mfma_f32_16x16x32_bf16 v[16:19], a[80:83], v[64:67], v[16:19]
  v_mfma_f32_16x16x32_bf16 v[20:23], a[84:87], v[64:67], v[20:23]
  v_mfma_f32_16x16x32_bf16 v[24:27], a[80:83], v[68:71], v[24:27]
  s_add_u32 m0, s56, 2048
  s_add_u32 s57, s62, 4456448
  buffer_load_dwordx4 v2, s[44:47], s57 offen lds
  v_mfma_f32_16x16x32_bf16 v[28:31], a[84:87], v[68:71], v[28:31]
  s_waitcnt lgkmcnt(0)
  v_mfma_f32_16x16x32_bf16 v[16:19], a[88:91], v[72:75], v[16:19]
  v_mfma_f32_16x16x32_bf16 v[20:23], a[92:95], v[72:75], v[20:23]
  v_mfma_f32_16x16x32_bf16 v[24:27], a[88:91], v[76:79], v[24:27]
  v_mfma_f32_16x16x32_bf16 v[28:31], a[92:95], v[76:79], v[28:31]
  ds_read_b128 v[48:51], v10 offset:0
  ds_read_b128 v[52:55], v10 offset:2048
  ds_read_b128 v[56:59], v11 offset:0
  ds_read_b128 v[60:63], v11 offset:2048
  ds_read_b128 v[64:67], v10 offset:4096
  s_add_u32 m0, s56, 3072
  s_add_u32 s57, s62, 4587520
  buffer_load_dwordx4 v2, s[44:47], s57 offen lds
  ds_read_b128 v[68:71], v10 offset:6144
  ds_read_b128 v[72:75], v11 offset:4096
  ds_read_b128 v[76:79], v11 offset:6144
  s_waitcnt lgkmcnt(6)
  v_mfma_f32_16x16x32_bf16 v[32:35], a[0:3], v[48:51], 0
  v_mfma_f32_16x16x32_bf16 v[36:39], a[4:7], v[48:51], 0
  v_mfma_f32_16x16x32_bf16 v[40:43], a[0:3], v[52:55], 0
  v_mfma_f32_16x16x32_bf16 v[44:47], a[4:7], v[52:55], 0
  s_waitcnt lgkmcnt(4)
  v_mfma_f32_16x16x32_bf16 v[32:35], a[8:11], v[56:59], v[32:35]
  v_mfma_f32_16x16x32_bf16 v[36:39], a[12:15], v[56:59], v[36:39]
  s_add_u32 m0, s56, 4096
  s_add_u32 s57, s62, 4718592
  buffer_load_dwordx4 v2, s[44:47], s57 offen lds
  v_mfma_f32_16x16x32_bf16 v[40:43], a[8:11], v[60:63], v[40:43]
  v_mfma_f32_16x16x32_bf16 v[44:47], a[12:15], v[60:63], v[44:47]
  s_waitcnt lgkmcnt(2)
  v_mfma_f32_16x16x32_bf16 v[32:35], a[16:19], v[64:67], v[32:35]
  v_mfma_f32_16x16x32_bf16 v[36:39], a[20:23], v[64:67], v[36:39]
  v_mfma_f32_16x16x32_bf16 v[40:43], a[16:19], v[68:71], v[40:43]
  v_mfma_f32_16x16x32_bf16 v[44:47], a[20:23], v[68:71], v[44:47]
  s_waitcnt lgkmcnt(0)
  v_mfma_f32_16x16x32_bf16 v[32:35], a[24:27], v[72:75], v[32:35]
  v_mfma_f32_16x16x32_bf16 v[36:39], a[28:31], v[72:75], v[36:39]
  v_mfma_f32_16x16x32_bf16 v[40:43], a[24:27], v[76:79], v[40:43]
  v_mfma_f32_16x16x32_bf16 v[44:47], a[28:31], v[76:79], v[44:47]
  s_add_u32 m0, s56, 5120
  s_add_u32 s57, s62, 4849664
  buffer_load_dwordx4 v2, s[44:47], s57 offen lds
  s_waitcnt vmcnt(7)
  ds_read_b64_tr_b16 a[96:97], v3 offset:8192
  ds_read_b64_tr_b16 a[98:99], v3 offset:8448
  ds_read_b64_tr_b16 a[100:101], v3 offset:8224
  ds_read_b64_tr_b16 a[102:103], v3 offset:8480
  ds_read_b64_tr_b16 a[104:105], v3 offset:10240
  ds_read_b64_tr_b16 a[106:107], v3 offset:10496
  ds_read_b64_tr_b16 a[108:109], v3 offset:10272
  ds_read_b64_tr_b16 a[110:111], v3 offset:10528
  s_add_u32 m0, s56, 6144
  s_add_u32 s57, s62, 4980736
  buffer_load_dwordx4 v2, s[44:47], s57 offen lds
  ds_read_b64_tr_b16 a[112:113], v3 offset:12288
  ds_read_b64_tr_b16 a[114:115], v3 offset:12544
  ds_read_b64_tr_b16 a[116:117], v3 offset:12320
  ds_read_b64_tr_b16 a[118:119], v3 offset:12576
  ds_read_b64_tr_b16 a[120:121], v3 offset:14336
  ds_read_b64_tr_b16 a[122:123], v3 offset:14592
  ds_read_b64_tr_b16 a[124:125], v3 offset:14368
  ds_read_b64_tr_b16 a[126:127], v3 offset:14624
  s_add_u32 m0, s56, 7168
  s_add_u32 s57, s62, 5111808
  buffer_load_dwordx4 v2, s[44:47], s57 offen lds
  s_waitcnt lgkmcnt(0)
  s_add_u32 m0, s56, 8192
  s_add_u32 s57, s62, 5242880
  buffer_load_dwordx4 v2, s[44:47], s57 offen lds
  ds_read_b128 v[48:51], v8 offset:24576
  ds_read_b128 v[52:55], v8 offset:26624
  ds_read_b128 v[56:59], v9 offset:24576
  ds_read_b128 v[60:63], v9 offset:26624
  ds_read_b128 v[64:67], v8 offset:28672
  ds_read_b128 v[68:71], v8 offset:30720
  ds_read_b128 v[72:75], v9 offset:28672
  ds_read_b128 v[76:79], v9 offset:30720
  s_waitcnt lgkmcnt(6)
  v_mfma_f32_16x16x32_bf16 v[16:19], a[96:99], v[48:51], v[16:19]
  v_mfma_f32_16x16x32_bf16 v[20:23], a[100:103], v[48:51], v[20:23]
  s_add_u32 m0, s56, 9216
  s_add_u32 s57, s62, 5373952
  buffer_load_dwordx4 v2, s[44:47], s57 offen lds
  v_mfma_f32_16x16x32_bf16 v[24:27], a[96:99], v[52:55], v[24:27]
  v_mfma_f32_16x16x32_bf16 v[28:31], a[100:103], v[52:55], v[28:31]
  s_waitcnt lgkmcnt(4)
  v_mfma_f32_16x16x32_bf16 v[16:19], a[104:107], v[56:59], v[16:19]
  v_mfma_f32_16x16x32_bf16 v[20:23], a[108:111], v[56:59], v[20:23]
  v_mfma_f32_16x16x32_bf16 v[24:27], a[104:107], v[60:63], v[24:27]
  v_mfma_f32_16x16x32_bf16 v[28:31], a[108:111], v[60:63], v[28:31]
  s_waitcnt lgkmcnt(2)
  v_mfma_f32_16x16x32_bf16 v[16:19], a[112:115], v[64:67], v[16:19]
  v_mfma_f32_16x16x32_bf16 v[20:23], a[116:119], v[64:67], v[20:23]
  v_mfma_f32_16x16x32_bf16 v[24:27], a[112:115], v[68:71], v[24:27]
  s_add_u32 m0, s56, 10240
  s_add_u32 s57, s62, 5505024
  buffer_load_dwordx4 v2, s[44:47], s57 offen lds
  v_mfma_f32_16x16x32_bf16 v[28:31], a[116:119], v[68:71], v[28:31]
  s_waitcnt lgkmcnt(0)
  v_mfma_f32_16x16x32_bf16 v[16:19], a[120:123], v[72:75], v[16:19]
  v_mfma_f32_16x16x32_bf16 v[20:23], a[124:127], v[72:75], v[20:23]
  v_mfma_f32_16x16x32_bf16 v[24:27], a[120:123], v[76:79], v[24:27]
  v_mfma_f32_16x16x32_bf16 v[28:31], a[124:127], v[76:79], v[28:31]
  ds_read_b128 v[48:51], v10 offset:8192
  ds_read_b128 v[52:55], v10 offset:10240
  ds_read_b128 v[56:59], v11 offset:8192
  ds_read_b128 v[60:63], v11 offset:10240
  ds_read_b128 v[64:67], v10 offset:12288
  s_add_u32 m0, s56, 11264
  s_add_u32 s57, s62, 5636096
  buffer_load_dwordx4 v2, s[44:47], s57 offen lds
  ds_read_b128 v[68:71], v10 offset:14336
  ds_read_b128 v[72:75], v11 offset:12288
  ds_read_b128 v[76:79], v11 offset:14336
  s_waitcnt lgkmcnt(6)
  v_mfma_f32_16x16x32_bf16 v[32:35], a[32:35], v[48:51], v[32:35]
  v_mfma_f32_16x16x32_bf16 v[36:39], a[36:39], v[48:51], v[36:39]
  v_mfma_f32_16x16x32_bf16 v[40:43], a[32:35], v[52:55], v[40:43]
  v_mfma_f32_16x16x32_bf16 v[44:47], a[36:39], v[52:55], v[44:47]
  s_waitcnt lgkmcnt(4)
  v_mfma_f32_16x16x32_bf16 v[32:35], a[40:43], v[56:59], v[32:35]
  v_mfma_f32_16x16x32_bf16 v[36:39], a[44:47], v[56:59], v[36:39]
  s_add_u32 m0, s56, 12288
  s_add_u32 s57, s62, 5767168
  buffer_load_dwordx4 v2, s[44:47], s57 offen lds
  v_mfma_f32_16x16x32_bf16 v[40:43], a[40:43], v[60:63], v[40:43]
  v_mfma_f32_16x16x32_bf16 v[44:47], a[44:47], v[60:63], v[44:47]
  s_waitcnt lgkmcnt(2)
  v_mfma_f32_16x16x32_bf16 v[32:35], a[48:51], v[64:67], v[32:35]
  v_mfma_f32_16x16x32_bf16 v[36:39], a[52:55], v[64:67], v[36:39]
  v_mfma_f32_16x16x32_bf16 v[40:43], a[48:51], v[68:71], v[40:43]
  v_mfma_f32_16x16x32_bf16 v[44:47], a[52:55], v[68:71], v[44:47]
  s_waitcnt lgkmcnt(0)
  v_mfma_f32_16x16x32_bf16 v[32:35], a[56:59], v[72:75], v[32:35]
  v_mfma_f32_16x16x32_bf16 v[36:39], a[60:63], v[72:75], v[36:39]
  v_mfma_f32_16x16x32_bf16 v[40:43], a[56:59], v[76:79], v[40:43]
  v_mfma_f32_16x16x32_bf16 v[44:47], a[60:63], v[76:79], v[44:47]
  s_add_u32 m0, s56, 13312
  s_add_u32 s57, s62, 5898240
  buffer_load_dwordx4 v2, s[44:47], s57 offen lds
  s_waitcnt vmcnt(6)
  ds_read_b64_tr_b16 a[128:129], v3 offset:0
  ds_read_b64_tr_b16 a[130:131], v3 offset:256
  ds_read_b64_tr_b16 a[132:133], v3 offset:32
  ds_read_b64_tr_b16 a[134:135], v3 offset:288
  ds_read_b64_tr_b16 a[136:137], v3 offset:2048
  ds_read_b64_tr_b16 a[138:139], v3 offset:2304
  ds_read_b64_tr_b16 a[140:141], v3 offset:2080
  ds_read_b64_tr_b16 a[142:143], v3 offset:2336
  s_add_u32 m0, s56, 14336
  s_add_u32 s57, s62, 6029312
  buffer_load_dwordx4 v2, s[44:47], s57 offen lds
  ds_read_b64_tr_b16 a[144:145], v3 offset:4096
  ds_read_b64_tr_b16 a[146:147], v3 offset:4352
  ds_read_b64_tr_b16 a[148:149], v3 offset:4128
  ds_read_b64_tr_b16 a[150:151], v3 offset:4384
  ds_read_b64_tr_b16 a[152:153], v3 offset:6144
  ds_read_b64_tr_b16 a[154:155], v3 offset:6400
  ds_read_b64_tr_b16 a[156:157], v3 offset:6176
  ds_read_b64_tr_b16 a[158:159], v3 offset:6432
  s_add_u32 m0, s56, 15360
  s_add_u32 s57, s62, 6160384
  buffer_load_dwordx4 v2, s[44:47], s57 offen lds
  s_waitcnt lgkmcnt(0)
  s_add_u32 m0, s56, 0
  s_add_u32 s57, s62, 6291456
  buffer_load_dwordx4 v2, s[44:47], s57 offen lds
  ds_read_b128 v[48:51], v8 offset:32768
  ds_read_b128 v[52:55], v8 offset:34816
  ds_read_b128 v[56:59], v9 offset:32768
  ds_read_b128 v[60:63], v9 offset:34816
  ds_read_b128 v[64:67], v8 offset:36864
  ds_read_b128 v[68:71], v8 offset:38912
  ds_read_b128 v[72:75], v9 offset:36864
  ds_read_b128 v[76:79], v9 offset:38912
  s_waitcnt lgkmcnt(6)
  v_mfma_f32_16x16x32_bf16 v[16:19], a[128:131], v[48:51], v[16:19]
  v_mfma_f32_16x16x32_bf16 v[20:23], a[132:135], v[48:51], v[20:23]
  s_add_u32 m0, s56, 1024
  s_add_u32 s57, s62, 6422528
  buffer_load_dwordx4 v2, s[44:47], s57 offen lds
  v_mfma_f32_16x16x32_bf16 v[24:27], a[128:131], v[52:55], v[24:27]
  v_mfma_f32_16x16x32_bf16 v[28:31], a[132:135], v[52:55], v[28:31]
  s_waitcnt lgkmcnt(4)
  v_mfma_f32_16x16x32_bf16 v[16:19], a[136:139], v[56:59], v[16:19]
  v_mfma_f32_16x16x32_bf16 v[20:23], a[140:143], v[56:59], v[20:23]
  v_mfma_f32_16x16x32_bf16 v[24:27], a[136:139], v[60:63], v[24:27]
  v_mfma_f32_16x16x32_bf16 v[28:31], a[140:143], v[60:63], v[28:31]
  s_waitcnt lgkmcnt(2)
  v_mfma_f32_16x16x32_bf16 v[16:19], a[144:147], v[64:67], v[16:19]
  v_mfma_f32_16x16x32_bf16 v[20:23], a[148:151], v[64:67], v[20:23]
  v_mfma_f32_16x16x32_bf16 v[24:27], a[144:147], v[68:71], v[24:27]
  s_add_u32 m0, s56, 2048
  s_add_u32 s57, s62, 6553600
  buffer_load_dwordx4 v2, s[44:47], s57 offen lds
  v_mfma_f32_16x16x32_bf16 v[28:31], a[148:151], v[68:71], v[28:31]
  s_waitcnt lgkmcnt(0)
  v_mfma_f32_16x16x32_bf16 v[16:19], a[152:155], v[72:75], v[16:19]
  v_mfma_f32_16x16x32_bf16 v[20:23], a[156:159], v[72:75], v[20:23]
  v_mfma_f32_16x16x32_bf16 v[24:27], a[152:155], v[76:79], v[24:27]
  v_mfma_f32_16x16x32_bf16 v[28:31], a[156:159], v[76:79], v[28:31]
  ds_read_b128 v[48:51], v10 offset:16384
  ds_read_b128 v[52:55], v10 offset:18432
  ds_read_b128 v[56:59], v11 offset:16384
  ds_read_b128 v[60:63], v11 offset:18432
  ds_read_b128 v[64:67], v10 offset:20480
  s_add_u32 m0, s56, 3072
  s_add_u32 s57, s62, 6684672
  buffer_load_dwordx4 v2, s[44:47], s57 offen lds
  ds_read_b128 v[68:71], v10 offset:22528
  ds_read_b128 v[72:75], v11 offset:20480
  ds_read_b128 v[76:79], v11 offset:22528
  s_waitcnt lgkmcnt(6)
  v_mfma_f32_16x16x32_bf16 v[32:35], a[64:67], v[48:51], v[32:35]
  v_mfma_f32_16x16x32_bf16 v[36:39], a[68:71], v[48:51], v[36:39]
  v_mfma_f32_16x16x32_bf16 v[40:43], a[64:67], v[52:55], v[40:43]
  v_mfma_f32_16x16x32_bf16 v[44:47], a[68:71], v[52:55], v[44:47]
  s_waitcnt lgkmcnt(4)
  v_mfma_f32_16x16x32_bf16 v[32:35], a[72:75], v[56:59], v[32:35]
  v_mfma_f32_16x16x32_bf16 v[36:39], a[76:79], v[56:59], v[36:39]
  s_add_u32 m0, s56, 4096
  s_add_u32 s57, s62, 6815744
  buffer_load_dwordx4 v2, s[44:47], s57 offen lds
  v_mfma_f32_16x16x32_bf16 v[40:43], a[72:75], v[60:63], v[40:43]
  v_mfma_f32_16x16x32_bf16 v[44:47], a[76:79], v[60:63], v[44:47]
  s_waitcnt lgkmcnt(2)
  v_mfma_f32_16x16x32_bf16 v[32:35], a[80:83], v[64:67], v[32:35]
  v_mfma_f32_16x16x32_bf16 v[36:39], a[84:87], v[64:67], v[36:39]
  v_mfma_f32_16x16x32_bf16 v[40:43], a[80:83], v[68:71], v[40:43]
  v_mfma_f32_16x16x32_bf16 v[44:47], a[84:87], v[68:71], v[44:47]
  s_waitcnt lgkmcnt(0)
  v_mfma_f32_16x16x32_bf16 v[32:35], a[88:91], v[72:75], v[32:35]
  v_mfma_f32_16x16x32_bf16 v[36:39], a[92:95], v[72:75], v[36:39]
  v_mfma_f32_16x16x32_bf16 v[40:43], a[88:91], v[76:79], v[40:43]
  v_mfma_f32_16x16x32_bf16 v[44:47], a[92:95], v[76:79], v[44:47]
  s_add_u32 m0, s56, 5120
  s_add_u32 s57, s62, 6946816
  buffer_load_dwordx4 v2, s[44:47], s57 offen lds
  s_waitcnt vmcnt(6)
  ds_read_b64_tr_b16 a[160:161], v3 offset:8192
  ds_read_b64_tr_b16 a[162:163], v3 offset:8448
  ds_read_b64_tr_b16 a[164:165], v3 offset:8224
  ds_read_b64_tr_b16 a[166:167], v3 offset:8480
  ds_read_b64_tr_b16 a[168:169], v3 offset:10240
  ds_read_b64_tr_b16 a[170:171], v3 offset:10496
  ds_read_b64_tr_b16 a[172:173], v3 offset:10272
  ds_read_b64_tr_b16 a[174:175], v3 offset:10528
  s_add_u32 m0, s56, 6144
  s_add_u32 s57, s62, 7077888
  buffer_load_dwordx4 v2, s[44:47], s57 offen lds
  ds_read_b64_tr_b16 a[176:177], v3 offset:12288
  ds_read_b64_tr_b16 a[178:179], v3 offset:12544
  ds_read_b64_tr_b16 a[180:181], v3 offset:12320
  ds_read_b64_tr_b16 a[182:183], v3 offset:12576
  ds_read_b64_tr_b16 a[184:185], v3 offset:14336
  ds_read_b64_tr_b16 a[186:187], v3 offset:14592
  ds_read_b64_tr_b16 a[188:189], v3 offset:14368
  ds_read_b64_tr_b16 a[190:191], v3 offset:14624
  s_add_u32 m0, s56, 7168
  s_add_u32 s57, s62, 7208960
  buffer_load_dwordx4 v2, s[44:47], s57 offen lds
  s_waitcnt lgkmcnt(0)
  s_add_u32 m0, s56, 8192
  s_add_u32 s57, s62, 7340032
  buffer_load_dwordx4 v2, s[44:47], s57 offen lds
  ds_read_b128 v[48:51], v8 offset:40960
  ds_read_b128 v[52:55], v8 offset:43008
  ds_read_b128 v[56:59], v9 offset:40960
  ds_read_b128 v[60:63], v9 offset:43008
  ds_read_b128 v[64:67], v8 offset:45056
  ds_read_b128 v[68:71], v8 offset:47104
  ds_read_b128 v[72:75], v9 offset:45056
  ds_read_b128 v[76:79], v9 offset:47104
  s_waitcnt lgkmcnt(6)
  v_mfma_f32_16x16x32_bf16 v[16:19], a[160:163], v[48:51], v[16:19]
  v_mfma_f32_16x16x32_bf16 v[20:23], a[164:167], v[48:51], v[20:23]
  s_add_u32 m0, s56, 9216
  s_add_u32 s57, s62, 7471104
  buffer_load_dwordx4 v2, s[44:47], s57 offen lds
  v_mfma_f32_16x16x32_bf16 v[24:27], a[160:163], v[52:55], v[24:27]
  v_mfma_f32_16x16x32_bf16 v[28:31], a[164:167], v[52:55], v[28:31]
  s_waitcnt lgkmcnt(4)
  v_mfma_f32_16x16x32_bf16 v[16:19], a[168:171], v[56:59], v[16:19]
  v_mfma_f32_16x16x32_bf16 v[20:23], a[172:175], v[56:59], v[20:23]
  v_mfma_f32_16x16x32_bf16 v[24:27], a[168:171], v[60:63], v[24:27]
  v_mfma_f32_16x16x32_bf16 v[28:31], a[172:175], v[60:63], v[28:31]
  s_waitcnt lgkmcnt(2)
  v_mfma_f32_16x16x32_bf16 v[16:19], a[176:179], v[64:67], v[16:19]
  v_mfma_f32_16x16x32_bf16 v[20:23], a[180:183], v[64:67], v[20:23]
  v_mfma_f32_16x16x32_bf16 v[24:27], a[176:179], v[68:71], v[24:27]
  s_add_u32 m0, s56, 10240
  s_add_u32 s57, s62, 7602176
  buffer_load_dwordx4 v2, s[44:47], s57 offen lds
  v_mfma_f32_16x16x32_bf16 v[28:31], a[180:183], v[68:71], v[28:31]
  s_waitcnt lgkmcnt(0)
  v_mfma_f32_16x16x32_bf16 v[16:19], a[184:187], v[72:75], v[16:19]
  v_mfma_f32_16x16x32_bf16 v[20:23], a[188:191], v[72:75], v[20:23]
  v_mfma_f32_16x16x32_bf16 v[24:27], a[184:187], v[76:79], v[24:27]
  v_mfma_f32_16x16x32_bf16 v[28:31], a[188:191], v[76:79], v[28:31]
  ds_read_b128 v[48:51], v10 offset:24576
  ds_read_b128 v[52:55], v10 offset:26624
  ds_read_b128 v[56:59], v11 offset:24576
  ds_read_b128 v[60:63], v11 offset:26624
  ds_read_b128 v[64:67], v10 offset:28672
  s_add_u32 m0, s56, 11264
  s_add_u32 s57, s62, 7733248
  buffer_load_dwordx4 v2, s[44:47], s57 offen lds
  ds_read_b128 v[68:71], v10 offset:30720
  ds_read_b128 v[72:75], v11 offset:28672
  ds_read_b128 v[76:79], v11 offset:30720
  s_waitcnt lgkmcnt(6)
  v_mfma_f32_16x16x32_bf16 v[32:35], a[96:99], v[48:51], v[32:35]
  v_mfma_f32_16x16x32_bf16 v[36:39], a[100:103], v[48:51], v[36:39]
  v_mfma_f32_16x16x32_bf16 v[40:43], a[96:99], v[52:55], v[40:43]
  v_mfma_f32_16x16x32_bf16 v[44:47], a[100:103], v[52:55], v[44:47]
  s_waitcnt lgkmcnt(4)
  v_mfma_f32_16x16x32_bf16 v[32:35], a[104:107], v[56:59], v[32:35]
  v_mfma_f32_16x16x32_bf16 v[36:39], a[108:111], v[56:59], v[36:39]
  s_add_u32 m0, s56, 12288
  s_add_u32 s57, s62, 7864320
  buffer_load_dwordx4 v2, s[44:47], s57 offen lds
  v_mfma_f32_16x16x32_bf16 v[40:43], a[104:107], v[60:63], v[40:43]
  v_mfma_f32_16x16x32_bf16 v[44:47], a[108:111], v[60:63], v[44:47]
  s_waitcnt lgkmcnt(2)
  v_mfma_f32_16x16x32_bf16 v[32:35], a[112:115], v[64:67], v[32:35]
  v_mfma_f32_16x16x32_bf16 v[36:39], a[116:119], v[64:67], v[36:39]
  v_mfma_f32_16x16x32_bf16 v[40:43], a[112:115], v[68:71], v[40:43]
  v_mfma_f32_16x16x32_bf16 v[44:47], a[116:119], v[68:71], v[44:47]
  s_waitcnt lgkmcnt(0)
  v_mfma_f32_16x16x32_bf16 v[32:35], a[120:123], v[72:75], v[32:35]
  v_mfma_f32_16x16x32_bf16 v[36:39], a[124:127], v[72:75], v[36:39]
  v_mfma_f32_16x16x32_bf16 v[40:43], a[120:123], v[76:79], v[40:43]
  v_mfma_f32_16x16x32_bf16 v[44:47], a[124:127], v[76:79], v[44:47]
  s_add_u32 m0, s56, 13312
  s_add_u32 s57, s62, 7995392
  buffer_load_dwordx4 v2, s[44:47], s57 offen lds
  s_waitcnt vmcnt(6)
  ds_read_b64_tr_b16 a[192:193], v3 offset:0
  ds_read_b64_tr_b16 a[194:195], v3 offset:256
  ds_read_b64_tr_b16 a[196:197], v3 offset:32
  ds_read_b64_tr_b16 a[198:199], v3 offset:288
  ds_read_b64_tr_b16 a[200:201], v3 offset:2048
  ds_read_b64_tr_b16 a[202:203], v3 offset:2304
  ds_read_b64_tr_b16 a[204:205], v3 offset:2080
  ds_read_b64_tr_b16 a[206:207], v3 offset:2336
  s_add_u32 m0, s56, 14336
  s_add_u32 s57, s62, 8126464
  buffer_load_dwordx4 v2, s[44:47], s57 offen lds
  ds_read_b64_tr_b16 a[208:209], v3 offset:4096
  ds_read_b64_tr_b16 a[210:211], v3 offset:4352
  ds_read_b64_tr_b16 a[212:213], v3 offset:4128
  ds_read_b64_tr_b16 a[214:215], v3 offset:4384
  ds_read_b64_tr_b16 a[216:217], v3 offset:6144
  ds_read_b64_tr_b16 a[218:219], v3 offset:6400
  ds_read_b64_tr_b16 a[220:221], v3 offset:6176
  ds_read_b64_tr_b16 a[222:223], v3 offset:6432
  s_add_u32 m0, s56, 15360
  s_add_u32 s57, s62, 8257536
  buffer_load_dwordx4 v2, s[44:47], s57 offen lds
  s_waitcnt lgkmcnt(0)
  ds_read_b128 v[48:51], v8 offset:49152
  ds_read_b128 v[52:55], v8 offset:51200
  ds_read_b128 v[56:59], v9 offset:49152
  ds_read_b128 v[60:63], v9 offset:51200
  ds_read_b128 v[64:67], v8 offset:53248
  ds_read_b128 v[68:71], v8 offset:55296
  ds_read_b128 v[72:75], v9 offset:53248
  ds_read_b128 v[76:79], v9 offset:55296
  s_waitcnt lgkmcnt(6)
  v_mfma_f32_16x16x32_bf16 v[16:19], a[192:195], v[48:51], v[16:19]
  v_mfma_f32_16x16x32_bf16 v[20:23], a[196:199], v[48:51], v[20:23]
  v_mfma_f32_16x16x32_bf16 v[24:27], a[192:195], v[52:55], v[24:27]
  v_mfma_f32_16x16x32_bf16 v[28:31], a[196:199], v[52:55], v[28:31]
  s_waitcnt lgkmcnt(4)
  v_mfma_f32_16x16x32_bf16 v[16:19], a[200:203], v[56:59], v[16:19]
  v_mfma_f32_16x16x32_bf16 v[20:23], a[204:207], v[56:59], v[20:23]
  v_mfma_f32_16x16x32_bf16 v[24:27], a[200:203], v[60:63], v[24:27]
  v_mfma_f32_16x16x32_bf16 v[28:31], a[204:207], v[60:63], v[28:31]
  s_waitcnt lgkmcnt(2)
  v_mfma_f32_16x16x32_bf16 v[16:19], a[208:211], v[64:67], v[16:19]
  v_mfma_f32_16x16x32_bf16 v[20:23], a[212:215], v[64:67], v[20:23]
  v_mfma_f32_16x16x32_bf16 v[24:27], a[208:211], v[68:71], v[24:27]
  v_mfma_f32_16x16x32_bf16 v[28:31], a[212:215], v[68:71], v[28:31]
  s_waitcnt lgkmcnt(0)
  v_mfma_f32_16x16x32_bf16 v[16:19], a[216:219], v[72:75], v[16:19]
  v_mfma_f32_16x16x32_bf16 v[20:23], a[220:223], v[72:75], v[20:23]
  v_mfma_f32_16x16x32_bf16 v[24:27], a[216:219], v[76:79], v[24:27]
  v_mfma_f32_16x16x32_bf16 v[28:31], a[220:223], v[76:79], v[28:31]
  s_waitcnt vmcnt(0)
  ds_read_b64_tr_b16 a[224:225], v3 offset:8192
  ds_read_b64_tr_b16 a[226:227], v3 offset:8448
  ds_read_b64_tr_b16 a[228:229], v3 offset:8224
  ds_read_b64_tr_b16 a[230:231], v3 offset:8480
  ds_read_b64_tr_b16 a[232:233], v3 offset:10240
  ds_read_b64_tr_b16 a[234:235], v3 offset:10496
  ds_read_b64_tr_b16 a[236:237], v3 offset:10272
  ds_read_b64_tr_b16 a[238:239], v3 offset:10528
  ds_read_b64_tr_b16 a[240:241], v3 offset:12288
  ds_read_b64_tr_b16 a[242:243], v3 offset:12544
  ds_read_b64_tr_b16 a[244:245], v3 offset:12320
  ds_read_b64_tr_b16 a[246:247], v3 offset:12576
  ds_read_b64_tr_b16 a[248:249], v3 offset:14336
  ds_read_b64_tr_b16 a[250:251], v3 offset:14592
  ds_read_b64_tr_b16 a[252:253], v3 offset:14368
  ds_read_b64_tr_b16 a[254:255], v3 offset:14624
  s_waitcnt lgkmcnt(0)
  s_barrier
  s_add_u32 m0, s61, 97280
  s_nop 0
  buffer_load_dwordx4 v4, s[48:51], s64 offen offset:1024 lds
  s_add_u32 m0, s61, 101248
  s_nop 0
  buffer_load_dwordx4 v4, s[48:51], s64 offen offset:1152 lds
  s_add_u32 m0, s61, 105216
  s_nop 0
  buffer_load_dwordx4 v4, s[48:51], s64 offen offset:1280 lds
  s_add_u32 m0, s61, 109184
  s_nop 0
  buffer_load_dwordx4 v4, s[48:51], s64 offen offset:1408 lds
  s_add_u32 m0, s61, 113152
  s_nop 0
  buffer_load_dwordx4 v4, s[48:51], s64 offen offset:1536 lds
  s_add_u32 m0, s61, 117120
  s_nop 0
  buffer_load_dwordx4 v4, s[48:51], s64 offen offset:1664 lds
  s_add_u32 m0, s61, 121088
  s_nop 0
  buffer_load_dwordx4 v4, s[48:51], s64 offen offset:1792 lds
  s_add_u32 m0, s61, 125056
  s_nop 0
  buffer_load_dwordx4 v4, s[48:51], s64 offen offset:1920 lds
  ds_read_b128 v[48:51], v8 offset:57344
  ds_read_b128 v[52:55], v8 offset:59392
  ds_read_b128 v[56:59], v9 offset:57344
  ds_read_b128 v[60:63], v9 offset:59392
  ds_read_b128 v[64:67], v8 offset:61440
  ds_read_b128 v[68:71], v8 offset:63488
  ds_read_b128 v[72:75], v9 offset:61440
  ds_read_b128 v[76:79], v9 offset:63488
  s_waitcnt lgkmcnt(6)
  v_mfma_f32_16x16x32_bf16 v[16:19], a[224:227], v[48:51], v[16:19]
  v_mfma_f32_16x16x32_bf16 v[20:23], a[228:231], v[48:51], v[20:23]
  v_mfma_f32_16x16x32_bf16 v[24:27], a[224:227], v[52:55], v[24:27]
  v_mfma_f32_16x16x32_bf16 v[28:31], a[228:231], v[52:55], v[28:31]
  s_waitcnt lgkmcnt(4)
  v_mfma_f32_16x16x32_bf16 v[16:19], a[232:235], v[56:59], v[16:19]
  v_mfma_f32_16x16x32_bf16 v[20:23], a[236:239], v[56:59], v[20:23]
  v_mfma_f32_16x16x32_bf16 v[24:27], a[232:235], v[60:63], v[24:27]
  v_mfma_f32_16x16x32_bf16 v[28:31], a[236:239], v[60:63], v[28:31]
  s_waitcnt lgkmcnt(2)
  v_mfma_f32_16x16x32_bf16 v[16:19], a[240:243], v[64:67], v[16:19]
  v_mfma_f32_16x16x32_bf16 v[20:23], a[244:247], v[64:67], v[20:23]
  v_mfma_f32_16x16x32_bf16 v[24:27], a[240:243], v[68:71], v[24:27]
  v_mfma_f32_16x16x32_bf16 v[28:31], a[244:247], v[68:71], v[28:31]
  s_waitcnt lgkmcnt(0)
  v_mfma_f32_16x16x32_bf16 v[16:19], a[248:251], v[72:75], v[16:19]
  v_mfma_f32_16x16x32_bf16 v[20:23], a[252:255], v[72:75], v[20:23]
  v_mfma_f32_16x16x32_bf16 v[24:27], a[248:251], v[76:79], v[24:27]
  v_mfma_f32_16x16x32_bf16 v[28:31], a[252:255], v[76:79], v[28:31]
  s_nop 7
  v_cvt_pk_bf16_f32 v84, v16, v17
  v_cvt_pk_bf16_f32 v85, v18, v19
  v_cvt_pk_bf16_f32 v86, v20, v21
  v_cvt_pk_bf16_f32 v87, v22, v23
  buffer_store_dwordx4 v[84:87], v5, s[52:55], s59 offen offset:0 sc1
  v_cvt_pk_bf16_f32 v88, v24, v25
  v_cvt_pk_bf16_f32 v89, v26, v27
  v_cvt_pk_bf16_f32 v90, v28, v29
  v_cvt_pk_bf16_f32 v91, v30, v31
  buffer_store_dwordx4 v[88:91], v5, s[52:55], s59 offen offset:1024 sc1
  s_mov_b32 s60, 0x10000
  s_mov_b32 s57, 0x20000
  s_mov_b32 s64, 0x30000
  s_waitcnt vmcnt(0)
  s_atomic_add s92, s[34:35], s83
  s_barrier
  ds_read_b128 v[48:51], v10 offset:32768
  ds_read_b128 v[52:55], v10 offset:34816
  ds_read_b128 v[56:59], v11 offset:32768
  ds_read_b128 v[60:63], v11 offset:34816
  ds_read_b128 v[64:67], v10 offset:36864
  ds_read_b128 v[68:71], v10 offset:38912
  s_waitcnt lgkmcnt(4)
  v_mfma_f32_16x16x32_bf16 v[32:35], a[128:131], v[48:51], v[32:35]
  ds_read_b128 v[72:75], v11 offset:36864
  s_add_u32 m0, s61, 0
  v_mfma_f32_16x16x32_bf16 v[36:39], a[132:135], v[48:51], v[36:39]
  buffer_load_dwordx4 v4, s[48:51], s57 offen offset:0 lds
  v_mfma_f32_16x16x32_bf16 v[40:43], a[128:131], v[52:55], v[40:43]
  ds_read_b128 v[76:79], v11 offset:38912
  s_add_u32 m0, s61, 3968
  v_mfma_f32_16x16x32_bf16 v[44:47], a[132:135], v[52:55], v[44:47]
  buffer_load_dwordx4 v4, s[48:51], s57 offen offset:128 lds
  s_waitcnt lgkmcnt(4)
  v_mfma_f32_16x16x32_bf16 v[32:35], a[136:139], v[56:59], v[32:35]
  ds_read_b128 v[48:51], v10 offset:40960
  v_mfma_f32_16x16x32_bf16 v[36:39], a[140:143], v[56:59], v[36:39]
  s_add_u32 m0, s61, 7936
  v_mfma_f32_16x16x32_bf16 v[40:43], a[136:139], v[60:63], v[40:43]
  ds_read_b128 v[52:55], v10 offset:43008
  buffer_load_dwordx4 v4, s[48:51], s57 offen offset:256 lds
  v_mfma_f32_16x16x32_bf16 v[44:47], a[140:143], v[60:63], v[44:47]
  s_add_u32 m0, s61, 11904
  s_waitcnt lgkmcnt(4)
  v_mfma_f32_16x16x32_bf16 v[32:35], a[144:147], v[64:67], v[32:35]
  ds_read_b128 v[56:59], v11 offset:40960
  buffer_load_dwordx4 v4, s[48:51], s57 offen offset:384 lds
  v_mfma_f32_16x16x32_bf16 v[36:39], a[148:151], v[64:67], v[36:39]
  v_mfma_f32_16x16x32_bf16 v[40:43], a[144:147], v[68:71], v[40:43]
  ds_read_b128 v[60:63], v11 offset:43008
  s_add_u32 m0, s61, 15872
  v_mfma_f32_16x16x32_bf16 v[44:47], a[148:151], v[68:71], v[44:47]
  buffer_load_dwordx4 v4, s[48:51], s57 offen offset:512 lds
  s_waitcnt lgkmcnt(4)
  v_mfma_f32_16x16x32_bf16 v[32:35], a[152:155], v[72:75], v[32:35]
  ds_read_b128 v[64:67], v10 offset:45056
  s_add_u32 m0, s61, 19840
  v_mfma_f32_16x16x32_bf16 v[36:39], a[156:159], v[72:75], v[36:39]
  buffer_load_dwordx4 v4, s[48:51], s57 offen offset:640 lds
  v_mfma_f32_16x16x32_bf16 v[40:43], a[152:155], v[76:79], v[40:43]
  ds_read_b128 v[68:71], v10 offset:47104
  v_mfma_f32_16x16x32_bf16 v[44:47], a[156:159], v[76:79], v[44:47]
  s_add_u32 m0, s61, 23808
  s_waitcnt lgkmcnt(4)
  v_mfma_f32_16x16x32_bf16 v[32:35], a[160:163], v[48:51], v[32:35]
  ds_read_b128 v[72:75], v11 offset:45056
  buffer_load_dwordx4 v4, s[48:51], s57 offen offset:768 lds
  v_mfma_f32_16x16x32_bf16 v[36:39], a[164:167], v[48:51], v[36:39]
  s_add_u32 m0, s61, 27776
  v_mfma_f32_16x16x32_bf16 v[40:43], a[160:163], v[52:55], v[40:43]
  ds_read_b128 v[76:79], v11 offset:47104
  buffer_load_dwordx4 v4, s[48:51], s57 offen offset:896 lds
  v_mfma_f32_16x16x32_bf16 v[44:47], a[164:167], v[52:55], v[44:47]
  s_waitcnt lgkmcnt(4)
  v_mfma_f32_16x16x32_bf16 v[32:35], a[168:171], v[56:59], v[32:35]
  ds_read_b128 v[48:51], v10 offset:49152
  s_add_u32 m0, s61, 31744
  v_mfma_f32_16x16x32_bf16 v[36:39], a[172:175], v[56:59], v[36:39]
  buffer_load_dwordx4 v4, s[48:51], s57 offen offset:1024 lds
  v_mfma_f32_16x16x32_bf16 v[40:43], a[168:171], v[60:63], v[40:43]
  ds_read_b128 v[52:55], v10 offset:51200
  s_add_u32 m0, s61, 35712
  v_mfma_f32_16x16x32_bf16 v[44:47], a[172:175], v[60:63], v[44:47]
  buffer_load_dwordx4 v4, s[48:51], s57 offen offset:1152 lds
  s_waitcnt lgkmcnt(4)
  v_mfma_f32_16x16x32_bf16 v[32:35], a[176:179], v[64:67], v[32:35]
  ds_read_b128 v[56:59], v11 offset:49152
  v_mfma_f32_16x16x32_bf16 v[36:39], a[180:183], v[64:67], v[36:39]
  s_add_u32 m0, s61, 39680
  v_mfma_f32_16x16x32_bf16 v[40:43], a[176:179], v[68:71], v[40:43]
  ds_read_b128 v[60:63], v11 offset:51200
  buffer_load_dwordx4 v4, s[48:51], s57 offen offset:1280 lds
  v_mfma_f32_16x16x32_bf16 v[44:47], a[180:183], v[68:71], v[44:47]
  s_add_u32 m0, s61, 43648
  s_waitcnt lgkmcnt(4)
  v_mfma_f32_16x16x32_bf16 v[32:35], a[184:187], v[72:75], v[32:35]
  ds_read_b128 v[64:67], v10 offset:53248
  buffer_load_dwordx4 v4, s[48:51], s57 offen offset:1408 lds
  v_mfma_f32_16x16x32_bf16 v[36:39], a[188:191], v[72:75], v[36:39]
  v_mfma_f32_16x16x32_bf16 v[40:43], a[184:187], v[76:79], v[40:43]
  ds_read_b128 v[68:71], v10 offset:55296
  s_add_u32 m0, s61, 47616
  v_mfma_f32_16x16x32_bf16 v[44:47], a[188:191], v[76:79], v[44:47]
  buffer_load_dwordx4 v4, s[48:51], s57 offen offset:1536 lds
  s_waitcnt vmcnt(9)
  s_barrier
  s_waitcnt lgkmcnt(4)
  v_mfma_f32_16x16x32_bf16 v[32:35], a[192:195], v[48:51], v[32:35]
  ds_read_b128 v[72:75], v11 offset:53248
  s_add_u32 m0, s61, 51584
  v_mfma_f32_16x16x32_bf16 v[36:39], a[196:199], v[48:51], v[36:39]
  buffer_load_dwordx4 v4, s[48:51], s57 offen offset:1664 lds
  v_mfma_f32_16x16x32_bf16 v[40:43], a[192:195], v[52:55], v[40:43]
  ds_read_b128 v[76:79], v11 offset:55296
  v_mfma_f32_16x16x32_bf16 v[44:47], a[196:199], v[52:55], v[44:47]
  s_add_u32 m0, s61, 55552
  s_waitcnt lgkmcnt(4)
  v_mfma_f32_16x16x32_bf16 v[32:35], a[200:203], v[56:59], v[32:35]
  ds_read_b128 v[48:51], v10 offset:57344
  buffer_load_dwordx4 v4, s[48:51], s57 offen offset:1792 lds
  v_mfma_f32_16x16x32_bf16 v[36:39], a[204:207], v[56:59], v[36:39]
  s_add_u32 m0, s61, 59520
  v_mfma_f32_16x16x32_bf16 v[40:43], a[200:203], v[60:63], v[40:43]
  ds_read_b128 v[52:55], v10 offset:59392
  buffer_load_dwordx4 v4, s[48:51], s57 offen offset:1920 lds
  v_mfma_f32_16x16x32_bf16 v[44:47], a[204:207], v[60:63], v[44:47]
  s_waitcnt lgkmcnt(4)
  v_mfma_f32_16x16x32_bf16 v[32:35], a[208:211], v[64:67], v[32:35]
  ds_read_b128 v[56:59], v11 offset:57344
  s_add_u32 m0, s61, 65536
  v_mfma_f32_16x16x32_bf16 v[36:39], a[212:215], v[64:67], v[36:39]
  buffer_load_dwordx4 v4, s[48:51], s64 offen offset:0 lds
  v_mfma_f32_16x16x32_bf16 v[40:43], a[208:211], v[68:71], v[40:43]
  ds_read_b128 v[60:63], v11 offset:59392
  s_add_u32 m0, s61, 69504
  v_mfma_f32_16x16x32_bf16 v[44:47], a[212:215], v[68:71], v[44:47]
  buffer_load_dwordx4 v4, s[48:51], s64 offen offset:128 lds
  s_waitcnt lgkmcnt(4)
  v_mfma_f32_16x16x32_bf16 v[32:35], a[216:219], v[72:75], v[32:35]
  ds_read_b128 v[64:67], v10 offset:61440
  v_mfma_f32_16x16x32_bf16 v[36:39], a[220:223], v[72:75], v[36:39]
  s_add_u32 m0, s61, 73472
  v_mfma_f32_16x16x32_bf16 v[40:43], a[216:219], v[76:79], v[40:43]
  ds_read_b128 v[68:71], v10 offset:63488
  buffer_load_dwordx4 v4, s[48:51], s64 offen offset:256 lds
  v_mfma_f32_16x16x32_bf16 v[44:47], a[220:223], v[76:79], v[44:47]
  s_add_u32 m0, s61, 77440
  s_waitcnt lgkmcnt(4)
  v_mfma_f32_16x16x32_bf16 v[32:35], a[224:227], v[48:51], v[32:35]
  ds_read_b128 v[72:75], v11 offset:61440
  buffer_load_dwordx4 v4, s[48:51], s64 offen offset:384 lds
  v_mfma_f32_16x16x32_bf16 v[36:39], a[228:231], v[48:51], v[36:39]
  v_mfma_f32_16x16x32_bf16 v[40:43], a[224:227], v[52:55], v[40:43]
  ds_read_b128 v[76:79], v11 offset:63488
  s_add_u32 m0, s61, 81408
  v_mfma_f32_16x16x32_bf16 v[44:47], a[228:231], v[52:55], v[44:47]
  buffer_load_dwordx4 v4, s[48:51], s64 offen offset:512 lds
  s_waitcnt lgkmcnt(4)
  v_mfma_f32_16x16x32_bf16 v[32:35], a[232:235], v[56:59], v[32:35]
  ds_read_b128 v[48:51], v8 offset:0
  s_add_u32 m0, s61, 85376
  v_mfma_f32_16x16x32_bf16 v[36:39], a[236:239], v[56:59], v[36:39]
  buffer_load_dwordx4 v4, s[48:51], s64 offen offset:640 lds
  v_mfma_f32_16x16x32_bf16 v[40:43], a[232:235], v[60:63], v[40:43]
  ds_read_b128 v[52:55], v8 offset:2048
  v_mfma_f32_16x16x32_bf16 v[44:47], a[236:239], v[60:63], v[44:47]
  s_add_u32 m0, s61, 89344
  s_waitcnt lgkmcnt(4)
  v_mfma_f32_16x16x32_bf16 v[32:35], a[240:243], v[64:67], v[32:35]
  ds_read_b128 v[56:59], v9 offset:0
  buffer_load_dwordx4 v4, s[48:51], s64 offen offset:768 lds
  v_mfma_f32_16x16x32_bf16 v[36:39], a[244:247], v[64:67], v[36:39]
  s_add_u32 m0, s61, 93312
  v_mfma_f32_16x16x32_bf16 v[40:43], a[240:243], v[68:71], v[40:43]
  ds_read_b128 v[60:63], v9 offset:2048
  buffer_load_dwordx4 v4, s[48:51], s64 offen offset:896 lds
  v_mfma_f32_16x16x32_bf16 v[44:47], a[244:247], v[68:71], v[44:47]
  s_waitcnt lgkmcnt(4)
  v_mfma_f32_16x16x32_bf16 v[32:35], a[248:251], v[72:75], v[32:35]
  ds_read_b128 v[64:67], v8 offset:4096
  v_mfma_f32_16x16x32_bf16 v[36:39], a[252:255], v[72:75], v[36:39]
  buffer_load_dword v7, v6, s[48:51], s60 offen
  v_mfma_f32_16x16x32_bf16 v[40:43], a[248:251], v[76:79], v[40:43]
  ds_read_b128 v[68:71], v8 offset:6144
  s_mov_b32 s59, 262144
  s_mov_b32 s58, 2
  s_mov_b32 s60, 0x20000
  v_mfma_f32_16x16x32_bf16 v[44:47], a[252:255], v[76:79], v[44:47]
  s_cmp_eq_u32 s37, 5
  s_cbranch_scc1 L_qa
L_p_loopK:
  s_waitcnt vmcnt(16)
  s_barrier
  s_add_u32 s57, s60, 0x10000
  s_waitcnt lgkmcnt(4)
  v_mfma_f32_16x16x32_bf16 v[16:19], a[0:3], v[48:51], 0
  ds_read_b128 v[72:75], v9 offset:4096
  v_mfma_f32_16x16x32_bf16 v[20:23], a[4:7], v[48:51], 0
  buffer_load_dword v7, v6, s[48:51], s60 offen
  v_mfma_f32_16x16x32_bf16 v[24:27], a[0:3], v[52:55], 0
  ds_read_b128 v[76:79], v9 offset:6144
  s_cmp_eq_u32 s58, 8
  s_cbranch_scc1 L_em_20_s
L_em_20:
  v_mfma_f32_16x16x32_bf16 v[28:31], a[4:7], v[52:55], 0
  s_waitcnt lgkmcnt(4)
  v_mfma_f32_16x16x32_bf16 v[16:19], a[8:11], v[56:59], v[16:19]
  ds_read_b128 v[48:51], v8 offset:8192
  s_add_u32 m0, s61, 97280
  v_mfma_f32_16x16x32_bf16 v[20:23], a[12:15], v[56:59], v[20:23]
  buffer_load_dwordx4 v4, s[48:51], s57 offen offset:1024 lds
  v_cvt_pk_bf16_f32 v84, v32, v33
  v_mfma_f32_16x16x32_bf16 v[24:27], a[8:11], v[60:63], v[24:27]
  ds_read_b128 v[52:55], v8 offset:10240
  v_cvt_pk_bf16_f32 v85, v34, v35
  v_mfma_f32_16x16x32_bf16 v[28:31], a[12:15], v[60:63], v[28:31]
  v_cvt_pk_bf16_f32 v86, v36, v37
  s_waitcnt lgkmcnt(4)
  v_mfma_f32_16x16x32_bf16 v[16:19], a[16:19], v[64:67], v[16:19]
  ds_read_b128 v[56:59], v9 offset:8192
  v_cvt_pk_bf16_f32 v87, v38, v39
  v_mfma_f32_16x16x32_bf16 v[20:23], a[20:23], v[64:67], v[20:23]
  buffer_store_dwordx4 v[84:87], v5, s[52:55], s59 offen offset:0 sc1
  v_mfma_f32_16x16x32_bf16 v[24:27], a[16:19], v[68:71], v[24:27]
  ds_read_b128 v[60:63], v9 offset:10240
  v_mfma_f32_16x16x32_bf16 v[28:31], a[20:23], v[68:71], v[28:31]
  s_waitcnt lgkmcnt(4)
  v_mfma_f32_16x16x32_bf16 v[16:19], a[24:27], v[72:75], v[16:19]
  ds_read_b128 v[64:67], v8 offset:12288
  s_add_u32 m0, s61, 101248
  v_mfma_f32_16x16x32_bf16 v[20:23], a[28:31], v[72:75], v[20:23]
  buffer_load_dwordx4 v4, s[48:51], s57 offen offset:1152 lds
  v_cvt_pk_bf16_f32 v88, v40, v41
  v_mfma_f32_16x16x32_bf16 v[24:27], a[24:27], v[76:79], v[24:27]
  ds_read_b128 v[68:71], v8 offset:14336
  v_cvt_pk_bf16_f32 v89, v42, v43
  v_mfma_f32_16x16x32_bf16 v[28:31], a[28:31], v[76:79], v[28:31]
  v_cvt_pk_bf16_f32 v90, v44, v45
  s_waitcnt lgkmcnt(4)
  v_mfma_f32_16x16x32_bf16 v[16:19], a[32:35], v[48:51], v[16:19]
  ds_read_b128 v[72:75], v9 offset:12288
  v_cvt_pk_bf16_f32 v91, v46, v47
  v_mfma_f32_16x16x32_bf16 v[20:23], a[36:39], v[48:51], v[20:23]
  buffer_store_dwordx4 v[88:91], v5, s[52:55], s59 offen offset:1024 sc1
  v_mfma_f32_16x16x32_bf16 v[24:27], a[32:35], v[52:55], v[24:27]
  ds_read_b128 v[76:79], v9 offset:14336
  v_mfma_f32_16x16x32_bf16 v[28:31], a[36:39], v[52:55], v[28:31]
  s_waitcnt lgkmcnt(4)
  v_mfma_f32_16x16x32_bf16 v[16:19], a[40:43], v[56:59], v[16:19]
  ds_read_b128 v[48:51], v8 offset:16384
  s_add_u32 m0, s61, 105216
  v_mfma_f32_16x16x32_bf16 v[20:23], a[44:47], v[56:59], v[20:23]
  buffer_load_dwordx4 v4, s[48:51], s57 offen offset:1280 lds
  v_mfma_f32_16x16x32_bf16 v[24:27], a[40:43], v[60:63], v[24:27]
  ds_read_b128 v[52:55], v8 offset:18432
  v_mfma_f32_16x16x32_bf16 v[28:31], a[44:47], v[60:63], v[28:31]
  s_waitcnt lgkmcnt(4)
  v_mfma_f32_16x16x32_bf16 v[16:19], a[48:51], v[64:67], v[16:19]
  ds_read_b128 v[56:59], v9 offset:16384
  v_mfma_f32_16x16x32_bf16 v[20:23], a[52:55], v[64:67], v[20:23]
  v_mfma_f32_16x16x32_bf16 v[24:27], a[48:51], v[68:71], v[24:27]
  ds_read_b128 v[60:63], v9 offset:18432
  v_mfma_f32_16x16x32_bf16 v[28:31], a[52:55], v[68:71], v[28:31]
  s_waitcnt lgkmcnt(4)
  v_mfma_f32_16x16x32_bf16 v[16:19], a[56:59], v[72:75], v[16:19]
  ds_read_b128 v[64:67], v8 offset:20480
  s_add_u32 m0, s61, 109184
  v_mfma_f32_16x16x32_bf16 v[20:23], a[60:63], v[72:75], v[20:23]
  buffer_load_dwordx4 v4, s[48:51], s57 offen offset:1408 lds
  v_mfma_f32_16x16x32_bf16 v[24:27], a[56:59], v[76:79], v[24:27]
  ds_read_b128 v[68:71], v8 offset:22528
  v_mfma_f32_16x16x32_bf16 v[28:31], a[60:63], v[76:79], v[28:31]
  s_waitcnt vmcnt(16)
  s_barrier
  s_waitcnt lgkmcnt(4)
  v_mfma_f32_16x16x32_bf16 v[16:19], a[64:67], v[48:51], v[16:19]
  ds_read_b128 v[72:75], v9 offset:20480
  v_mfma_f32_16x16x32_bf16 v[20:23], a[68:71], v[48:51], v[20:23]
  v_mfma_f32_16x16x32_bf16 v[24:27], a[64:67], v[52:55], v[24:27]
  ds_read_b128 v[76:79], v9 offset:22528
  v_mfma_f32_16x16x32_bf16 v[28:31], a[68:71], v[52:55], v[28:31]
  s_waitcnt lgkmcnt(4)
  v_mfma_f32_16x16x32_bf16 v[16:19], a[72:75], v[56:59], v[16:19]
  ds_read_b128 v[48:51], v8 offset:24576
  s_add_u32 m0, s61, 113152
  v_mfma_f32_16x16x32_bf16 v[20:23], a[76:79], v[56:59], v[20:23]
  buffer_load_dwordx4 v4, s[48:51], s57 offen offset:1536 lds
  v_mfma_f32_16x16x32_bf16 v[24:27], a[72:75], v[60:63], v[24:27]
  ds_read_b128 v[52:55], v8 offset:26624
  v_mfma_f32_16x16x32_bf16 v[28:31], a[76:79], v[60:63], v[28:31]
  s_waitcnt lgkmcnt(4)
  v_mfma_f32_16x16x32_bf16 v[16:19], a[80:83], v[64:67], v[16:19]
  ds_read_b128 v[56:59], v9 offset:24576
  v_mfma_f32_16x16x32_bf16 v[20:23], a[84:87], v[64:67], v[20:23]
  v_mfma_f32_16x16x32_bf16 v[24:27], a[80:83], v[68:71], v[24:27]
  ds_read_b128 v[60:63], v9 offset:26624
  v_mfma_f32_16x16x32_bf16 v[28:31], a[84:87], v[68:71], v[28:31]
  s_waitcnt lgkmcnt(4)
  v_mfma_f32_16x16x32_bf16 v[16:19], a[88:91], v[72:75], v[16:19]
  ds_read_b128 v[64:67], v8 offset:28672
  s_add_u32 m0, s61, 117120
  v_mfma_f32_16x16x32_bf16 v[20:23], a[92:95], v[72:75], v[20:23]
  buffer_load_dwordx4 v4, s[48:51], s57 offen offset:1664 lds
  v_mfma_f32_16x16x32_bf16 v[24:27], a[88:91], v[76:79], v[24:27]
  ds_read_b128 v[68:71], v8 offset:30720
  v_mfma_f32_16x16x32_bf16 v[28:31], a[92:95], v[76:79], v[28:31]
  s_waitcnt lgkmcnt(4)
  v_mfma_f32_16x16x32_bf16 v[16:19], a[96:99], v[48:51], v[16:19]
  ds_read_b128 v[72:75], v9 offset:28672
  v_mfma_f32_16x16x32_bf16 v[20:23], a[100:103], v[48:51], v[20:23]
  v_mfma_f32_16x16x32_bf16 v[24:27], a[96:99], v[52:55], v[24:27]
  ds_read_b128 v[76:79], v9 offset:30720
  v_mfma_f32_16x16x32_bf16 v[28:31], a[100:103], v[52:55], v[28:31]
  s_waitcnt lgkmcnt(4)
  v_mfma_f32_16x16x32_bf16 v[16:19], a[104:107], v[56:59], v[16:19]
  ds_read_b128 v[48:51], v8 offset:32768
  s_add_u32 m0, s61, 121088
  v_mfma_f32_16x16x32_bf16 v[20:23], a[108:111], v[56:59], v[20:23]
  buffer_load_dwordx4 v4, s[48:51], s57 offen offset:1792 lds
  v_mfma_f32_16x16x32_bf16 v[24:27], a[104:107], v[60:63], v[24:27]
  ds_read_b128 v[52:55], v8 offset:34816
  v_mfma_f32_16x16x32_bf16 v[28:31], a[108:111], v[60:63], v[28:31]
  s_waitcnt lgkmcnt(4)
  v_mfma_f32_16x16x32_bf16 v[16:19], a[112:115], v[64:67], v[16:19]
  ds_read_b128 v[56:59], v9 offset:32768
  v_mfma_f32_16x16x32_bf16 v[20:23], a[116:119], v[64:67], v[20:23]
  v_mfma_f32_16x16x32_bf16 v[24:27], a[112:115], v[68:71], v[24:27]
  ds_read_b128 v[60:63], v9 offset:34816
  v_mfma_f32_16x16x32_bf16 v[28:31], a[116:119], v[68:71], v[28:31]
  s_waitcnt lgkmcnt(4)
  v_mfma_f32_16x16x32_bf16 v[16:19], a[120:123], v[72:75], v[16:19]
  ds_read_b128 v[64:67], v8 offset:36864
  s_add_u32 m0, s61, 125056
  v_mfma_f32_16x16x32_bf16 v[20:23], a[124:127], v[72:75], v[20:23]
  buffer_load_dwordx4 v4, s[48:51], s57 offen offset:1920 lds
  v_mfma_f32_16x16x32_bf16 v[24:27], a[120:123], v[76:79], v[24:27]
  ds_read_b128 v[68:71], v8 offset:38912
  v_mfma_f32_16x16x32_bf16 v[28:31], a[124:127], v[76:79], v[28:31]
  s_waitcnt vmcnt(16)
  s_barrier
  s_add_u32 s57, s60, 0x20000
  s_waitcnt lgkmcnt(4)
  v_mfma_f32_16x16x32_bf16 v[16:19], a[128:131], v[48:51], v[16:19]
  ds_read_b128 v[72:75], v9 offset:36864
  v_mfma_f32_16x16x32_bf16 v[20:23], a[132:135], v[48:51], v[20:23]
  s_waitcnt vmcnt(6)
  s_atomic_add s92, s[34:35], s83
  v_mfma_f32_16x16x32_bf16 v[24:27], a[128:131], v[52:55], v[24:27]
  ds_read_b128 v[76:79], v9 offset:38912
  v_mfma_f32_16x16x32_bf16 v[28:31], a[132:135], v[52:55], v[28:31]
  s_waitcnt lgkmcnt(4)
  v_mfma_f32_16x16x32_bf16 v[16:19], a[136:139], v[56:59], v[16:19]
  ds_read_b128 v[48:51], v8 offset:40960
  s_add_u32 m0, s61, 0
  v_mfma_f32_16x16x32_bf16 v[20:23], a[140:143], v[56:59], v[20:23]
  buffer_load_dwordx4 v4, s[48:51], s57 offen offset:0 lds
  v_mfma_f32_16x16x32_bf16 v[24:27], a[136:139], v[60:63], v[24:27]
  ds_read_b128 v[52:55], v8 offset:43008
  v_mfma_f32_16x16x32_bf16 v[28:31], a[140:143], v[60:63], v[28:31]
  s_waitcnt lgkmcnt(4)
  v_mfma_f32_16x16x32_bf16 v[16:19], a[144:147], v[64:67], v[16:19]
  ds_read_b128 v[56:59], v9 offset:40960
  v_mfma_f32_16x16x32_bf16 v[20:23], a[148:151], v[64:67], v[20:23]
  v_mfma_f32_16x16x32_bf16 v[24:27], a[144:147], v[68:71], v[24:27]
  ds_read_b128 v[60:63], v9 offset:43008
  v_mfma_f32_16x16x32_bf16 v[28:31], a[148:151], v[68:71], v[28:31]
  s_waitcnt lgkmcnt(4)
  v_mfma_f32_16x16x32_bf16 v[16:19], a[152:155], v[72:75], v[16:19]
  ds_read_b128 v[64:67], v8 offset:45056
  s_add_u32 m0, s61, 3968
  v_mfma_f32_16x16x32_bf16 v[20:23], a[156:159], v[72:75], v[20:23]
  buffer_load_dwordx4 v4, s[48:51], s57 offen offset:128 lds
  v_mfma_f32_16x16x32_bf16 v[24:27], a[152:155], v[76:79], v[24:27]
  ds_read_b128 v[68:71], v8 offset:47104
  v_mfma_f32_16x16x32_bf16 v[28:31], a[156:159], v[76:79], v[28:31]
  s_waitcnt lgkmcnt(4)
  v_mfma_f32_16x16x32_bf16 v[16:19], a[160:163], v[48:51], v[16:19]
  ds_read_b128 v[72:75], v9 offset:45056
  v_mfma_f32_16x16x32_bf16 v[20:23], a[164:167], v[48:51], v[20:23]
  v_mfma_f32_16x16x32_bf16 v[24:27], a[160:163], v[52:55], v[24:27]
  ds_read_b128 v[76:79], v9 offset:47104
  v_mfma_f32_16x16x32_bf16 v[28:31], a[164:167], v[52:55], v[28:31]
  s_waitcnt lgkmcnt(4)
  v_mfma_f32_16x16x32_bf16 v[16:19], a[168:171], v[56:59], v[16:19]
  ds_read_b128 v[48:51], v8 offset:49152
  s_add_u32 m0, s61, 7936
  v_mfma_f32_16x16x32_bf16 v[20:23], a[172:175], v[56:59], v[20:23]
  buffer_load_dwordx4 v4, s[48:51], s57 offen offset:256 lds
  v_mfma_f32_16x16x32_bf16 v[24:27], a[168:171], v[60:63], v[24:27]
  ds_read_b128 v[52:55], v8 offset:51200
  v_mfma_f32_16x16x32_bf16 v[28:31], a[172:175], v[60:63], v[28:31]
  s_waitcnt lgkmcnt(4)
  v_mfma_f32_16x16x32_bf16 v[16:19], a[176:179], v[64:67], v[16:19]
  ds_read_b128 v[56:59], v9 offset:49152
  v_mfma_f32_16x16x32_bf16 v[20:23], a[180:183], v[64:67], v[20:23]
  v_mfma_f32_16x16x32_bf16 v[24:27], a[176:179], v[68:71], v[24:27]
  ds_read_b128 v[60:63], v9 offset:51200
  v_mfma_f32_16x16x32_bf16 v[28:31], a[180:183], v[68:71], v[28:31]
  s_waitcnt lgkmcnt(4)
  v_mfma_f32_16x16x32_bf16 v[16:19], a[184:187], v[72:75], v[16:19]
  ds_read_b128 v[64:67], v8 offset:53248
  s_add_u32 m0, s61, 11904
  v_mfma_f32_16x16x32_bf16 v[20:23], a[188:191], v[72:75], v[20:23]
  buffer_load_dwordx4 v4, s[48:51], s57 offen offset:384 lds
  v_mfma_f32_16x16x32_bf16 v[24:27], a[184:187], v[76:79], v[24:27]
  ds_read_b128 v[68:71], v8 offset:55296
  v_mfma_f32_16x16x32_bf16 v[28:31], a[188:191], v[76:79], v[28:31]
  s_waitcnt vmcnt(16)
  s_barrier
  s_waitcnt lgkmcnt(4)
  v_mfma_f32_16x16x32_bf16 v[16:19], a[192:195], v[48:51], v[16:19]
  ds_read_b128 v[72:75], v9 offset:53248
  v_mfma_f32_16x16x32_bf16 v[20:23], a[196:199], v[48:51], v[20:23]
  v_mfma_f32_16x16x32_bf16 v[24:27], a[192:195], v[52:55], v[24:27]
  ds_read_b128 v[76:79], v9 offset:55296
  v_mfma_f32_16x16x32_bf16 v[28:31], a[196:199], v[52:55], v[28:31]
  s_waitcnt lgkmcnt(4)
  v_mfma_f32_16x16x32_bf16 v[16:19], a[200:203], v[56:59], v[16:19]
  ds_read_b128 v[48:51], v8 offset:57344
  s_add_u32 m0, s61, 15872
  v_mfma_f32_16x16x32_bf16 v[20:23], a[204:207], v[56:59], v[20:23]
  buffer_load_dwordx4 v4, s[48:51], s57 offen offset:512 lds
  v_mfma_f32_16x16x32_bf16 v[24:27], a[200:203], v[60:63], v[24:27]
  ds_read_b128 v[52:55], v8 offset:59392
  v_mfma_f32_16x16x32_bf16 v[28:31], a[204:207], v[60:63], v[28:31]
  s_waitcnt lgkmcnt(4)
  v_mfma_f32_16x16x32_bf16 v[16:19], a[208:211], v[64:67], v[16:19]
  ds_read_b128 v[56:59], v9 offset:57344
  v_mfma_f32_16x16x32_bf16 v[20:23], a[212:215], v[64:67], v[20:23]
  v_mfma_f32_16x16x32_bf16 v[24:27], a[208:211], v[68:71], v[24:27]
  ds_read_b128 v[60:63], v9 offset:59392
  v_mfma_f32_16x16x32_bf16 v[28:31], a[212:215], v[68:71], v[28:31]
  s_waitcnt lgkmcnt(4)
  v_mfma_f32_16x16x32_bf16 v[16:19], a[216:219], v[72:75], v[16:19]
  ds_read_b128 v[64:67], v8 offset:61440
  s_add_u32 m0, s61, 19840
  v_mfma_f32_16x16x32_bf16 v[20:23], a[220:223], v[72:75], v[20:23]
  buffer_load_dwordx4 v4, s[48:51], s57 offen offset:640 lds
  v_mfma_f32_16x16x32_bf16 v[24:27], a[216:219], v[76:79], v[24:27]
  ds_read_b128 v[68:71], v8 offset:63488
  v_mfma_f32_16x16x32_bf16 v[28:31], a[220:223], v[76:79], v[28:31]
  s_waitcnt lgkmcnt(4)
  v_mfma_f32_16x16x32_bf16 v[16:19], a[224:227], v[48:51], v[16:19]
  ds_read_b128 v[72:75], v9 offset:61440
  v_mfma_f32_16x16x32_bf16 v[20:23], a[228:231], v[48:51], v[20:23]
  v_mfma_f32_16x16x32_bf16 v[24:27], a[224:227], v[52:55], v[24:27]
  ds_read_b128 v[76:79], v9 offset:63488
  v_mfma_f32_16x16x32_bf16 v[28:31], a[228:231], v[52:55], v[28:31]
  s_waitcnt lgkmcnt(4)
  v_mfma_f32_16x16x32_bf16 v[16:19], a[232:235], v[56:59], v[16:19]
  ds_read_b128 v[48:51], v10 offset:0
  s_add_u32 m0, s61, 23808
  v_mfma_f32_16x16x32_bf16 v[20:23], a[236:239], v[56:59], v[20:23]
  buffer_load_dwordx4 v4, s[48:51], s57 offen offset:768 lds
  v_mfma_f32_16x16x32_bf16 v[24:27], a[232:235], v[60:63], v[24:27]
  ds_read_b128 v[52:55], v10 offset:2048
  v_mfma_f32_16x16x32_bf16 v[28:31], a[236:239], v[60:63], v[28:31]
  s_waitcnt lgkmcnt(4)
  v_mfma_f32_16x16x32_bf16 v[16:19], a[240:243], v[64:67], v[16:19]
  ds_read_b128 v[56:59], v11 offset:0
  v_mfma_f32_16x16x32_bf16 v[20:23], a[244:247], v[64:67], v[20:23]
  s_lshl_b32 s59, s58, 18
  s_add_u32 s58, s58, 1
  v_mfma_f32_16x16x32_bf16 v[24:27], a[240:243], v[68:71], v[24:27]
  ds_read_b128 v[60:63], v11 offset:2048
  v_mfma_f32_16x16x32_bf16 v[28:31], a[244:247], v[68:71], v[28:31]
  s_waitcnt lgkmcnt(4)
  v_mfma_f32_16x16x32_bf16 v[16:19], a[248:251], v[72:75], v[16:19]
  ds_read_b128 v[64:67], v10 offset:4096
  s_add_u32 m0, s61, 27776
  v_mfma_f32_16x16x32_bf16 v[20:23], a[252:255], v[72:75], v[20:23]
  buffer_load_dwordx4 v4, s[48:51], s57 offen offset:896 lds
  v_mfma_f32_16x16x32_bf16 v[24:27], a[248:251], v[76:79], v[24:27]
  ds_read_b128 v[68:71], v10 offset:6144
  s_add_u32 s60, s60, 0x10000
  v_mfma_f32_16x16x32_bf16 v[28:31], a[252:255], v[76:79], v[28:31]
  s_waitcnt vmcnt(16)
  s_barrier
  s_add_u32 s57, s60, 0x10000
  s_waitcnt lgkmcnt(4)
  v_mfma_f32_16x16x32_bf16 v[32:35], a[0:3], v[48:51], 0
  ds_read_b128 v[72:75], v11 offset:4096
  v_mfma_f32_16x16x32_bf16 v[36:39], a[4:7], v[48:51], 0
  buffer_load_dword v7, v6, s[48:51], s60 offen
  v_mfma_f32_16x16x32_bf16 v[40:43], a[0:3], v[52:55], 0
  ds_read_b128 v[76:79], v11 offset:6144
  v_mfma_f32_16x16x32_bf16 v[44:47], a[4:7], v[52:55], 0
  s_waitcnt lgkmcnt(4)
  v_mfma_f32_16x16x32_bf16 v[32:35], a[8:11], v[56:59], v[32:35]
  ds_read_b128 v[48:51], v10 offset:8192
  s_add_u32 m0, s61, 31744
  v_mfma_f32_16x16x32_bf16 v[36:39], a[12:15], v[56:59], v[36:39]
  buffer_load_dwordx4 v4, s[48:51], s57 offen offset:1024 lds
  v_cvt_pk_bf16_f32 v84, v16, v17
  v_mfma_f32_16x16x32_bf16 v[40:43], a[8:11], v[60:63], v[40:43]
  ds_read_b128 v[52:55], v10 offset:10240
  v_cvt_pk_bf16_f32 v85, v18, v19
  v_mfma_f32_16x16x32_bf16 v[44:47], a[12:15], v[60:63], v[44:47]
  v_cvt_pk_bf16_f32 v86, v20, v21
  s_waitcnt lgkmcnt(4)
  v_mfma_f32_16x16x32_bf16 v[32:35], a[16:19], v[64:67], v[32:35]
  ds_read_b128 v[56:59], v11 offset:8192
  v_cvt_pk_bf16_f32 v87, v22, v23
  v_mfma_f32_16x16x32_bf16 v[36:39], a[20:23], v[64:67], v[36:39]
  buffer_store_dwordx4 v[84:87], v5, s[52:55], s59 offen offset:0 sc1
  v_mfma_f32_16x16x32_bf16 v[40:43], a[16:19], v[68:71], v[40:43]
  ds_read_b128 v[60:63], v11 offset:10240
  v_mfma_f32_16x16x32_bf16 v[44:47], a[20:23], v[68:71], v[44:47]
  s_waitcnt lgkmcnt(4)
  v_mfma_f32_16x16x32_bf16 v[32:35], a[24:27], v[72:75], v[32:35]
  ds_read_b128 v[64:67], v10 offset:12288
  s_add_u32 m0, s61, 35712
  v_mfma_f32_16x16x32_bf16 v[36:39], a[28:31], v[72:75], v[36:39]
  buffer_load_dwordx4 v4, s[48:51], s57 offen offset:1152 lds
  v_cvt_pk_bf16_f32 v88, v24, v25
  v_mfma_f32_16x16x32_bf16 v[40:43], a[24:27], v[76:79], v[40:43]
  ds_read_b128 v[68:71], v10 offset:14336
  v_cvt_pk_bf16_f32 v89, v26, v27
  v_mfma_f32_16x16x32_bf16 v[44:47], a[28:31], v[76:79], v[44:47]
  v_cvt_pk_bf16_f32 v90, v28, v29
  s_waitcnt lgkmcnt(4)
  v_mfma_f32_16x16x32_bf16 v[32:35], a[32:35], v[48:51], v[32:35]
  ds_read_b128 v[72:75], v11 offset:12288
  v_cvt_pk_bf16_f32 v91, v30, v31
  v_mfma_f32_16x16x32_bf16 v[36:39], a[36:39], v[48:51], v[36:39]
  buffer_store_dwordx4 v[88:91], v5, s[52:55], s59 offen offset:1024 sc1
  v_mfma_f32_16x16x32_bf16 v[40:43], a[32:35], v[52:55], v[40:43]
  ds_read_b128 v[76:79], v11 offset:14336
  v_mfma_f32_16x16x32_bf16 v[44:47], a[36:39], v[52:55], v[44:47]
  s_waitcnt lgkmcnt(4)
  v_mfma_f32_16x16x32_bf16 v[32:35], a[40:43], v[56:59], v[32:35]
  ds_read_b128 v[48:51], v10 offset:16384
  s_add_u32 m0, s61, 39680
  v_mfma_f32_16x16x32_bf16 v[36:39], a[44:47], v[56:59], v[36:39]
  buffer_load_dwordx4 v4, s[48:51], s57 offen offset:1280 lds
  v_mfma_f32_16x16x32_bf16 v[40:43], a[40:43], v[60:63], v[40:43]
  ds_read_b128 v[52:55], v10 offset:18432
  v_mfma_f32_16x16x32_bf16 v[44:47], a[44:47], v[60:63], v[44:47]
  s_waitcnt lgkmcnt(4)
  v_mfma_f32_16x16x32_bf16 v[32:35], a[48:51], v[64:67], v[32:35]
  ds_read_b128 v[56:59], v11 offset:16384
  v_mfma_f32_16x16x32_bf16 v[36:39], a[52:55], v[64:67], v[36:39]
  v_mfma_f32_16x16x32_bf16 v[40:43], a[48:51], v[68:71], v[40:43]
  ds_read_b128 v[60:63], v11 offset:18432
  v_mfma_f32_16x16x32_bf16 v[44:47], a[52:55], v[68:71], v[44:47]
  s_waitcnt lgkmcnt(4)
  v_mfma_f32_16x16x32_bf16 v[32:35], a[56:59], v[72:75], v[32:35]
  ds_read_b128 v[64:67], v10 offset:20480
  s_add_u32 m0, s61, 43648
  v_mfma_f32_16x16x32_bf16 v[36:39], a[60:63], v[72:75], v[36:39]
  buffer_load_dwordx4 v4, s[48:51], s57 offen offset:1408 lds
  v_mfma_f32_16x16x32_bf16 v[40:43], a[56:59], v[76:79], v[40:43]
  ds_read_b128 v[68:71], v10 offset:22528
  v_mfma_f32_16x16x32_bf16 v[44:47], a[60:63], v[76:79], v[44:47]
  s_waitcnt vmcnt(16)
  s_barrier
  s_waitcnt lgkmcnt(4)
  v_mfma_f32_16x16x32_bf16 v[32:35], a[64:67], v[48:51], v[32:35]
  ds_read_b128 v[72:75], v11 offset:20480
  v_mfma_f32_16x16x32_bf16 v[36:39], a[68:71], v[48:51], v[36:39]
  v_mfma_f32_16x16x32_bf16 v[40:43], a[64:67], v[52:55], v[40:43]
  ds_read_b128 v[76:79], v11 offset:22528
  v_mfma_f32_16x16x32_bf16 v[44:47], a[68:71], v[52:55], v[44:47]
  s_waitcnt lgkmcnt(4)
  v_mfma_f32_16x16x32_bf16 v[32:35], a[72:75], v[56:59], v[32:35]
  ds_read_b128 v[48:51], v10 offset:24576
  s_add_u32 m0, s61, 47616
  v_mfma_f32_16x16x32_bf16 v[36:39], a[76:79], v[56:59], v[36:39]
  buffer_load_dwordx4 v4, s[48:51], s57 offen offset:1536 lds
  v_mfma_f32_16x16x32_bf16 v[40:43], a[72:75], v[60:63], v[40:43]
  ds_read_b128 v[52:55], v10 offset:26624
  v_mfma_f32_16x16x32_bf16 v[44:47], a[76:79], v[60:63], v[44:47]
  s_waitcnt lgkmcnt(4)
  v_mfma_f32_16x16x32_bf16 v[32:35], a[80:83], v[64:67], v[32:35]
  ds_read_b128 v[56:59], v11 offset:24576
  v_mfma_f32_16x16x32_bf16 v[36:39], a[84:87], v[64:67], v[36:39]
  v_mfma_f32_16x16x32_bf16 v[40:43], a[80:83], v[68:71], v[40:43]
  ds_read_b128 v[60:63], v11 offset:26624
  v_mfma_f32_16x16x32_bf16 v[44:47], a[84:87], v[68:71], v[44:47]
  s_waitcnt lgkmcnt(4)
  v_mfma_f32_16x16x32_bf16 v[32:35], a[88:91], v[72:75], v[32:35]
  ds_read_b128 v[64:67], v10 offset:28672
  s_add_u32 m0, s61, 51584
  v_mfma_f32_16x16x32_bf16 v[36:39], a[92:95], v[72:75], v[36:39]
  buffer_load_dwordx4 v4, s[48:51], s57 offen offset:1664 lds
  v_mfma_f32_16x16x32_bf16 v[40:43], a[88:91], v[76:79], v[40:43]
  ds_read_b128 v[68:71], v10 offset:30720
  v_mfma_f32_16x16x32_bf16 v[44:47], a[92:95], v[76:79], v[44:47]
  s_waitcnt lgkmcnt(4)
  v_mfma_f32_16x16x32_bf16 v[32:35], a[96:99], v[48:51], v[32:35]
  ds_read_b128 v[72:75], v11 offset:28672
  v_mfma_f32_16x16x32_bf16 v[36:39], a[100:103], v[48:51], v[36:39]
  v_mfma_f32_16x16x32_bf16 v[40:43], a[96:99], v[52:55], v[40:43]
  ds_read_b128 v[76:79], v11 offset:30720
  v_mfma_f32_16x16x32_bf16 v[44:47], a[100:103], v[52:55], v[44:47]
  s_waitcnt lgkmcnt(4)
  v_mfma_f32_16x16x32_bf16 v[32:35], a[104:107], v[56:59], v[32:35]
  ds_read_b128 v[48:51], v10 offset:32768
  s_add_u32 m0, s61, 55552
  v_mfma_f32_16x16x32_bf16 v[36:39], a[108:111], v[56:59], v[36:39]
  buffer_load_dwordx4 v4, s[48:51], s57 offen offset:1792 lds
  v_mfma_f32_16x16x32_bf16 v[40:43], a[104:107], v[60:63], v[40:43]
  ds_read_b128 v[52:55], v10 offset:34816
  v_mfma_f32_16x16x32_bf16 v[44:47], a[108:111], v[60:63], v[44:47]
  s_waitcnt lgkmcnt(4)
  v_mfma_f32_16x16x32_bf16 v[32:35], a[112:115], v[64:67], v[32:35]
  ds_read_b128 v[56:59], v11 offset:32768
  v_mfma_f32_16x16x32_bf16 v[36:39], a[116:119], v[64:67], v[36:39]
  v_mfma_f32_16x16x32_bf16 v[40:43], a[112:115], v[68:71], v[40:43]
  ds_read_b128 v[60:63], v11 offset:34816
  v_mfma_f32_16x16x32_bf16 v[44:47], a[116:119], v[68:71], v[44:47]
  s_waitcnt lgkmcnt(4)
  v_mfma_f32_16x16x32_bf16 v[32:35], a[120:123], v[72:75], v[32:35]
  ds_read_b128 v[64:67], v10 offset:36864
  s_add_u32 m0, s61, 59520
  v_mfma_f32_16x16x32_bf16 v[36:39], a[124:127], v[72:75], v[36:39]
  buffer_load_dwordx4 v4, s[48:51], s57 offen offset:1920 lds
  v_mfma_f32_16x16x32_bf16 v[40:43], a[120:123], v[76:79], v[40:43]
  ds_read_b128 v[68:71], v10 offset:38912
  v_mfma_f32_16x16x32_bf16 v[44:47], a[124:127], v[76:79], v[44:47]
  s_waitcnt vmcnt(16)
  s_barrier
  s_add_u32 s57, s60, 0x20000
  s_waitcnt lgkmcnt(4)
  v_mfma_f32_16x16x32_bf16 v[32:35], a[128:131], v[48:51], v[32:35]
  ds_read_b128 v[72:75], v11 offset:36864
  v_mfma_f32_16x16x32_bf16 v[36:39], a[132:135], v[48:51], v[36:39]
  s_waitcnt vmcnt(6)
  s_atomic_add s92, s[34:35], s83
  v_mfma_f32_16x16x32_bf16 v[40:43], a[128:131], v[52:55], v[40:43]
  ds_read_b128 v[76:79], v11 offset:38912
  v_mfma_f32_16x16x32_bf16 v[44:47], a[132:135], v[52:55], v[44:47]
  s_waitcnt lgkmcnt(4)
  v_mfma_f32_16x16x32_bf16 v[32:35], a[136:139], v[56:59], v[32:35]
  ds_read_b128 v[48:51], v10 offset:40960
  s_add_u32 m0, s61, 65536
  v_mfma_f32_16x16x32_bf16 v[36:39], a[140:143], v[56:59], v[36:39]
  buffer_load_dwordx4 v4, s[48:51], s57 offen offset:0 lds
  v_mfma_f32_16x16x32_bf16 v[40:43], a[136:139], v[60:63], v[40:43]
  ds_read_b128 v[52:55], v10 offset:43008
  v_mfma_f32_16x16x32_bf16 v[44:47], a[140:143], v[60:63], v[44:47]
  s_waitcnt lgkmcnt(4)
  v_mfma_f32_16x16x32_bf16 v[32:35], a[144:147], v[64:67], v[32:35]
  ds_read_b128 v[56:59], v11 offset:40960
  v_mfma_f32_16x16x32_bf16 v[36:39], a[148:151], v[64:67], v[36:39]
  v_mfma_f32_16x16x32_bf16 v[40:43], a[144:147], v[68:71], v[40:43]
  ds_read_b128 v[60:63], v11 offset:43008
  v_mfma_f32_16x16x32_bf16 v[44:47], a[148:151], v[68:71], v[44:47]
  s_waitcnt lgkmcnt(4)
  v_mfma_f32_16x16x32_bf16 v[32:35], a[152:155], v[72:75], v[32:35]
  ds_read_b128 v[64:67], v10 offset:45056
  s_add_u32 m0, s61, 69504
  v_mfma_f32_16x16x32_bf16 v[36:39], a[156:159], v[72:75], v[36:39]
  buffer_load_dwordx4 v4, s[48:51], s57 offen offset:128 lds
  v_mfma_f32_16x16x32_bf16 v[40:43], a[152:155], v[76:79], v[40:43]
  ds_read_b128 v[68:71], v10 offset:47104
  v_mfma_f32_16x16x32_bf16 v[44:47], a[156:159], v[76:79], v[44:47]
  s_waitcnt lgkmcnt(4)
  v_mfma_f32_16x16x32_bf16 v[32:35], a[160:163], v[48:51], v[32:35]
  ds_read_b128 v[72:75], v11 offset:45056
  v_mfma_f32_16x16x32_bf16 v[36:39], a[164:167], v[48:51], v[36:39]
  v_mfma_f32_16x16x32_bf16 v[40:43], a[160:163], v[52:55], v[40:43]
  ds_read_b128 v[76:79], v11 offset:47104
  v_mfma_f32_16x16x32_bf16 v[44:47], a[164:167], v[52:55], v[44:47]
  s_waitcnt lgkmcnt(4)
  v_mfma_f32_16x16x32_bf16 v[32:35], a[168:171], v[56:59], v[32:35]
  ds_read_b128 v[48:51], v10 offset:49152
  s_add_u32 m0, s61, 73472
  v_mfma_f32_16x16x32_bf16 v[36:39], a[172:175], v[56:59], v[36:39]
  buffer_load_dwordx4 v4, s[48:51], s57 offen offset:256 lds
  v_mfma_f32_16x16x32_bf16 v[40:43], a[168:171], v[60:63], v[40:43]
  ds_read_b128 v[52:55], v10 offset:51200
  v_mfma_f32_16x16x32_bf16 v[44:47], a[172:175], v[60:63], v[44:47]
  s_waitcnt lgkmcnt(4)
  v_mfma_f32_16x16x32_bf16 v[32:35], a[176:179], v[64:67], v[32:35]
  ds_read_b128 v[56:59], v11 offset:49152
  v_mfma_f32_16x16x32_bf16 v[36:39], a[180:183], v[64:67], v[36:39]
  v_mfma_f32_16x16x32_bf16 v[40:43], a[176:179], v[68:71], v[40:43]
  ds_read_b128 v[60:63], v11 offset:51200
  v_mfma_f32_16x16x32_bf16 v[44:47], a[180:183], v[68:71], v[44:47]
  s_waitcnt lgkmcnt(4)
  v_mfma_f32_16x16x32_bf16 v[32:35], a[184:187], v[72:75], v[32:35]
  ds_read_b128 v[64:67], v10 offset:53248
  s_add_u32 m0, s61, 77440
  v_mfma_f32_16x16x32_bf16 v[36:39], a[188:191], v[72:75], v[36:39]
  buffer_load_dwordx4 v4, s[48:51], s57 offen offset:384 lds
  v_mfma_f32_16x16x32_bf16 v[40:43], a[184:187], v[76:79], v[40:43]
  ds_read_b128 v[68:71], v10 offset:55296
  v_mfma_f32_16x16x32_bf16 v[44:47], a[188:191], v[76:79], v[44:47]
  s_waitcnt vmcnt(16)
  s_barrier
  s_waitcnt lgkmcnt(4)
  v_mfma_f32_16x16x32_bf16 v[32:35], a[192:195], v[48:51], v[32:35]
  ds_read_b128 v[72:75], v11 offset:53248
  v_mfma_f32_16x16x32_bf16 v[36:39], a[196:199], v[48:51], v[36:39]
  v_mfma_f32_16x16x32_bf16 v[40:43], a[192:195], v[52:55], v[40:43]
  ds_read_b128 v[76:79], v11 offset:55296
  v_mfma_f32_16x16x32_bf16 v[44:47], a[196:199], v[52:55], v[44:47]
  s_waitcnt lgkmcnt(4)
  v_mfma_f32_16x16x32_bf16 v[32:35], a[200:203], v[56:59], v[32:35]
  ds_read_b128 v[48:51], v10 offset:57344
  s_add_u32 m0, s61, 81408
  v_mfma_f32_16x16x32_bf16 v[36:39], a[204:207], v[56:59], v[36:39]
  buffer_load_dwordx4 v4, s[48:51], s57 offen offset:512 lds
  v_mfma_f32_16x16x32_bf16 v[40:43], a[200:203], v[60:63], v[40:43]
  ds_read_b128 v[52:55], v10 offset:59392
  v_mfma_f32_16x16x32_bf16 v[44:47], a[204:207], v[60:63], v[44:47]
  s_waitcnt lgkmcnt(4)
  v_mfma_f32_16x16x32_bf16 v[32:35], a[208:211], v[64:67], v[32:35]
  ds_read_b128 v[56:59], v11 offset:57344
  v_mfma_f32_16x16x32_bf16 v[36:39], a[212:215], v[64:67], v[36:39]
  v_mfma_f32_16x16x32_bf16 v[40:43], a[208:211], v[68:71], v[40:43]
  ds_read_b128 v[60:63], v11 offset:59392
  v_mfma_f32_16x16x32_bf16 v[44:47], a[212:215], v[68:71], v[44:47]
  s_waitcnt lgkmcnt(4)
  v_mfma_f32_16x16x32_bf16 v[32:35], a[216:219], v[72:75], v[32:35]
  ds_read_b128 v[64:67], v10 offset:61440
  s_add_u32 m0, s61, 85376
  v_mfma_f32_16x16x32_bf16 v[36:39], a[220:223], v[72:75], v[36:39]
  buffer_load_dwordx4 v4, s[48:51], s57 offen offset:640 lds
  v_mfma_f32_16x16x32_bf16 v[40:43], a[216:219], v[76:79], v[40:43]
  ds_read_b128 v[68:71], v10 offset:63488
  v_mfma_f32_16x16x32_bf16 v[44:47], a[220:223], v[76:79], v[44:47]
  s_waitcnt lgkmcnt(4)
  v_mfma_f32_16x16x32_bf16 v[32:35], a[224:227], v[48:51], v[32:35]
  ds_read_b128 v[72:75], v11 offset:61440
  v_mfma_f32_16x16x32_bf16 v[36:39], a[228:231], v[48:51], v[36:39]
  v_mfma_f32_16x16x32_bf16 v[40:43], a[224:227], v[52:55], v[40:43]
  ds_read_b128 v[76:79], v11 offset:63488
  v_mfma_f32_16x16x32_bf16 v[44:47], a[228:231], v[52:55], v[44:47]
  s_waitcnt lgkmcnt(4)
  v_mfma_f32_16x16x32_bf16 v[32:35], a[232:235], v[56:59], v[32:35]
  ds_read_b128 v[48:51], v8 offset:0
  s_add_u32 m0, s61, 89344
  v_mfma_f32_16x16x32_bf16 v[36:39], a[236:239], v[56:59], v[36:39]
  buffer_load_dwordx4 v4, s[48:51], s57 offen offset:768 lds
  v_mfma_f32_16x16x32_bf16 v[40:43], a[232:235], v[60:63], v[40:43]
  ds_read_b128 v[52:55], v8 offset:2048
  v_mfma_f32_16x16x32_bf16 v[44:47], a[236:239], v[60:63], v[44:47]
  s_waitcnt lgkmcnt(4)
  v_mfma_f32_16x16x32_bf16 v[32:35], a[240:243], v[64:67], v[32:35]
  ds_read_b128 v[56:59], v9 offset:0
  v_mfma_f32_16x16x32_bf16 v[36:39], a[244:247], v[64:67], v[36:39]
  s_lshl_b32 s59, s58, 18
  s_add_u32 s58, s58, 1
  v_mfma_f32_16x16x32_bf16 v[40:43], a[240:243], v[68:71], v[40:43]
  ds_read_b128 v[60:63], v9 offset:2048
  v_mfma_f32_16x16x32_bf16 v[44:47], a[244:247], v[68:71], v[44:47]
  s_waitcnt lgkmcnt(4)
  v_mfma_f32_16x16x32_bf16 v[32:35], a[248:251], v[72:75], v[32:35]
  ds_read_b128 v[64:67], v8 offset:4096
  s_add_u32 m0, s61, 93312
  v_mfma_f32_16x16x32_bf16 v[36:39], a[252:255], v[72:75], v[36:39]
  buffer_load_dwordx4 v4, s[48:51], s57 offen offset:896 lds
  v_mfma_f32_16x16x32_bf16 v[40:43], a[248:251], v[76:79], v[40:43]
  ds_read_b128 v[68:71], v8 offset:6144
  s_add_u32 s60, s60, 0x10000
  v_mfma_f32_16x16x32_bf16 v[44:47], a[252:255], v[76:79], v[44:47]
  s_cmp_lt_u32 s58, 64
  s_cbranch_scc1 L_p_loopK
  s_nop 7
  v_cvt_pk_bf16_f32 v84, v32, v33
  v_cvt_pk_bf16_f32 v85, v34, v35
  v_cvt_pk_bf16_f32 v86, v36, v37
  v_cvt_pk_bf16_f32 v87, v38, v39
  buffer_store_dwordx4 v[84:87], v5, s[52:55], s59 offen offset:0 sc1
  v_cvt_pk_bf16_f32 v88, v40, v41
  v_cvt_pk_bf16_f32 v89, v42, v43
  v_cvt_pk_bf16_f32 v90, v44, v45
  v_cvt_pk_bf16_f32 v91, v46, v47
  buffer_store_dwordx4 v[88:91], v5, s[52:55], s59 offen offset:1024 sc1
  s_branch L_p_done
L_p_startV:
  s_mov_b32 s57, 0
  s_mov_b32 exec_hi, 0
  buffer_load_dword v81, v80, s[44:47], s57 offen
  s_mov_b64 exec, -1
  s_mov_b32 s57, 2097152
  s_mov_b32 exec_hi, 0
  buffer_load_dword v81, v80, s[44:47], s57 offen
  s_mov_b64 exec, -1
  s_add_u32 m0, s56, 0
  s_add_u32 s57, s62, 0
  buffer_load_dwordx4 v2, s[44:47], s57 offen lds
  s_add_u32 m0, s56, 1024
  s_add_u32 s57, s62, 131072
  buffer_load_dwordx4 v2, s[44:47], s57 offen lds
  s_add_u32 m0, s56, 2048
  s_add_u32 s57, s62, 262144
  buffer_load_dwordx4 v2, s[44:47], s57 offen lds
  s_add_u32 m0, s56, 3072
  s_add_u32 s57, s62, 393216
  buffer_load_dwordx4 v2, s[44:47], s57 offen lds
  s_add_u32 m0, s56, 4096
  s_add_u32 s57, s62, 524288
  buffer_load_dwordx4 v2, s[44:47], s57 offen lds
  s_add_u32 m0, s56, 5120
  s_add_u32 s57, s62, 655360
  buffer_load_dwordx4 v2, s[44:47], s57 offen lds
  s_add_u32 m0, s56, 6144
  s_add_u32 s57, s62, 786432
  buffer_load_dwordx4 v2, s[44:47], s57 offen lds
  s_add_u32 m0, s56, 7168
  s_add_u32 s57, s62, 917504
  buffer_load_dwordx4 v2, s[44:47], s57 offen lds
  s_waitcnt lgkmcnt(0)
  s_add_u32 m0, s56, 8192
  s_add_u32 s57, s62, 1048576
  buffer_load_dwordx4 v2, s[44:47], s57 offen lds
  s_add_u32 m0, s56, 9216
  s_add_u32 s57, s62, 1179648
  buffer_load_dwordx4 v2, s[44:47], s57 offen lds
  s_add_u32 m0, s56, 10240
  s_add_u32 s57, s62, 1310720
  buffer_load_dwordx4 v2, s[44:47], s57 offen lds
  s_add_u32 m0, s56, 11264
  s_add_u32 s57, s62, 1441792
  buffer_load_dwordx4 v2, s[44:47], s57 offen lds
  s_add_u32 m0, s56, 12288
  s_add_u32 s57, s62, 1572864
  buffer_load_dwordx4 v2, s[44:47], s57 offen lds
  s_add_u32 m0, s56, 13312
  s_add_u32 s57, s62, 1703936
  buffer_load_dwordx4 v2, s[44:47], s57 offen lds
  s_waitcnt vmcnt(6)
  ds_read_b64_tr_b16 a[0:1], v3 offset:0
  ds_read_b64_tr_b16 a[2:3], v3 offset:256
  ds_read_b64_tr_b16 a[4:5], v3 offset:32
  ds_read_b64_tr_b16 a[6:7], v3 offset:288
  ds_read_b64_tr_b16 a[8:9], v3 offset:2048
  ds_read_b64_tr_b16 a[10:11], v3 offset:2304
  ds_read_b64_tr_b16 a[12:13], v3 offset:2080
  ds_read_b64_tr_b16 a[14:15], v3 offset:2336
  s_add_u32 m0, s56, 14336
  s_add_u32 s57, s62, 1835008
  buffer_load_dwordx4 v2, s[44:47], s57 offen lds
  ds_read_b64_tr_b16 a[16:17], v3 offset:4096
  ds_read_b64_tr_b16 a[18:19], v3 offset:4352
  ds_read_b64_tr_b16 a[20:21], v3 offset:4128
  ds_read_b64_tr_b16 a[22:23], v3 offset:4384
  ds_read_b64_tr_b16 a[24:25], v3 offset:6144
  ds_read_b64_tr_b16 a[26:27], v3 offset:6400
  ds_read_b64_tr_b16 a[28:29], v3 offset:6176
  ds_read_b64_tr_b16 a[30:31], v3 offset:6432
  s_add_u32 m0, s56, 15360
  s_add_u32 s57, s62, 1966080
  buffer_load_dwordx4 v2, s[44:47], s57 offen lds
  s_waitcnt lgkmcnt(0)
  s_cmp_eq_u32 s36, 0
  s_cbranch_scc0 L_arr_21
  s_mov_b32 s41, 0x10000
  s_atomic_add s41, s[32:33], 4 glc
  s_waitcnt lgkmcnt(0)
  s_lshr_b32 s40, s41, 16
  s_cmp_eq_u32 s40, 255
  s_cbranch_scc0 L_arr_21
  s_mov_b32 s84, 0
  s_atomic_add s84, s[32:33], 0 glc
  s_mov_b32 s85, 0
  s_atomic_add s85, s[32:33], 32 glc
  s_mov_b32 s86, 0
  s_atomic_add s86, s[32:33], 64 glc
  s_mov_b32 s87, 0
  s_atomic_add s87, s[32:33], 96 glc
  s_mov_b32 s88, 0
  s_atomic_add s88, s[32:33], 128 glc
  s_mov_b32 s89, 0
  s_atomic_add s89, s[32:33], 160 glc
  s_mov_b32 s90, 0
  s_atomic_add s90, s[32:33], 192 glc
  s_mov_b32 s91, 0
  s_atomic_add s91, s[32:33], 224 glc
  s_and_b32 s41, s41, 0xffff
  s_cmp_ge_u32 s41, 64
  s_cselect_b32 s41, 3, 1
  s_mov_b32 s40, 4
  s_waitcnt lgkmcnt(0)
  s_cmp_eq_u32 s84, 32
  s_cselect_b32 s40, s40, 0
  s_cmp_eq_u32 s85, 32
  s_cselect_b32 s40, s40, 0
  s_cmp_eq_u32 s86, 32
  s_cselect_b32 s40, s40, 0
  s_cmp_eq_u32 s87, 32
  s_cselect_b32 s40, s40, 0
  s_cmp_eq_u32 s88, 32
  s_cselect_b32 s40, s40, 0
  s_cmp_eq_u32 s89, 32
  s_cselect_b32 s40, s40, 0
  s_cmp_eq_u32 s90, 32
  s_cselect_b32 s40, s40, 0
  s_cmp_eq_u32 s91, 32
  s_cselect_b32 s40, s40, 0
  s_add_u32 s41, s41, s40
  s_atomic_add s41, s[32:33], 252
L_arr_21:
  s_add_u32 m0, s61, 0
  s_nop 0
  buffer_load_dwordx4 v4, s[48:51], s60 offen offset:0 lds
  s_add_u32 m0, s61, 3968
  s_nop 0
  buffer_load_dwordx4 v4, s[48:51], s60 offen offset:128 lds
  s_add_u32 m0, s61, 7936
  s_nop 0
  buffer_load_dwordx4 v4, s[48:51], s60 offen offset:256 lds
  s_add_u32 m0, s61, 11904
  s_nop 0
  buffer_load_dwordx4 v4, s[48:51], s60 offen offset:384 lds
  s_add_u32 m0, s61, 15872
  s_nop 0
  buffer_load_dwordx4 v4, s[48:51], s60 offen offset:512 lds
  s_add_u32 m0, s61, 19840
  s_nop 0
  buffer_load_dwordx4 v4, s[48:51], s60 offen offset:640 lds
  s_add_u32 m0, s61, 23808
  s_nop 0
  buffer_load_dwordx4 v4, s[48:51], s60 offen offset:768 lds
  s_add_u32 m0, s61, 27776
  s_nop 0
  buffer_load_dwordx4 v4, s[48:51], s60 offen offset:896 lds
  s_add_u32 m0, s61, 31744
  s_nop 0
  buffer_load_dwordx4 v4, s[48:51], s60 offen offset:1024 lds
  s_add_u32 m0, s61, 35712
  s_nop 0
  buffer_load_dwordx4 v4, s[48:51], s60 offen offset:1152 lds
  s_add_u32 m0, s61, 39680
  s_nop 0
  buffer_load_dwordx4 v4, s[48:51], s60 offen offset:1280 lds
  s_add_u32 m0, s61, 43648
  s_nop 0
  buffer_load_dwordx4 v4, s[48:51], s60 offen offset:1408 lds
  s_add_u32 m0, s61, 47616
  s_nop 0
  buffer_load_dwordx4 v4, s[48:51], s60 offen offset:1536 lds
  s_add_u32 m0, s61, 51584
  s_nop 0
  buffer_load_dwordx4 v4, s[48:51], s60 offen offset:1664 lds
  s_add_u32 m0, s61, 55552
  s_nop 0
  buffer_load_dwordx4 v4, s[48:51], s60 offen offset:1792 lds
  s_add_u32 m0, s61, 59520
  s_nop 0
  buffer_load_dwordx4 v4, s[48:51], s60 offen offset:1920 lds
  s_add_u32 m0, s61, 65536
  s_nop 0
  buffer_load_dwordx4 v4, s[48:51], s64 offen offset:0 lds
  s_add_u32 m0, s61, 69504
  s_nop 0
  buffer_load_dwordx4 v4, s[48:51], s64 offen offset:128 lds
  s_add_u32 m0, s61, 73472
  s_nop 0
  buffer_load_dwordx4 v4, s[48:51], s64 offen offset:256 lds
  s_add_u32 m0, s61, 77440
  s_nop 0
  buffer_load_dwordx4 v4, s[48:51], s64 offen offset:384 lds
  s_add_u32 m0, s61, 81408
  s_nop 0
  buffer_load_dwordx4 v4, s[48:51], s64 offen offset:512 lds
  s_add_u32 m0, s61, 85376
  s_nop 0
  buffer_load_dwordx4 v4, s[48:51], s64 offen offset:640 lds
  s_add_u32 m0, s61, 89344
  s_nop 0
  buffer_load_dwordx4 v4, s[48:51], s64 offen offset:768 lds
  s_add_u32 m0, s61, 93312
  s_nop 0
  buffer_load_dwordx4 v4, s[48:51], s64 offen offset:896 lds
  s_mov_b32 s57, 4194304
  s_mov_b32 exec_hi, 0
  buffer_load_dword v81, v80, s[44:47], s57 offen
  s_mov_b64 exec, -1
  s_add_u32 m0, s56, 0
  s_add_u32 s57, s62, 2097152
  buffer_load_dwordx4 v2, s[44:47], s57 offen lds
  s_add_u32 m0, s56, 1024
  s_add_u32 s57, s62, 2228224
  buffer_load_dwordx4 v2, s[44:47], s57 offen lds
  s_add_u32 m0, s56, 2048
  s_add_u32 s57, s62, 2359296
  buffer_load_dwordx4 v2, s[44:47], s57 offen lds
  s_add_u32 m0, s56, 3072
  s_add_u32 s57, s62, 2490368
  buffer_load_dwordx4 v2, s[44:47], s57 offen lds
  s_add_u32 m0, s56, 4096
  s_add_u32 s57, s62, 2621440
  buffer_load_dwordx4 v2, s[44:47], s57 offen lds
  s_add_u32 m0, s56, 5120
  s_add_u32 s57, s62, 2752512
  buffer_load_dwordx4 v2, s[44:47], s57 offen lds
  s_waitcnt vmcnt(31)
  ds_read_b64_tr_b16 a[32:33], v3 offset:8192
  ds_read_b64_tr_b16 a[34:35], v3 offset:8448
  ds_read_b64_tr_b16 a[36:37], v3 offset:8224
  ds_read_b64_tr_b16 a[38:39], v3 offset:8480
  ds_read_b64_tr_b16 a[40:41], v3 offset:10240
  ds_read_b64_tr_b16 a[42:43], v3 offset:10496
  ds_read_b64_tr_b16 a[44:45], v3 offset:10272
  ds_read_b64_tr_b16 a[46:47], v3 offset:10528
  s_add_u32 m0, s56, 6144
  s_add_u32 s57, s62, 2883584
  buffer_load_dwordx4 v2, s[44:47], s57 offen lds
  ds_read_b64_tr_b16 a[48:49], v3 offset:12288
  ds_read_b64_tr_b16 a[50:51], v3 offset:12544
  ds_read_b64_tr_b16 a[52:53], v3 offset:12320
  ds_read_b64_tr_b16 a[54:55], v3 offset:12576
  ds_read_b64_tr_b16 a[56:57], v3 offset:14336
  ds_read_b64_tr_b16 a[58:59], v3 offset:14592
  ds_read_b64_tr_b16 a[60:61], v3 offset:14368
  ds_read_b64_tr_b16 a[62:63], v3 offset:14624
  s_add_u32 m0, s56, 7168
  s_add_u32 s57, s62, 3014656
  buffer_load_dwordx4 v2, s[44:47], s57 offen lds
  s_waitcnt lgkmcnt(0)
  s_waitcnt vmcnt(9)
  s_barrier
  s_add_u32 m0, s56, 8192
  s_add_u32 s57, s62, 3145728
  buffer_load_dwordx4 v2, s[44:47], s57 offen lds
  ds_read_b128 v[48:51], v8 offset:0
  ds_read_b128 v[52:55], v8 offset:2048
  ds_read_b128 v[56:59], v9 offset:0
  ds_read_b128 v[60:63], v9 offset:2048
  ds_read_b128 v[64:67], v8 offset:4096
  ds_read_b128 v[68:71], v8 offset:6144
  ds_read_b128 v[72:75], v9 offset:4096
  ds_read_b128 v[76:79], v9 offset:6144
  s_waitcnt lgkmcnt(6)
  v_mfma_f32_16x16x32_bf16 v[16:19], v[48:51], a[0:3], 0
  v_mfma_f32_16x16x32_bf16 v[20:23], v[48:51], a[4:7], 0
  s_add_u32 m0, s56, 9216
  s_add_u32 s57, s62, 3276800
  buffer_load_dwordx4 v2, s[44:47], s57 offen lds
  v_mfma_f32_16x16x32_bf16 v[24:27], v[52:55], a[0:3], 0
  v_mfma_f32_16x16x32_bf16 v[28:31], v[52:55], a[4:7], 0
  s_waitcnt lgkmcnt(4)
  v_mfma_f32_16x16x32_bf16 v[16:19], v[56:59], a[8:11], v[16:19]
  v_mfma_f32_16x16x32_bf16 v[20:23], v[56:59], a[12:15], v[20:23]
  v_mfma_f32_16x16x32_bf16 v[24:27], v[60:63], a[8:11], v[24:27]
  v_mfma_f32_16x16x32_bf16 v[28:31], v[60:63], a[12:15], v[28:31]
  s_waitcnt lgkmcnt(2)
  v_mfma_f32_16x16x32_bf16 v[16:19], v[64:67], a[16:19], v[16:19]
  v_mfma_f32_16x16x32_bf16 v[20:23], v[64:67], a[20:23], v[20:23]
  v_mfma_f32_16x16x32_bf16 v[24:27], v[68:71], a[16:19], v[24:27]
  s_add_u32 m0, s56, 10240
  s_add_u32 s57, s62, 3407872
  buffer_load_dwordx4 v2, s[44:47], s57 offen lds
  v_mfma_f32_16x16x32_bf16 v[28:31], v[68:71], a[20:23], v[28:31]
  s_waitcnt lgkmcnt(0)
  v_mfma_f32_16x16x32_bf16 v[16:19], v[72:75], a[24:27], v[16:19]
  v_mfma_f32_16x16x32_bf16 v[20:23], v[72:75], a[28:31], v[20:23]
  v_mfma_f32_16x16x32_bf16 v[24:27], v[76:79], a[24:27], v[24:27]
  v_mfma_f32_16x16x32_bf16 v[28:31], v[76:79], a[28:31], v[28:31]
  ds_read_b128 v[48:51], v8 offset:8192
  ds_read_b128 v[52:55], v8 offset:10240
  ds_read_b128 v[56:59], v9 offset:8192
  ds_read_b128 v[60:63], v9 offset:10240
  ds_read_b128 v[64:67], v8 offset:12288
  s_add_u32 m0, s56, 11264
  s_add_u32 s57, s62, 3538944
  buffer_load_dwordx4 v2, s[44:47], s57 offen lds
  ds_read_b128 v[68:71], v8 offset:14336
  ds_read_b128 v[72:75], v9 offset:12288
  ds_read_b128 v[76:79], v9 offset:14336
  s_waitcnt lgkmcnt(6)
  v_mfma_f32_16x16x32_bf16 v[16:19], v[48:51], a[32:35], v[16:19]
  v_mfma_f32_16x16x32_bf16 v[20:23], v[48:51], a[36:39], v[20:23]
  v_mfma_f32_16x16x32_bf16 v[24:27], v[52:55], a[32:35], v[24:27]
  v_mfma_f32_16x16x32_bf16 v[28:31], v[52:55], a[36:39], v[28:31]
  s_waitcnt lgkmcnt(4)
  v_mfma_f32_16x16x32_bf16 v[16:19], v[56:59], a[40:43], v[16:19]
  v_mfma_f32_16x16x32_bf16 v[20:23], v[56:59], a[44:47], v[20:23]
  s_add_u32 m0, s56, 12288
  s_add_u32 s57, s62, 3670016
  buffer_load_dwordx4 v2, s[44:47], s57 offen lds
  v_mfma_f32_16x16x32_bf16 v[24:27], v[60:63], a[40:43], v[24:27]
  v_mfma_f32_16x16x32_bf16 v[28:31], v[60:63], a[44:47], v[28:31]
  s_waitcnt lgkmcnt(2)
  v_mfma_f32_16x16x32_bf16 v[16:19], v[64:67], a[48:51], v[16:19]
  v_mfma_f32_16x16x32_bf16 v[20:23], v[64:67], a[52:55], v[20:23]
  v_mfma_f32_16x16x32_bf16 v[24:27], v[68:71], a[48:51], v[24:27]
  v_mfma_f32_16x16x32_bf16 v[28:31], v[68:71], a[52:55], v[28:31]
  s_waitcnt lgkmcnt(0)
  v_mfma_f32_16x16x32_bf16 v[16:19], v[72:75], a[56:59], v[16:19]
  v_mfma_f32_16x16x32_bf16 v[20:23], v[72:75], a[60:63], v[20:23]
  v_mfma_f32_16x16x32_bf16 v[24:27], v[76:79], a[56:59], v[24:27]
  v_mfma_f32_16x16x32_bf16 v[28:31], v[76:79], a[60:63], v[28:31]
  s_add_u32 m0, s56, 13312
  s_add_u32 s57, s62, 3801088
  buffer_load_dwordx4 v2, s[44:47], s57 offen lds
  s_waitcnt vmcnt(6)
  ds_read_b64_tr_b16 a[64:65], v3 offset:0
  ds_read_b64_tr_b16 a[66:67], v3 offset:256
  ds_read_b64_tr_b16 a[68:69], v3 offset:32
  ds_read_b64_tr_b16 a[70:71], v3 offset:288
  ds_read_b64_tr_b16 a[72:73], v3 offset:2048
  ds_read_b64_tr_b16 a[74:75], v3 offset:2304
  ds_read_b64_tr_b16 a[76:77], v3 offset:2080
  ds_read_b64_tr_b16 a[78:79], v3 offset:2336
  s_add_u32 m0, s56, 14336
  s_add_u32 s57, s62, 3932160
  buffer_load_dwordx4 v2, s[44:47], s57 offen lds
  ds_read_b64_tr_b16 a[80:81], v3 offset:4096
  ds_read_b64_tr_b16 a[82:83], v3 offset:4352
  ds_read_b64_tr_b16 a[84:85], v3 offset:4128
  ds_read_b64_tr_b16 a[86:87], v3 offset:4384
  ds_read_b64_tr_b16 a[88:89], v3 offset:6144
  ds_read_b64_tr_b16 a[90:91], v3 offset:6400
  ds_read_b64_tr_b16 a[92:93], v3 offset:6176
  ds_read_b64_tr_b16 a[94:95], v3 offset:6432
  s_add_u32 m0, s56, 15360
  s_add_u32 s57, s62, 4063232
  buffer_load_dwordx4 v2, s[44:47], s57 offen lds
  s_waitcnt lgkmcnt(0)
  s_mov_b32 s57, 6291456
  s_mov_b32 exec_hi, 0
  buffer_load_dword v81, v80, s[44:47], s57 offen
  s_mov_b64 exec, -1
  s_add_u32 m0, s56, 0
  s_add_u32 s57, s62, 4194304
  buffer_load_dwordx4 v2, s[44:47], s57 offen lds
  ds_read_b128 v[48:51], v8 offset:16384
  ds_read_b128 v[52:55], v8 offset:18432
  ds_read_b128 v[56:59], v9 offset:16384
  ds_read_b128 v[60:63], v9 offset:18432
  ds_read_b128 v[64:67], v8 offset:20480
  ds_read_b128 v[68:71], v8 offset:22528
  ds_read_b128 v[72:75], v9 offset:20480
  ds_read_b128 v[76:79], v9 offset:22528
  s_waitcnt lgkmcnt(6)
  v_mfma_f32_16x16x32_bf16 v[16:19], v[48:51], a[64:67], v[16:19]
  v_mfma_f32_16x16x32_bf16 v[20:23], v[48:51], a[68:71], v[20:23]
  s_add_u32 m0, s56, 1024
  s_add_u32 s57, s62, 4325376
  buffer_load_dwordx4 v2, s[44:47], s57 offen lds
  v_mfma_f32_16x16x32_bf16 v[24:27], v[52:55], a[64:67], v[24:27]
  v_mfma_f32_16x16x32_bf16 v[28:31], v[52:55], a[68:71], v[28:31]
  s_waitcnt lgkmcnt(4)
  v_mfma_f32_16x16x32_bf16 v[16:19], v[56:59], a[72:75], v[16:19]
  v_mfma_f32_16x16x32_bf16 v[20:23], v[56:59], a[76:79], v[20:23]
  v_mfma_f32_16x16x32_bf16 v[24:27], v[60:63], a[72:75], v[24:27]
  v_mfma_f32_16x16x32_bf16 v[28:31], v[60:63], a[76:79], v[28:31]
  s_waitcnt lgkmcnt(2)
  v_mfma_f32_16x16x32_bf16 v[16:19], v[64:67], a[80:83], v[16:19]
  v_mfma_f32_16x16x32_bf16 v[20:23], v[64:67], a[84:87], v[20:23]
  v_mfma_f32_16x16x32_bf16 v[24:27], v[68:71], a[80:83], v[24:27]
  s_add_u32 m0, s56, 2048
  s_add_u32 s57, s62, 4456448
  buffer_load_dwordx4 v2, s[44:47], s57 offen lds
  v_mfma_f32_16x16x32_bf16 v[28:31], v[68:71], a[84:87], v[28:31]
  s_waitcnt lgkmcnt(0)
  v_mfma_f32_16x16x32_bf16 v[16:19], v[72:75], a[88:91], v[16:19]
  v_mfma_f32_16x16x32_bf16 v[20:23], v[72:75], a[92:95], v[20:23]
  v_mfma_f32_16x16x32_bf16 v[24:27], v[76:79], a[88:91], v[24:27]
  v_mfma_f32_16x16x32_bf16 v[28:31], v[76:79], a[92:95], v[28:31]
  ds_read_b128 v[48:51], v10 offset:0
  ds_read_b128 v[52:55], v10 offset:2048
  ds_read_b128 v[56:59], v11 offset:0
  ds_read_b128 v[60:63], v11 offset:2048
  ds_read_b128 v[64:67], v10 offset:4096
  s_add_u32 m0, s56, 3072
  s_add_u32 s57, s62, 4587520
  buffer_load_dwordx4 v2, s[44:47], s57 offen lds
  ds_read_b128 v[68:71], v10 offset:6144
  ds_read_b128 v[72:75], v11 offset:4096
  ds_read_b128 v[76:79], v11 offset:6144
  s_waitcnt lgkmcnt(6)
  v_mfma_f32_16x16x32_bf16 v[32:35], v[48:51], a[0:3], 0
  v_mfma_f32_16x16x32_bf16 v[36:39], v[48:51], a[4:7], 0
  v_mfma_f32_16x16x32_bf16 v[40:43], v[52:55], a[0:3], 0
  v_mfma_f32_16x16x32_bf16 v[44:47], v[52:55], a[4:7], 0
  s_waitcnt lgkmcnt(4)
  v_mfma_f32_16x16x32_bf16 v[32:35], v[56:59], a[8:11], v[32:35]
  v_mfma_f32_16x16x32_bf16 v[36:39], v[56:59], a[12:15], v[36:39]
  s_add_u32 m0, s56, 4096
  s_add_u32 s57, s62, 4718592
  buffer_load_dwordx4 v2, s[44:47], s57 offen lds
  v_mfma_f32_16x16x32_bf16 v[40:43], v[60:63], a[8:11], v[40:43]
  v_mfma_f32_16x16x32_bf16 v[44:47], v[60:63], a[12:15], v[44:47]
  s_waitcnt lgkmcnt(2)
  v_mfma_f32_16x16x32_bf16 v[32:35], v[64:67], a[16:19], v[32:35]
  v_mfma_f32_16x16x32_bf16 v[36:39], v[64:67], a[20:23], v[36:39]
  v_mfma_f32_16x16x32_bf16 v[40:43], v[68:71], a[16:19], v[40:43]
  v_mfma_f32_16x16x32_bf16 v[44:47], v[68:71], a[20:23], v[44:47]
  s_waitcnt lgkmcnt(0)
  v_mfma_f32_16x16x32_bf16 v[32:35], v[72:75], a[24:27], v[32:35]
  v_mfma_f32_16x16x32_bf16 v[36:39], v[72:75], a[28:31], v[36:39]
  v_mfma_f32_16x16x32_bf16 v[40:43], v[76:79], a[24:27], v[40:43]
  v_mfma_f32_16x16x32_bf16 v[44:47], v[76:79], a[28:31], v[44:47]
  s_add_u32 m0, s56, 5120
  s_add_u32 s57, s62, 4849664
  buffer_load_dwordx4 v2, s[44:47], s57 offen lds
  s_waitcnt vmcnt(7)
  ds_read_b64_tr_b16 a[96:97], v3 offset:8192
  ds_read_b64_tr_b16 a[98:99], v3 offset:8448
  ds_read_b64_tr_b16 a[100:101], v3 offset:8224
  ds_read_b64_tr_b16 a[102:103], v3 offset:8480
  ds_read_b64_tr_b16 a[104:105], v3 offset:10240
  ds_read_b64_tr_b16 a[106:107], v3 offset:10496
  ds_read_b64_tr_b16 a[108:109], v3 offset:10272
  ds_read_b64_tr_b16 a[110:111], v3 offset:10528
  s_add_u32 m0, s56, 6144
  s_add_u32 s57, s62, 4980736
  buffer_load_dwordx4 v2, s[44:47], s57 offen lds
  ds_read_b64_tr_b16 a[112:113], v3 offset:12288
  ds_read_b64_tr_b16 a[114:115], v3 offset:12544
  ds_read_b64_tr_b16 a[116:117], v3 offset:12320
  ds_read_b64_tr_b16 a[118:119], v3 offset:12576
  ds_read_b64_tr_b16 a[120:121], v3 offset:14336
  ds_read_b64_tr_b16 a[122:123], v3 offset:14592
  ds_read_b64_tr_b16 a[124:125], v3 offset:14368
  ds_read_b64_tr_b16 a[126:127], v3 offset:14624
  s_add_u32 m0, s56, 7168
  s_add_u32 s57, s62, 5111808
  buffer_load_dwordx4 v2, s[44:47], s57 offen lds
  s_waitcnt lgkmcnt(0)
  s_add_u32 m0, s56, 8192
  s_add_u32 s57, s62, 5242880
  buffer_load_dwordx4 v2, s[44:47], s57 offen lds
  ds_read_b128 v[48:51], v8 offset:24576
  ds_read_b128 v[52:55], v8 offset:26624
  ds_read_b128 v[56:59], v9 offset:24576
  ds_read_b128 v[60:63], v9 offset:26624
  ds_read_b128 v[64:67], v8 offset:28672
  ds_read_b128 v[68:71], v8 offset:30720
  ds_read_b128 v[72:75], v9 offset:28672
  ds_read_b128 v[76:79], v9 offset:30720
  s_waitcnt lgkmcnt(6)
  v_mfma_f32_16x16x32_bf16 v[16:19], v[48:51], a[96:99], v[16:19]
  v_mfma_f32_16x16x32_bf16 v[20:23], v[48:51], a[100:103], v[20:23]
  s_add_u32 m0, s56, 9216
  s_add_u32 s57, s62, 5373952
  buffer_load_dwordx4 v2, s[44:47], s57 offen lds
  v_mfma_f32_16x16x32_bf16 v[24:27], v[52:55], a[96:99], v[24:27]
  v_mfma_f32_16x16x32_bf16 v[28:31], v[52:55], a[100:103], v[28:31]
  s_waitcnt lgkmcnt(4)
  v_mfma_f32_16x16x32_bf16 v[16:19], v[56:59], a[104:107], v[16:19]
  v_mfma_f32_16x16x32_bf16 v[20:23], v[56:59], a[108:111], v[20:23]
  v_mfma_f32_16x16x32_bf16 v[24:27], v[60:63], a[104:107], v[24:27]
  v_mfma_f32_16x16x32_bf16 v[28:31], v[60:63], a[108:111], v[28:31]
  s_waitcnt lgkmcnt(2)
  v_mfma_f32_16x16x32_bf16 v[16:19], v[64:67], a[112:115], v[16:19]
  v_mfma_f32_16x16x32_bf16 v[20:23], v[64:67], a[116:119], v[20:23]
  v_mfma_f32_16x16x32_bf16 v[24:27], v[68:71], a[112:115], v[24:27]
  s_add_u32 m0, s56, 10240
  s_add_u32 s57, s62, 5505024
  buffer_load_dwordx4 v2, s[44:47], s57 offen lds
  v_mfma_f32_16x16x32_bf16 v[28:31], v[68:71], a[116:119], v[28:31]
  s_waitcnt lgkmcnt(0)
  v_mfma_f32_16x16x32_bf16 v[16:19], v[72:75], a[120:123], v[16:19]
  v_mfma_f32_16x16x32_bf16 v[20:23], v[72:75], a[124:127], v[20:23]
  v_mfma_f32_16x16x32_bf16 v[24:27], v[76:79], a[120:123], v[24:27]
  v_mfma_f32_16x16x32_bf16 v[28:31], v[76:79], a[124:127], v[28:31]
  ds_read_b128 v[48:51], v10 offset:8192
  ds_read_b128 v[52:55], v10 offset:10240
  ds_read_b128 v[56:59], v11 offset:8192
  ds_read_b128 v[60:63], v11 offset:10240
  ds_read_b128 v[64:67], v10 offset:12288
  s_add_u32 m0, s56, 11264
  s_add_u32 s57, s62, 5636096
  buffer_load_dwordx4 v2, s[44:47], s57 offen lds
  ds_read_b128 v[68:71], v10 offset:14336
  ds_read_b128 v[72:75], v11 offset:12288
  ds_read_b128 v[76:79], v11 offset:14336
  s_waitcnt lgkmcnt(6)
  v_mfma_f32_16x16x32_bf16 v[32:35], v[48:51], a[32:35], v[32:35]
  v_mfma_f32_16x16x32_bf16 v[36:39], v[48:51], a[36:39], v[36:39]
  v_mfma_f32_16x16x32_bf16 v[40:43], v[52:55], a[32:35], v[40:43]
  v_mfma_f32_16x16x32_bf16 v[44:47], v[52:55], a[36:39], v[44:47]
  s_waitcnt lgkmcnt(4)
  v_mfma_f32_16x16x32_bf16 v[32:35], v[56:59], a[40:43], v[32:35]
  v_mfma_f32_16x16x32_bf16 v[36:39], v[56:59], a[44:47], v[36:39]
  s_add_u32 m0, s56, 12288
  s_add_u32 s57, s62, 5767168
  buffer_load_dwordx4 v2, s[44:47], s57 offen lds
  v_mfma_f32_16x16x32_bf16 v[40:43], v[60:63], a[40:43], v[40:43]
  v_mfma_f32_16x16x32_bf16 v[44:47], v[60:63], a[44:47], v[44:47]
  s_waitcnt lgkmcnt(2)
  v_mfma_f32_16x16x32_bf16 v[32:35], v[64:67], a[48:51], v[32:35]
  v_mfma_f32_16x16x32_bf16 v[36:39], v[64:67], a[52:55], v[36:39]
  v_mfma_f32_16x16x32_bf16 v[40:43], v[68:71], a[48:51], v[40:43]
  v_mfma_f32_16x16x32_bf16 v[44:47], v[68:71], a[52:55], v[44:47]
  s_waitcnt lgkmcnt(0)
  v_mfma_f32_16x16x32_bf16 v[32:35], v[72:75], a[56:59], v[32:35]
  v_mfma_f32_16x16x32_bf16 v[36:39], v[72:75], a[60:63], v[36:39]
  v_mfma_f32_16x16x32_bf16 v[40:43], v[76:79], a[56:59], v[40:43]
  v_mfma_f32_16x16x32_bf16 v[44:47], v[76:79], a[60:63], v[44:47]
  s_add_u32 m0, s56, 13312
  s_add_u32 s57, s62, 5898240
  buffer_load_dwordx4 v2, s[44:47], s57 offen lds
  s_waitcnt vmcnt(6)
  ds_read_b64_tr_b16 a[128:129], v3 offset:0
  ds_read_b64_tr_b16 a[130:131], v3 offset:256
  ds_read_b64_tr_b16 a[132:133], v3 offset:32
  ds_read_b64_tr_b16 a[134:135], v3 offset:288
  ds_read_b64_tr_b16 a[136:137], v3 offset:2048
  ds_read_b64_tr_b16 a[138:139], v3 offset:2304
  ds_read_b64_tr_b16 a[140:141], v3 offset:2080
  ds_read_b64_tr_b16 a[142:143], v3 offset:2336
  s_add_u32 m0, s56, 14336
  s_add_u32 s57, s62, 6029312
  buffer_load_dwordx4 v2, s[44:47], s57 offen lds
  ds_read_b64_tr_b16 a[144:145], v3 offset:4096
  ds_read_b64_tr_b16 a[146:147], v3 offset:4352
  ds_read_b64_tr_b16 a[148:149], v3 offset:4128
  ds_read_b64_tr_b16 a[150:151], v3 offset:4384
  ds_read_b64_tr_b16 a[152:153], v3 offset:6144
  ds_read_b64_tr_b16 a[154:155], v3 offset:6400
  ds_read_b64_tr_b16 a[156:157], v3 offset:6176
  ds_read_b64_tr_b16 a[158:159], v3 offset:6432
  s_add_u32 m0, s56, 15360
  s_add_u32 s57, s62, 6160384
  buffer_load_dwordx4 v2, s[44:47], s57 offen lds
  s_waitcnt lgkmcnt(0)
  s_add_u32 m0, s56, 0
  s_add_u32 s57, s62, 6291456
  buffer_load_dwordx4 v2, s[44:47], s57 offen lds
  ds_read_b128 v[48:51], v8 offset:32768
  ds_read_b128 v[52:55], v8 offset:34816
  ds_read_b128 v[56:59], v9 offset:32768
  ds_read_b128 v[60:63], v9 offset:34816
  ds_read_b128 v[64:67], v8 offset:36864
  ds_read_b128 v[68:71], v8 offset:38912
  ds_read_b128 v[72:75], v9 offset:36864
  ds_read_b128 v[76:79], v9 offset:38912
  s_waitcnt lgkmcnt(6)
  v_mfma_f32_16x16x32_bf16 v[16:19], v[48:51], a[128:131], v[16:19]
  v_mfma_f32_16x16x32_bf16 v[20:23], v[48:51], a[132:135], v[20:23]
  s_add_u32 m0, s56, 1024
  s_add_u32 s57, s62, 6422528
  buffer_load_dwordx4 v2, s[44:47], s57 offen lds
  v_mfma_f32_16x16x32_bf16 v[24:27], v[52:55], a[128:131], v[24:27]
  v_mfma_f32_16x16x32_bf16 v[28:31], v[52:55], a[132:135], v[28:31]
  s_waitcnt lgkmcnt(4)
  v_mfma_f32_16x16x32_bf16 v[16:19], v[56:59], a[136:139], v[16:19]
  v_mfma_f32_16x16x32_bf16 v[20:23], v[56:59], a[140:143], v[20:23]
  v_mfma_f32_16x16x32_bf16 v[24:27], v[60:63], a[136:139], v[24:27]
  v_mfma_f32_16x16x32_bf16 v[28:31], v[60:63], a[140:143], v[28:31]
  s_waitcnt lgkmcnt(2)
  v_mfma_f32_16x16x32_bf16 v[16:19], v[64:67], a[144:147], v[16:19]
  v_mfma_f32_16x16x32_bf16 v[20:23], v[64:67], a[148:151], v[20:23]
  v_mfma_f32_16x16x32_bf16 v[24:27], v[68:71], a[144:147], v[24:27]
  s_add_u32 m0, s56, 2048
  s_add_u32 s57, s62, 6553600
  buffer_load_dwordx4 v2, s[44:47], s57 offen lds
  v_mfma_f32_16x16x32_bf16 v[28:31], v[68:71], a[148:151], v[28:31]
  s_waitcnt lgkmcnt(0)
  v_mfma_f32_16x16x32_bf16 v[16:19], v[72:75], a[152:155], v[16:19]
  v_mfma_f32_16x16x32_bf16 v[20:23], v[72:75], a[156:159], v[20:23]
  v_mfma_f32_16x16x32_bf16 v[24:27], v[76:79], a[152:155], v[24:27]
  v_mfma_f32_16x16x32_bf16 v[28:31], v[76:79], a[156:159], v[28:31]
  ds_read_b128 v[48:51], v10 offset:16384
  ds_read_b128 v[52:55], v10 offset:18432
  ds_read_b128 v[56:59], v11 offset:16384
  ds_read_b128 v[60:63], v11 offset:18432
  ds_read_b128 v[64:67], v10 offset:20480
  s_add_u32 m0, s56, 3072
  s_add_u32 s57, s62, 6684672
  buffer_load_dwordx4 v2, s[44:47], s57 offen lds
  ds_read_b128 v[68:71], v10 offset:22528
  ds_read_b128 v[72:75], v11 offset:20480
  ds_read_b128 v[76:79], v11 offset:22528
  s_waitcnt lgkmcnt(6)
  v_mfma_f32_16x16x32_bf16 v[32:35], v[48:51], a[64:67], v[32:35]
  v_mfma_f32_16x16x32_bf16 v[36:39], v[48:51], a[68:71], v[36:39]
  v_mfma_f32_16x16x32_bf16 v[40:43], v[52:55], a[64:67], v[40:43]
  v_mfma_f32_16x16x32_bf16 v[44:47], v[52:55], a[68:71], v[44:47]
  s_waitcnt lgkmcnt(4)
  v_mfma_f32_16x16x32_bf16 v[32:35], v[56:59], a[72:75], v[32:35]
  v_mfma_f32_16x16x32_bf16 v[36:39], v[56:59], a[76:79], v[36:39]
  s_add_u32 m0, s56, 4096
  s_add_u32 s57, s62, 6815744
  buffer_load_dwordx4 v2, s[44:47], s57 offen lds
  v_mfma_f32_16x16x32_bf16 v[40:43], v[60:63], a[72:75], v[40:43]
  v_mfma_f32_16x16x32_bf16 v[44:47], v[60:63], a[76:79], v[44:47]
  s_waitcnt lgkmcnt(2)
  v_mfma_f32_16x16x32_bf16 v[32:35], v[64:67], a[80:83], v[32:35]
  v_mfma_f32_16x16x32_bf16 v[36:39], v[64:67], a[84:87], v[36:39]
  v_mfma_f32_16x16x32_bf16 v[40:43], v[68:71], a[80:83], v[40:43]
  v_mfma_f32_16x16x32_bf16 v[44:47], v[68:71], a[84:87], v[44:47]
  s_waitcnt lgkmcnt(0)
  v_mfma_f32_16x16x32_bf16 v[32:35], v[72:75], a[88:91], v[32:35]
  v_mfma_f32_16x16x32_bf16 v[36:39], v[72:75], a[92:95], v[36:39]
  v_mfma_f32_16x16x32_bf16 v[40:43], v[76:79], a[88:91], v[40:43]
  v_mfma_f32_16x16x32_bf16 v[44:47], v[76:79], a[92:95], v[44:47]
  s_add_u32 m0, s56, 5120
  s_add_u32 s57, s62, 6946816
  buffer_load_dwordx4 v2, s[44:47], s57 offen lds
  s_waitcnt vmcnt(6)
  ds_read_b64_tr_b16 a[160:161], v3 offset:8192
  ds_read_b64_tr_b16 a[162:163], v3 offset:8448
  ds_read_b64_tr_b16 a[164:165], v3 offset:8224
  ds_read_b64_tr_b16 a[166:167], v3 offset:8480
  ds_read_b64_tr_b16 a[168:169], v3 offset:10240
  ds_read_b64_tr_b16 a[170:171], v3 offset:10496
  ds_read_b64_tr_b16 a[172:173], v3 offset:10272
  ds_read_b64_tr_b16 a[174:175], v3 offset:10528
  s_add_u32 m0, s56, 6144
  s_add_u32 s57, s62, 7077888
  buffer_load_dwordx4 v2, s[44:47], s57 offen lds
  ds_read_b64_tr_b16 a[176:177], v3 offset:12288
  ds_read_b64_tr_b16 a[178:179], v3 offset:12544
  ds_read_b64_tr_b16 a[180:181], v3 offset:12320
  ds_read_b64_tr_b16 a[182:183], v3 offset:12576
  ds_read_b64_tr_b16 a[184:185], v3 offset:14336
  ds_read_b64_tr_b16 a[186:187], v3 offset:14592
  ds_read_b64_tr_b16 a[188:189], v3 offset:14368
  ds_read_b64_tr_b16 a[190:191], v3 offset:14624
  s_add_u32 m0, s56, 7168
  s_add_u32 s57, s62, 7208960
  buffer_load_dwordx4 v2, s[44:47], s57 offen lds
  s_waitcnt lgkmcnt(0)
  s_add_u32 m0, s56, 8192
  s_add_u32 s57, s62, 7340032
  buffer_load_dwordx4 v2, s[44:47], s57 offen lds
  ds_read_b128 v[48:51], v8 offset:40960
  ds_read_b128 v[52:55], v8 offset:43008
  ds_read_b128 v[56:59], v9 offset:40960
  ds_read_b128 v[60:63], v9 offset:43008
  ds_read_b128 v[64:67], v8 offset:45056
  ds_read_b128 v[68:71], v8 offset:47104
  ds_read_b128 v[72:75], v9 offset:45056
  ds_read_b128 v[76:79], v9 offset:47104
  s_waitcnt lgkmcnt(6)
  v_mfma_f32_16x16x32_bf16 v[16:19], v[48:51], a[160:163], v[16:19]
  v_mfma_f32_16x16x32_bf16 v[20:23], v[48:51], a[164:167], v[20:23]
  s_add_u32 m0, s56, 9216
  s_add_u32 s57, s62, 7471104
  buffer_load_dwordx4 v2, s[44:47], s57 offen lds
  v_mfma_f32_16x16x32_bf16 v[24:27], v[52:55], a[160:163], v[24:27]
  v_mfma_f32_16x16x32_bf16 v[28:31], v[52:55], a[164:167], v[28:31]
  s_waitcnt lgkmcnt(4)
  v_mfma_f32_16x16x32_bf16 v[16:19], v[56:59], a[168:171], v[16:19]
  v_mfma_f32_16x16x32_bf16 v[20:23], v[56:59], a[172:175], v[20:23]
  v_mfma_f32_16x16x32_bf16 v[24:27], v[60:63], a[168:171], v[24:27]
  v_mfma_f32_16x16x32_bf16 v[28:31], v[60:63], a[172:175], v[28:31]
  s_waitcnt lgkmcnt(2)
  v_mfma_f32_16x16x32_bf16 v[16:19], v[64:67], a[176:179], v[16:19]
  v_mfma_f32_16x16x32_bf16 v[20:23], v[64:67], a[180:183], v[20:23]
  v_mfma_f32_16x16x32_bf16 v[24:27], v[68:71], a[176:179], v[24:27]
  s_add_u32 m0, s56, 10240
  s_add_u32 s57, s62, 7602176
  buffer_load_dwordx4 v2, s[44:47], s57 offen lds
  v_mfma_f32_16x16x32_bf16 v[28:31], v[68:71], a[180:183], v[28:31]
  s_waitcnt lgkmcnt(0)
  v_mfma_f32_16x16x32_bf16 v[16:19], v[72:75], a[184:187], v[16:19]
  v_mfma_f32_16x16x32_bf16 v[20:23], v[72:75], a[188:191], v[20:23]
  v_mfma_f32_16x16x32_bf16 v[24:27], v[76:79], a[184:187], v[24:27]
  v_mfma_f32_16x16x32_bf16 v[28:31], v[76:79], a[188:191], v[28:31]
  ds_read_b128 v[48:51], v10 offset:24576
  ds_read_b128 v[52:55], v10 offset:26624
  ds_read_b128 v[56:59], v11 offset:24576
  ds_read_b128 v[60:63], v11 offset:26624
  ds_read_b128 v[64:67], v10 offset:28672
  s_add_u32 m0, s56, 11264
  s_add_u32 s57, s62, 7733248
  buffer_load_dwordx4 v2, s[44:47], s57 offen lds
  ds_read_b128 v[68:71], v10 offset:30720
  ds_read_b128 v[72:75], v11 offset:28672
  ds_read_b128 v[76:79], v11 offset:30720
  s_waitcnt lgkmcnt(6)
  v_mfma_f32_16x16x32_bf16 v[32:35], v[48:51], a[96:99], v[32:35]
  v_mfma_f32_16x16x32_bf16 v[36:39], v[48:51], a[100:103], v[36:39]
  v_mfma_f32_16x16x32_bf16 v[40:43], v[52:55], a[96:99], v[40:43]
  v_mfma_f32_16x16x32_bf16 v[44:47], v[52:55], a[100:103], v[44:47]
  s_waitcnt lgkmcnt(4)
  v_mfma_f32_16x16x32_bf16 v[32:35], v[56:59], a[104:107], v[32:35]
  v_mfma_f32_16x16x32_bf16 v[36:39], v[56:59], a[108:111], v[36:39]
  s_add_u32 m0, s56, 12288
  s_add_u32 s57, s62, 7864320
  buffer_load_dwordx4 v2, s[44:47], s57 offen lds
  v_mfma_f32_16x16x32_bf16 v[40:43], v[60:63], a[104:107], v[40:43]
  v_mfma_f32_16x16x32_bf16 v[44:47], v[60:63], a[108:111], v[44:47]
  s_waitcnt lgkmcnt(2)
  v_mfma_f32_16x16x32_bf16 v[32:35], v[64:67], a[112:115], v[32:35]
  v_mfma_f32_16x16x32_bf16 v[36:39], v[64:67], a[116:119], v[36:39]
  v_mfma_f32_16x16x32_bf16 v[40:43], v[68:71], a[112:115], v[40:43]
  v_mfma_f32_16x16x32_bf16 v[44:47], v[68:71], a[116:119], v[44:47]
  s_waitcnt lgkmcnt(0)
  v_mfma_f32_16x16x32_bf16 v[32:35], v[72:75], a[120:123], v[32:35]
  v_mfma_f32_16x16x32_bf16 v[36:39], v[72:75], a[124:127], v[36:39]
  v_mfma_f32_16x16x32_bf16 v[40:43], v[76:79], a[120:123], v[40:43]
  v_mfma_f32_16x16x32_bf16 v[44:47], v[76:79], a[124:127], v[44:47]
  s_add_u32 m0, s56, 13312
  s_add_u32 s57, s62, 7995392
  buffer_load_dwordx4 v2, s[44:47], s57 offen lds
  s_waitcnt vmcnt(6)
  ds_read_b64_tr_b16 a[192:193], v3 offset:0
  ds_read_b64_tr_b16 a[194:195], v3 offset:256
  ds_read_b64_tr_b16 a[196:197], v3 offset:32
  ds_read_b64_tr_b16 a[198:199], v3 offset:288
  ds_read_b64_tr_b16 a[200:201], v3 offset:2048
  ds_read_b64_tr_b16 a[202:203], v3 offset:2304
  ds_read_b64_tr_b16 a[204:205], v3 offset:2080
  ds_read_b64_tr_b16 a[206:207], v3 offset:2336
  s_add_u32 m0, s56, 14336
  s_add_u32 s57, s62, 8126464
  buffer_load_dwordx4 v2, s[44:47], s57 offen lds
  ds_read_b64_tr_b16 a[208:209], v3 offset:4096
  ds_read_b64_tr_b16 a[210:211], v3 offset:4352
  ds_read_b64_tr_b16 a[212:213], v3 offset:4128
  ds_read_b64_tr_b16 a[214:215], v3 offset:4384
  ds_read_b64_tr_b16 a[216:217], v3 offset:6144
  ds_read_b64_tr_b16 a[218:219], v3 offset:6400
  ds_read_b64_tr_b16 a[220:221], v3 offset:6176
  ds_read_b64_tr_b16 a[222:223], v3 offset:6432
  s_add_u32 m0, s56, 15360
  s_add_u32 s57, s62, 8257536
  buffer_load_dwordx4 v2, s[44:47], s57 offen lds
  s_waitcnt lgkmcnt(0)
  ds_read_b128 v[48:51], v8 offset:49152
  ds_read_b128 v[52:55], v8 offset:51200
  ds_read_b128 v[56:59], v9 offset:49152
  ds_read_b128 v[60:63], v9 offset:51200
  ds_read_b128 v[64:67], v8 offset:53248
  ds_read_b128 v[68:71], v8 offset:55296
  ds_read_b128 v[72:75], v9 offset:53248
  ds_read_b128 v[76:79], v9 offset:55296
  s_waitcnt lgkmcnt(6)
  v_mfma_f32_16x16x32_bf16 v[16:19], v[48:51], a[192:195], v[16:19]
  v_mfma_f32_16x16x32_bf16 v[20:23], v[48:51], a[196:199], v[20:23]
  v_mfma_f32_16x16x32_bf16 v[24:27], v[52:55], a[192:195], v[24:27]
  v_mfma_f32_16x16x32_bf16 v[28:31], v[52:55], a[196:199], v[28:31]
  s_waitcnt lgkmcnt(4)
  v_mfma_f32_16x16x32_bf16 v[16:19], v[56:59], a[200:203], v[16:19]
  v_mfma_f32_16x16x32_bf16 v[20:23], v[56:59], a[204:207], v[20:23]
  v_mfma_f32_16x16x32_bf16 v[24:27], v[60:63], a[200:203], v[24:27]
  v_mfma_f32_16x16x32_bf16 v[28:31], v[60:63], a[204:207], v[28:31]
  s_waitcnt lgkmcnt(2)
  v_mfma_f32_16x16x32_bf16 v[16:19], v[64:67], a[208:211], v[16:19]
  v_mfma_f32_16x16x32_bf16 v[20:23], v[64:67], a[212:215], v[20:23]
  v_mfma_f32_16x16x32_bf16 v[24:27], v[68:71], a[208:211], v[24:27]
  v_mfma_f32_16x16x32_bf16 v[28:31], v[68:71], a[212:215], v[28:31]
  s_waitcnt lgkmcnt(0)
  v_mfma_f32_16x16x32_bf16 v[16:19], v[72:75], a[216:219], v[16:19]
  v_mfma_f32_16x16x32_bf16 v[20:23], v[72:75], a[220:223], v[20:23]
  v_mfma_f32_16x16x32_bf16 v[24:27], v[76:79], a[216:219], v[24:27]
  v_mfma_f32_16x16x32_bf16 v[28:31], v[76:79], a[220:223], v[28:31]
  s_waitcnt vmcnt(0)
  ds_read_b64_tr_b16 a[224:225], v3 offset:8192
  ds_read_b64_tr_b16 a[226:227], v3 offset:8448
  ds_read_b64_tr_b16 a[228:229], v3 offset:8224
  ds_read_b64_tr_b16 a[230:231], v3 offset:8480
  ds_read_b64_tr_b16 a[232:233], v3 offset:10240
  ds_read_b64_tr_b16 a[234:235], v3 offset:10496
  ds_read_b64_tr_b16 a[236:237], v3 offset:10272
  ds_read_b64_tr_b16 a[238:239], v3 offset:10528
  ds_read_b64_tr_b16 a[240:241], v3 offset:12288
  ds_read_b64_tr_b16 a[242:243], v3 offset:12544
  ds_read_b64_tr_b16 a[244:245], v3 offset:12320
  ds_read_b64_tr_b16 a[246:247], v3 offset:12576
  ds_read_b64_tr_b16 a[248:249], v3 offset:14336
  ds_read_b64_tr_b16 a[250:251], v3 offset:14592
  ds_read_b64_tr_b16 a[252:253], v3 offset:14368
  ds_read_b64_tr_b16 a[254:255], v3 offset:14624
  s_waitcnt lgkmcnt(0)
  s_barrier
  s_add_u32 m0, s61, 97280
  s_nop 0
  buffer_load_dwordx4 v4, s[48:51], s64 offen offset:1024 lds
  s_add_u32 m0, s61, 101248
  s_nop 0
  buffer_load_dwordx4 v4, s[48:51], s64 offen offset:1152 lds
  s_add_u32 m0, s61, 105216
  s_nop 0
  buffer_load_dwordx4 v4, s[48:51], s64 offen offset:1280 lds
  s_add_u32 m0, s61, 109184
  s_nop 0
  buffer_load_dwordx4 v4, s[48:51], s64 offen offset:1408 lds
  s_add_u32 m0, s61, 113152
  s_nop 0
  buffer_load_dwordx4 v4, s[48:51], s64 offen offset:1536 lds
  s_add_u32 m0, s61, 117120
  s_nop 0
  buffer_load_dwordx4 v4, s[48:51], s64 offen offset:1664 lds
  s_add_u32 m0, s61, 121088
  s_nop 0
  buffer_load_dwordx4 v4, s[48:51], s64 offen offset:1792 lds
  s_add_u32 m0, s61, 125056
  s_nop 0
  buffer_load_dwordx4 v4, s[48:51], s64 offen offset:1920 lds
  ds_read_b128 v[48:51], v8 offset:57344
  ds_read_b128 v[52:55], v8 offset:59392
  ds_read_b128 v[56:59], v9 offset:57344
  ds_read_b128 v[60:63], v9 offset:59392
  ds_read_b128 v[64:67], v8 offset:61440
  ds_read_b128 v[68:71], v8 offset:63488
  ds_read_b128 v[72:75], v9 offset:61440
  ds_read_b128 v[76:79], v9 offset:63488
  s_waitcnt lgkmcnt(6)
  v_mfma_f32_16x16x32_bf16 v[16:19], v[48:51], a[224:227], v[16:19]
  v_mfma_f32_16x16x32_bf16 v[20:23], v[48:51], a[228:231], v[20:23]
  v_mfma_f32_16x16x32_bf16 v[24:27], v[52:55], a[224:227], v[24:27]
  v_mfma_f32_16x16x32_bf16 v[28:31], v[52:55], a[228:231], v[28:31]
  s_waitcnt lgkmcnt(4)
  v_mfma_f32_16x16x32_bf16 v[16:19], v[56:59], a[232:235], v[16:19]
  v_mfma_f32_16x16x32_bf16 v[20:23], v[56:59], a[236:239], v[20:23]
  v_mfma_f32_16x16x32_bf16 v[24:27], v[60:63], a[232:235], v[24:27]
  v_mfma_f32_16x16x32_bf16 v[28:31], v[60:63], a[236:239], v[28:31]
  s_waitcnt lgkmcnt(2)
  v_mfma_f32_16x16x32_bf16 v[16:19], v[64:67], a[240:243], v[16:19]
  v_mfma_f32_16x16x32_bf16 v[20:23], v[64:67], a[244:247], v[20:23]
  v_mfma_f32_16x16x32_bf16 v[24:27], v[68:71], a[240:243], v[24:27]
  v_mfma_f32_16x16x32_bf16 v[28:31], v[68:71], a[244:247], v[28:31]
  s_waitcnt lgkmcnt(0)
  v_mfma_f32_16x16x32_bf16 v[16:19], v[72:75], a[248:251], v[16:19]
  v_mfma_f32_16x16x32_bf16 v[20:23], v[72:75], a[252:255], v[20:23]
  v_mfma_f32_16x16x32_bf16 v[24:27], v[76:79], a[248:251], v[24:27]
  v_mfma_f32_16x16x32_bf16 v[28:31], v[76:79], a[252:255], v[28:31]
  s_nop 7
  v_cvt_pk_bf16_f32 v84, v16, v17
  v_cvt_pk_bf16_f32 v85, v18, v19
  v_cvt_pk_bf16_f32 v86, v24, v25
  v_cvt_pk_bf16_f32 v87, v26, v27
  buffer_store_dwordx4 v[84:87], v5, s[52:55], s59 offen offset:0 sc1
  v_cvt_pk_bf16_f32 v88, v20, v21
  v_cvt_pk_bf16_f32 v89, v22, v23
  v_cvt_pk_bf16_f32 v90, v28, v29
  v_cvt_pk_bf16_f32 v91, v30, v31
  buffer_store_dwordx4 v[88:91], v5, s[52:55], s59 offen offset:1024 sc1
  s_mov_b32 s60, 0x10000
  s_mov_b32 s57, 0x20000
  s_mov_b32 s64, 0x30000
  s_waitcnt vmcnt(0)
  s_atomic_add s92, s[34:35], s83
  s_barrier
  ds_read_b128 v[48:51], v10 offset:32768
  ds_read_b128 v[52:55], v10 offset:34816
  ds_read_b128 v[56:59], v11 offset:32768
  ds_read_b128 v[60:63], v11 offset:34816
  ds_read_b128 v[64:67], v10 offset:36864
  ds_read_b128 v[68:71], v10 offset:38912
  s_waitcnt lgkmcnt(4)
  v_mfma_f32_16x16x32_bf16 v[32:35], v[48:51], a[128:131], v[32:35]
  ds_read_b128 v[72:75], v11 offset:36864
  s_add_u32 m0, s61, 0
  v_mfma_f32_16x16x32_bf16 v[36:39], v[48:51], a[132:135], v[36:39]
  buffer_load_dwordx4 v4, s[48:51], s57 offen offset:0 lds
  v_mfma_f32_16x16x32_bf16 v[40:43], v[52:55], a[128:131], v[40:43]
  ds_read_b128 v[76:79], v11 offset:38912
  s_add_u32 m0, s61, 3968
  v_mfma_f32_16x16x32_bf16 v[44:47], v[52:55], a[132:135], v[44:47]
  buffer_load_dwordx4 v4, s[48:51], s57 offen offset:128 lds
  s_waitcnt lgkmcnt(4)
  v_mfma_f32_16x16x32_bf16 v[32:35], v[56:59], a[136:139], v[32:35]
  ds_read_b128 v[48:51], v10 offset:40960
  v_mfma_f32_16x16x32_bf16 v[36:39], v[56:59], a[140:143], v[36:39]
  s_add_u32 m0, s61, 7936
  v_mfma_f32_16x16x32_bf16 v[40:43], v[60:63], a[136:139], v[40:43]
  ds_read_b128 v[52:55], v10 offset:43008
  buffer_load_dwordx4 v4, s[48:51], s57 offen offset:256 lds
  v_mfma_f32_16x16x32_bf16 v[44:47], v[60:63], a[140:143], v[44:47]
  s_add_u32 m0, s61, 11904
  s_waitcnt lgkmcnt(4)
  v_mfma_f32_16x16x32_bf16 v[32:35], v[64:67], a[144:147], v[32:35]
  ds_read_b128 v[56:59], v11 offset:40960
  buffer_load_dwordx4 v4, s[48:51], s57 offen offset:384 lds
  v_mfma_f32_16x16x32_bf16 v[36:39], v[64:67], a[148:151], v[36:39]
  v_mfma_f32_16x16x32_bf16 v[40:43], v[68:71], a[144:147], v[40:43]
  ds_read_b128 v[60:63], v11 offset:43008
  s_add_u32 m0, s61, 15872
  v_mfma_f32_16x16x32_bf16 v[44:47], v[68:71], a[148:151], v[44:47]
  buffer_load_dwordx4 v4, s[48:51], s57 offen offset:512 lds
  s_waitcnt lgkmcnt(4)
  v_mfma_f32_16x16x32_bf16 v[32:35], v[72:75], a[152:155], v[32:35]
  ds_read_b128 v[64:67], v10 offset:45056
  s_add_u32 m0, s61, 19840
  v_mfma_f32_16x16x32_bf16 v[36:39], v[72:75], a[156:159], v[36:39]
  buffer_load_dwordx4 v4, s[48:51], s57 offen offset:640 lds
  v_mfma_f32_16x16x32_bf16 v[40:43], v[76:79], a[152:155], v[40:43]
  ds_read_b128 v[68:71], v10 offset:47104
  v_mfma_f32_16x16x32_bf16 v[44:47], v[76:79], a[156:159], v[44:47]
  s_add_u32 m0, s61, 23808
  s_waitcnt lgkmcnt(4)
  v_mfma_f32_16x16x32_bf16 v[32:35], v[48:51], a[160:163], v[32:35]
  ds_read_b128 v[72:75], v11 offset:45056
  buffer_load_dwordx4 v4, s[48:51], s57 offen offset:768 lds
  v_mfma_f32_16x16x32_bf16 v[36:39], v[48:51], a[164:167], v[36:39]
  s_add_u32 m0, s61, 27776
  v_mfma_f32_16x16x32_bf16 v[40:43], v[52:55], a[160:163], v[40:43]
  ds_read_b128 v[76:79], v11 offset:47104
  buffer_load_dwordx4 v4, s[48:51], s57 offen offset:896 lds
  v_mfma_f32_16x16x32_bf16 v[44:47], v[52:55], a[164:167], v[44:47]
  s_waitcnt lgkmcnt(4)
  v_mfma_f32_16x16x32_bf16 v[32:35], v[56:59], a[168:171], v[32:35]
  ds_read_b128 v[48:51], v10 offset:49152
  s_add_u32 m0, s61, 31744
  v_mfma_f32_16x16x32_bf16 v[36:39], v[56:59], a[172:175], v[36:39]
  buffer_load_dwordx4 v4, s[48:51], s57 offen offset:1024 lds
  v_mfma_f32_16x16x32_bf16 v[40:43], v[60:63], a[168:171], v[40:43]
  ds_read_b128 v[52:55], v10 offset:51200
  s_add_u32 m0, s61, 35712
  v_mfma_f32_16x16x32_bf16 v[44:47], v[60:63], a[172:175], v[44:47]
  buffer_load_dwordx4 v4, s[48:51], s57 offen offset:1152 lds
  s_waitcnt lgkmcnt(4)
  v_mfma_f32_16x16x32_bf16 v[32:35], v[64:67], a[176:179], v[32:35]
  ds_read_b128 v[56:59], v11 offset:49152
  v_mfma_f32_16x16x32_bf16 v[36:39], v[64:67], a[180:183], v[36:39]
  s_add_u32 m0, s61, 39680
  v_mfma_f32_16x16x32_bf16 v[40:43], v[68:71], a[176:179], v[40:43]
  ds_read_b128 v[60:63], v11 offset:51200
  buffer_load_dwordx4 v4, s[48:51], s57 offen offset:1280 lds
  v_mfma_f32_16x16x32_bf16 v[44:47], v[68:71], a[180:183], v[44:47]
  s_add_u32 m0, s61, 43648
  s_waitcnt lgkmcnt(4)
  v_mfma_f32_16x16x32_bf16 v[32:35], v[72:75], a[184:187], v[32:35]
  ds_read_b128 v[64:67], v10 offset:53248
  buffer_load_dwordx4 v4, s[48:51], s57 offen offset:1408 lds
  v_mfma_f32_16x16x32_bf16 v[36:39], v[72:75], a[188:191], v[36:39]
  v_mfma_f32_16x16x32_bf16 v[40:43], v[76:79], a[184:187], v[40:43]
  ds_read_b128 v[68:71], v10 offset:55296
  s_add_u32 m0, s61, 47616
  v_mfma_f32_16x16x32_bf16 v[44:47], v[76:79], a[188:191], v[44:47]
  buffer_load_dwordx4 v4, s[48:51], s57 offen offset:1536 lds
  s_waitcnt vmcnt(9)
  s_barrier
  s_waitcnt lgkmcnt(4)
  v_mfma_f32_16x16x32_bf16 v[32:35], v[48:51], a[192:195], v[32:35]
  ds_read_b128 v[72:75], v11 offset:53248
  s_add_u32 m0, s61, 51584
  v_mfma_f32_16x16x32_bf16 v[36:39], v[48:51], a[196:199], v[36:39]
  buffer_load_dwordx4 v4, s[48:51], s57 offen offset:1664 lds
  v_mfma_f32_16x16x32_bf16 v[40:43], v[52:55], a[192:195], v[40:43]
  ds_read_b128 v[76:79], v11 offset:55296
  v_mfma_f32_16x16x32_bf16 v[44:47], v[52:55], a[196:199], v[44:47]
  s_add_u32 m0, s61, 55552
  s_waitcnt lgkmcnt(4)
  v_mfma_f32_16x16x32_bf16 v[32:35], v[56:59], a[200:203], v[32:35]
  ds_read_b128 v[48:51], v10 offset:57344
  buffer_load_dwordx4 v4, s[48:51], s57 offen offset:1792 lds
  v_mfma_f32_16x16x32_bf16 v[36:39], v[56:59], a[204:207], v[36:39]
  s_add_u32 m0, s61, 59520
  v_mfma_f32_16x16x32_bf16 v[40:43], v[60:63], a[200:203], v[40:43]
  ds_read_b128 v[52:55], v10 offset:59392
  buffer_load_dwordx4 v4, s[48:51], s57 offen offset:1920 lds
  v_mfma_f32_16x16x32_bf16 v[44:47], v[60:63], a[204:207], v[44:47]
  s_waitcnt lgkmcnt(4)
  v_mfma_f32_16x16x32_bf16 v[32:35], v[64:67], a[208:211], v[32:35]
  ds_read_b128 v[56:59], v11 offset:57344
  s_add_u32 m0, s61, 65536
  v_mfma_f32_16x16x32_bf16 v[36:39], v[64:67], a[212:215], v[36:39]
  buffer_load_dwordx4 v4, s[48:51], s64 offen offset:0 lds
  v_mfma_f32_16x16x32_bf16 v[40:43], v[68:71], a[208:211], v[40:43]
  ds_read_b128 v[60:63], v11 offset:59392
  s_add_u32 m0, s61, 69504
  v_mfma_f32_16x16x32_bf16 v[44:47], v[68:71], a[212:215], v[44:47]
  buffer_load_dwordx4 v4, s[48:51], s64 offen offset:128 lds
  s_waitcnt lgkmcnt(4)
  v_mfma_f32_16x16x32_bf16 v[32:35], v[72:75], a[216:219], v[32:35]
  ds_read_b128 v[64:67], v10 offset:61440
  v_mfma_f32_16x16x32_bf16 v[36:39], v[72:75], a[220:223], v[36:39]
  s_add_u32 m0, s61, 73472
  v_mfma_f32_16x16x32_bf16 v[40:43], v[76:79], a[216:219], v[40:43]
  ds_read_b128 v[68:71], v10 offset:63488
  buffer_load_dwordx4 v4, s[48:51], s64 offen offset:256 lds
  v_mfma_f32_16x16x32_bf16 v[44:47], v[76:79], a[220:223], v[44:47]
  s_add_u32 m0, s61, 77440
  s_waitcnt lgkmcnt(4)
  v_mfma_f32_16x16x32_bf16 v[32:35], v[48:51], a[224:227], v[32:35]
  ds_read_b128 v[72:75], v11 offset:61440
  buffer_load_dwordx4 v4, s[48:51], s64 offen offset:384 lds
  v_mfma_f32_16x16x32_bf16 v[36:39], v[48:51], a[228:231], v[36:39]
  v_mfma_f32_16x16x32_bf16 v[40:43], v[52:55], a[224:227], v[40:43]
  ds_read_b128 v[76:79], v11 offset:63488
  s_add_u32 m0, s61, 81408
  v_mfma_f32_16x16x32_bf16 v[44:47], v[52:55], a[228:231], v[44:47]
  buffer_load_dwordx4 v4, s[48:51], s64 offen offset:512 lds
  s_waitcnt lgkmcnt(4)
  v_mfma_f32_16x16x32_bf16 v[32:35], v[56:59], a[232:235], v[32:35]
  ds_read_b128 v[48:51], v8 offset:0
  s_add_u32 m0, s61, 85376
  v_mfma_f32_16x16x32_bf16 v[36:39], v[56:59], a[236:239], v[36:39]
  buffer_load_dwordx4 v4, s[48:51], s64 offen offset:640 lds
  v_mfma_f32_16x16x32_bf16 v[40:43], v[60:63], a[232:235], v[40:43]
  ds_read_b128 v[52:55], v8 offset:2048
  v_mfma_f32_16x16x32_bf16 v[44:47], v[60:63], a[236:239], v[44:47]
  s_add_u32 m0, s61, 89344
  s_waitcnt lgkmcnt(4)
  v_mfma_f32_16x16x32_bf16 v[32:35], v[64:67], a[240:243], v[32:35]
  ds_read_b128 v[56:59], v9 offset:0
  buffer_load_dwordx4 v4, s[48:51], s64 offen offset:768 lds
  v_mfma_f32_16x16x32_bf16 v[36:39], v[64:67], a[244:247], v[36:39]
  s_add_u32 m0, s61, 93312
  v_mfma_f32_16x16x32_bf16 v[40:43], v[68:71], a[240:243], v[40:43]
  ds_read_b128 v[60:63], v9 offset:2048
  buffer_load_dwordx4 v4, s[48:51], s64 offen offset:896 lds
  v_mfma_f32_16x16x32_bf16 v[44:47], v[68:71], a[244:247], v[44:47]
  s_waitcnt lgkmcnt(4)
  v_mfma_f32_16x16x32_bf16 v[32:35], v[72:75], a[248:251], v[32:35]
  ds_read_b128 v[64:67], v8 offset:4096
  v_mfma_f32_16x16x32_bf16 v[36:39], v[72:75], a[252:255], v[36:39]
  buffer_load_dword v7, v6, s[48:51], s60 offen
  v_mfma_f32_16x16x32_bf16 v[40:43], v[76:79], a[248:251], v[40:43]
  ds_read_b128 v[68:71], v8 offset:6144
  s_mov_b32 s59, 262144
  s_mov_b32 s58, 2
  s_mov_b32 s60, 0x20000
  v_mfma_f32_16x16x32_bf16 v[44:47], v[76:79], a[252:255], v[44:47]
L_p_loopV:
  s_waitcnt vmcnt(16)
  s_barrier
  s_add_u32 s57, s60, 0x10000
  s_waitcnt lgkmcnt(4)
  v_mfma_f32_16x16x32_bf16 v[16:19], v[48:51], a[0:3], 0
  ds_read_b128 v[72:75], v9 offset:4096
  v_mfma_f32_16x16x32_bf16 v[20:23], v[48:51], a[4:7], 0
  buffer_load_dword v7, v6, s[48:51], s60 offen
  v_mfma_f32_16x16x32_bf16 v[24:27], v[52:55], a[0:3], 0
  ds_read_b128 v[76:79], v9 offset:6144
  s_cmp_eq_u32 s58, 8
  s_cbranch_scc1 L_em_22_s
L_em_22:
  v_mfma_f32_16x16x32_bf16 v[28:31], v[52:55], a[4:7], 0
  s_waitcnt lgkmcnt(4)
  v_mfma_f32_16x16x32_bf16 v[16:19], v[56:59], a[8:11], v[16:19]
  ds_read_b128 v[48:51], v8 offset:8192
  s_add_u32 m0, s61, 97280
  v_mfma_f32_16x16x32_bf16 v[20:23], v[56:59], a[12:15], v[20:23]
  buffer_load_dwordx4 v4, s[48:51], s57 offen offset:1024 lds
  v_cvt_pk_bf16_f32 v84, v32, v33
  v_mfma_f32_16x16x32_bf16 v[24:27], v[60:63], a[8:11], v[24:27]
  ds_read_b128 v[52:55], v8 offset:10240
  v_cvt_pk_bf16_f32 v85, v34, v35
  v_mfma_f32_16x16x32_bf16 v[28:31], v[60:63], a[12:15], v[28:31]
  v_cvt_pk_bf16_f32 v86, v40, v41
  s_waitcnt lgkmcnt(4)
  v_mfma_f32_16x16x32_bf16 v[16:19], v[64:67], a[16:19], v[16:19]
  ds_read_b128 v[56:59], v9 offset:8192
  v_cvt_pk_bf16_f32 v87, v42, v43
  v_mfma_f32_16x16x32_bf16 v[20:23], v[64:67], a[20:23], v[20:23]
  buffer_store_dwordx4 v[84:87], v5, s[52:55], s59 offen offset:0 sc1
  v_mfma_f32_16x16x32_bf16 v[24:27], v[68:71], a[16:19], v[24:27]
  ds_read_b128 v[60:63], v9 offset:10240
  v_mfma_f32_16x16x32_bf16 v[28:31], v[68:71], a[20:23], v[28:31]
  s_waitcnt lgkmcnt(4)
  v_mfma_f32_16x16x32_bf16 v[16:19], v[72:75], a[24:27], v[16:19]
  ds_read_b128 v[64:67], v8 offset:12288
  s_add_u32 m0, s61, 101248
  v_mfma_f32_16x16x32_bf16 v[20:23], v[72:75], a[28:31], v[20:23]
  buffer_load_dwordx4 v4, s[48:51], s57 offen offset:1152 lds
  v_cvt_pk_bf16_f32 v88, v36, v37
  v_mfma_f32_16x16x32_bf16 v[24:27], v[76:79], a[24:27], v[24:27]
  ds_read_b128 v[68:71], v8 offset:14336
  v_cvt_pk_bf16_f32 v89, v38, v39
  v_mfma_f32_16x16x32_bf16 v[28:31], v[76:79], a[28:31], v[28:31]
  v_cvt_pk_bf16_f32 v90, v44, v45
  s_waitcnt lgkmcnt(4)
  v_mfma_f32_16x16x32_bf16 v[16:19], v[48:51], a[32:35], v[16:19]
  ds_read_b128 v[72:75], v9 offset:12288
  v_cvt_pk_bf16_f32 v91, v46, v47
  v_mfma_f32_16x16x32_bf16 v[20:23], v[48:51], a[36:39], v[20:23]
  buffer_store_dwordx4 v[88:91], v5, s[52:55], s59 offen offset:1024 sc1
  v_mfma_f32_16x16x32_bf16 v[24:27], v[52:55], a[32:35], v[24:27]
  ds_read_b128 v[76:79], v9 offset:14336
  v_mfma_f32_16x16x32_bf16 v[28:31], v[52:55], a[36:39], v[28:31]
  s_waitcnt lgkmcnt(4)
  v_mfma_f32_16x16x32_bf16 v[16:19], v[56:59], a[40:43], v[16:19]
  ds_read_b128 v[48:51], v8 offset:16384
  s_add_u32 m0, s61, 105216
  v_mfma_f32_16x16x32_bf16 v[20:23], v[56:59], a[44:47], v[20:23]
  buffer_load_dwordx4 v4, s[48:51], s57 offen offset:1280 lds
  v_mfma_f32_16x16x32_bf16 v[24:27], v[60:63], a[40:43], v[24:27]
  ds_read_b128 v[52:55], v8 offset:18432
  v_mfma_f32_16x16x32_bf16 v[28:31], v[60:63], a[44:47], v[28:31]
  s_waitcnt lgkmcnt(4)
  v_mfma_f32_16x16x32_bf16 v[16:19], v[64:67], a[48:51], v[16:19]
  ds_read_b128 v[56:59], v9 offset:16384
  v_mfma_f32_16x16x32_bf16 v[20:23], v[64:67], a[52:55], v[20:23]
  v_mfma_f32_16x16x32_bf16 v[24:27], v[68:71], a[48:51], v[24:27]
  ds_read_b128 v[60:63], v9 offset:18432
  v_mfma_f32_16x16x32_bf16 v[28:31], v[68:71], a[52:55], v[28:31]
  s_waitcnt lgkmcnt(4)
  v_mfma_f32_16x16x32_bf16 v[16:19], v[72:75], a[56:59], v[16:19]
  ds_read_b128 v[64:67], v8 offset:20480
  s_add_u32 m0, s61, 109184
  v_mfma_f32_16x16x32_bf16 v[20:23], v[72:75], a[60:63], v[20:23]
  buffer_load_dwordx4 v4, s[48:51], s57 offen offset:1408 lds
  v_mfma_f32_16x16x32_bf16 v[24:27], v[76:79], a[56:59], v[24:27]
  ds_read_b128 v[68:71], v8 offset:22528
  v_mfma_f32_16x16x32_bf16 v[28:31], v[76:79], a[60:63], v[28:31]
  s_waitcnt vmcnt(16)
  s_barrier
  s_waitcnt lgkmcnt(4)
  v_mfma_f32_16x16x32_bf16 v[16:19], v[48:51], a[64:67], v[16:19]
  ds_read_b128 v[72:75], v9 offset:20480
  v_mfma_f32_16x16x32_bf16 v[20:23], v[48:51], a[68:71], v[20:23]
  v_mfma_f32_16x16x32_bf16 v[24:27], v[52:55], a[64:67], v[24:27]
  ds_read_b128 v[76:79], v9 offset:22528
  v_mfma_f32_16x16x32_bf16 v[28:31], v[52:55], a[68:71], v[28:31]
  s_waitcnt lgkmcnt(4)
  v_mfma_f32_16x16x32_bf16 v[16:19], v[56:59], a[72:75], v[16:19]
  ds_read_b128 v[48:51], v8 offset:24576
  s_add_u32 m0, s61, 113152
  v_mfma_f32_16x16x32_bf16 v[20:23], v[56:59], a[76:79], v[20:23]
  buffer_load_dwordx4 v4, s[48:51], s57 offen offset:1536 lds
  v_mfma_f32_16x16x32_bf16 v[24:27], v[60:63], a[72:75], v[24:27]
  ds_read_b128 v[52:55], v8 offset:26624
  v_mfma_f32_16x16x32_bf16 v[28:31], v[60:63], a[76:79], v[28:31]
  s_waitcnt lgkmcnt(4)
  v_mfma_f32_16x16x32_bf16 v[16:19], v[64:67], a[80:83], v[16:19]
  ds_read_b128 v[56:59], v9 offset:24576
  v_mfma_f32_16x16x32_bf16 v[20:23], v[64:67], a[84:87], v[20:23]
  v_mfma_f32_16x16x32_bf16 v[24:27], v[68:71], a[80:83], v[24:27]
  ds_read_b128 v[60:63], v9 offset:26624
  v_mfma_f32_16x16x32_bf16 v[28:31], v[68:71], a[84:87], v[28:31]
  s_waitcnt lgkmcnt(4)
  v_mfma_f32_16x16x32_bf16 v[16:19], v[72:75], a[88:91], v[16:19]
  ds_read_b128 v[64:67], v8 offset:28672
  s_add_u32 m0, s61, 117120
  v_mfma_f32_16x16x32_bf16 v[20:23], v[72:75], a[92:95], v[20:23]
  buffer_load_dwordx4 v4, s[48:51], s57 offen offset:1664 lds
  v_mfma_f32_16x16x32_bf16 v[24:27], v[76:79], a[88:91], v[24:27]
  ds_read_b128 v[68:71], v8 offset:30720
  v_mfma_f32_16x16x32_bf16 v[28:31], v[76:79], a[92:95], v[28:31]
  s_waitcnt lgkmcnt(4)
  v_mfma_f32_16x16x32_bf16 v[16:19], v[48:51], a[96:99], v[16:19]
  ds_read_b128 v[72:75], v9 offset:28672
  v_mfma_f32_16x16x32_bf16 v[20:23], v[48:51], a[100:103], v[20:23]
  v_mfma_f32_16x16x32_bf16 v[24:27], v[52:55], a[96:99], v[24:27]
  ds_read_b128 v[76:79], v9 offset:30720
  v_mfma_f32_16x16x32_bf16 v[28:31], v[52:55], a[100:103], v[28:31]
  s_waitcnt lgkmcnt(4)
  v_mfma_f32_16x16x32_bf16 v[16:19], v[56:59], a[104:107], v[16:19]
  ds_read_b128 v[48:51], v8 offset:32768
  s_add_u32 m0, s61, 121088
  v_mfma_f32_16x16x32_bf16 v[20:23], v[56:59], a[108:111], v[20:23]
  buffer_load_dwordx4 v4, s[48:51], s57 offen offset:1792 lds
  v_mfma_f32_16x16x32_bf16 v[24:27], v[60:63], a[104:107], v[24:27]
  ds_read_b128 v[52:55], v8 offset:34816
  v_mfma_f32_16x16x32_bf16 v[28:31], v[60:63], a[108:111], v[28:31]
  s_waitcnt lgkmcnt(4)
  v_mfma_f32_16x16x32_bf16 v[16:19], v[64:67], a[112:115], v[16:19]
  ds_read_b128 v[56:59], v9 offset:32768
  v_mfma_f32_16x16x32_bf16 v[20:23], v[64:67], a[116:119], v[20:23]
  v_mfma_f32_16x16x32_bf16 v[24:27], v[68:71], a[112:115], v[24:27]
  ds_read_b128 v[60:63], v9 offset:34816
  v_mfma_f32_16x16x32_bf16 v[28:31], v[68:71], a[116:119], v[28:31]
  s_waitcnt lgkmcnt(4)
  v_mfma_f32_16x16x32_bf16 v[16:19], v[72:75], a[120:123], v[16:19]
  ds_read_b128 v[64:67], v8 offset:36864
  s_add_u32 m0, s61, 125056
  v_mfma_f32_16x16x32_bf16 v[20:23], v[72:75], a[124:127], v[20:23]
  buffer_load_dwordx4 v4, s[48:51], s57 offen offset:1920 lds
  v_mfma_f32_16x16x32_bf16 v[24:27], v[76:79], a[120:123], v[24:27]
  ds_read_b128 v[68:71], v8 offset:38912
  v_mfma_f32_16x16x32_bf16 v[28:31], v[76:79], a[124:127], v[28:31]
  s_waitcnt vmcnt(16)
  s_barrier
  s_add_u32 s57, s60, 0x20000
  s_waitcnt lgkmcnt(4)
  v_mfma_f32_16x16x32_bf16 v[16:19], v[48:51], a[128:131], v[16:19]
  ds_read_b128 v[72:75], v9 offset:36864
  v_mfma_f32_16x16x32_bf16 v[20:23], v[48:51], a[132:135], v[20:23]
  s_waitcnt vmcnt(6)
  s_atomic_add s92, s[34:35], s83
  v_mfma_f32_16x16x32_bf16 v[24:27], v[52:55], a[128:131], v[24:27]
  ds_read_b128 v[76:79], v9 offset:38912
  v_mfma_f32_16x16x32_bf16 v[28:31], v[52:55], a[132:135], v[28:31]
  s_waitcnt lgkmcnt(4)
  v_mfma_f32_16x16x32_bf16 v[16:19], v[56:59], a[136:139], v[16:19]
  ds_read_b128 v[48:51], v8 offset:40960
  s_add_u32 m0, s61, 0
  v_mfma_f32_16x16x32_bf16 v[20:23], v[56:59], a[140:143], v[20:23]
  buffer_load_dwordx4 v4, s[48:51], s57 offen offset:0 lds
  v_mfma_f32_16x16x32_bf16 v[24:27], v[60:63], a[136:139], v[24:27]
  ds_read_b128 v[52:55], v8 offset:43008
  v_mfma_f32_16x16x32_bf16 v[28:31], v[60:63], a[140:143], v[28:31]
  s_waitcnt lgkmcnt(4)
  v_mfma_f32_16x16x32_bf16 v[16:19], v[64:67], a[144:147], v[16:19]
  ds_read_b128 v[56:59], v9 offset:40960
  v_mfma_f32_16x16x32_bf16 v[20:23], v[64:67], a[148:151], v[20:23]
  v_mfma_f32_16x16x32_bf16 v[24:27], v[68:71], a[144:147], v[24:27]
  ds_read_b128 v[60:63], v9 offset:43008
  v_mfma_f32_16x16x32_bf16 v[28:31], v[68:71], a[148:151], v[28:31]
  s_waitcnt lgkmcnt(4)
  v_mfma_f32_16x16x32_bf16 v[16:19], v[72:75], a[152:155], v[16:19]
  ds_read_b128 v[64:67], v8 offset:45056
  s_add_u32 m0, s61, 3968
  v_mfma_f32_16x16x32_bf16 v[20:23], v[72:75], a[156:159], v[20:23]
  buffer_load_dwordx4 v4, s[48:51], s57 offen offset:128 lds
  v_mfma_f32_16x16x32_bf16 v[24:27], v[76:79], a[152:155], v[24:27]
  ds_read_b128 v[68:71], v8 offset:47104
  v_mfma_f32_16x16x32_bf16 v[28:31], v[76:79], a[156:159], v[28:31]
  s_waitcnt lgkmcnt(4)
  v_mfma_f32_16x16x32_bf16 v[16:19], v[48:51], a[160:163], v[16:19]
  ds_read_b128 v[72:75], v9 offset:45056
  v_mfma_f32_16x16x32_bf16 v[20:23], v[48:51], a[164:167], v[20:23]
  v_mfma_f32_16x16x32_bf16 v[24:27], v[52:55], a[160:163], v[24:27]
  ds_read_b128 v[76:79], v9 offset:47104
  v_mfma_f32_16x16x32_bf16 v[28:31], v[52:55], a[164:167], v[28:31]
  s_waitcnt lgkmcnt(4)
  v_mfma_f32_16x16x32_bf16 v[16:19], v[56:59], a[168:171], v[16:19]
  ds_read_b128 v[48:51], v8 offset:49152
  s_add_u32 m0, s61, 7936
  v_mfma_f32_16x16x32_bf16 v[20:23], v[56:59], a[172:175], v[20:23]
  buffer_load_dwordx4 v4, s[48:51], s57 offen offset:256 lds
  v_mfma_f32_16x16x32_bf16 v[24:27], v[60:63], a[168:171], v[24:27]
  ds_read_b128 v[52:55], v8 offset:51200
  v_mfma_f32_16x16x32_bf16 v[28:31], v[60:63], a[172:175], v[28:31]
  s_waitcnt lgkmcnt(4)
  v_mfma_f32_16x16x32_bf16 v[16:19], v[64:67], a[176:179], v[16:19]
  ds_read_b128 v[56:59], v9 offset:49152
  v_mfma_f32_16x16x32_bf16 v[20:23], v[64:67], a[180:183], v[20:23]
  v_mfma_f32_16x16x32_bf16 v[24:27], v[68:71], a[176:179], v[24:27]
  ds_read_b128 v[60:63], v9 offset:51200
  v_mfma_f32_16x16x32_bf16 v[28:31], v[68:71], a[180:183], v[28:31]
  s_waitcnt lgkmcnt(4)
  v_mfma_f32_16x16x32_bf16 v[16:19], v[72:75], a[184:187], v[16:19]
  ds_read_b128 v[64:67], v8 offset:53248
  s_add_u32 m0, s61, 11904
  v_mfma_f32_16x16x32_bf16 v[20:23], v[72:75], a[188:191], v[20:23]
  buffer_load_dwordx4 v4, s[48:51], s57 offen offset:384 lds
  v_mfma_f32_16x16x32_bf16 v[24:27], v[76:79], a[184:187], v[24:27]
  ds_read_b128 v[68:71], v8 offset:55296
  v_mfma_f32_16x16x32_bf16 v[28:31], v[76:79], a[188:191], v[28:31]
  s_waitcnt vmcnt(16)
  s_barrier
  s_waitcnt lgkmcnt(4)
  v_mfma_f32_16x16x32_bf16 v[16:19], v[48:51], a[192:195], v[16:19]
  ds_read_b128 v[72:75], v9 offset:53248
  v_mfma_f32_16x16x32_bf16 v[20:23], v[48:51], a[196:199], v[20:23]
  v_mfma_f32_16x16x32_bf16 v[24:27], v[52:55], a[192:195], v[24:27]
  ds_read_b128 v[76:79], v9 offset:55296
  v_mfma_f32_16x16x32_bf16 v[28:31], v[52:55], a[196:199], v[28:31]
  s_waitcnt lgkmcnt(4)
  v_mfma_f32_16x16x32_bf16 v[16:19], v[56:59], a[200:203], v[16:19]
  ds_read_b128 v[48:51], v8 offset:57344
  s_add_u32 m0, s61, 15872
  v_mfma_f32_16x16x32_bf16 v[20:23], v[56:59], a[204:207], v[20:23]
  buffer_load_dwordx4 v4, s[48:51], s57 offen offset:512 lds
  v_mfma_f32_16x16x32_bf16 v[24:27], v[60:63], a[200:203], v[24:27]
  ds_read_b128 v[52:55], v8 offset:59392
  v_mfma_f32_16x16x32_bf16 v[28:31], v[60:63], a[204:207], v[28:31]
  s_waitcnt lgkmcnt(4)
  v_mfma_f32_16x16x32_bf16 v[16:19], v[64:67], a[208:211], v[16:19]
  ds_read_b128 v[56:59], v9 offset:57344
  v_mfma_f32_16x16x32_bf16 v[20:23], v[64:67], a[212:215], v[20:23]
  v_mfma_f32_16x16x32_bf16 v[24:27], v[68:71], a[208:211], v[24:27]
  ds_read_b128 v[60:63], v9 offset:59392
  v_mfma_f32_16x16x32_bf16 v[28:31], v[68:71], a[212:215], v[28:31]
  s_waitcnt lgkmcnt(4)
  v_mfma_f32_16x16x32_bf16 v[16:19], v[72:75], a[216:219], v[16:19]
  ds_read_b128 v[64:67], v8 offset:61440
  s_add_u32 m0, s61, 19840
  v_mfma_f32_16x16x32_bf16 v[20:23], v[72:75], a[220:223], v[20:23]
  buffer_load_dwordx4 v4, s[48:51], s57 offen offset:640 lds
  v_mfma_f32_16x16x32_bf16 v[24:27], v[76:79], a[216:219], v[24:27]
  ds_read_b128 v[68:71], v8 offset:63488
  v_mfma_f32_16x16x32_bf16 v[28:31], v[76:79], a[220:223], v[28:31]
  s_waitcnt lgkmcnt(4)
  v_mfma_f32_16x16x32_bf16 v[16:19], v[48:51], a[224:227], v[16:19]
  ds_read_b128 v[72:75], v9 offset:61440
  v_mfma_f32_16x16x32_bf16 v[20:23], v[48:51], a[228:231], v[20:23]
  v_mfma_f32_16x16x32_bf16 v[24:27], v[52:55], a[224:227], v[24:27]
  ds_read_b128 v[76:79], v9 offset:63488
  v_mfma_f32_16x16x32_bf16 v[28:31], v[52:55], a[228:231], v[28:31]
  s_waitcnt lgkmcnt(4)
  v_mfma_f32_16x16x32_bf16 v[16:19], v[56:59], a[232:235], v[16:19]
  ds_read_b128 v[48:51], v10 offset:0
  s_add_u32 m0, s61, 23808
  v_mfma_f32_16x16x32_bf16 v[20:23], v[56:59], a[236:239], v[20:23]
  buffer_load_dwordx4 v4, s[48:51], s57 offen offset:768 lds
  v_mfma_f32_16x16x32_bf16 v[24:27], v[60:63], a[232:235], v[24:27]
  ds_read_b128 v[52:55], v10 offset:2048
  v_mfma_f32_16x16x32_bf16 v[28:31], v[60:63], a[236:239], v[28:31]
  s_waitcnt lgkmcnt(4)
  v_mfma_f32_16x16x32_bf16 v[16:19], v[64:67], a[240:243], v[16:19]
  ds_read_b128 v[56:59], v11 offset:0
  v_mfma_f32_16x16x32_bf16 v[20:23], v[64:67], a[244:247], v[20:23]
  s_lshl_b32 s59, s58, 18
  s_add_u32 s58, s58, 1
  v_mfma_f32_16x16x32_bf16 v[24:27], v[68:71], a[240:243], v[24:27]
  ds_read_b128 v[60:63], v11 offset:2048
  v_mfma_f32_16x16x32_bf16 v[28:31], v[68:71], a[244:247], v[28:31]
  s_waitcnt lgkmcnt(4)
  v_mfma_f32_16x16x32_bf16 v[16:19], v[72:75], a[248:251], v[16:19]
  ds_read_b128 v[64:67], v10 offset:4096
  s_add_u32 m0, s61, 27776
  v_mfma_f32_16x16x32_bf16 v[20:23], v[72:75], a[252:255], v[20:23]
  buffer_load_dwordx4 v4, s[48:51], s57 offen offset:896 lds
  v_mfma_f32_16x16x32_bf16 v[24:27], v[76:79], a[248:251], v[24:27]
  ds_read_b128 v[68:71], v10 offset:6144
  s_add_u32 s60, s60, 0x10000
  v_mfma_f32_16x16x32_bf16 v[28:31], v[76:79], a[252:255], v[28:31]
  s_waitcnt vmcnt(16)
  s_barrier
  s_add_u32 s57, s60, 0x10000
  s_waitcnt lgkmcnt(4)
  v_mfma_f32_16x16x32_bf16 v[32:35], v[48:51], a[0:3], 0
  ds_read_b128 v[72:75], v11 offset:4096
  v_mfma_f32_16x16x32_bf16 v[36:39], v[48:51], a[4:7], 0
  buffer_load_dword v7, v6, s[48:51], s60 offen
  v_mfma_f32_16x16x32_bf16 v[40:43], v[52:55], a[0:3], 0
  ds_read_b128 v[76:79], v11 offset:6144
  v_mfma_f32_16x16x32_bf16 v[44:47], v[52:55], a[4:7], 0
  s_waitcnt lgkmcnt(4)
  v_mfma_f32_16x16x32_bf16 v[32:35], v[56:59], a[8:11], v[32:35]
  ds_read_b128 v[48:51], v10 offset:8192
  s_add_u32 m0, s61, 31744
  v_mfma_f32_16x16x32_bf16 v[36:39], v[56:59], a[12:15], v[36:39]
  buffer_load_dwordx4 v4, s[48:51], s57 offen offset:1024 lds
  v_cvt_pk_bf16_f32 v84, v16, v17
  v_mfma_f32_16x16x32_bf16 v[40:43], v[60:63], a[8:11], v[40:43]
  ds_read_b128 v[52:55], v10 offset:10240
  v_cvt_pk_bf16_f32 v85, v18, v19
  v_mfma_f32_16x16x32_bf16 v[44:47], v[60:63], a[12:15], v[44:47]
  v_cvt_pk_bf16_f32 v86, v24, v25
  s_waitcnt lgkmcnt(4)
  v_mfma_f32_16x16x32_bf16 v[32:35], v[64:67], a[16:19], v[32:35]
  ds_read_b128 v[56:59], v11 offset:8192
  v_cvt_pk_bf16_f32 v87, v26, v27
  v_mfma_f32_16x16x32_bf16 v[36:39], v[64:67], a[20:23], v[36:39]
  buffer_store_dwordx4 v[84:87], v5, s[52:55], s59 offen offset:0 sc1
  v_mfma_f32_16x16x32_bf16 v[40:43], v[68:71], a[16:19], v[40:43]
  ds_read_b128 v[60:63], v11 offset:10240
  v_mfma_f32_16x16x32_bf16 v[44:47], v[68:71], a[20:23], v[44:47]
  s_waitcnt lgkmcnt(4)
  v_mfma_f32_16x16x32_bf16 v[32:35], v[72:75], a[24:27], v[32:35]
  ds_read_b128 v[64:67], v10 offset:12288
  s_add_u32 m0, s61, 35712
  v_mfma_f32_16x16x32_bf16 v[36:39], v[72:75], a[28:31], v[36:39]
  buffer_load_dwordx4 v4, s[48:51], s57 offen offset:1152 lds
  v_cvt_pk_bf16_f32 v88, v20, v21
  v_mfma_f32_16x16x32_bf16 v[40:43], v[76:79], a[24:27], v[40:43]
  ds_read_b128 v[68:71], v10 offset:14336
  v_cvt_pk_bf16_f32 v89, v22, v23
  v_mfma_f32_16x16x32_bf16 v[44:47], v[76:79], a[28:31], v[44:47]
  v_cvt_pk_bf16_f32 v90, v28, v29
  s_waitcnt lgkmcnt(4)
  v_mfma_f32_16x16x32_bf16 v[32:35], v[48:51], a[32:35], v[32:35]
  ds_read_b128 v[72:75], v11 offset:12288
  v_cvt_pk_bf16_f32 v91, v30, v31
  v_mfma_f32_16x16x32_bf16 v[36:39], v[48:51], a[36:39], v[36:39]
  buffer_store_dwordx4 v[88:91], v5, s[52:55], s59 offen offset:1024 sc1
  v_mfma_f32_16x16x32_bf16 v[40:43], v[52:55], a[32:35], v[40:43]
  ds_read_b128 v[76:79], v11 offset:14336
  v_mfma_f32_16x16x32_bf16 v[44:47], v[52:55], a[36:39], v[44:47]
  s_waitcnt lgkmcnt(4)
  v_mfma_f32_16x16x32_bf16 v[32:35], v[56:59], a[40:43], v[32:35]
  ds_read_b128 v[48:51], v10 offset:16384
  s_add_u32 m0, s61, 39680
  v_mfma_f32_16x16x32_bf16 v[36:39], v[56:59], a[44:47], v[36:39]
  buffer_load_dwordx4 v4, s[48:51], s57 offen offset:1280 lds
  v_mfma_f32_16x16x32_bf16 v[40:43], v[60:63], a[40:43], v[40:43]
  ds_read_b128 v[52:55], v10 offset:18432
  v_mfma_f32_16x16x32_bf16 v[44:47], v[60:63], a[44:47], v[44:47]
  s_waitcnt lgkmcnt(4)
  v_mfma_f32_16x16x32_bf16 v[32:35], v[64:67], a[48:51], v[32:35]
  ds_read_b128 v[56:59], v11 offset:16384
  v_mfma_f32_16x16x32_bf16 v[36:39], v[64:67], a[52:55], v[36:39]
  v_mfma_f32_16x16x32_bf16 v[40:43], v[68:71], a[48:51], v[40:43]
  ds_read_b128 v[60:63], v11 offset:18432
  v_mfma_f32_16x16x32_bf16 v[44:47], v[68:71], a[52:55], v[44:47]
  s_waitcnt lgkmcnt(4)
  v_mfma_f32_16x16x32_bf16 v[32:35], v[72:75], a[56:59], v[32:35]
  ds_read_b128 v[64:67], v10 offset:20480
  s_add_u32 m0, s61, 43648
  v_mfma_f32_16x16x32_bf16 v[36:39], v[72:75], a[60:63], v[36:39]
  buffer_load_dwordx4 v4, s[48:51], s57 offen offset:1408 lds
  v_mfma_f32_16x16x32_bf16 v[40:43], v[76:79], a[56:59], v[40:43]
  ds_read_b128 v[68:71], v10 offset:22528
  v_mfma_f32_16x16x32_bf16 v[44:47], v[76:79], a[60:63], v[44:47]
  s_waitcnt vmcnt(16)
  s_barrier
  s_waitcnt lgkmcnt(4)
  v_mfma_f32_16x16x32_bf16 v[32:35], v[48:51], a[64:67], v[32:35]
  ds_read_b128 v[72:75], v11 offset:20480
  v_mfma_f32_16x16x32_bf16 v[36:39], v[48:51], a[68:71], v[36:39]
  v_mfma_f32_16x16x32_bf16 v[40:43], v[52:55], a[64:67], v[40:43]
  ds_read_b128 v[76:79], v11 offset:22528
  v_mfma_f32_16x16x32_bf16 v[44:47], v[52:55], a[68:71], v[44:47]
  s_waitcnt lgkmcnt(4)
  v_mfma_f32_16x16x32_bf16 v[32:35], v[56:59], a[72:75], v[32:35]
  ds_read_b128 v[48:51], v10 offset:24576
  s_add_u32 m0, s61, 47616
  v_mfma_f32_16x16x32_bf16 v[36:39], v[56:59], a[76:79], v[36:39]
  buffer_load_dwordx4 v4, s[48:51], s57 offen offset:1536 lds
  v_mfma_f32_16x16x32_bf16 v[40:43], v[60:63], a[72:75], v[40:43]
  ds_read_b128 v[52:55], v10 offset:26624
  v_mfma_f32_16x16x32_bf16 v[44:47], v[60:63], a[76:79], v[44:47]
  s_waitcnt lgkmcnt(4)
  v_mfma_f32_16x16x32_bf16 v[32:35], v[64:67], a[80:83], v[32:35]
  ds_read_b128 v[56:59], v11 offset:24576
  v_mfma_f32_16x16x32_bf16 v[36:39], v[64:67], a[84:87], v[36:39]
  v_mfma_f32_16x16x32_bf16 v[40:43], v[68:71], a[80:83], v[40:43]
  ds_read_b128 v[60:63], v11 offset:26624
  v_mfma_f32_16x16x32_bf16 v[44:47], v[68:71], a[84:87], v[44:47]
  s_waitcnt lgkmcnt(4)
  v_mfma_f32_16x16x32_bf16 v[32:35], v[72:75], a[88:91], v[32:35]
  ds_read_b128 v[64:67], v10 offset:28672
  s_add_u32 m0, s61, 51584
  v_mfma_f32_16x16x32_bf16 v[36:39], v[72:75], a[92:95], v[36:39]
  buffer_load_dwordx4 v4, s[48:51], s57 offen offset:1664 lds
  v_mfma_f32_16x16x32_bf16 v[40:43], v[76:79], a[88:91], v[40:43]
  ds_read_b128 v[68:71], v10 offset:30720
  v_mfma_f32_16x16x32_bf16 v[44:47], v[76:79], a[92:95], v[44:47]
  s_waitcnt lgkmcnt(4)
  v_mfma_f32_16x16x32_bf16 v[32:35], v[48:51], a[96:99], v[32:35]
  ds_read_b128 v[72:75], v11 offset:28672
  v_mfma_f32_16x16x32_bf16 v[36:39], v[48:51], a[100:103], v[36:39]
  v_mfma_f32_16x16x32_bf16 v[40:43], v[52:55], a[96:99], v[40:43]
  ds_read_b128 v[76:79], v11 offset:30720
  v_mfma_f32_16x16x32_bf16 v[44:47], v[52:55], a[100:103], v[44:47]
  s_waitcnt lgkmcnt(4)
  v_mfma_f32_16x16x32_bf16 v[32:35], v[56:59], a[104:107], v[32:35]
  ds_read_b128 v[48:51], v10 offset:32768
  s_add_u32 m0, s61, 55552
  v_mfma_f32_16x16x32_bf16 v[36:39], v[56:59], a[108:111], v[36:39]
  buffer_load_dwordx4 v4, s[48:51], s57 offen offset:1792 lds
  v_mfma_f32_16x16x32_bf16 v[40:43], v[60:63], a[104:107], v[40:43]
  ds_read_b128 v[52:55], v10 offset:34816
  v_mfma_f32_16x16x32_bf16 v[44:47], v[60:63], a[108:111], v[44:47]
  s_waitcnt lgkmcnt(4)
  v_mfma_f32_16x16x32_bf16 v[32:35], v[64:67], a[112:115], v[32:35]
  ds_read_b128 v[56:59], v11 offset:32768
  v_mfma_f32_16x16x32_bf16 v[36:39], v[64:67], a[116:119], v[36:39]
  v_mfma_f32_16x16x32_bf16 v[40:43], v[68:71], a[112:115], v[40:43]
  ds_read_b128 v[60:63], v11 offset:34816
  v_mfma_f32_16x16x32_bf16 v[44:47], v[68:71], a[116:119], v[44:47]
  s_waitcnt lgkmcnt(4)
  v_mfma_f32_16x16x32_bf16 v[32:35], v[72:75], a[120:123], v[32:35]
  ds_read_b128 v[64:67], v10 offset:36864
  s_add_u32 m0, s61, 59520
  v_mfma_f32_16x16x32_bf16 v[36:39], v[72:75], a[124:127], v[36:39]
  buffer_load_dwordx4 v4, s[48:51], s57 offen offset:1920 lds
  v_mfma_f32_16x16x32_bf16 v[40:43], v[76:79], a[120:123], v[40:43]
  ds_read_b128 v[68:71], v10 offset:38912
  v_mfma_f32_16x16x32_bf16 v[44:47], v[76:79], a[124:127], v[44:47]
  s_waitcnt vmcnt(16)
  s_barrier
  s_add_u32 s57, s60, 0x20000
  s_waitcnt lgkmcnt(4)
  v_mfma_f32_16x16x32_bf16 v[32:35], v[48:51], a[128:131], v[32:35]
  ds_read_b128 v[72:75], v11 offset:36864
  v_mfma_f32_16x16x32_bf16 v[36:39], v[48:51], a[132:135], v[36:39]
  s_waitcnt vmcnt(6)
  s_atomic_add s92, s[34:35], s83
  v_mfma_f32_16x16x32_bf16 v[40:43], v[52:55], a[128:131], v[40:43]
  ds_read_b128 v[76:79], v11 offset:38912
  v_mfma_f32_16x16x32_bf16 v[44:47], v[52:55], a[132:135], v[44:47]
  s_waitcnt lgkmcnt(4)
  v_mfma_f32_16x16x32_bf16 v[32:35], v[56:59], a[136:139], v[32:35]
  ds_read_b128 v[48:51], v10 offset:40960
  s_add_u32 m0, s61, 65536
  v_mfma_f32_16x16x32_bf16 v[36:39], v[56:59], a[140:143], v[36:39]
  buffer_load_dwordx4 v4, s[48:51], s57 offen offset:0 lds
  v_mfma_f32_16x16x32_bf16 v[40:43], v[60:63], a[136:139], v[40:43]
  ds_read_b128 v[52:55], v10 offset:43008
  v_mfma_f32_16x16x32_bf16 v[44:47], v[60:63], a[140:143], v[44:47]
  s_waitcnt lgkmcnt(4)
  v_mfma_f32_16x16x32_bf16 v[32:35], v[64:67], a[144:147], v[32:35]
  ds_read_b128 v[56:59], v11 offset:40960
  v_mfma_f32_16x16x32_bf16 v[36:39], v[64:67], a[148:151], v[36:39]
  v_mfma_f32_16x16x32_bf16 v[40:43], v[68:71], a[144:147], v[40:43]
  ds_read_b128 v[60:63], v11 offset:43008
  v_mfma_f32_16x16x32_bf16 v[44:47], v[68:71], a[148:151], v[44:47]
  s_waitcnt lgkmcnt(4)
  v_mfma_f32_16x16x32_bf16 v[32:35], v[72:75], a[152:155], v[32:35]
  ds_read_b128 v[64:67], v10 offset:45056
  s_add_u32 m0, s61, 69504
  v_mfma_f32_16x16x32_bf16 v[36:39], v[72:75], a[156:159], v[36:39]
  buffer_load_dwordx4 v4, s[48:51], s57 offen offset:128 lds
  v_mfma_f32_16x16x32_bf16 v[40:43], v[76:79], a[152:155], v[40:43]
  ds_read_b128 v[68:71], v10 offset:47104
  v_mfma_f32_16x16x32_bf16 v[44:47], v[76:79], a[156:159], v[44:47]
  s_waitcnt lgkmcnt(4)
  v_mfma_f32_16x16x32_bf16 v[32:35], v[48:51], a[160:163], v[32:35]
  ds_read_b128 v[72:75], v11 offset:45056
  v_mfma_f32_16x16x32_bf16 v[36:39], v[48:51], a[164:167], v[36:39]
  v_mfma_f32_16x16x32_bf16 v[40:43], v[52:55], a[160:163], v[40:43]
  ds_read_b128 v[76:79], v11 offset:47104
  v_mfma_f32_16x16x32_bf16 v[44:47], v[52:55], a[164:167], v[44:47]
  s_waitcnt lgkmcnt(4)
  v_mfma_f32_16x16x32_bf16 v[32:35], v[56:59], a[168:171], v[32:35]
  ds_read_b128 v[48:51], v10 offset:49152
  s_add_u32 m0, s61, 73472
  v_mfma_f32_16x16x32_bf16 v[36:39], v[56:59], a[172:175], v[36:39]
  buffer_load_dwordx4 v4, s[48:51], s57 offen offset:256 lds
  v_mfma_f32_16x16x32_bf16 v[40:43], v[60:63], a[168:171], v[40:43]
  ds_read_b128 v[52:55], v10 offset:51200
  v_mfma_f32_16x16x32_bf16 v[44:47], v[60:63], a[172:175], v[44:47]
  s_waitcnt lgkmcnt(4)
  v_mfma_f32_16x16x32_bf16 v[32:35], v[64:67], a[176:179], v[32:35]
  ds_read_b128 v[56:59], v11 offset:49152
  v_mfma_f32_16x16x32_bf16 v[36:39], v[64:67], a[180:183], v[36:39]
  v_mfma_f32_16x16x32_bf16 v[40:43], v[68:71], a[176:179], v[40:43]
  ds_read_b128 v[60:63], v11 offset:51200
  v_mfma_f32_16x16x32_bf16 v[44:47], v[68:71], a[180:183], v[44:47]
  s_waitcnt lgkmcnt(4)
  v_mfma_f32_16x16x32_bf16 v[32:35], v[72:75], a[184:187], v[32:35]
  ds_read_b128 v[64:67], v10 offset:53248
  s_add_u32 m0, s61, 77440
  v_mfma_f32_16x16x32_bf16 v[36:39], v[72:75], a[188:191], v[36:39]
  buffer_load_dwordx4 v4, s[48:51], s57 offen offset:384 lds
  v_mfma_f32_16x16x32_bf16 v[40:43], v[76:79], a[184:187], v[40:43]
  ds_read_b128 v[68:71], v10 offset:55296
  v_mfma_f32_16x16x32_bf16 v[44:47], v[76:79], a[188:191], v[44:47]
  s_waitcnt vmcnt(16)
  s_barrier
  s_waitcnt lgkmcnt(4)
  v_mfma_f32_16x16x32_bf16 v[32:35], v[48:51], a[192:195], v[32:35]
  ds_read_b128 v[72:75], v11 offset:53248
  v_mfma_f32_16x16x32_bf16 v[36:39], v[48:51], a[196:199], v[36:39]
  v_mfma_f32_16x16x32_bf16 v[40:43], v[52:55], a[192:195], v[40:43]
  ds_read_b128 v[76:79], v11 offset:55296
  v_mfma_f32_16x16x32_bf16 v[44:47], v[52:55], a[196:199], v[44:47]
  s_waitcnt lgkmcnt(4)
  v_mfma_f32_16x16x32_bf16 v[32:35], v[56:59], a[200:203], v[32:35]
  ds_read_b128 v[48:51], v10 offset:57344
  s_add_u32 m0, s61, 81408
  v_mfma_f32_16x16x32_bf16 v[36:39], v[56:59], a[204:207], v[36:39]
  buffer_load_dwordx4 v4, s[48:51], s57 offen offset:512 lds
  v_mfma_f32_16x16x32_bf16 v[40:43], v[60:63], a[200:203], v[40:43]
  ds_read_b128 v[52:55], v10 offset:59392
  v_mfma_f32_16x16x32_bf16 v[44:47], v[60:63], a[204:207], v[44:47]
  s_waitcnt lgkmcnt(4)
  v_mfma_f32_16x16x32_bf16 v[32:35], v[64:67], a[208:211], v[32:35]
  ds_read_b128 v[56:59], v11 offset:57344
  v_mfma_f32_16x16x32_bf16 v[36:39], v[64:67], a[212:215], v[36:39]
  v_mfma_f32_16x16x32_bf16 v[40:43], v[68:71], a[208:211], v[40:43]
  ds_read_b128 v[60:63], v11 offset:59392
  v_mfma_f32_16x16x32_bf16 v[44:47], v[68:71], a[212:215], v[44:47]
  s_waitcnt lgkmcnt(4)
  v_mfma_f32_16x16x32_bf16 v[32:35], v[72:75], a[216:219], v[32:35]
  ds_read_b128 v[64:67], v10 offset:61440
  s_add_u32 m0, s61, 85376
  v_mfma_f32_16x16x32_bf16 v[36:39], v[72:75], a[220:223], v[36:39]
  buffer_load_dwordx4 v4, s[48:51], s57 offen offset:640 lds
  v_mfma_f32_16x16x32_bf16 v[40:43], v[76:79], a[216:219], v[40:43]
  ds_read_b128 v[68:71], v10 offset:63488
  v_mfma_f32_16x16x32_bf16 v[44:47], v[76:79], a[220:223], v[44:47]
  s_waitcnt lgkmcnt(4)
  v_mfma_f32_16x16x32_bf16 v[32:35], v[48:51], a[224:227], v[32:35]
  ds_read_b128 v[72:75], v11 offset:61440
  v_mfma_f32_16x16x32_bf16 v[36:39], v[48:51], a[228:231], v[36:39]
  v_mfma_f32_16x16x32_bf16 v[40:43], v[52:55], a[224:227], v[40:43]
  ds_read_b128 v[76:79], v11 offset:63488
  v_mfma_f32_16x16x32_bf16 v[44:47], v[52:55], a[228:231], v[44:47]
  s_waitcnt lgkmcnt(4)
  v_mfma_f32_16x16x32_bf16 v[32:35], v[56:59], a[232:235], v[32:35]
  ds_read_b128 v[48:51], v8 offset:0
  s_add_u32 m0, s61, 89344
  v_mfma_f32_16x16x32_bf16 v[36:39], v[56:59], a[236:239], v[36:39]
  buffer_load_dwordx4 v4, s[48:51], s57 offen offset:768 lds
  v_mfma_f32_16x16x32_bf16 v[40:43], v[60:63], a[232:235], v[40:43]
  ds_read_b128 v[52:55], v8 offset:2048
  v_mfma_f32_16x16x32_bf16 v[44:47], v[60:63], a[236:239], v[44:47]
  s_waitcnt lgkmcnt(4)
  v_mfma_f32_16x16x32_bf16 v[32:35], v[64:67], a[240:243], v[32:35]
  ds_read_b128 v[56:59], v9 offset:0
  v_mfma_f32_16x16x32_bf16 v[36:39], v[64:67], a[244:247], v[36:39]
  s_lshl_b32 s59, s58, 18
  s_add_u32 s58, s58, 1
  v_mfma_f32_16x16x32_bf16 v[40:43], v[68:71], a[240:243], v[40:43]
  ds_read_b128 v[60:63], v9 offset:2048
  v_mfma_f32_16x16x32_bf16 v[44:47], v[68:71], a[244:247], v[44:47]
  s_waitcnt lgkmcnt(4)
  v_mfma_f32_16x16x32_bf16 v[32:35], v[72:75], a[248:251], v[32:35]
  ds_read_b128 v[64:67], v8 offset:4096
  s_add_u32 m0, s61, 93312
  v_mfma_f32_16x16x32_bf16 v[36:39], v[72:75], a[252:255], v[36:39]
  buffer_load_dwordx4 v4, s[48:51], s57 offen offset:896 lds
  v_mfma_f32_16x16x32_bf16 v[40:43], v[76:79], a[248:251], v[40:43]
  ds_read_b128 v[68:71], v8 offset:6144
  s_add_u32 s60, s60, 0x10000
  v_mfma_f32_16x16x32_bf16 v[44:47], v[76:79], a[252:255], v[44:47]
  s_cmp_lt_u32 s58, 64
  s_cbranch_scc1 L_p_loopV
  s_nop 7
  v_cvt_pk_bf16_f32 v84, v32, v33
  v_cvt_pk_bf16_f32 v85, v34, v35
  v_cvt_pk_bf16_f32 v86, v40, v41
  v_cvt_pk_bf16_f32 v87, v42, v43
  buffer_store_dwordx4 v[84:87], v5, s[52:55], s59 offen offset:0 sc1
  v_cvt_pk_bf16_f32 v88, v36, v37
  v_cvt_pk_bf16_f32 v89, v38, v39
  v_cvt_pk_bf16_f32 v90, v44, v45
  v_cvt_pk_bf16_f32 v91, v46, v47
  buffer_store_dwordx4 v[88:91], v5, s[52:55], s59 offen offset:1024 sc1
L_p_done:
  s_waitcnt vmcnt(0) lgkmcnt(0)
  s_atomic_add s92, s[34:35], s83
  s_barrier
  s_mov_b32 s44, s20
  s_and_b32 s45, s21, 0xffff
  s_mov_b32 s46, 0x400000
  s_mov_b32 s47, 0x20000
  s_mov_b32 s48, s22
  s_and_b32 s49, s23, 0xffff
  s_mov_b32 s50, 0x400000
  s_mov_b32 s51, 0x20000
  s_mov_b32 s60, s30
  s_and_b32 s61, s31, 0xffff
  s_mov_b32 s62, 0x800000
  s_mov_b32 s63, 0x20000
  v_mov_b32 v8, 0
  v_mov_b32 v9, 0
  v_mov_b32 v10, 0
  v_mov_b32 v11, 0
  s_and_b32 s72, s37, 2
  s_lshl_b32 s72, s72, 8
  s_lshl_b32 s40, s38, 4
  s_add_u32 s72, s72, s40
  v_and_b32 v1, 31, v0
  v_min_u32 v1, 29, v1
  v_lshlrev_b32 v1, 4, v1
  v_lshrrev_b32 v2, 5, v0
  s_movk_i32 s40, 4576
  v_mad_u32_u24 v1, v2, s40, v1
  s_mul_i32 s40, s36, 18304
  v_add_u32 v1, s40, v1
  ds_write_b128 v1, v[8:11] offset:4096
  ds_write_b128 v1, v[8:11] offset:13248
  s_and_b32 s42, s38, 3
  s_xor_b32 s42, s42, s36
  v_lshrrev_b32 v1, 1, v0
  v_and_b32 v2, 1, v0
  v_lshlrev_b32 v3, 14, v1
  v_lshl_add_u32 v3, v2, 4, v3
  s_lshl_b32 s40, s72, 1
  s_lshl_b32 s41, s42, 19
  s_add_u32 s40, s40, s41
  v_add_u32 v3, s40, v3
  s_mov_b32 s40, 36608
  v_mul_lo_u32 v4, v2, s40
  v_lshlrev_b32 v1, 4, v1
  v_sub_u32 v4, v4, v1
  s_lshl_b32 s40, s42, 9
  s_sub_u32 s40, 2032, s40
  v_add_u32 v4, s40, v4
  s_and_b32 s40, s38, 1
  s_lshl_b32 s41, s40, 21
  v_add_u32 v3, s41, v3
  v_xor_b32 v250, 0x200000, v3
  s_lshl_b32 s41, s40, 11
  v_add_u32 v251, s41, v4
  s_xor_b32 s41, s41, 2048
  v_add_u32 v4, s41, v4
  s_lshl_b32 s40, s72, 3
  v_lshl_add_u32 v1, v2, 6, s40
  global_load_dwordx4 v[12:15], v1, s[24:25] offset:0
  global_load_dwordx4 v[16:19], v1, s[24:25] offset:16
  global_load_dwordx4 v[20:23], v1, s[24:25] offset:32
  global_load_dwordx4 v[24:27], v1, s[24:25] offset:48
  v_add_u32 v28, -6144, v3
  v_add_u32 v29, -4096, v3
  v_add_u32 v30, -2048, v3
  buffer_load_dwordx4 v[64:67], v28, s[44:47], 0 offen
  buffer_load_dwordx4 v[68:71], v29, s[44:47], 0 offen
  buffer_load_dwordx4 v[72:75], v30, s[44:47], 0 offen
  s_mov_b32 s65, 0
  buffer_load_dwordx4 v[76:79], v3, s[44:47], s65 offen offset:0
  buffer_load_dwordx4 v[108:111], v3, s[48:51], s65 offen offset:0
  buffer_load_dwordx4 v[80:83], v3, s[44:47], s65 offen offset:2048
  buffer_load_dwordx4 v[112:115], v3, s[48:51], s65 offen offset:2048
  s_mov_b32 s65, 4096
  buffer_load_dwordx4 v[84:87], v3, s[44:47], s65 offen offset:0
  buffer_load_dwordx4 v[116:119], v3, s[48:51], s65 offen offset:0
  buffer_load_dwordx4 v[88:91], v3, s[44:47], s65 offen offset:2048
  buffer_load_dwordx4 v[120:123], v3, s[48:51], s65 offen offset:2048
  s_mov_b32 s65, 8192
  buffer_load_dwordx4 v[92:95], v3, s[44:47], s65 offen offset:0
  buffer_load_dwordx4 v[124:127], v3, s[48:51], s65 offen offset:0
  buffer_load_dwordx4 v[96:99], v3, s[44:47], s65 offen offset:2048
  buffer_load_dwordx4 v[128:131], v3, s[48:51], s65 offen offset:2048
  s_mov_b32 s65, 12288
  buffer_load_dwordx4 v[100:103], v3, s[44:47], s65 offen offset:0
  buffer_load_dwordx4 v[132:135], v3, s[48:51], s65 offen offset:0
  buffer_load_dwordx4 v[104:107], v3, s[44:47], s65 offen offset:2048
  buffer_load_dwordx4 v[136:139], v3, s[48:51], s65 offen offset:2048
  v_add_u32 v28, -6144, v250
  v_add_u32 v29, -4096, v250
  v_add_u32 v30, -2048, v250
  buffer_load_dwordx4 v[168:171], v28, s[44:47], 0 offen
  buffer_load_dwordx4 v[172:175], v29, s[44:47], 0 offen
  buffer_load_dwordx4 v[176:179], v30, s[44:47], 0 offen
  s_mov_b32 s65, 0
  buffer_load_dwordx4 v[180:183], v250, s[44:47], s65 offen offset:0
  buffer_load_dwordx4 v[212:215], v250, s[48:51], s65 offen offset:0
  buffer_load_dwordx4 v[184:187], v250, s[44:47], s65 offen offset:2048
  buffer_load_dwordx4 v[216:219], v250, s[48:51], s65 offen offset:2048
  s_mov_b32 s65, 4096
  buffer_load_dwordx4 v[188:191], v250, s[44:47], s65 offen offset:0
  buffer_load_dwordx4 v[220:223], v250, s[48:51], s65 offen offset:0
  buffer_load_dwordx4 v[192:195], v250, s[44:47], s65 offen offset:2048
  buffer_load_dwordx4 v[224:227], v250, s[48:51], s65 offen offset:2048
  s_mov_b32 s65, 8192
  buffer_load_dwordx4 v[196:199], v250, s[44:47], s65 offen offset:0
  buffer_load_dwordx4 v[228:231], v250, s[48:51], s65 offen offset:0
  buffer_load_dwordx4 v[200:203], v250, s[44:47], s65 offen offset:2048
  buffer_load_dwordx4 v[232:235], v250, s[48:51], s65 offen offset:2048
  s_mov_b32 s65, 12288
  buffer_load_dwordx4 v[204:207], v250, s[44:47], s65 offen offset:0
  buffer_load_dwordx4 v[236:239], v250, s[48:51], s65 offen offset:0
  buffer_load_dwordx4 v[208:211], v250, s[44:47], s65 offen offset:2048
  buffer_load_dwordx4 v[240:243], v250, s[48:51], s65 offen offset:2048
  s_waitcnt vmcnt(38)
  v_lshlrev_b32 v32, 16, v12
  v_and_b32 v33, 0xffff0000, v12
  v_lshlrev_b32 v34, 16, v13
  v_and_b32 v35, 0xffff0000, v13
  v_lshlrev_b32 v36, 16, v14
  v_and_b32 v37, 0xffff0000, v14
  v_lshlrev_b32 v38, 16, v15
  v_and_b32 v39, 0xffff0000, v15
  v_lshlrev_b32 v40, 16, v16
  v_and_b32 v41, 0xffff0000, v16
  v_lshlrev_b32 v42, 16, v17
  v_and_b32 v43, 0xffff0000, v17
  v_lshlrev_b32 v44, 16, v18
  v_and_b32 v45, 0xffff0000, v18
  v_lshlrev_b32 v46, 16, v19
  v_and_b32 v47, 0xffff0000, v19
  v_lshlrev_b32 v48, 16, v20
  v_and_b32 v49, 0xffff0000, v20
  v_lshlrev_b32 v50, 16, v21
  v_and_b32 v51, 0xffff0000, v21
  v_lshlrev_b32 v52, 16, v22
  v_and_b32 v53, 0xffff0000, v22
  v_lshlrev_b32 v54, 16, v23
  v_and_b32 v55, 0xffff0000, v23
  v_lshlrev_b32 v56, 16, v24
  v_and_b32 v57, 0xffff0000, v24
  v_lshlrev_b32 v58, 16, v25
  v_and_b32 v59, 0xffff0000, v25
  v_lshlrev_b32 v60, 16, v26
  v_and_b32 v61, 0xffff0000, v26
  v_lshlrev_b32 v62, 16, v27
  v_and_b32 v63, 0xffff0000, v27
  s_waitcnt vmcnt(19)
  v_lshlrev_b32 v140, 16, v64
  v_lshlrev_b32 v141, 16, v68
  v_lshlrev_b32 v142, 16, v72
  v_lshlrev_b32 v143, 16, v76
  v_lshlrev_b32 v144, 16, v80
  v_lshlrev_b32 v145, 16, v84
  v_lshlrev_b32 v146, 16, v88
  v_lshlrev_b32 v147, 16, v92
  v_lshlrev_b32 v148, 16, v96
  v_lshlrev_b32 v149, 16, v100
  v_lshlrev_b32 v150, 16, v104
  v_mul_f32 v152, v140, v35
  v_mul_f32 v153, v141, v35
  v_mul_f32 v154, v142, v35
  v_mul_f32 v155, v143, v35
  v_mul_f32 v156, v144, v35
  v_mul_f32 v157, v145, v35
  v_mul_f32 v158, v146, v35
  v_mul_f32 v159, v147, v35
  v_fmac_f32 v152, v141, v34
  v_fmac_f32 v153, v142, v34
  v_fmac_f32 v154, v143, v34
  v_fmac_f32 v155, v144, v34
  v_fmac_f32 v156, v145, v34
  v_fmac_f32 v157, v146, v34
  v_fmac_f32 v158, v147, v34
  v_fmac_f32 v159, v148, v34
  v_fmac_f32 v152, v142, v33
  v_fmac_f32 v153, v143, v33
  v_fmac_f32 v154, v144, v33
  v_fmac_f32 v155, v145, v33
  v_fmac_f32 v156, v146, v33
  v_fmac_f32 v157, v147, v33
  v_fmac_f32 v158, v148, v33
  v_fmac_f32 v159, v149, v33
  v_fmac_f32 v152, v143, v32
  v_fmac_f32 v153, v144, v32
  v_fmac_f32 v154, v145, v32
  v_fmac_f32 v155, v146, v32
  v_fmac_f32 v156, v147, v32
  v_fmac_f32 v157, v148, v32
  v_fmac_f32 v158, v149, v32
  v_fmac_f32 v159, v150, v32
  v_lshlrev_b32 v140, 16, v108
  v_lshlrev_b32 v141, 16, v112
  v_lshlrev_b32 v142, 16, v116
  v_lshlrev_b32 v143, 16, v120
  v_lshlrev_b32 v144, 16, v124
  v_lshlrev_b32 v145, 16, v128
  v_lshlrev_b32 v146, 16, v132
  v_lshlrev_b32 v147, 16, v136
  v_mul_f32 v152, v152, v140
  v_mul_f32 v153, v153, v141
  v_mul_f32 v154, v154, v142
  v_mul_f32 v155, v155, v143
  v_mul_f32 v156, v156, v144
  v_mul_f32 v157, v157, v145
  v_mul_f32 v158, v158, v146
  v_mul_f32 v159, v159, v147
  v_cvt_pk_bf16_f32 v160, v159, v158
  v_cvt_pk_bf16_f32 v161, v157, v156
  v_cvt_pk_bf16_f32 v162, v155, v154
  v_cvt_pk_bf16_f32 v163, v153, v152
  ds_write_b128 v4, v[160:163] offset:0
  v_and_b32 v140, 0xffff0000, v64
  v_and_b32 v141, 0xffff0000, v68
  v_and_b32 v142, 0xffff0000, v72
  v_and_b32 v143, 0xffff0000, v76
  v_and_b32 v144, 0xffff0000, v80
  v_and_b32 v145, 0xffff0000, v84
  v_and_b32 v146, 0xffff0000, v88
  v_and_b32 v147, 0xffff0000, v92
  v_and_b32 v148, 0xffff0000, v96
  v_and_b32 v149, 0xffff0000, v100
  v_and_b32 v150, 0xffff0000, v104
  v_mul_f32 v152, v140, v39
  v_mul_f32 v153, v141, v39
  v_mul_f32 v154, v142, v39
  v_mul_f32 v155, v143, v39
  v_mul_f32 v156, v144, v39
  v_mul_f32 v157, v145, v39
  v_mul_f32 v158, v146, v39
  v_mul_f32 v159, v147, v39
  v_fmac_f32 v152, v141, v38
  v_fmac_f32 v153, v142, v38
  v_fmac_f32 v154, v143, v38
  v_fmac_f32 v155, v144, v38
  v_fmac_f32 v156, v145, v38
  v_fmac_f32 v157, v146, v38
  v_fmac_f32 v158, v147, v38
  v_fmac_f32 v159, v148, v38
  v_fmac_f32 v152, v142, v37
  v_fmac_f32 v153, v143, v37
  v_fmac_f32 v154, v144, v37
  v_fmac_f32 v155, v145, v37
  v_fmac_f32 v156, v146, v37
  v_fmac_f32 v157, v147, v37
  v_fmac_f32 v158, v148, v37
  v_fmac_f32 v159, v149, v37
  v_fmac_f32 v152, v143, v36
  v_fmac_f32 v153, v144, v36
  v_fmac_f32 v154, v145, v36
  v_fmac_f32 v155, v146, v36
  v_fmac_f32 v156, v147, v36
  v_fmac_f32 v157, v148, v36
  v_fmac_f32 v158, v149, v36
  v_fmac_f32 v159, v150, v36
  v_and_b32 v140, 0xffff0000, v108
  v_and_b32 v141, 0xffff0000, v112
  v_and_b32 v142, 0xffff0000, v116
  v_and_b32 v143, 0xffff0000, v120
  v_and_b32 v144, 0xffff0000, v124
  v_and_b32 v145, 0xffff0000, v128
  v_and_b32 v146, 0xffff0000, v132
  v_and_b32 v147, 0xffff0000, v136
  v_mul_f32 v152, v152, v140
  v_mul_f32 v153, v153, v141
  v_mul_f32 v154, v154, v142
  v_mul_f32 v155, v155, v143
  v_mul_f32 v156, v156, v144
  v_mul_f32 v157, v157, v145
  v_mul_f32 v158, v158, v146
  v_mul_f32 v159, v159, v147
  v_cvt_pk_bf16_f32 v164, v159, v158
  v_cvt_pk_bf16_f32 v165, v157, v156
  v_cvt_pk_bf16_f32 v166, v155, v154
  v_cvt_pk_bf16_f32 v167, v153, v152
  ds_write_b128 v4, v[164:167] offset:4576
  v_lshlrev_b32 v140, 16, v65
  v_lshlrev_b32 v141, 16, v69
  v_lshlrev_b32 v142, 16, v73
  v_lshlrev_b32 v143, 16, v77
  v_lshlrev_b32 v144, 16, v81
  v_lshlrev_b32 v145, 16, v85
  v_lshlrev_b32 v146, 16, v89
  v_lshlrev_b32 v147, 16, v93
  v_lshlrev_b32 v148, 16, v97
  v_lshlrev_b32 v149, 16, v101
  v_lshlrev_b32 v150, 16, v105
  v_mul_f32 v152, v140, v43
  v_mul_f32 v153, v141, v43
  v_mul_f32 v154, v142, v43
  v_mul_f32 v155, v143, v43
  v_mul_f32 v156, v144, v43
  v_mul_f32 v157, v145, v43
  v_mul_f32 v158, v146, v43
  v_mul_f32 v159, v147, v43
  v_fmac_f32 v152, v141, v42
  v_fmac_f32 v153, v142, v42
  v_fmac_f32 v154, v143, v42
  v_fmac_f32 v155, v144, v42
  v_fmac_f32 v156, v145, v42
  v_fmac_f32 v157, v146, v42
  v_fmac_f32 v158, v147, v42
  v_fmac_f32 v159, v148, v42
  v_fmac_f32 v152, v142, v41
  v_fmac_f32 v153, v143, v41
  v_fmac_f32 v154, v144, v41
  v_fmac_f32 v155, v145, v41
  v_fmac_f32 v156, v146, v41
  v_fmac_f32 v157, v147, v41
  v_fmac_f32 v158, v148, v41
  v_fmac_f32 v159, v149, v41
  v_fmac_f32 v152, v143, v40
  v_fmac_f32 v153, v144, v40
  v_fmac_f32 v154, v145, v40
  v_fmac_f32 v155, v146, v40
  v_fmac_f32 v156, v147, v40
  v_fmac_f32 v157, v148, v40
  v_fmac_f32 v158, v149, v40
  v_fmac_f32 v159, v150, v40
  v_lshlrev_b32 v140, 16, v109
  v_lshlrev_b32 v141, 16, v113
  v_lshlrev_b32 v142, 16, v117
  v_lshlrev_b32 v143, 16, v121
  v_lshlrev_b32 v144, 16, v125
  v_lshlrev_b32 v145, 16, v129
  v_lshlrev_b32 v146, 16, v133
  v_lshlrev_b32 v147, 16, v137
  v_mul_f32 v152, v152, v140
  v_mul_f32 v153, v153, v141
  v_mul_f32 v154, v154, v142
  v_mul_f32 v155, v155, v143
  v_mul_f32 v156, v156, v144
  v_mul_f32 v157, v157, v145
  v_mul_f32 v158, v158, v146
  v_mul_f32 v159, v159, v147
  v_cvt_pk_bf16_f32 v160, v159, v158
  v_cvt_pk_bf16_f32 v161, v157, v156
  v_cvt_pk_bf16_f32 v162, v155, v154
  v_cvt_pk_bf16_f32 v163, v153, v152
  ds_write_b128 v4, v[160:163] offset:9152
  v_and_b32 v140, 0xffff0000, v65
  v_and_b32 v141, 0xffff0000, v69
  v_and_b32 v142, 0xffff0000, v73
  v_and_b32 v143, 0xffff0000, v77
  v_and_b32 v144, 0xffff0000, v81
  v_and_b32 v145, 0xffff0000, v85
  v_and_b32 v146, 0xffff0000, v89
  v_and_b32 v147, 0xffff0000, v93
  v_and_b32 v148, 0xffff0000, v97
  v_and_b32 v149, 0xffff0000, v101
  v_and_b32 v150, 0xffff0000, v105
  v_mul_f32 v152, v140, v47
  v_mul_f32 v153, v141, v47
  v_mul_f32 v154, v142, v47
  v_mul_f32 v155, v143, v47
  v_mul_f32 v156, v144, v47
  v_mul_f32 v157, v145, v47
  v_mul_f32 v158, v146, v47
  v_mul_f32 v159, v147, v47
  v_fmac_f32 v152, v141, v46
  v_fmac_f32 v153, v142, v46
  v_fmac_f32 v154, v143, v46
  v_fmac_f32 v155, v144, v46
  v_fmac_f32 v156, v145, v46
  v_fmac_f32 v157, v146, v46
  v_fmac_f32 v158, v147, v46
  v_fmac_f32 v159, v148, v46
  v_fmac_f32 v152, v142, v45
  v_fmac_f32 v153, v143, v45
  v_fmac_f32 v154, v144, v45
  v_fmac_f32 v155, v145, v45
  v_fmac_f32 v156, v146, v45
  v_fmac_f32 v157, v147, v45
  v_fmac_f32 v158, v148, v45
  v_fmac_f32 v159, v149, v45
  v_fmac_f32 v152, v143, v44
  v_fmac_f32 v153, v144, v44
  v_fmac_f32 v154, v145, v44
  v_fmac_f32 v155, v146, v44
  v_fmac_f32 v156, v147, v44
  v_fmac_f32 v157, v148, v44
  v_fmac_f32 v158, v149, v44
  v_fmac_f32 v159, v150, v44
  v_and_b32 v140, 0xffff0000, v109
  v_and_b32 v141, 0xffff0000, v113
  v_and_b32 v142, 0xffff0000, v117
  v_and_b32 v143, 0xffff0000, v121
  v_and_b32 v144, 0xffff0000, v125
  v_and_b32 v145, 0xffff0000, v129
  v_and_b32 v146, 0xffff0000, v133
  v_and_b32 v147, 0xffff0000, v137
  v_mul_f32 v152, v152, v140
  v_mul_f32 v153, v153, v141
  v_mul_f32 v154, v154, v142
  v_mul_f32 v155, v155, v143
  v_mul_f32 v156, v156, v144
  v_mul_f32 v157, v157, v145
  v_mul_f32 v158, v158, v146
  v_mul_f32 v159, v159, v147
  v_cvt_pk_bf16_f32 v164, v159, v158
  v_cvt_pk_bf16_f32 v165, v157, v156
  v_cvt_pk_bf16_f32 v166, v155, v154
  v_cvt_pk_bf16_f32 v167, v153, v152
  ds_write_b128 v4, v[164:167] offset:13728
  v_lshlrev_b32 v140, 16, v66
  v_lshlrev_b32 v141, 16, v70
  v_lshlrev_b32 v142, 16, v74
  v_lshlrev_b32 v143, 16, v78
  v_lshlrev_b32 v144, 16, v82
  v_lshlrev_b32 v145, 16, v86
  v_lshlrev_b32 v146, 16, v90
  v_lshlrev_b32 v147, 16, v94
  v_lshlrev_b32 v148, 16, v98
  v_lshlrev_b32 v149, 16, v102
  v_lshlrev_b32 v150, 16, v106
  v_mul_f32 v152, v140, v51
  v_mul_f32 v153, v141, v51
  v_mul_f32 v154, v142, v51
  v_mul_f32 v155, v143, v51
  v_mul_f32 v156, v144, v51
  v_mul_f32 v157, v145, v51
  v_mul_f32 v158, v146, v51
  v_mul_f32 v159, v147, v51
  v_fmac_f32 v152, v141, v50
  v_fmac_f32 v153, v142, v50
  v_fmac_f32 v154, v143, v50
  v_fmac_f32 v155, v144, v50
  v_fmac_f32 v156, v145, v50
  v_fmac_f32 v157, v146, v50
  v_fmac_f32 v158, v147, v50
  v_fmac_f32 v159, v148, v50
  v_fmac_f32 v152, v142, v49
  v_fmac_f32 v153, v143, v49
  v_fmac_f32 v154, v144, v49
  v_fmac_f32 v155, v145, v49
  v_fmac_f32 v156, v146, v49
  v_fmac_f32 v157, v147, v49
  v_fmac_f32 v158, v148, v49
  v_fmac_f32 v159, v149, v49
  v_fmac_f32 v152, v143, v48
  v_fmac_f32 v153, v144, v48
  v_fmac_f32 v154, v145, v48
  v_fmac_f32 v155, v146, v48
  v_fmac_f32 v156, v147, v48
  v_fmac_f32 v157, v148, v48
  v_fmac_f32 v158, v149, v48
  v_fmac_f32 v159, v150, v48
  v_lshlrev_b32 v140, 16, v110
  v_lshlrev_b32 v141, 16, v114
  v_lshlrev_b32 v142, 16, v118
  v_lshlrev_b32 v143, 16, v122
  v_lshlrev_b32 v144, 16, v126
  v_lshlrev_b32 v145, 16, v130
  v_lshlrev_b32 v146, 16, v134
  v_lshlrev_b32 v147, 16, v138
  v_mul_f32 v152, v152, v140
  v_mul_f32 v153, v153, v141
  v_mul_f32 v154, v154, v142
  v_mul_f32 v155, v155, v143
  v_mul_f32 v156, v156, v144
  v_mul_f32 v157, v157, v145
  v_mul_f32 v158, v158, v146
  v_mul_f32 v159, v159, v147
  v_cvt_pk_bf16_f32 v160, v159, v158
  v_cvt_pk_bf16_f32 v161, v157, v156
  v_cvt_pk_bf16_f32 v162, v155, v154
  v_cvt_pk_bf16_f32 v163, v153, v152
  ds_write_b128 v4, v[160:163] offset:18304
  v_and_b32 v140, 0xffff0000, v66
  v_and_b32 v141, 0xffff0000, v70
  v_and_b32 v142, 0xffff0000, v74
  v_and_b32 v143, 0xffff0000, v78
  v_and_b32 v144, 0xffff0000, v82
  v_and_b32 v145, 0xffff0000, v86
  v_and_b32 v146, 0xffff0000, v90
  v_and_b32 v147, 0xffff0000, v94
  v_and_b32 v148, 0xffff0000, v98
  v_and_b32 v149, 0xffff0000, v102
  v_and_b32 v150, 0xffff0000, v106
  v_mul_f32 v152, v140, v55
  v_mul_f32 v153, v141, v55
  v_mul_f32 v154, v142, v55
  v_mul_f32 v155, v143, v55
  v_mul_f32 v156, v144, v55
  v_mul_f32 v157, v145, v55
  v_mul_f32 v158, v146, v55
  v_mul_f32 v159, v147, v55
  v_fmac_f32 v152, v141, v54
  v_fmac_f32 v153, v142, v54
  v_fmac_f32 v154, v143, v54
  v_fmac_f32 v155, v144, v54
  v_fmac_f32 v156, v145, v54
  v_fmac_f32 v157, v146, v54
  v_fmac_f32 v158, v147, v54
  v_fmac_f32 v159, v148, v54
  v_fmac_f32 v152, v142, v53
  v_fmac_f32 v153, v143, v53
  v_fmac_f32 v154, v144, v53
  v_fmac_f32 v155, v145, v53
  v_fmac_f32 v156, v146, v53
  v_fmac_f32 v157, v147, v53
  v_fmac_f32 v158, v148, v53
  v_fmac_f32 v159, v149, v53
  v_fmac_f32 v152, v143, v52
  v_fmac_f32 v153, v144, v52
  v_fmac_f32 v154, v145, v52
  v_fmac_f32 v155, v146, v52
  v_fmac_f32 v156, v147, v52
  v_fmac_f32 v157, v148, v52
  v_fmac_f32 v158, v149, v52
  v_fmac_f32 v159, v150, v52
  v_and_b32 v140, 0xffff0000, v110
  v_and_b32 v141, 0xffff0000, v114
  v_and_b32 v142, 0xffff0000, v118
  v_and_b32 v143, 0xffff0000, v122
  v_and_b32 v144, 0xffff0000, v126
  v_and_b32 v145, 0xffff0000, v130
  v_and_b32 v146, 0xffff0000, v134
  v_and_b32 v147, 0xffff0000, v138
  v_mul_f32 v152, v152, v140
  v_mul_f32 v153, v153, v141
  v_mul_f32 v154, v154, v142
  v_mul_f32 v155, v155, v143
  v_mul_f32 v156, v156, v144
  v_mul_f32 v157, v157, v145
  v_mul_f32 v158, v158, v146
  v_mul_f32 v159, v159, v147
  v_cvt_pk_bf16_f32 v164, v159, v158
  v_cvt_pk_bf16_f32 v165, v157, v156
  v_cvt_pk_bf16_f32 v166, v155, v154
  v_cvt_pk_bf16_f32 v167, v153, v152
  ds_write_b128 v4, v[164:167] offset:22880
  v_lshlrev_b32 v140, 16, v67
  v_lshlrev_b32 v141, 16, v71
  v_lshlrev_b32 v142, 16, v75
  v_lshlrev_b32 v143, 16, v79
  v_lshlrev_b32 v144, 16, v83
  v_lshlrev_b32 v145, 16, v87
  v_lshlrev_b32 v146, 16, v91
  v_lshlrev_b32 v147, 16, v95
  v_lshlrev_b32 v148, 16, v99
  v_lshlrev_b32 v149, 16, v103
  v_lshlrev_b32 v150, 16, v107
  v_mul_f32 v152, v140, v59
  v_mul_f32 v153, v141, v59
  v_mul_f32 v154, v142, v59
  v_mul_f32 v155, v143, v59
  v_mul_f32 v156, v144, v59
  v_mul_f32 v157, v145, v59
  v_mul_f32 v158, v146, v59
  v_mul_f32 v159, v147, v59
  v_fmac_f32 v152, v141, v58
  v_fmac_f32 v153, v142, v58
  v_fmac_f32 v154, v143, v58
  v_fmac_f32 v155, v144, v58
  v_fmac_f32 v156, v145, v58
  v_fmac_f32 v157, v146, v58
  v_fmac_f32 v158, v147, v58
  v_fmac_f32 v159, v148, v58
  v_fmac_f32 v152, v142, v57
  v_fmac_f32 v153, v143, v57
  v_fmac_f32 v154, v144, v57
  v_fmac_f32 v155, v145, v57
  v_fmac_f32 v156, v146, v57
  v_fmac_f32 v157, v147, v57
  v_fmac_f32 v158, v148, v57
  v_fmac_f32 v159, v149, v57
  v_fmac_f32 v152, v143, v56
  v_fmac_f32 v153, v144, v56
  v_fmac_f32 v154, v145, v56
  v_fmac_f32 v155, v146, v56
  v_fmac_f32 v156, v147, v56
  v_fmac_f32 v157, v148, v56
  v_fmac_f32 v158, v149, v56
  v_fmac_f32 v159, v150, v56
  v_lshlrev_b32 v140, 16, v111
  v_lshlrev_b32 v141, 16, v115
  v_lshlrev_b32 v142, 16, v119
  v_lshlrev_b32 v143, 16, v123
  v_lshlrev_b32 v144, 16, v127
  v_lshlrev_b32 v145, 16, v131
  v_lshlrev_b32 v146, 16, v135
  v_lshlrev_b32 v147, 16, v139
  v_mul_f32 v152, v152, v140
  v_mul_f32 v153, v153, v141
  v_mul_f32 v154, v154, v142
  v_mul_f32 v155, v155, v143
  v_mul_f32 v156, v156, v144
  v_mul_f32 v157, v157, v145
  v_mul_f32 v158, v158, v146
  v_mul_f32 v159, v159, v147
  v_cvt_pk_bf16_f32 v160, v159, v158
  v_cvt_pk_bf16_f32 v161, v157, v156
  v_cvt_pk_bf16_f32 v162, v155, v154
  v_cvt_pk_bf16_f32 v163, v153, v152
  ds_write_b128 v4, v[160:163] offset:27456
  v_and_b32 v140, 0xffff0000, v67
  v_and_b32 v141, 0xffff0000, v71
  v_and_b32 v142, 0xffff0000, v75
  v_and_b32 v143, 0xffff0000, v79
  v_and_b32 v144, 0xffff0000, v83
  v_and_b32 v145, 0xffff0000, v87
  v_and_b32 v146, 0xffff0000, v91
  v_and_b32 v147, 0xffff0000, v95
  v_and_b32 v148, 0xffff0000, v99
  v_and_b32 v149, 0xffff0000, v103
  v_and_b32 v150, 0xffff0000, v107
  v_mul_f32 v152, v140, v63
  v_mul_f32 v153, v141, v63
  v_mul_f32 v154, v142, v63
  v_mul_f32 v155, v143, v63
  v_mul_f32 v156, v144, v63
  v_mul_f32 v157, v145, v63
  v_mul_f32 v158, v146, v63
  v_mul_f32 v159, v147, v63
  v_fmac_f32 v152, v141, v62
  v_fmac_f32 v153, v142, v62
  v_fmac_f32 v154, v143, v62
  v_fmac_f32 v155, v144, v62
  v_fmac_f32 v156, v145, v62
  v_fmac_f32 v157, v146, v62
  v_fmac_f32 v158, v147, v62
  v_fmac_f32 v159, v148, v62
  v_fmac_f32 v152, v142, v61
  v_fmac_f32 v153, v143, v61
  v_fmac_f32 v154, v144, v61
  v_fmac_f32 v155, v145, v61
  v_fmac_f32 v156, v146, v61
  v_fmac_f32 v157, v147, v61
  v_fmac_f32 v158, v148, v61
  v_fmac_f32 v159, v149, v61
  v_fmac_f32 v152, v143, v60
  v_fmac_f32 v153, v144, v60
  v_fmac_f32 v154, v145, v60
  v_fmac_f32 v155, v146, v60
  v_fmac_f32 v156, v147, v60
  v_fmac_f32 v157, v148, v60
  v_fmac_f32 v158, v149, v60
  v_fmac_f32 v159, v150, v60
  v_and_b32 v140, 0xffff0000, v111
  v_and_b32 v141, 0xffff0000, v115
  v_and_b32 v142, 0xffff0000, v119
  v_and_b32 v143, 0xffff0000, v123
  v_and_b32 v144, 0xffff0000, v127
  v_and_b32 v145, 0xffff0000, v131
  v_and_b32 v146, 0xffff0000, v135
  v_and_b32 v147, 0xffff0000, v139
  v_mul_f32 v152, v152, v140
  v_mul_f32 v153, v153, v141
  v_mul_f32 v154, v154, v142
  v_mul_f32 v155, v155, v143
  v_mul_f32 v156, v156, v144
  v_mul_f32 v157, v157, v145
  v_mul_f32 v158, v158, v146
  v_mul_f32 v159, v159, v147
  v_cvt_pk_bf16_f32 v164, v159, v158
  v_cvt_pk_bf16_f32 v165, v157, v156
  v_cvt_pk_bf16_f32 v166, v155, v154
  v_cvt_pk_bf16_f32 v167, v153, v152
  ds_write_b128 v4, v[164:167] offset:32032
  s_waitcnt vmcnt(0)
  v_lshlrev_b32 v140, 16, v168
  v_lshlrev_b32 v141, 16, v172
  v_lshlrev_b32 v142, 16, v176
  v_lshlrev_b32 v143, 16, v180
  v_lshlrev_b32 v144, 16, v184
  v_lshlrev_b32 v145, 16, v188
  v_lshlrev_b32 v146, 16, v192
  v_lshlrev_b32 v147, 16, v196
  v_lshlrev_b32 v148, 16, v200
  v_lshlrev_b32 v149, 16, v204
  v_lshlrev_b32 v150, 16, v208
  v_mul_f32 v152, v140, v35
  v_mul_f32 v153, v141, v35
  v_mul_f32 v154, v142, v35
  v_mul_f32 v155, v143, v35
  v_mul_f32 v156, v144, v35
  v_mul_f32 v157, v145, v35
  v_mul_f32 v158, v146, v35
  v_mul_f32 v159, v147, v35
  v_fmac_f32 v152, v141, v34
  v_fmac_f32 v153, v142, v34
  v_fmac_f32 v154, v143, v34
  v_fmac_f32 v155, v144, v34
  v_fmac_f32 v156, v145, v34
  v_fmac_f32 v157, v146, v34
  v_fmac_f32 v158, v147, v34
  v_fmac_f32 v159, v148, v34
  v_fmac_f32 v152, v142, v33
  v_fmac_f32 v153, v143, v33
  v_fmac_f32 v154, v144, v33
  v_fmac_f32 v155, v145, v33
  v_fmac_f32 v156, v146, v33
  v_fmac_f32 v157, v147, v33
  v_fmac_f32 v158, v148, v33
  v_fmac_f32 v159, v149, v33
  v_fmac_f32 v152, v143, v32
  v_fmac_f32 v153, v144, v32
  v_fmac_f32 v154, v145, v32
  v_fmac_f32 v155, v146, v32
  v_fmac_f32 v156, v147, v32
  v_fmac_f32 v157, v148, v32
  v_fmac_f32 v158, v149, v32
  v_fmac_f32 v159, v150, v32
  v_lshlrev_b32 v140, 16, v212
  v_lshlrev_b32 v141, 16, v216
  v_lshlrev_b32 v142, 16, v220
  v_lshlrev_b32 v143, 16, v224
  v_lshlrev_b32 v144, 16, v228
  v_lshlrev_b32 v145, 16, v232
  v_lshlrev_b32 v146, 16, v236
  v_lshlrev_b32 v147, 16, v240
  v_mul_f32 v152, v152, v140
  v_mul_f32 v153, v153, v141
  v_mul_f32 v154, v154, v142
  v_mul_f32 v155, v155, v143
  v_mul_f32 v156, v156, v144
  v_mul_f32 v157, v157, v145
  v_mul_f32 v158, v158, v146
  v_mul_f32 v159, v159, v147
  v_cvt_pk_bf16_f32 v160, v159, v158
  v_cvt_pk_bf16_f32 v161, v157, v156
  v_cvt_pk_bf16_f32 v162, v155, v154
  v_cvt_pk_bf16_f32 v163, v153, v152
  ds_write_b128 v251, v[160:163] offset:0
  v_and_b32 v140, 0xffff0000, v168
  v_and_b32 v141, 0xffff0000, v172
  v_and_b32 v142, 0xffff0000, v176
  v_and_b32 v143, 0xffff0000, v180
  v_and_b32 v144, 0xffff0000, v184
  v_and_b32 v145, 0xffff0000, v188
  v_and_b32 v146, 0xffff0000, v192
  v_and_b32 v147, 0xffff0000, v196
  v_and_b32 v148, 0xffff0000, v200
  v_and_b32 v149, 0xffff0000, v204
  v_and_b32 v150, 0xffff0000, v208
  v_mul_f32 v152, v140, v39
  v_mul_f32 v153, v141, v39
  v_mul_f32 v154, v142, v39
  v_mul_f32 v155, v143, v39
  v_mul_f32 v156, v144, v39
  v_mul_f32 v157, v145, v39
  v_mul_f32 v158, v146, v39
  v_mul_f32 v159, v147, v39
  v_fmac_f32 v152, v141, v38
  v_fmac_f32 v153, v142, v38
  v_fmac_f32 v154, v143, v38
  v_fmac_f32 v155, v144, v38
  v_fmac_f32 v156, v145, v38
  v_fmac_f32 v157, v146, v38
  v_fmac_f32 v158, v147, v38
  v_fmac_f32 v159, v148, v38
  v_fmac_f32 v152, v142, v37
  v_fmac_f32 v153, v143, v37
  v_fmac_f32 v154, v144, v37
  v_fmac_f32 v155, v145, v37
  v_fmac_f32 v156, v146, v37
  v_fmac_f32 v157, v147, v37
  v_fmac_f32 v158, v148, v37
  v_fmac_f32 v159, v149, v37
  v_fmac_f32 v152, v143, v36
  v_fmac_f32 v153, v144, v36
  v_fmac_f32 v154, v145, v36
  v_fmac_f32 v155, v146, v36
  v_fmac_f32 v156, v147, v36
  v_fmac_f32 v157, v148, v36
  v_fmac_f32 v158, v149, v36
  v_fmac_f32 v159, v150, v36
  v_and_b32 v140, 0xffff0000, v212
  v_and_b32 v141, 0xffff0000, v216
  v_and_b32 v142, 0xffff0000, v220
  v_and_b32 v143, 0xffff0000, v224
  v_and_b32 v144, 0xffff0000, v228
  v_and_b32 v145, 0xffff0000, v232
  v_and_b32 v146, 0xffff0000, v236
  v_and_b32 v147, 0xffff0000, v240
  v_mul_f32 v152, v152, v140
  v_mul_f32 v153, v153, v141
  v_mul_f32 v154, v154, v142
  v_mul_f32 v155, v155, v143
  v_mul_f32 v156, v156, v144
  v_mul_f32 v157, v157, v145
  v_mul_f32 v158, v158, v146
  v_mul_f32 v159, v159, v147
  v_cvt_pk_bf16_f32 v164, v159, v158
  v_cvt_pk_bf16_f32 v165, v157, v156
  v_cvt_pk_bf16_f32 v166, v155, v154
  v_cvt_pk_bf16_f32 v167, v153, v152
  ds_write_b128 v251, v[164:167] offset:4576
  v_lshlrev_b32 v140, 16, v169
  v_lshlrev_b32 v141, 16, v173
  v_lshlrev_b32 v142, 16, v177
  v_lshlrev_b32 v143, 16, v181
  v_lshlrev_b32 v144, 16, v185
  v_lshlrev_b32 v145, 16, v189
  v_lshlrev_b32 v146, 16, v193
  v_lshlrev_b32 v147, 16, v197
  v_lshlrev_b32 v148, 16, v201
  v_lshlrev_b32 v149, 16, v205
  v_lshlrev_b32 v150, 16, v209
  v_mul_f32 v152, v140, v43
  v_mul_f32 v153, v141, v43
  v_mul_f32 v154, v142, v43
  v_mul_f32 v155, v143, v43
  v_mul_f32 v156, v144, v43
  v_mul_f32 v157, v145, v43
  v_mul_f32 v158, v146, v43
  v_mul_f32 v159, v147, v43
  v_fmac_f32 v152, v141, v42
  v_fmac_f32 v153, v142, v42
  v_fmac_f32 v154, v143, v42
  v_fmac_f32 v155, v144, v42
  v_fmac_f32 v156, v145, v42
  v_fmac_f32 v157, v146, v42
  v_fmac_f32 v158, v147, v42
  v_fmac_f32 v159, v148, v42
  v_fmac_f32 v152, v142, v41
  v_fmac_f32 v153, v143, v41
  v_fmac_f32 v154, v144, v41
  v_fmac_f32 v155, v145, v41
  v_fmac_f32 v156, v146, v41
  v_fmac_f32 v157, v147, v41
  v_fmac_f32 v158, v148, v41
  v_fmac_f32 v159, v149, v41
  v_fmac_f32 v152, v143, v40
  v_fmac_f32 v153, v144, v40
  v_fmac_f32 v154, v145, v40
  v_fmac_f32 v155, v146, v40
  v_fmac_f32 v156, v147, v40
  v_fmac_f32 v157, v148, v40
  v_fmac_f32 v158, v149, v40
  v_fmac_f32 v159, v150, v40
  v_lshlrev_b32 v140, 16, v213
  v_lshlrev_b32 v141, 16, v217
  v_lshlrev_b32 v142, 16, v221
  v_lshlrev_b32 v143, 16, v225
  v_lshlrev_b32 v144, 16, v229
  v_lshlrev_b32 v145, 16, v233
  v_lshlrev_b32 v146, 16, v237
  v_lshlrev_b32 v147, 16, v241
  v_mul_f32 v152, v152, v140
  v_mul_f32 v153, v153, v141
  v_mul_f32 v154, v154, v142
  v_mul_f32 v155, v155, v143
  v_mul_f32 v156, v156, v144
  v_mul_f32 v157, v157, v145
  v_mul_f32 v158, v158, v146
  v_mul_f32 v159, v159, v147
  v_cvt_pk_bf16_f32 v160, v159, v158
  v_cvt_pk_bf16_f32 v161, v157, v156
  v_cvt_pk_bf16_f32 v162, v155, v154
  v_cvt_pk_bf16_f32 v163, v153, v152
  ds_write_b128 v251, v[160:163] offset:9152
  v_and_b32 v140, 0xffff0000, v169
  v_and_b32 v141, 0xffff0000, v173
  v_and_b32 v142, 0xffff0000, v177
  v_and_b32 v143, 0xffff0000, v181
  v_and_b32 v144, 0xffff0000, v185
  v_and_b32 v145, 0xffff0000, v189
  v_and_b32 v146, 0xffff0000, v193
  v_and_b32 v147, 0xffff0000, v197
  v_and_b32 v148, 0xffff0000, v201
  v_and_b32 v149, 0xffff0000, v205
  v_and_b32 v150, 0xffff0000, v209
  v_mul_f32 v152, v140, v47
  v_mul_f32 v153, v141, v47
  v_mul_f32 v154, v142, v47
  v_mul_f32 v155, v143, v47
  v_mul_f32 v156, v144, v47
  v_mul_f32 v157, v145, v47
  v_mul_f32 v158, v146, v47
  v_mul_f32 v159, v147, v47
  v_fmac_f32 v152, v141, v46
  v_fmac_f32 v153, v142, v46
  v_fmac_f32 v154, v143, v46
  v_fmac_f32 v155, v144, v46
  v_fmac_f32 v156, v145, v46
  v_fmac_f32 v157, v146, v46
  v_fmac_f32 v158, v147, v46
  v_fmac_f32 v159, v148, v46
  v_fmac_f32 v152, v142, v45
  v_fmac_f32 v153, v143, v45
  v_fmac_f32 v154, v144, v45
  v_fmac_f32 v155, v145, v45
  v_fmac_f32 v156, v146, v45
  v_fmac_f32 v157, v147, v45
  v_fmac_f32 v158, v148, v45
  v_fmac_f32 v159, v149, v45
  v_fmac_f32 v152, v143, v44
  v_fmac_f32 v153, v144, v44
  v_fmac_f32 v154, v145, v44
  v_fmac_f32 v155, v146, v44
  v_fmac_f32 v156, v147, v44
  v_fmac_f32 v157, v148, v44
  v_fmac_f32 v158, v149, v44
  v_fmac_f32 v159, v150, v44
  v_and_b32 v140, 0xffff0000, v213
  v_and_b32 v141, 0xffff0000, v217
  v_and_b32 v142, 0xffff0000, v221
  v_and_b32 v143, 0xffff0000, v225
  v_and_b32 v144, 0xffff0000, v229
  v_and_b32 v145, 0xffff0000, v233
  v_and_b32 v146, 0xffff0000, v237
  v_and_b32 v147, 0xffff0000, v241
  v_mul_f32 v152, v152, v140
  v_mul_f32 v153, v153, v141
  v_mul_f32 v154, v154, v142
  v_mul_f32 v155, v155, v143
  v_mul_f32 v156, v156, v144
  v_mul_f32 v157, v157, v145
  v_mul_f32 v158, v158, v146
  v_mul_f32 v159, v159, v147
  v_cvt_pk_bf16_f32 v164, v159, v158
  v_cvt_pk_bf16_f32 v165, v157, v156
  v_cvt_pk_bf16_f32 v166, v155, v154
  v_cvt_pk_bf16_f32 v167, v153, v152
  ds_write_b128 v251, v[164:167] offset:13728
  v_lshlrev_b32 v140, 16, v170
  v_lshlrev_b32 v141, 16, v174
  v_lshlrev_b32 v142, 16, v178
  v_lshlrev_b32 v143, 16, v182
  v_lshlrev_b32 v144, 16, v186
  v_lshlrev_b32 v145, 16, v190
  v_lshlrev_b32 v146, 16, v194
  v_lshlrev_b32 v147, 16, v198
  v_lshlrev_b32 v148, 16, v202
  v_lshlrev_b32 v149, 16, v206
  v_lshlrev_b32 v150, 16, v210
  v_mul_f32 v152, v140, v51
  v_mul_f32 v153, v141, v51
  v_mul_f32 v154, v142, v51
  v_mul_f32 v155, v143, v51
  v_mul_f32 v156, v144, v51
  v_mul_f32 v157, v145, v51
  v_mul_f32 v158, v146, v51
  v_mul_f32 v159, v147, v51
  v_fmac_f32 v152, v141, v50
  v_fmac_f32 v153, v142, v50
  v_fmac_f32 v154, v143, v50
  v_fmac_f32 v155, v144, v50
  v_fmac_f32 v156, v145, v50
  v_fmac_f32 v157, v146, v50
  v_fmac_f32 v158, v147, v50
  v_fmac_f32 v159, v148, v50
  v_fmac_f32 v152, v142, v49
  v_fmac_f32 v153, v143, v49
  v_fmac_f32 v154, v144, v49
  v_fmac_f32 v155, v145, v49
  v_fmac_f32 v156, v146, v49
  v_fmac_f32 v157, v147, v49
  v_fmac_f32 v158, v148, v49
  v_fmac_f32 v159, v149, v49
  v_fmac_f32 v152, v143, v48
  v_fmac_f32 v153, v144, v48
  v_fmac_f32 v154, v145, v48
  v_fmac_f32 v155, v146, v48
  v_fmac_f32 v156, v147, v48
  v_fmac_f32 v157, v148, v48
  v_fmac_f32 v158, v149, v48
  v_fmac_f32 v159, v150, v48
  v_lshlrev_b32 v140, 16, v214
  v_lshlrev_b32 v141, 16, v218
  v_lshlrev_b32 v142, 16, v222
  v_lshlrev_b32 v143, 16, v226
  v_lshlrev_b32 v144, 16, v230
  v_lshlrev_b32 v145, 16, v234
  v_lshlrev_b32 v146, 16, v238
  v_lshlrev_b32 v147, 16, v242
  v_mul_f32 v152, v152, v140
  v_mul_f32 v153, v153, v141
  v_mul_f32 v154, v154, v142
  v_mul_f32 v155, v155, v143
  v_mul_f32 v156, v156, v144
  v_mul_f32 v157, v157, v145
  v_mul_f32 v158, v158, v146
  v_mul_f32 v159, v159, v147
  v_cvt_pk_bf16_f32 v160, v159, v158
  v_cvt_pk_bf16_f32 v161, v157, v156
  v_cvt_pk_bf16_f32 v162, v155, v154
  v_cvt_pk_bf16_f32 v163, v153, v152
  ds_write_b128 v251, v[160:163] offset:18304
  v_and_b32 v140, 0xffff0000, v170
  v_and_b32 v141, 0xffff0000, v174
  v_and_b32 v142, 0xffff0000, v178
  v_and_b32 v143, 0xffff0000, v182
  v_and_b32 v144, 0xffff0000, v186
  v_and_b32 v145, 0xffff0000, v190
  v_and_b32 v146, 0xffff0000, v194
  v_and_b32 v147, 0xffff0000, v198
  v_and_b32 v148, 0xffff0000, v202
  v_and_b32 v149, 0xffff0000, v206
  v_and_b32 v150, 0xffff0000, v210
  v_mul_f32 v152, v140, v55
  v_mul_f32 v153, v141, v55
  v_mul_f32 v154, v142, v55
  v_mul_f32 v155, v143, v55
  v_mul_f32 v156, v144, v55
  v_mul_f32 v157, v145, v55
  v_mul_f32 v158, v146, v55
  v_mul_f32 v159, v147, v55
  v_fmac_f32 v152, v141, v54
  v_fmac_f32 v153, v142, v54
  v_fmac_f32 v154, v143, v54
  v_fmac_f32 v155, v144, v54
  v_fmac_f32 v156, v145, v54
  v_fmac_f32 v157, v146, v54
  v_fmac_f32 v158, v147, v54
  v_fmac_f32 v159, v148, v54
  v_fmac_f32 v152, v142, v53
  v_fmac_f32 v153, v143, v53
  v_fmac_f32 v154, v144, v53
  v_fmac_f32 v155, v145, v53
  v_fmac_f32 v156, v146, v53
  v_fmac_f32 v157, v147, v53
  v_fmac_f32 v158, v148, v53
  v_fmac_f32 v159, v149, v53
  v_fmac_f32 v152, v143, v52
  v_fmac_f32 v153, v144, v52
  v_fmac_f32 v154, v145, v52
  v_fmac_f32 v155, v146, v52
  v_fmac_f32 v156, v147, v52
  v_fmac_f32 v157, v148, v52
  v_fmac_f32 v158, v149, v52
  v_fmac_f32 v159, v150, v52
  v_and_b32 v140, 0xffff0000, v214
  v_and_b32 v141, 0xffff0000, v218
  v_and_b32 v142, 0xffff0000, v222
  v_and_b32 v143, 0xffff0000, v226
  v_and_b32 v144, 0xffff0000, v230
  v_and_b32 v145, 0xffff0000, v234
  v_and_b32 v146, 0xffff0000, v238
  v_and_b32 v147, 0xffff0000, v242
  v_mul_f32 v152, v152, v140
  v_mul_f32 v153, v153, v141
  v_mul_f32 v154, v154, v142
  v_mul_f32 v155, v155, v143
  v_mul_f32 v156, v156, v144
  v_mul_f32 v157, v157, v145
  v_mul_f32 v158, v158, v146
  v_mul_f32 v159, v159, v147
  v_cvt_pk_bf16_f32 v164, v159, v158
  v_cvt_pk_bf16_f32 v165, v157, v156
  v_cvt_pk_bf16_f32 v166, v155, v154
  v_cvt_pk_bf16_f32 v167, v153, v152
  ds_write_b128 v251, v[164:167] offset:22880
  v_lshlrev_b32 v140, 16, v171
  v_lshlrev_b32 v141, 16, v175
  v_lshlrev_b32 v142, 16, v179
  v_lshlrev_b32 v143, 16, v183
  v_lshlrev_b32 v144, 16, v187
  v_lshlrev_b32 v145, 16, v191
  v_lshlrev_b32 v146, 16, v195
  v_lshlrev_b32 v147, 16, v199
  v_lshlrev_b32 v148, 16, v203
  v_lshlrev_b32 v149, 16, v207
  v_lshlrev_b32 v150, 16, v211
  v_mul_f32 v152, v140, v59
  v_mul_f32 v153, v141, v59
  v_mul_f32 v154, v142, v59
  v_mul_f32 v155, v143, v59
  v_mul_f32 v156, v144, v59
  v_mul_f32 v157, v145, v59
  v_mul_f32 v158, v146, v59
  v_mul_f32 v159, v147, v59
  v_fmac_f32 v152, v141, v58
  v_fmac_f32 v153, v142, v58
  v_fmac_f32 v154, v143, v58
  v_fmac_f32 v155, v144, v58
  v_fmac_f32 v156, v145, v58
  v_fmac_f32 v157, v146, v58
  v_fmac_f32 v158, v147, v58
  v_fmac_f32 v159, v148, v58
  v_fmac_f32 v152, v142, v57
  v_fmac_f32 v153, v143, v57
  v_fmac_f32 v154, v144, v57
  v_fmac_f32 v155, v145, v57
  v_fmac_f32 v156, v146, v57
  v_fmac_f32 v157, v147, v57
  v_fmac_f32 v158, v148, v57
  v_fmac_f32 v159, v149, v57
  v_fmac_f32 v152, v143, v56
  v_fmac_f32 v153, v144, v56
  v_fmac_f32 v154, v145, v56
  v_fmac_f32 v155, v146, v56
  v_fmac_f32 v156, v147, v56
  v_fmac_f32 v157, v148, v56
  v_fmac_f32 v158, v149, v56
  v_fmac_f32 v159, v150, v56
  v_lshlrev_b32 v140, 16, v215
  v_lshlrev_b32 v141, 16, v219
  v_lshlrev_b32 v142, 16, v223
  v_lshlrev_b32 v143, 16, v227
  v_lshlrev_b32 v144, 16, v231
  v_lshlrev_b32 v145, 16, v235
  v_lshlrev_b32 v146, 16, v239
  v_lshlrev_b32 v147, 16, v243
  v_mul_f32 v152, v152, v140
  v_mul_f32 v153, v153, v141
  v_mul_f32 v154, v154, v142
  v_mul_f32 v155, v155, v143
  v_mul_f32 v156, v156, v144
  v_mul_f32 v157, v157, v145
  v_mul_f32 v158, v158, v146
  v_mul_f32 v159, v159, v147
  v_cvt_pk_bf16_f32 v160, v159, v158
  v_cvt_pk_bf16_f32 v161, v157, v156
  v_cvt_pk_bf16_f32 v162, v155, v154
  v_cvt_pk_bf16_f32 v163, v153, v152
  ds_write_b128 v251, v[160:163] offset:27456
  v_and_b32 v140, 0xffff0000, v171
  v_and_b32 v141, 0xffff0000, v175
  v_and_b32 v142, 0xffff0000, v179
  v_and_b32 v143, 0xffff0000, v183
  v_and_b32 v144, 0xffff0000, v187
  v_and_b32 v145, 0xffff0000, v191
  v_and_b32 v146, 0xffff0000, v195
  v_and_b32 v147, 0xffff0000, v199
  v_and_b32 v148, 0xffff0000, v203
  v_and_b32 v149, 0xffff0000, v207
  v_and_b32 v150, 0xffff0000, v211
  v_mul_f32 v152, v140, v63
  v_mul_f32 v153, v141, v63
  v_mul_f32 v154, v142, v63
  v_mul_f32 v155, v143, v63
  v_mul_f32 v156, v144, v63
  v_mul_f32 v157, v145, v63
  v_mul_f32 v158, v146, v63
  v_mul_f32 v159, v147, v63
  v_fmac_f32 v152, v141, v62
  v_fmac_f32 v153, v142, v62
  v_fmac_f32 v154, v143, v62
  v_fmac_f32 v155, v144, v62
  v_fmac_f32 v156, v145, v62
  v_fmac_f32 v157, v146, v62
  v_fmac_f32 v158, v147, v62
  v_fmac_f32 v159, v148, v62
  v_fmac_f32 v152, v142, v61
  v_fmac_f32 v153, v143, v61
  v_fmac_f32 v154, v144, v61
  v_fmac_f32 v155, v145, v61
  v_fmac_f32 v156, v146, v61
  v_fmac_f32 v157, v147, v61
  v_fmac_f32 v158, v148, v61
  v_fmac_f32 v159, v149, v61
  v_fmac_f32 v152, v143, v60
  v_fmac_f32 v153, v144, v60
  v_fmac_f32 v154, v145, v60
  v_fmac_f32 v155, v146, v60
  v_fmac_f32 v156, v147, v60
  v_fmac_f32 v157, v148, v60
  v_fmac_f32 v158, v149, v60
  v_fmac_f32 v159, v150, v60
  v_and_b32 v140, 0xffff0000, v215
  v_and_b32 v141, 0xffff0000, v219
  v_and_b32 v142, 0xffff0000, v223
  v_and_b32 v143, 0xffff0000, v227
  v_and_b32 v144, 0xffff0000, v231
  v_and_b32 v145, 0xffff0000, v235
  v_and_b32 v146, 0xffff0000, v239
  v_and_b32 v147, 0xffff0000, v243
  v_mul_f32 v152, v152, v140
  v_mul_f32 v153, v153, v141
  v_mul_f32 v154, v154, v142
  v_mul_f32 v155, v155, v143
  v_mul_f32 v156, v156, v144
  v_mul_f32 v157, v157, v145
  v_mul_f32 v158, v158, v146
  v_mul_f32 v159, v159, v147
  v_cvt_pk_bf16_f32 v164, v159, v158
  v_cvt_pk_bf16_f32 v165, v157, v156
  v_cvt_pk_bf16_f32 v166, v155, v154
  v_cvt_pk_bf16_f32 v167, v153, v152
  ds_write_b128 v251, v[164:167] offset:32032
  v_and_b32 v1, 15, v0
  v_lshrrev_b32 v2, 4, v0
  s_mul_i32 s42, s36, 16512
  s_add_u32 s42, s42, 73216
  v_and_b32 v5, 3, v0
  v_mul_u32_u24 v5, 4128, v5
  v_and_b32 v12, 12, v0
  v_lshl_add_u32 v5, v12, 1, v5
  v_lshlrev_b32 v12, 7, v2
  v_sub_u32 v5, v5, v12
  s_add_u32 s41, s42, 384
  v_add_u32 v5, s41, v5
  v_lshlrev_b32 v12, 4, v0
  v_add_u32 v13, s42, v12
  v_lshlrev_b32 v6, 5, v1
  v_lshl_add_u32 v7, v2, 3, v6
  v_lshl_add_u32 v6, v2, 7, v6
  s_mul_i32 s40, s36, 18304
  s_add_u32 s41, s40, 864
  v_sub_u32 v6, s41, v6
  s_add_u32 s41, s40, 504
  v_sub_u32 v7, s41, v7
  s_lshl_b32 s40, s36, 2
  s_add_u32 s67, s72, s40
  s_lshl_b32 s40, s67, 1
  s_load_dwordx2 s[68:69], s[28:29], s40
  s_lshl_b32 s40, s67, 12
  s_add_u32 s56, s26, s40
  s_addc_u32 s57, s27, 0
  s_and_b32 s57, s57, 0xffff
  s_mov_b32 s58, 4096
  s_mov_b32 s59, 0x20000
  s_mov_b32 s64, 0
  v_mov_b32 v44, 0
  v_mov_b32 v46, 0
  s_mov_b64 exec, 3
  ds_write_b128 v13, v[8:11] offset:0
  ds_write_b128 v13, v[8:11] offset:4128
  ds_write_b128 v13, v[8:11] offset:8256
  ds_write_b128 v13, v[8:11] offset:12384
  s_mov_b64 exec, -1
  s_waitcnt lgkmcnt(0)
  buffer_load_dwordx4 v[16:19], v12, s[56:59], 0 offen offset:4
  buffer_load_dwordx4 v[20:23], v12, s[56:59], 0 offen offset:8
  buffer_load_dword v24, v12, s[56:59], 0 offen offset:0
  buffer_load_dwordx4 v[26:29], v12, s[56:59], 0 offen offset:1028
  buffer_load_dwordx4 v[30:33], v12, s[56:59], 0 offen offset:1032
  buffer_load_dword v34, v12, s[56:59], 0 offen offset:1024
  s_barrier
  ds_read_b128 a[224:227], v6 offset:0
  ds_read_b128 a[228:231], v6 offset:16
  ds_read_b128 a[232:235], v6 offset:32
  ds_read_b128 a[236:239], v6 offset:48
  ds_read_b128 a[240:243], v6 offset:64
  ds_read_b128 a[244:247], v6 offset:80
  ds_read_b128 a[248:251], v6 offset:96
  ds_read_b128 a[252:255], v6 offset:112
  ds_read_b128 a[192:195], v6 offset:512
  ds_read_b128 a[196:199], v6 offset:528
  ds_read_b128 a[200:203], v6 offset:544
  ds_read_b128 a[204:207], v6 offset:560
  ds_read_b128 a[208:211], v6 offset:576
  ds_read_b128 a[212:215], v6 offset:592
  ds_read_b128 a[216:219], v6 offset:608
  ds_read_b128 a[220:223], v6 offset:624
  ds_read_b128 a[160:163], v6 offset:1024
  ds_read_b128 a[164:167], v6 offset:1040
  ds_read_b128 a[168:171], v6 offset:1056
  ds_read_b128 a[172:175], v6 offset:1072
  ds_read_b128 a[176:179], v6 offset:1088
  ds_read_b128 a[180:183], v6 offset:1104
  ds_read_b128 a[184:187], v6 offset:1120
  ds_read_b128 a[188:191], v6 offset:1136
  ds_read_b128 a[128:131], v6 offset:1536
  ds_read_b128 a[132:135], v6 offset:1552
  ds_read_b128 a[136:139], v6 offset:1568
  ds_read_b128 a[140:143], v6 offset:1584
  ds_read_b128 a[144:147], v6 offset:1600
  ds_read_b128 a[148:151], v6 offset:1616
  ds_read_b128 a[152:155], v6 offset:1632
  ds_read_b128 a[156:159], v6 offset:1648
  s_waitcnt vmcnt(3)
  ds_write_b128 v13, v[16:19] offset:4160
  v_alignbit_b32 v36, v16, v24, 16
  v_alignbit_b32 v37, v17, v16, 16
  v_alignbit_b32 v38, v18, v17, 16
  v_alignbit_b32 v39, v19, v18, 16
  ds_write_b128 v13, v[20:23] offset:12416
  v_alignbit_b32 v40, v20, v16, 16
  v_alignbit_b32 v41, v21, v17, 16
  v_alignbit_b32 v42, v22, v18, 16
  v_alignbit_b32 v43, v23, v19, 16
  ds_write_b128 v13, v[36:39] offset:32
  ds_write_b128 v13, v[40:43] offset:8288
  v_lshlrev_b32 v45, 16, v24
  v_mov_b32 v47, v24
  v_mov_b32 v48, v45
  v_mov_b32 v49, v36
  v_mov_b32 v50, v24
  v_mov_b32 v51, v16
  s_mov_b64 exec, 1
  ds_write_b64 v13, v[44:45] offset:24
  s_mov_b64 exec, -1
  s_mov_b64 exec, 1
  ds_write_b64 v13, v[46:47] offset:4152
  s_mov_b64 exec, -1
  s_mov_b64 exec, 1
  ds_write_b64 v13, v[48:49] offset:8280
  s_mov_b64 exec, -1
  s_mov_b64 exec, 1
  ds_write_b64 v13, v[50:51] offset:12408
  s_mov_b64 exec, -1
  buffer_load_dwordx4 v[16:19], v12, s[56:59], 0 offen offset:2052
  buffer_load_dwordx4 v[20:23], v12, s[56:59], 0 offen offset:2056
  buffer_load_dword v24, v12, s[56:59], 0 offen offset:2048
  s_waitcnt vmcnt(3)
  ds_write_b128 v13, v[26:29] offset:5184
  v_alignbit_b32 v36, v26, v34, 16
  v_alignbit_b32 v37, v27, v26, 16
  v_alignbit_b32 v38, v28, v27, 16
  v_alignbit_b32 v39, v29, v28, 16
  ds_write_b128 v13, v[30:33] offset:13440
  v_alignbit_b32 v40, v30, v26, 16
  v_alignbit_b32 v41, v31, v27, 16
  v_alignbit_b32 v42, v32, v28, 16
  v_alignbit_b32 v43, v33, v29, 16
  ds_write_b128 v13, v[36:39] offset:1056
  ds_write_b128 v13, v[40:43] offset:9312
  buffer_load_dwordx4 v[26:29], v12, s[56:59], 0 offen offset:3076
  buffer_load_dwordx4 v[30:33], v12, s[56:59], 0 offen offset:3080
  buffer_load_dword v34, v12, s[56:59], 0 offen offset:3072
  ds_read_b128 a[96:99], v6 offset:2048
  ds_read_b128 a[100:103], v6 offset:2064
  ds_read_b128 a[104:107], v6 offset:2080
  ds_read_b128 a[108:111], v6 offset:2096
  ds_read_b128 a[112:115], v6 offset:2112
  ds_read_b128 a[116:119], v6 offset:2128
  ds_read_b128 a[120:123], v6 offset:2144
  ds_read_b128 a[124:127], v6 offset:2160
  ds_read_b128 a[64:67], v6 offset:2560
  ds_read_b128 a[68:71], v6 offset:2576
  ds_read_b128 a[72:75], v6 offset:2592
  ds_read_b128 a[76:79], v6 offset:2608
  ds_read_b128 a[80:83], v6 offset:2624
  ds_read_b128 a[84:87], v6 offset:2640
  ds_read_b128 a[88:91], v6 offset:2656
  ds_read_b128 a[92:95], v6 offset:2672
  ds_read_b128 a[32:35], v6 offset:3072
  ds_read_b128 a[36:39], v6 offset:3088
  ds_read_b128 a[40:43], v6 offset:3104
  ds_read_b128 a[44:47], v6 offset:3120
  ds_read_b128 a[48:51], v6 offset:3136
  ds_read_b128 a[52:55], v6 offset:3152
  ds_read_b128 a[56:59], v6 offset:3168
  ds_read_b128 a[60:63], v6 offset:3184
  ds_read_b128 a[0:3], v6 offset:3584
  ds_read_b128 a[4:7], v6 offset:3600
  ds_read_b128 a[8:11], v6 offset:3616
  ds_read_b128 a[12:15], v6 offset:3632
  ds_read_b128 a[16:19], v6 offset:3648
  ds_read_b128 a[20:23], v6 offset:3664
  ds_read_b128 a[24:27], v6 offset:3680
  ds_read_b128 a[28:31], v6 offset:3696
  s_waitcnt vmcnt(3)
  ds_write_b128 v13, v[16:19] offset:6208
  v_alignbit_b32 v36, v16, v24, 16
  v_alignbit_b32 v37, v17, v16, 16
  v_alignbit_b32 v38, v18, v17, 16
  v_alignbit_b32 v39, v19, v18, 16
  ds_write_b128 v13, v[20:23] offset:14464
  v_alignbit_b32 v40, v20, v16, 16
  v_alignbit_b32 v41, v21, v17, 16
  v_alignbit_b32 v42, v22, v18, 16
  v_alignbit_b32 v43, v23, v19, 16
  ds_write_b128 v13, v[36:39] offset:2080
  ds_write_b128 v13, v[40:43] offset:10336
  ds_read_b64 v[64:65], v5 offset:0
  ds_read_b64 v[66:67], v5 offset:8
  ds_read_b64 v[68:69], v5 offset:16
  ds_read_b64 v[70:71], v5 offset:24
  ds_read_b64 v[72:73], v5 offset:32
  ds_read_b64 v[74:75], v5 offset:40
  ds_read_b64 v[76:77], v5 offset:48
  ds_read_b64 v[78:79], v5 offset:56
  ds_read_b64 v[80:81], v5 offset:64
  ds_read_b64 v[82:83], v5 offset:72
  ds_read_b64 v[84:85], v5 offset:80
  ds_read_b64 v[86:87], v5 offset:88
  ds_read_b64 v[88:89], v5 offset:96
  ds_read_b64 v[90:91], v5 offset:104
  ds_read_b64 v[92:93], v5 offset:112
  ds_read_b64 v[94:95], v5 offset:120
  s_mov_b32 s44, s18
  s_and_b32 s45, s19, 0xffff
  s_mov_b32 s46, 0x400000
  s_mov_b32 s47, 0x20000
L_cv_loop:
  s_waitcnt lgkmcnt(0)
  v_mfma_f32_16x16x32_bf16 v[220:223], v[64:67], a[224:227], 0
  ds_read_b64 v[96:97], v5 offset:512
  v_mfma_f32_16x16x32_bf16 v[220:223], v[68:71], a[228:231], v[220:223]
  ds_read_b64 v[98:99], v5 offset:520
  v_mfma_f32_16x16x32_bf16 v[220:223], v[72:75], a[232:235], v[220:223]
  v_mfma_f32_16x16x32_bf16 v[220:223], v[76:79], a[236:239], v[220:223]
  ds_read_b64 v[100:101], v5 offset:528
  v_mfma_f32_16x16x32_bf16 v[220:223], v[80:83], a[240:243], v[220:223]
  v_mfma_f32_16x16x32_bf16 v[220:223], v[84:87], a[244:247], v[220:223]
  ds_read_b64 v[102:103], v5 offset:536
  v_mfma_f32_16x16x32_bf16 v[220:223], v[88:91], a[248:251], v[220:223]
  ds_read_b64 v[104:105], v5 offset:544
  v_mfma_f32_16x16x32_bf16 v[220:223], v[92:95], a[252:255], v[220:223]
  v_mfma_f32_16x16x32_bf16 v[216:219], v[64:67], a[192:195], 0
  ds_read_b128 a[224:227], v6 offset:4576
  ds_read_b64 v[106:107], v5 offset:552
  v_mfma_f32_16x16x32_bf16 v[216:219], v[68:71], a[196:199], v[216:219]
  ds_read_b128 a[228:231], v6 offset:4592
  v_mfma_f32_16x16x32_bf16 v[216:219], v[72:75], a[200:203], v[216:219]
  ds_read_b128 a[232:235], v6 offset:4608
  ds_read_b64 v[108:109], v5 offset:560
  v_mfma_f32_16x16x32_bf16 v[216:219], v[76:79], a[204:207], v[216:219]
  ds_read_b128 a[236:239], v6 offset:4624
  v_mfma_f32_16x16x32_bf16 v[216:219], v[80:83], a[208:211], v[216:219]
  ds_read_b128 a[240:243], v6 offset:4640
  ds_read_b64 v[110:111], v5 offset:568
  v_mfma_f32_16x16x32_bf16 v[216:219], v[84:87], a[212:215], v[216:219]
  ds_read_b128 a[244:247], v6 offset:4656
  ds_read_b64 v[112:113], v5 offset:576
  v_mfma_f32_16x16x32_bf16 v[216:219], v[88:91], a[216:219], v[216:219]
  ds_read_b128 a[248:251], v6 offset:4672
  v_mfma_f32_16x16x32_bf16 v[216:219], v[92:95], a[220:223], v[216:219]
  ds_read_b128 a[252:255], v6 offset:4688
  ds_read_b64 v[114:115], v5 offset:584
  v_mfma_f32_16x16x32_bf16 v[212:215], v[64:67], a[160:163], 0
  v_mfma_f32_16x16x32_bf16 v[212:215], v[68:71], a[164:167], v[212:215]
  ds_read_b64 v[116:117], v5 offset:592
  v_mfma_f32_16x16x32_bf16 v[212:215], v[72:75], a[168:171], v[212:215]
  v_mfma_f32_16x16x32_bf16 v[212:215], v[76:79], a[172:175], v[212:215]
  ds_read_b64 v[118:119], v5 offset:600
  v_mfma_f32_16x16x32_bf16 v[212:215], v[80:83], a[176:179], v[212:215]
  ds_read_b64 v[120:121], v5 offset:608
  v_mfma_f32_16x16x32_bf16 v[212:215], v[84:87], a[180:183], v[212:215]
  v_mfma_f32_16x16x32_bf16 v[212:215], v[88:91], a[184:187], v[212:215]
  ds_read_b64 v[122:123], v5 offset:616
  v_mfma_f32_16x16x32_bf16 v[212:215], v[92:95], a[188:191], v[212:215]
  v_mfma_f32_16x16x32_bf16 v[208:211], v[64:67], a[128:131], 0
  ds_read_b64 v[124:125], v5 offset:624
  v_mfma_f32_16x16x32_bf16 v[208:211], v[68:71], a[132:135], v[208:211]
  ds_read_b64 v[126:127], v5 offset:632
  v_mfma_f32_16x16x32_bf16 v[208:211], v[72:75], a[136:139], v[208:211]
  v_mfma_f32_16x16x32_bf16 v[208:211], v[76:79], a[140:143], v[208:211]
  s_waitcnt vmcnt(0)
  v_mfma_f32_16x16x32_bf16 v[208:211], v[80:83], a[144:147], v[208:211]
  v_mfma_f32_16x16x32_bf16 v[208:211], v[84:87], a[148:151], v[208:211]
  ds_write_b128 v13, v[26:29] offset:7232
  v_mfma_f32_16x16x32_bf16 v[208:211], v[88:91], a[152:155], v[208:211]
  v_mfma_f32_16x16x32_bf16 v[208:211], v[92:95], a[156:159], v[208:211]
  v_alignbit_b32 v36, v26, v34, 16
  v_mfma_f32_16x16x32_bf16 v[204:207], v[64:67], a[96:99], 0
  v_alignbit_b32 v37, v27, v26, 16
  v_mfma_f32_16x16x32_bf16 v[204:207], v[68:71], a[100:103], v[204:207]
  v_mfma_f32_16x16x32_bf16 v[204:207], v[72:75], a[104:107], v[204:207]
  v_alignbit_b32 v38, v28, v27, 16
  v_mfma_f32_16x16x32_bf16 v[204:207], v[76:79], a[108:111], v[204:207]
  v_mfma_f32_16x16x32_bf16 v[204:207], v[80:83], a[112:115], v[204:207]
  v_alignbit_b32 v39, v29, v28, 16
  v_mfma_f32_16x16x32_bf16 v[204:207], v[84:87], a[116:119], v[204:207]
  v_mfma_f32_16x16x32_bf16 v[204:207], v[88:91], a[120:123], v[204:207]
  ds_write_b128 v13, v[30:33] offset:15488
  v_mfma_f32_16x16x32_bf16 v[204:207], v[92:95], a[124:127], v[204:207]
  v_alignbit_b32 v40, v30, v26, 16
  v_mfma_f32_16x16x32_bf16 v[200:203], v[64:67], a[64:67], 0
  v_mfma_f32_16x16x32_bf16 v[200:203], v[68:71], a[68:71], v[200:203]
  v_alignbit_b32 v41, v31, v27, 16
  v_mfma_f32_16x16x32_bf16 v[200:203], v[72:75], a[72:75], v[200:203]
  v_mfma_f32_16x16x32_bf16 v[200:203], v[76:79], a[76:79], v[200:203]
  v_alignbit_b32 v42, v32, v28, 16
  v_mfma_f32_16x16x32_bf16 v[200:203], v[80:83], a[80:83], v[200:203]
  v_alignbit_b32 v43, v33, v29, 16
  v_mfma_f32_16x16x32_bf16 v[200:203], v[84:87], a[84:87], v[200:203]
  v_mfma_f32_16x16x32_bf16 v[200:203], v[88:91], a[88:91], v[200:203]
  ds_write_b128 v13, v[36:39] offset:3104
  v_mfma_f32_16x16x32_bf16 v[200:203], v[92:95], a[92:95], v[200:203]
  v_mfma_f32_16x16x32_bf16 v[196:199], v[64:67], a[32:35], 0
  v_mfma_f32_16x16x32_bf16 v[196:199], v[68:71], a[36:39], v[196:199]
  v_mfma_f32_16x16x32_bf16 v[196:199], v[72:75], a[40:43], v[196:199]
  v_mfma_f32_16x16x32_bf16 v[196:199], v[76:79], a[44:47], v[196:199]
  ds_write_b128 v13, v[40:43] offset:11360
  v_mfma_f32_16x16x32_bf16 v[196:199], v[80:83], a[48:51], v[196:199]
  v_mfma_f32_16x16x32_bf16 v[196:199], v[84:87], a[52:55], v[196:199]
  s_lshl_b32 s66, s68, 16
  s_lshr_b64 s[68:69], s[68:69], 16
  v_mfma_f32_16x16x32_bf16 v[196:199], v[88:91], a[56:59], v[196:199]
  v_mfma_f32_16x16x32_bf16 v[196:199], v[92:95], a[60:63], v[196:199]
  s_add_u32 s56, s56, 4096
  s_addc_u32 s57, s57, 0
  s_cmp_lt_u32 s64, 3
  s_cselect_b32 s58, 4096, 0
  v_mfma_f32_16x16x32_bf16 v[192:195], v[64:67], a[0:3], 0
  v_mfma_f32_16x16x32_bf16 v[192:195], v[68:71], a[4:7], v[192:195]
  buffer_load_dwordx4 v[16:19], v12, s[56:59], 0 offen offset:4
  v_mfma_f32_16x16x32_bf16 v[192:195], v[72:75], a[8:11], v[192:195]
  buffer_load_dwordx4 v[20:23], v12, s[56:59], 0 offen offset:8
  v_mfma_f32_16x16x32_bf16 v[192:195], v[76:79], a[12:15], v[192:195]
  v_mfma_f32_16x16x32_bf16 v[192:195], v[80:83], a[16:19], v[192:195]
  buffer_load_dword v24, v12, s[56:59], 0 offen offset:0
  v_mfma_f32_16x16x32_bf16 v[192:195], v[84:87], a[20:23], v[192:195]
  v_mfma_f32_16x16x32_bf16 v[192:195], v[88:91], a[24:27], v[192:195]
  s_cmp_eq_u32 s64, 0
  s_cbranch_scc1 L_cq_23_0
  s_cmp_eq_u32 s64, 1
  s_cbranch_scc1 L_cq_23_1
  s_cmp_eq_u32 s64, 2
  s_cbranch_scc1 L_cq_23_2
  s_mov_b32 s65, 8192
  buffer_load_dwordx4 v[176:179], v250, s[44:47], s65 offen
  s_mov_b32 s65, 10240
  buffer_load_dwordx4 v[180:183], v250, s[44:47], s65 offen
L_cq_23:
  v_mfma_f32_16x16x32_bf16 v[192:195], v[92:95], a[28:31], v[192:195]
  s_waitcnt lgkmcnt(15)
  v_mfma_f32_16x16x32_bf16 v[220:223], v[96:99], a[192:195], v[220:223]
  ds_read_b64 v[64:65], v5 offset:1024
  s_waitcnt lgkmcnt(15)
  v_mfma_f32_16x16x32_bf16 v[220:223], v[100:103], a[196:199], v[220:223]
  ds_read_b64 v[66:67], v5 offset:1032
  s_waitcnt lgkmcnt(15)
  v_mfma_f32_16x16x32_bf16 v[220:223], v[104:107], a[200:203], v[220:223]
  s_waitcnt lgkmcnt(15)
  v_mfma_f32_16x16x32_bf16 v[220:223], v[108:111], a[204:207], v[220:223]
  ds_read_b64 v[68:69], v5 offset:1040
  s_waitcnt lgkmcnt(13)
  v_mfma_f32_16x16x32_bf16 v[220:223], v[112:115], a[208:211], v[220:223]
  ds_read_b64 v[70:71], v5 offset:1048
  s_waitcnt lgkmcnt(12)
  v_mfma_f32_16x16x32_bf16 v[220:223], v[116:119], a[212:215], v[220:223]
  s_waitcnt lgkmcnt(10)
  v_mfma_f32_16x16x32_bf16 v[220:223], v[120:123], a[216:219], v[220:223]
  ds_read_b64 v[72:73], v5 offset:1056
  s_waitcnt lgkmcnt(9)
  v_mfma_f32_16x16x32_bf16 v[220:223], v[124:127], a[220:223], v[220:223]
  v_mfma_f32_16x16x32_bf16 v[216:219], v[96:99], a[160:163], v[216:219]
  ds_read_b128 a[192:195], v6 offset:5088
  ds_read_b64 v[74:75], v5 offset:1064
  v_mfma_f32_16x16x32_bf16 v[216:219], v[100:103], a[164:167], v[216:219]
  ds_read_b128 a[196:199], v6 offset:5104
  ds_read_b64 v[76:77], v5 offset:1072
  v_mfma_f32_16x16x32_bf16 v[216:219], v[104:107], a[168:171], v[216:219]
  ds_read_b128 a[200:203], v6 offset:5120
  v_mfma_f32_16x16x32_bf16 v[216:219], v[108:111], a[172:175], v[216:219]
  ds_read_b128 a[204:207], v6 offset:5136
  ds_read_b64 v[78:79], v5 offset:1080
  v_mfma_f32_16x16x32_bf16 v[216:219], v[112:115], a[176:179], v[216:219]
  ds_read_b128 a[208:211], v6 offset:5152
  v_mfma_f32_16x16x32_bf16 v[216:219], v[116:119], a[180:183], v[216:219]
  ds_read_b128 a[212:215], v6 offset:5168
  ds_read_b64 v[80:81], v5 offset:1088
  v_mfma_f32_16x16x32_bf16 v[216:219], v[120:123], a[184:187], v[216:219]
  ds_read_b128 a[216:219], v6 offset:5184
  ds_read_b64 v[82:83], v5 offset:1096
  v_mfma_f32_16x16x32_bf16 v[216:219], v[124:127], a[188:191], v[216:219]
  ds_read_b128 a[220:223], v6 offset:5200
  v_mfma_f32_16x16x32_bf16 v[212:215], v[96:99], a[128:131], v[212:215]
  ds_read_b64 v[84:85], v5 offset:1104
  v_mfma_f32_16x16x32_bf16 v[212:215], v[100:103], a[132:135], v[212:215]
  v_mfma_f32_16x16x32_bf16 v[212:215], v[104:107], a[136:139], v[212:215]
  ds_read_b64 v[86:87], v5 offset:1112
  v_mfma_f32_16x16x32_bf16 v[212:215], v[108:111], a[140:143], v[212:215]
  ds_read_b64 v[88:89], v5 offset:1120
  v_mfma_f32_16x16x32_bf16 v[212:215], v[112:115], a[144:147], v[212:215]
  v_mfma_f32_16x16x32_bf16 v[212:215], v[116:119], a[148:151], v[212:215]
  ds_read_b64 v[90:91], v5 offset:1128
  v_mfma_f32_16x16x32_bf16 v[212:215], v[120:123], a[152:155], v[212:215]
  v_mfma_f32_16x16x32_bf16 v[212:215], v[124:127], a[156:159], v[212:215]
  ds_read_b64 v[92:93], v5 offset:1136
  v_mfma_f32_16x16x32_bf16 v[208:211], v[96:99], a[96:99], v[208:211]
  ds_read_b64 v[94:95], v5 offset:1144
  v_mfma_f32_16x16x32_bf16 v[208:211], v[100:103], a[100:103], v[208:211]
  v_mfma_f32_16x16x32_bf16 v[208:211], v[104:107], a[104:107], v[208:211]
  ds_read_b64 v[224:225], v7 offset:3584
  v_mfma_f32_16x16x32_bf16 v[208:211], v[108:111], a[108:111], v[208:211]
  v_mfma_f32_16x16x32_bf16 v[208:211], v[112:115], a[112:115], v[208:211]
  v_mfma_f32_16x16x32_bf16 v[208:211], v[116:119], a[116:119], v[208:211]
  v_mfma_f32_16x16x32_bf16 v[208:211], v[120:123], a[120:123], v[208:211]
  v_mfma_f32_16x16x32_bf16 v[208:211], v[124:127], a[124:127], v[208:211]
  s_waitcnt lgkmcnt(0)
  v_lshlrev_b32 v228, 16, v224
  v_mfma_f32_16x16x32_bf16 v[204:207], v[96:99], a[64:67], v[204:207]
  v_and_b32 v229, 0xffff0000, v224
  v_mfma_f32_16x16x32_bf16 v[204:207], v[100:103], a[68:71], v[204:207]
  v_mfma_f32_16x16x32_bf16 v[204:207], v[104:107], a[72:75], v[204:207]
  v_lshlrev_b32 v230, 16, v225
  v_mfma_f32_16x16x32_bf16 v[204:207], v[108:111], a[76:79], v[204:207]
  v_mfma_f32_16x16x32_bf16 v[204:207], v[112:115], a[80:83], v[204:207]
  v_and_b32 v231, 0xffff0000, v225
  v_mfma_f32_16x16x32_bf16 v[204:207], v[116:119], a[84:87], v[204:207]
  v_fma_f32 v228, v228, s66, v195
  v_mfma_f32_16x16x32_bf16 v[204:207], v[120:123], a[88:91], v[204:207]
  v_mfma_f32_16x16x32_bf16 v[204:207], v[124:127], a[92:95], v[204:207]
  v_fma_f32 v229, v229, s66, v194
  v_mfma_f32_16x16x32_bf16 v[200:203], v[96:99], a[32:35], v[200:203]
  v_mfma_f32_16x16x32_bf16 v[200:203], v[100:103], a[36:39], v[200:203]
  v_fma_f32 v230, v230, s66, v193
  v_mfma_f32_16x16x32_bf16 v[200:203], v[104:107], a[40:43], v[200:203]
  v_fma_f32 v231, v231, s66, v192
  v_mfma_f32_16x16x32_bf16 v[200:203], v[108:111], a[44:47], v[200:203]
  v_mfma_f32_16x16x32_bf16 v[200:203], v[112:115], a[48:51], v[200:203]
  v_cvt_pk_bf16_f32 v224, v228, v229
  v_mfma_f32_16x16x32_bf16 v[200:203], v[116:119], a[52:55], v[200:203]
  v_mfma_f32_16x16x32_bf16 v[200:203], v[120:123], a[56:59], v[200:203]
  v_cvt_pk_bf16_f32 v225, v230, v231
  v_mfma_f32_16x16x32_bf16 v[200:203], v[124:127], a[60:63], v[200:203]
  ds_write_b64 v7, v[224:225] offset:3584
  v_mfma_f32_16x16x32_bf16 v[196:199], v[96:99], a[0:3], v[196:199]
  v_mfma_f32_16x16x32_bf16 v[196:199], v[100:103], a[4:7], v[196:199]
  buffer_load_dwordx4 v[26:29], v12, s[56:59], 0 offen offset:1028
  v_mfma_f32_16x16x32_bf16 v[196:199], v[104:107], a[8:11], v[196:199]
  v_mfma_f32_16x16x32_bf16 v[196:199], v[108:111], a[12:15], v[196:199]
  buffer_load_dwordx4 v[30:33], v12, s[56:59], 0 offen offset:1032
  v_mfma_f32_16x16x32_bf16 v[196:199], v[112:115], a[16:19], v[196:199]
  buffer_load_dword v34, v12, s[56:59], 0 offen offset:1024
  v_mfma_f32_16x16x32_bf16 v[196:199], v[116:119], a[20:23], v[196:199]
  v_mfma_f32_16x16x32_bf16 v[196:199], v[120:123], a[24:27], v[196:199]
  s_cmp_eq_u32 s64, 0
  s_cbranch_scc1 L_cq_24_0
  s_cmp_eq_u32 s64, 1
  s_cbranch_scc1 L_cq_24_1
  s_cmp_eq_u32 s64, 2
  s_cbranch_scc1 L_cq_24_2
  s_mov_b32 s65, 12288
  buffer_load_dwordx4 v[184:187], v250, s[44:47], s65 offen
  s_mov_b32 s65, 14336
  buffer_load_dwordx4 v[188:191], v250, s[44:47], s65 offen
L_cq_24:
  v_mfma_f32_16x16x32_bf16 v[196:199], v[124:127], a[28:31], v[196:199]
  v_mfma_f32_16x16x32_bf16 v[220:223], v[64:67], a[160:163], v[220:223]
  ds_read_b64 v[96:97], v5 offset:1536
  ds_read_b64 v[98:99], v5 offset:1544
  v_mfma_f32_16x16x32_bf16 v[220:223], v[68:71], a[164:167], v[220:223]
  ds_read_b64 v[100:101], v5 offset:1552
  v_mfma_f32_16x16x32_bf16 v[220:223], v[72:75], a[168:171], v[220:223]
  ds_read_b64 v[102:103], v5 offset:1560
  v_mfma_f32_16x16x32_bf16 v[220:223], v[76:79], a[172:175], v[220:223]
  ds_read_b64 v[104:105], v5 offset:1568
  v_mfma_f32_16x16x32_bf16 v[220:223], v[80:83], a[176:179], v[220:223]
  ds_read_b64 v[106:107], v5 offset:1576
  v_mfma_f32_16x16x32_bf16 v[220:223], v[84:87], a[180:183], v[220:223]
  ds_read_b64 v[108:109], v5 offset:1584
  v_mfma_f32_16x16x32_bf16 v[220:223], v[88:91], a[184:187], v[220:223]
  ds_read_b64 v[110:111], v5 offset:1592
  v_mfma_f32_16x16x32_bf16 v[220:223], v[92:95], a[188:191], v[220:223]
  ds_read_b64 v[112:113], v5 offset:1600
  v_mfma_f32_16x16x32_bf16 v[216:219], v[64:67], a[128:131], v[216:219]
  ds_read_b128 a[160:163], v6 offset:5600
  ds_read_b64 v[114:115], v5 offset:1608
  v_mfma_f32_16x16x32_bf16 v[216:219], v[68:71], a[132:135], v[216:219]
  ds_read_b128 a[164:167], v6 offset:5616
  ds_read_b64 v[116:117], v5 offset:1616
  v_mfma_f32_16x16x32_bf16 v[216:219], v[72:75], a[136:139], v[216:219]
  ds_read_b128 a[168:171], v6 offset:5632
  ds_read_b64 v[118:119], v5 offset:1624
  v_mfma_f32_16x16x32_bf16 v[216:219], v[76:79], a[140:143], v[216:219]
  ds_read_b128 a[172:175], v6 offset:5648
  ds_read_b64 v[120:121], v5 offset:1632
  v_mfma_f32_16x16x32_bf16 v[216:219], v[80:83], a[144:147], v[216:219]
  ds_read_b128 a[176:179], v6 offset:5664
  ds_read_b64 v[122:123], v5 offset:1640
  ds_read_b64 v[124:125], v5 offset:1648
  v_mfma_f32_16x16x32_bf16 v[216:219], v[84:87], a[148:151], v[216:219]
  ds_read_b128 a[180:183], v6 offset:5680
  ds_read_b64 v[126:127], v5 offset:1656
  v_mfma_f32_16x16x32_bf16 v[216:219], v[88:91], a[152:155], v[216:219]
  ds_read_b128 a[184:187], v6 offset:5696
  ds_read_b64 v[226:227], v7 offset:3072
  v_mfma_f32_16x16x32_bf16 v[216:219], v[92:95], a[156:159], v[216:219]
  ds_read_b128 a[188:191], v6 offset:5712
  v_mfma_f32_16x16x32_bf16 v[212:215], v[64:67], a[96:99], v[212:215]
  v_mfma_f32_16x16x32_bf16 v[212:215], v[68:71], a[100:103], v[212:215]
  s_waitcnt lgkmcnt(1)
  v_lshlrev_b32 v228, 16, v226
  v_mfma_f32_16x16x32_bf16 v[212:215], v[72:75], a[104:107], v[212:215]
  v_and_b32 v229, 0xffff0000, v226
  v_mfma_f32_16x16x32_bf16 v[212:215], v[76:79], a[108:111], v[212:215]
  v_lshlrev_b32 v230, 16, v227
  v_mfma_f32_16x16x32_bf16 v[212:215], v[80:83], a[112:115], v[212:215]
  v_and_b32 v231, 0xffff0000, v227
  v_mfma_f32_16x16x32_bf16 v[212:215], v[84:87], a[116:119], v[212:215]
  v_fma_f32 v228, v228, s66, v199
  v_mfma_f32_16x16x32_bf16 v[212:215], v[88:91], a[120:123], v[212:215]
  v_fma_f32 v229, v229, s66, v198
  v_mfma_f32_16x16x32_bf16 v[212:215], v[92:95], a[124:127], v[212:215]
  v_fma_f32 v230, v230, s66, v197
  v_mfma_f32_16x16x32_bf16 v[208:211], v[64:67], a[64:67], v[208:211]
  v_fma_f32 v231, v231, s66, v196
  v_cvt_pk_bf16_f32 v226, v228, v229
  v_mfma_f32_16x16x32_bf16 v[208:211], v[68:71], a[68:71], v[208:211]
  v_cvt_pk_bf16_f32 v227, v230, v231
  v_mfma_f32_16x16x32_bf16 v[208:211], v[72:75], a[72:75], v[208:211]
  ds_write_b64 v7, v[226:227] offset:3072
  v_mfma_f32_16x16x32_bf16 v[208:211], v[76:79], a[76:79], v[208:211]
  s_waitcnt vmcnt(7)
  v_mfma_f32_16x16x32_bf16 v[208:211], v[80:83], a[80:83], v[208:211]
  ds_write_b128 v13, v[16:19] offset:4160
  v_mfma_f32_16x16x32_bf16 v[208:211], v[84:87], a[84:87], v[208:211]
  v_alignbit_b32 v36, v16, v24, 16
  v_mfma_f32_16x16x32_bf16 v[208:211], v[88:91], a[88:91], v[208:211]
  v_alignbit_b32 v37, v17, v16, 16
  v_mfma_f32_16x16x32_bf16 v[208:211], v[92:95], a[92:95], v[208:211]
  v_alignbit_b32 v38, v18, v17, 16
  v_mfma_f32_16x16x32_bf16 v[204:207], v[64:67], a[32:35], v[204:207]
  v_alignbit_b32 v39, v19, v18, 16
  v_mfma_f32_16x16x32_bf16 v[204:207], v[68:71], a[36:39], v[204:207]
  ds_write_b128 v13, v[20:23] offset:12416
  v_mfma_f32_16x16x32_bf16 v[204:207], v[72:75], a[40:43], v[204:207]
  v_alignbit_b32 v40, v20, v16, 16
  v_mfma_f32_16x16x32_bf16 v[204:207], v[76:79], a[44:47], v[204:207]
  v_alignbit_b32 v41, v21, v17, 16
  v_mfma_f32_16x16x32_bf16 v[204:207], v[80:83], a[48:51], v[204:207]
  v_alignbit_b32 v42, v22, v18, 16
  v_alignbit_b32 v43, v23, v19, 16
  v_mfma_f32_16x16x32_bf16 v[204:207], v[84:87], a[52:55], v[204:207]
  ds_write_b128 v13, v[36:39] offset:32
  v_mfma_f32_16x16x32_bf16 v[204:207], v[88:91], a[56:59], v[204:207]
  v_mfma_f32_16x16x32_bf16 v[204:207], v[92:95], a[60:63], v[204:207]
  v_mfma_f32_16x16x32_bf16 v[200:203], v[64:67], a[0:3], v[200:203]
  ds_write_b128 v13, v[40:43] offset:8288
  v_mfma_f32_16x16x32_bf16 v[200:203], v[68:71], a[4:7], v[200:203]
  v_lshlrev_b32 v45, 16, v24
  v_mov_b32 v47, v24
  v_mfma_f32_16x16x32_bf16 v[200:203], v[72:75], a[8:11], v[200:203]
  v_mov_b32 v48, v45
  v_mov_b32 v49, v36
  v_mfma_f32_16x16x32_bf16 v[200:203], v[76:79], a[12:15], v[200:203]
  v_mov_b32 v50, v24
  v_mov_b32 v51, v16
  v_mfma_f32_16x16x32_bf16 v[200:203], v[80:83], a[16:19], v[200:203]
  s_mov_b64 exec, 1
  ds_write_b64 v13, v[44:45] offset:24
  s_mov_b64 exec, -1
  v_mfma_f32_16x16x32_bf16 v[200:203], v[84:87], a[20:23], v[200:203]
  s_mov_b64 exec, 1
  ds_write_b64 v13, v[46:47] offset:4152
  s_mov_b64 exec, -1
  v_mfma_f32_16x16x32_bf16 v[200:203], v[88:91], a[24:27], v[200:203]
  s_mov_b64 exec, 1
  ds_write_b64 v13, v[48:49] offset:8280
  s_mov_b64 exec, -1
  v_mfma_f32_16x16x32_bf16 v[200:203], v[92:95], a[28:31], v[200:203]
  s_mov_b64 exec, 1
  ds_write_b64 v13, v[50:51] offset:12408
  s_mov_b64 exec, -1
  v_mfma_f32_16x16x32_bf16 v[220:223], v[96:99], a[128:131], v[220:223]
  ds_read_b64 v[64:65], v5 offset:2048
  v_mfma_f32_16x16x32_bf16 v[220:223], v[100:103], a[132:135], v[220:223]
  ds_read_b64 v[66:67], v5 offset:2056
  v_mfma_f32_16x16x32_bf16 v[220:223], v[104:107], a[136:139], v[220:223]
  ds_read_b64 v[68:69], v5 offset:2064
  v_mfma_f32_16x16x32_bf16 v[220:223], v[108:111], a[140:143], v[220:223]
  ds_read_b64 v[70:71], v5 offset:2072
  v_mfma_f32_16x16x32_bf16 v[220:223], v[112:115], a[144:147], v[220:223]
  ds_read_b64 v[72:73], v5 offset:2080
  v_mfma_f32_16x16x32_bf16 v[220:223], v[116:119], a[148:151], v[220:223]
  v_mfma_f32_16x16x32_bf16 v[220:223], v[120:123], a[152:155], v[220:223]
  ds_read_b64 v[74:75], v5 offset:2088
  v_mfma_f32_16x16x32_bf16 v[220:223], v[124:127], a[156:159], v[220:223]
  ds_read_b64 v[76:77], v5 offset:2096
  v_mfma_f32_16x16x32_bf16 v[216:219], v[96:99], a[96:99], v[216:219]
  ds_read_b128 a[128:131], v6 offset:6112
  ds_read_b64 v[78:79], v5 offset:2104
  v_mfma_f32_16x16x32_bf16 v[216:219], v[100:103], a[100:103], v[216:219]
  ds_read_b128 a[132:135], v6 offset:6128
  ds_read_b64 v[80:81], v5 offset:2112
  v_mfma_f32_16x16x32_bf16 v[216:219], v[104:107], a[104:107], v[216:219]
  ds_read_b128 a[136:139], v6 offset:6144
  ds_read_b64 v[82:83], v5 offset:2120
  v_mfma_f32_16x16x32_bf16 v[216:219], v[108:111], a[108:111], v[216:219]
  ds_read_b128 a[140:143], v6 offset:6160
  v_mfma_f32_16x16x32_bf16 v[216:219], v[112:115], a[112:115], v[216:219]
  ds_read_b128 a[144:147], v6 offset:6176
  ds_read_b64 v[84:85], v5 offset:2128
  v_mfma_f32_16x16x32_bf16 v[216:219], v[116:119], a[116:119], v[216:219]
  ds_read_b128 a[148:151], v6 offset:6192
  ds_read_b64 v[86:87], v5 offset:2136
  v_mfma_f32_16x16x32_bf16 v[216:219], v[120:123], a[120:123], v[216:219]
  ds_read_b128 a[152:155], v6 offset:6208
  ds_read_b64 v[88:89], v5 offset:2144
  v_mfma_f32_16x16x32_bf16 v[216:219], v[124:127], a[124:127], v[216:219]
  ds_read_b128 a[156:159], v6 offset:6224
  ds_read_b64 v[90:91], v5 offset:2152
  v_mfma_f32_16x16x32_bf16 v[212:215], v[96:99], a[64:67], v[212:215]
  ds_read_b64 v[92:93], v5 offset:2160
  v_mfma_f32_16x16x32_bf16 v[212:215], v[100:103], a[68:71], v[212:215]
  v_mfma_f32_16x16x32_bf16 v[212:215], v[104:107], a[72:75], v[212:215]
  ds_read_b64 v[94:95], v5 offset:2168
  v_mfma_f32_16x16x32_bf16 v[212:215], v[108:111], a[76:79], v[212:215]
  ds_read_b64 v[224:225], v7 offset:2560
  v_mfma_f32_16x16x32_bf16 v[212:215], v[112:115], a[80:83], v[212:215]
  v_mfma_f32_16x16x32_bf16 v[212:215], v[116:119], a[84:87], v[212:215]
  v_mfma_f32_16x16x32_bf16 v[212:215], v[120:123], a[88:91], v[212:215]
  v_mfma_f32_16x16x32_bf16 v[212:215], v[124:127], a[92:95], v[212:215]
  s_waitcnt lgkmcnt(0)
  v_lshlrev_b32 v228, 16, v224
  v_mfma_f32_16x16x32_bf16 v[208:211], v[96:99], a[32:35], v[208:211]
  v_and_b32 v229, 0xffff0000, v224
  v_mfma_f32_16x16x32_bf16 v[208:211], v[100:103], a[36:39], v[208:211]
  v_lshlrev_b32 v230, 16, v225
  v_mfma_f32_16x16x32_bf16 v[208:211], v[104:107], a[40:43], v[208:211]
  v_and_b32 v231, 0xffff0000, v225
  v_mfma_f32_16x16x32_bf16 v[208:211], v[108:111], a[44:47], v[208:211]
  v_fma_f32 v228, v228, s66, v203
  v_mfma_f32_16x16x32_bf16 v[208:211], v[112:115], a[48:51], v[208:211]
  v_mfma_f32_16x16x32_bf16 v[208:211], v[116:119], a[52:55], v[208:211]
  v_fma_f32 v229, v229, s66, v202
  v_mfma_f32_16x16x32_bf16 v[208:211], v[120:123], a[56:59], v[208:211]
  v_fma_f32 v230, v230, s66, v201
  v_mfma_f32_16x16x32_bf16 v[208:211], v[124:127], a[60:63], v[208:211]
  v_fma_f32 v231, v231, s66, v200
  v_mfma_f32_16x16x32_bf16 v[204:207], v[96:99], a[0:3], v[204:207]
  v_cvt_pk_bf16_f32 v224, v228, v229
  v_mfma_f32_16x16x32_bf16 v[204:207], v[100:103], a[4:7], v[204:207]
  v_cvt_pk_bf16_f32 v225, v230, v231
  v_mfma_f32_16x16x32_bf16 v[204:207], v[104:107], a[8:11], v[204:207]
  v_mfma_f32_16x16x32_bf16 v[204:207], v[108:111], a[12:15], v[204:207]
  ds_write_b64 v7, v[224:225] offset:2560
  v_mfma_f32_16x16x32_bf16 v[204:207], v[112:115], a[16:19], v[204:207]
  buffer_load_dwordx4 v[16:19], v12, s[56:59], 0 offen offset:2052
  v_mfma_f32_16x16x32_bf16 v[204:207], v[116:119], a[20:23], v[204:207]
  buffer_load_dwordx4 v[20:23], v12, s[56:59], 0 offen offset:2056
  v_mfma_f32_16x16x32_bf16 v[204:207], v[120:123], a[24:27], v[204:207]
  buffer_load_dword v24, v12, s[56:59], 0 offen offset:2048
  v_mfma_f32_16x16x32_bf16 v[204:207], v[124:127], a[28:31], v[204:207]
  v_mfma_f32_16x16x32_bf16 v[220:223], v[64:67], a[96:99], v[220:223]
  ds_read_b64 v[96:97], v5 offset:2560
  ds_read_b64 v[98:99], v5 offset:2568
  v_mfma_f32_16x16x32_bf16 v[220:223], v[68:71], a[100:103], v[220:223]
  ds_read_b64 v[100:101], v5 offset:2576
  v_mfma_f32_16x16x32_bf16 v[220:223], v[72:75], a[104:107], v[220:223]
  ds_read_b64 v[102:103], v5 offset:2584
  ds_read_b64 v[104:105], v5 offset:2592
  v_mfma_f32_16x16x32_bf16 v[220:223], v[76:79], a[108:111], v[220:223]
  ds_read_b64 v[106:107], v5 offset:2600
  v_mfma_f32_16x16x32_bf16 v[220:223], v[80:83], a[112:115], v[220:223]
  ds_read_b64 v[108:109], v5 offset:2608
  ds_read_b64 v[110:111], v5 offset:2616
  v_mfma_f32_16x16x32_bf16 v[220:223], v[84:87], a[116:119], v[220:223]
  ds_read_b64 v[112:113], v5 offset:2624
  v_mfma_f32_16x16x32_bf16 v[220:223], v[88:91], a[120:123], v[220:223]
  ds_read_b64 v[114:115], v5 offset:2632
  v_mfma_f32_16x16x32_bf16 v[220:223], v[92:95], a[124:127], v[220:223]
  ds_read_b64 v[116:117], v5 offset:2640
  ds_read_b64 v[118:119], v5 offset:2648
  v_mfma_f32_16x16x32_bf16 v[216:219], v[64:67], a[64:67], v[216:219]
  ds_read_b128 a[96:99], v6 offset:6624
  ds_read_b64 v[120:121], v5 offset:2656
  v_mfma_f32_16x16x32_bf16 v[216:219], v[68:71], a[68:71], v[216:219]
  ds_read_b128 a[100:103], v6 offset:6640
  ds_read_b64 v[122:123], v5 offset:2664
  ds_read_b64 v[124:125], v5 offset:2672
  v_mfma_f32_16x16x32_bf16 v[216:219], v[72:75], a[72:75], v[216:219]
  ds_read_b128 a[104:107], v6 offset:6656
  ds_read_b64 v[126:127], v5 offset:2680
  v_mfma_f32_16x16x32_bf16 v[216:219], v[76:79], a[76:79], v[216:219]
  ds_read_b128 a[108:111], v6 offset:6672
  ds_read_b64 v[226:227], v7 offset:2048
  v_mfma_f32_16x16x32_bf16 v[216:219], v[80:83], a[80:83], v[216:219]
  ds_read_b128 a[112:115], v6 offset:6688
  v_mfma_f32_16x16x32_bf16 v[216:219], v[84:87], a[84:87], v[216:219]
  ds_read_b128 a[116:119], v6 offset:6704
  s_waitcnt lgkmcnt(2)
  v_lshlrev_b32 v228, 16, v226
  v_mfma_f32_16x16x32_bf16 v[216:219], v[88:91], a[88:91], v[216:219]
  ds_read_b128 a[120:123], v6 offset:6720
  v_and_b32 v229, 0xffff0000, v226
  v_lshlrev_b32 v230, 16, v227
  v_mfma_f32_16x16x32_bf16 v[216:219], v[92:95], a[92:95], v[216:219]
  ds_read_b128 a[124:127], v6 offset:6736
  v_and_b32 v231, 0xffff0000, v227
  v_mfma_f32_16x16x32_bf16 v[212:215], v[64:67], a[32:35], v[212:215]
  v_fma_f32 v228, v228, s66, v207
  v_mfma_f32_16x16x32_bf16 v[212:215], v[68:71], a[36:39], v[212:215]
  v_fma_f32 v229, v229, s66, v206
  v_fma_f32 v230, v230, s66, v205
  v_mfma_f32_16x16x32_bf16 v[212:215], v[72:75], a[40:43], v[212:215]
  v_fma_f32 v231, v231, s66, v204
  v_mfma_f32_16x16x32_bf16 v[212:215], v[76:79], a[44:47], v[212:215]
  v_cvt_pk_bf16_f32 v226, v228, v229
  v_cvt_pk_bf16_f32 v227, v230, v231
  v_mfma_f32_16x16x32_bf16 v[212:215], v[80:83], a[48:51], v[212:215]
  ds_write_b64 v7, v[226:227] offset:2048
  v_mfma_f32_16x16x32_bf16 v[212:215], v[84:87], a[52:55], v[212:215]
  s_waitcnt vmcnt(5)
  v_mfma_f32_16x16x32_bf16 v[212:215], v[88:91], a[56:59], v[212:215]
  ds_write_b128 v13, v[26:29] offset:5184
  v_alignbit_b32 v36, v26, v34, 16
  v_mfma_f32_16x16x32_bf16 v[212:215], v[92:95], a[60:63], v[212:215]
  v_alignbit_b32 v37, v27, v26, 16
  v_mfma_f32_16x16x32_bf16 v[208:211], v[64:67], a[0:3], v[208:211]
  v_alignbit_b32 v38, v28, v27, 16
  v_alignbit_b32 v39, v29, v28, 16
  v_mfma_f32_16x16x32_bf16 v[208:211], v[68:71], a[4:7], v[208:211]
  ds_write_b128 v13, v[30:33] offset:13440
  v_mfma_f32_16x16x32_bf16 v[208:211], v[72:75], a[8:11], v[208:211]
  v_alignbit_b32 v40, v30, v26, 16
  v_mfma_f32_16x16x32_bf16 v[208:211], v[76:79], a[12:15], v[208:211]
  v_alignbit_b32 v41, v31, v27, 16
  v_alignbit_b32 v42, v32, v28, 16
  v_mfma_f32_16x16x32_bf16 v[208:211], v[80:83], a[16:19], v[208:211]
  v_alignbit_b32 v43, v33, v29, 16
  v_mfma_f32_16x16x32_bf16 v[208:211], v[84:87], a[20:23], v[208:211]
  ds_write_b128 v13, v[36:39] offset:1056
  v_mfma_f32_16x16x32_bf16 v[208:211], v[88:91], a[24:27], v[208:211]
  v_mfma_f32_16x16x32_bf16 v[208:211], v[92:95], a[28:31], v[208:211]
  ds_write_b128 v13, v[40:43] offset:9312
  v_mfma_f32_16x16x32_bf16 v[220:223], v[96:99], a[64:67], v[220:223]
  ds_read_b64 v[64:65], v5 offset:3072
  ds_read_b64 v[66:67], v5 offset:3080
  v_mfma_f32_16x16x32_bf16 v[220:223], v[100:103], a[68:71], v[220:223]
  ds_read_b64 v[68:69], v5 offset:3088
  v_mfma_f32_16x16x32_bf16 v[220:223], v[104:107], a[72:75], v[220:223]
  ds_read_b64 v[70:71], v5 offset:3096
  ds_read_b64 v[72:73], v5 offset:3104
  v_mfma_f32_16x16x32_bf16 v[220:223], v[108:111], a[76:79], v[220:223]
  ds_read_b64 v[74:75], v5 offset:3112
  v_mfma_f32_16x16x32_bf16 v[220:223], v[112:115], a[80:83], v[220:223]
  ds_read_b64 v[76:77], v5 offset:3120
  v_mfma_f32_16x16x32_bf16 v[220:223], v[116:119], a[84:87], v[220:223]
  ds_read_b64 v[78:79], v5 offset:3128
  ds_read_b64 v[80:81], v5 offset:3136
  v_mfma_f32_16x16x32_bf16 v[220:223], v[120:123], a[88:91], v[220:223]
  ds_read_b64 v[82:83], v5 offset:3144
  v_mfma_f32_16x16x32_bf16 v[220:223], v[124:127], a[92:95], v[220:223]
  ds_read_b64 v[84:85], v5 offset:3152
  v_mfma_f32_16x16x32_bf16 v[216:219], v[96:99], a[32:35], v[216:219]
  ds_read_b128 a[64:67], v6 offset:7136
  ds_read_b64 v[86:87], v5 offset:3160
  ds_read_b64 v[88:89], v5 offset:3168
  v_mfma_f32_16x16x32_bf16 v[216:219], v[100:103], a[36:39], v[216:219]
  ds_read_b128 a[68:71], v6 offset:7152
  ds_read_b64 v[90:91], v5 offset:3176
  v_mfma_f32_16x16x32_bf16 v[216:219], v[104:107], a[40:43], v[216:219]
  ds_read_b128 a[72:75], v6 offset:7168
  ds_read_b64 v[92:93], v5 offset:3184
  ds_read_b64 v[94:95], v5 offset:3192
  v_mfma_f32_16x16x32_bf16 v[216:219], v[108:111], a[44:47], v[216:219]
  ds_read_b128 a[76:79], v6 offset:7184
  ds_read_b64 v[224:225], v7 offset:1536
  v_mfma_f32_16x16x32_bf16 v[216:219], v[112:115], a[48:51], v[216:219]
  ds_read_b128 a[80:83], v6 offset:7200
  v_mfma_f32_16x16x32_bf16 v[216:219], v[116:119], a[52:55], v[216:219]
  ds_read_b128 a[84:87], v6 offset:7216
  s_waitcnt lgkmcnt(2)
  v_lshlrev_b32 v228, 16, v224
  v_mfma_f32_16x16x32_bf16 v[216:219], v[120:123], a[56:59], v[216:219]
  ds_read_b128 a[88:91], v6 offset:7232
  v_and_b32 v229, 0xffff0000, v224
  v_mfma_f32_16x16x32_bf16 v[216:219], v[124:127], a[60:63], v[216:219]
  ds_read_b128 a[92:95], v6 offset:7248
  v_lshlrev_b32 v230, 16, v225
  v_mfma_f32_16x16x32_bf16 v[212:215], v[96:99], a[0:3], v[212:215]
  v_and_b32 v231, 0xffff0000, v225
  v_fma_f32 v228, v228, s66, v211
  v_mfma_f32_16x16x32_bf16 v[212:215], v[100:103], a[4:7], v[212:215]
  v_fma_f32 v229, v229, s66, v210
  v_mfma_f32_16x16x32_bf16 v[212:215], v[104:107], a[8:11], v[212:215]
  v_fma_f32 v230, v230, s66, v209
  v_fma_f32 v231, v231, s66, v208
  v_mfma_f32_16x16x32_bf16 v[212:215], v[108:111], a[12:15], v[212:215]
  v_cvt_pk_bf16_f32 v224, v228, v229
  v_mfma_f32_16x16x32_bf16 v[212:215], v[112:115], a[16:19], v[212:215]
  v_cvt_pk_bf16_f32 v225, v230, v231
  v_mfma_f32_16x16x32_bf16 v[212:215], v[116:119], a[20:23], v[212:215]
  ds_write_b64 v7, v[224:225] offset:1536
  buffer_load_dwordx4 v[26:29], v12, s[56:59], 0 offen offset:3076
  v_mfma_f32_16x16x32_bf16 v[212:215], v[120:123], a[24:27], v[212:215]
  buffer_load_dwordx4 v[30:33], v12, s[56:59], 0 offen offset:3080
  v_mfma_f32_16x16x32_bf16 v[212:215], v[124:127], a[28:31], v[212:215]
  buffer_load_dword v34, v12, s[56:59], 0 offen offset:3072
  v_mfma_f32_16x16x32_bf16 v[220:223], v[64:67], a[32:35], v[220:223]
  ds_read_b64 v[96:97], v5 offset:3584
  ds_read_b64 v[98:99], v5 offset:3592
  ds_read_b64 v[100:101], v5 offset:3600
  v_mfma_f32_16x16x32_bf16 v[220:223], v[68:71], a[36:39], v[220:223]
  ds_read_b64 v[102:103], v5 offset:3608
  ds_read_b64 v[104:105], v5 offset:3616
  ds_read_b64 v[106:107], v5 offset:3624
  v_mfma_f32_16x16x32_bf16 v[220:223], v[72:75], a[40:43], v[220:223]
  ds_read_b64 v[108:109], v5 offset:3632
  ds_read_b64 v[110:111], v5 offset:3640
  ds_read_b64 v[112:113], v5 offset:3648
  v_mfma_f32_16x16x32_bf16 v[220:223], v[76:79], a[44:47], v[220:223]
  ds_read_b64 v[114:115], v5 offset:3656
  ds_read_b64 v[116:117], v5 offset:3664
  ds_read_b64 v[118:119], v5 offset:3672
  v_mfma_f32_16x16x32_bf16 v[220:223], v[80:83], a[48:51], v[220:223]
  ds_read_b64 v[120:121], v5 offset:3680
  ds_read_b64 v[122:123], v5 offset:3688
  ds_read_b64 v[124:125], v5 offset:3696
  v_mfma_f32_16x16x32_bf16 v[220:223], v[84:87], a[52:55], v[220:223]
  ds_read_b64 v[126:127], v5 offset:3704
  ds_read_b64 v[226:227], v7 offset:1024
  v_mfma_f32_16x16x32_bf16 v[220:223], v[88:91], a[56:59], v[220:223]
  s_waitcnt lgkmcnt(0)
  v_lshlrev_b32 v228, 16, v226
  v_mfma_f32_16x16x32_bf16 v[220:223], v[92:95], a[60:63], v[220:223]
  v_and_b32 v229, 0xffff0000, v226
  v_lshlrev_b32 v230, 16, v227
  v_and_b32 v231, 0xffff0000, v227
  v_mfma_f32_16x16x32_bf16 v[216:219], v[64:67], a[0:3], v[216:219]
  ds_read_b128 a[32:35], v6 offset:7648
  v_fma_f32 v228, v228, s66, v215
  v_fma_f32 v229, v229, s66, v214
  v_fma_f32 v230, v230, s66, v213
  v_mfma_f32_16x16x32_bf16 v[216:219], v[68:71], a[4:7], v[216:219]
  ds_read_b128 a[36:39], v6 offset:7664
  v_fma_f32 v231, v231, s66, v212
  v_cvt_pk_bf16_f32 v226, v228, v229
  v_cvt_pk_bf16_f32 v227, v230, v231
  v_mfma_f32_16x16x32_bf16 v[216:219], v[72:75], a[8:11], v[216:219]
  ds_read_b128 a[40:43], v6 offset:7680
  ds_write_b64 v7, v[226:227] offset:1024
  s_waitcnt vmcnt(3)
  v_mfma_f32_16x16x32_bf16 v[216:219], v[76:79], a[12:15], v[216:219]
  ds_read_b128 a[44:47], v6 offset:7696
  ds_write_b128 v13, v[16:19] offset:6208
  v_alignbit_b32 v36, v16, v24, 16
  v_alignbit_b32 v37, v17, v16, 16
  v_mfma_f32_16x16x32_bf16 v[216:219], v[80:83], a[16:19], v[216:219]
  ds_read_b128 a[48:51], v6 offset:7712
  v_alignbit_b32 v38, v18, v17, 16
  v_alignbit_b32 v39, v19, v18, 16
  ds_write_b128 v13, v[20:23] offset:14464
  v_mfma_f32_16x16x32_bf16 v[216:219], v[84:87], a[20:23], v[216:219]
  ds_read_b128 a[52:55], v6 offset:7728
  v_alignbit_b32 v40, v20, v16, 16
  v_alignbit_b32 v41, v21, v17, 16
  v_alignbit_b32 v42, v22, v18, 16
  v_mfma_f32_16x16x32_bf16 v[216:219], v[88:91], a[24:27], v[216:219]
  ds_read_b128 a[56:59], v6 offset:7744
  v_alignbit_b32 v43, v23, v19, 16
  ds_write_b128 v13, v[36:39] offset:2080
  v_mfma_f32_16x16x32_bf16 v[216:219], v[92:95], a[28:31], v[216:219]
  ds_read_b128 a[60:63], v6 offset:7760
  ds_write_b128 v13, v[40:43] offset:10336
  v_mfma_f32_16x16x32_bf16 v[220:223], v[96:99], a[0:3], v[220:223]
  ds_read_b64 v[64:65], v5 offset:0
  ds_read_b64 v[66:67], v5 offset:8
  ds_read_b64 v[68:69], v5 offset:16
  ds_read_b64 v[70:71], v5 offset:24
  v_mfma_f32_16x16x32_bf16 v[220:223], v[100:103], a[4:7], v[220:223]
  ds_read_b64 v[72:73], v5 offset:32
  ds_read_b64 v[74:75], v5 offset:40
  ds_read_b64 v[76:77], v5 offset:48
  ds_read_b64 v[78:79], v5 offset:56
  v_mfma_f32_16x16x32_bf16 v[220:223], v[104:107], a[8:11], v[220:223]
  ds_read_b64 v[80:81], v5 offset:64
  ds_read_b64 v[82:83], v5 offset:72
  ds_read_b64 v[84:85], v5 offset:80
  ds_read_b64 v[86:87], v5 offset:88
  v_mfma_f32_16x16x32_bf16 v[220:223], v[108:111], a[12:15], v[220:223]
  ds_read_b64 v[88:89], v5 offset:96
  ds_read_b64 v[90:91], v5 offset:104
  ds_read_b64 v[92:93], v5 offset:112
  v_mfma_f32_16x16x32_bf16 v[220:223], v[112:115], a[16:19], v[220:223]
  ds_read_b64 v[94:95], v5 offset:120
  ds_read_b64 v[224:225], v7 offset:512
  v_mfma_f32_16x16x32_bf16 v[220:223], v[116:119], a[20:23], v[220:223]
  s_waitcnt lgkmcnt(0)
  v_lshlrev_b32 v228, 16, v224
  v_and_b32 v229, 0xffff0000, v224
  v_lshlrev_b32 v230, 16, v225
  v_and_b32 v231, 0xffff0000, v225
  v_mfma_f32_16x16x32_bf16 v[220:223], v[120:123], a[24:27], v[220:223]
  v_fma_f32 v228, v228, s66, v219
  v_fma_f32 v229, v229, s66, v218
  v_fma_f32 v230, v230, s66, v217
  v_fma_f32 v231, v231, s66, v216
  v_mfma_f32_16x16x32_bf16 v[220:223], v[124:127], a[28:31], v[220:223]
  v_cvt_pk_bf16_f32 v224, v228, v229
  v_cvt_pk_bf16_f32 v225, v230, v231
  ds_write_b64 v7, v[224:225] offset:512
  ds_read_b128 a[0:3], v6 offset:8160
  ds_read_b128 a[4:7], v6 offset:8176
  ds_read_b128 a[8:11], v6 offset:8192
  ds_read_b128 a[12:15], v6 offset:8208
  ds_read_b128 a[16:19], v6 offset:8224
  ds_read_b128 a[20:23], v6 offset:8240
  ds_read_b128 a[24:27], v6 offset:8256
  ds_read_b128 a[28:31], v6 offset:8272
  ds_read_b64 v[226:227], v7 offset:0
  s_waitcnt lgkmcnt(0)
  v_lshlrev_b32 v228, 16, v226
  v_and_b32 v229, 0xffff0000, v226
  v_lshlrev_b32 v230, 16, v227
  v_and_b32 v231, 0xffff0000, v227
  v_fma_f32 v228, v228, s66, v223
  v_fma_f32 v229, v229, s66, v222
  v_fma_f32 v230, v230, s66, v221
  v_fma_f32 v231, v231, s66, v220
  v_cvt_pk_bf16_f32 v226, v228, v229
  v_cvt_pk_bf16_f32 v227, v230, v231
  ds_write_b64 v7, v[226:227] offset:0
  v_add_u32 v6, 4576, v6
  v_add_u32 v7, 4576, v7
  s_add_u32 s64, s64, 1
  s_cmp_lt_u32 s64, 4
  s_cbranch_scc1 L_cv_loop
  s_waitcnt vmcnt(0) lgkmcnt(0)
  s_barrier
  v_lshrrev_b32 v1, 11, v3
  v_lshlrev_b32 v5, 12, v1
  v_and_b32 v1, 2047, v3
  v_add3_u32 v5, v5, v1, 0
  v_xor_b32 v6, 0x400000, v5
  ds_read_b128 v[192:195], v4 offset:0
  ds_read_b128 v[196:199], v4 offset:4576
  ds_read_b128 v[200:203], v4 offset:9152
  ds_read_b128 v[204:207], v4 offset:13728
  ds_read_b128 v[208:211], v4 offset:18304
  ds_read_b128 v[212:215], v4 offset:22880
  ds_read_b128 v[216:219], v4 offset:27456
  ds_read_b128 v[220:223], v4 offset:32032
  s_waitcnt lgkmcnt(0)
  v_lshlrev_b32 v32, 16, v128
  v_and_b32 v40, 0xffff0000, v195
  v_and_b32 v33, 0xffff0000, v128
  v_and_b32 v41, 0xffff0000, v199
  v_lshlrev_b32 v34, 16, v129
  v_and_b32 v42, 0xffff0000, v203
  v_and_b32 v35, 0xffff0000, v129
  v_and_b32 v43, 0xffff0000, v207
  v_lshlrev_b32 v36, 16, v130
  v_and_b32 v44, 0xffff0000, v211
  v_and_b32 v37, 0xffff0000, v130
  v_and_b32 v45, 0xffff0000, v215
  v_lshlrev_b32 v38, 16, v131
  v_and_b32 v46, 0xffff0000, v219
  v_and_b32 v39, 0xffff0000, v131
  v_and_b32 v47, 0xffff0000, v223
  v_mul_f32 v32, v32, v40
  v_mul_f32 v33, v33, v41
  v_mul_f32 v34, v34, v42
  v_mul_f32 v35, v35, v43
  v_mul_f32 v36, v36, v44
  v_mul_f32 v37, v37, v45
  v_mul_f32 v38, v38, v46
  v_mul_f32 v39, v39, v47
  v_cvt_pk_bf16_f32 v224, v32, v33
  v_cvt_pk_bf16_f32 v225, v34, v35
  v_cvt_pk_bf16_f32 v226, v36, v37
  v_cvt_pk_bf16_f32 v227, v38, v39
  s_mov_b32 s65, 0
  buffer_store_dwordx4 v[224:227], v5, s[60:63], s65 offen offset:2048
  v_lshlrev_b32 v32, 16, v132
  v_lshlrev_b32 v40, 16, v195
  v_and_b32 v33, 0xffff0000, v132
  v_lshlrev_b32 v41, 16, v199
  v_lshlrev_b32 v34, 16, v133
  v_lshlrev_b32 v42, 16, v203
  v_and_b32 v35, 0xffff0000, v133
  v_lshlrev_b32 v43, 16, v207
  v_lshlrev_b32 v36, 16, v134
  v_lshlrev_b32 v44, 16, v211
  v_and_b32 v37, 0xffff0000, v134
  v_lshlrev_b32 v45, 16, v215
  v_lshlrev_b32 v38, 16, v135
  v_lshlrev_b32 v46, 16, v219
  v_and_b32 v39, 0xffff0000, v135
  v_lshlrev_b32 v47, 16, v223
  v_mul_f32 v32, v32, v40
  v_mul_f32 v33, v33, v41
  v_mul_f32 v34, v34, v42
  v_mul_f32 v35, v35, v43
  v_mul_f32 v36, v36, v44
  v_mul_f32 v37, v37, v45
  v_mul_f32 v38, v38, v46
  v_mul_f32 v39, v39, v47
  v_cvt_pk_bf16_f32 v228, v32, v33
  v_cvt_pk_bf16_f32 v229, v34, v35
  v_cvt_pk_bf16_f32 v230, v36, v37
  v_cvt_pk_bf16_f32 v231, v38, v39
  s_mov_b32 s65, 4096
  buffer_store_dwordx4 v[228:231], v5, s[60:63], s65 offen offset:2048
  v_lshlrev_b32 v32, 16, v136
  v_and_b32 v40, 0xffff0000, v194
  v_and_b32 v33, 0xffff0000, v136
  v_and_b32 v41, 0xffff0000, v198
  v_lshlrev_b32 v34, 16, v137
  v_and_b32 v42, 0xffff0000, v202
  v_and_b32 v35, 0xffff0000, v137
  v_and_b32 v43, 0xffff0000, v206
  v_lshlrev_b32 v36, 16, v138
  v_and_b32 v44, 0xffff0000, v210
  v_and_b32 v37, 0xffff0000, v138
  v_and_b32 v45, 0xffff0000, v214
  v_lshlrev_b32 v38, 16, v139
  v_and_b32 v46, 0xffff0000, v218
  v_and_b32 v39, 0xffff0000, v139
  v_and_b32 v47, 0xffff0000, v222
  v_mul_f32 v32, v32, v40
  v_mul_f32 v33, v33, v41
  v_mul_f32 v34, v34, v42
  v_mul_f32 v35, v35, v43
  v_mul_f32 v36, v36, v44
  v_mul_f32 v37, v37, v45
  v_mul_f32 v38, v38, v46
  v_mul_f32 v39, v39, v47
  v_cvt_pk_bf16_f32 v232, v32, v33
  v_cvt_pk_bf16_f32 v233, v34, v35
  v_cvt_pk_bf16_f32 v234, v36, v37
  v_cvt_pk_bf16_f32 v235, v38, v39
  s_mov_b32 s65, 8192
  buffer_store_dwordx4 v[232:235], v5, s[60:63], s65 offen offset:2048
  v_lshlrev_b32 v32, 16, v140
  v_lshlrev_b32 v40, 16, v194
  v_and_b32 v33, 0xffff0000, v140
  v_lshlrev_b32 v41, 16, v198
  v_lshlrev_b32 v34, 16, v141
  v_lshlrev_b32 v42, 16, v202
  v_and_b32 v35, 0xffff0000, v141
  v_lshlrev_b32 v43, 16, v206
  v_lshlrev_b32 v36, 16, v142
  v_lshlrev_b32 v44, 16, v210
  v_and_b32 v37, 0xffff0000, v142
  v_lshlrev_b32 v45, 16, v214
  v_lshlrev_b32 v38, 16, v143
  v_lshlrev_b32 v46, 16, v218
  v_and_b32 v39, 0xffff0000, v143
  v_lshlrev_b32 v47, 16, v222
  v_mul_f32 v32, v32, v40
  v_mul_f32 v33, v33, v41
  v_mul_f32 v34, v34, v42
  v_mul_f32 v35, v35, v43
  v_mul_f32 v36, v36, v44
  v_mul_f32 v37, v37, v45
  v_mul_f32 v38, v38, v46
  v_mul_f32 v39, v39, v47
  v_cvt_pk_bf16_f32 v236, v32, v33
  v_cvt_pk_bf16_f32 v237, v34, v35
  v_cvt_pk_bf16_f32 v238, v36, v37
  v_cvt_pk_bf16_f32 v239, v38, v39
  s_mov_b32 s65, 12288
  buffer_store_dwordx4 v[236:239], v5, s[60:63], s65 offen offset:2048
  v_lshlrev_b32 v32, 16, v144
  v_and_b32 v40, 0xffff0000, v193
  v_and_b32 v33, 0xffff0000, v144
  v_and_b32 v41, 0xffff0000, v197
  v_lshlrev_b32 v34, 16, v145
  v_and_b32 v42, 0xffff0000, v201
  v_and_b32 v35, 0xffff0000, v145
  v_and_b32 v43, 0xffff0000, v205
  v_lshlrev_b32 v36, 16, v146
  v_and_b32 v44, 0xffff0000, v209
  v_and_b32 v37, 0xffff0000, v146
  v_and_b32 v45, 0xffff0000, v213
  v_lshlrev_b32 v38, 16, v147
  v_and_b32 v46, 0xffff0000, v217
  v_and_b32 v39, 0xffff0000, v147
  v_and_b32 v47, 0xffff0000, v221
  v_mul_f32 v32, v32, v40
  v_mul_f32 v33, v33, v41
  v_mul_f32 v34, v34, v42
  v_mul_f32 v35, v35, v43
  v_mul_f32 v36, v36, v44
  v_mul_f32 v37, v37, v45
  v_mul_f32 v38, v38, v46
  v_mul_f32 v39, v39, v47
  v_cvt_pk_bf16_f32 v224, v32, v33
  v_cvt_pk_bf16_f32 v225, v34, v35
  v_cvt_pk_bf16_f32 v226, v36, v37
  v_cvt_pk_bf16_f32 v227, v38, v39
  s_mov_b32 s65, 16384
  buffer_store_dwordx4 v[224:227], v5, s[60:63], s65 offen offset:2048
  v_lshlrev_b32 v32, 16, v148
  v_lshlrev_b32 v40, 16, v193
  v_and_b32 v33, 0xffff0000, v148
  v_lshlrev_b32 v41, 16, v197
  v_lshlrev_b32 v34, 16, v149
  v_lshlrev_b32 v42, 16, v201
  v_and_b32 v35, 0xffff0000, v149
  v_lshlrev_b32 v43, 16, v205
  v_lshlrev_b32 v36, 16, v150
  v_lshlrev_b32 v44, 16, v209
  v_and_b32 v37, 0xffff0000, v150
  v_lshlrev_b32 v45, 16, v213
  v_lshlrev_b32 v38, 16, v151
  v_lshlrev_b32 v46, 16, v217
  v_and_b32 v39, 0xffff0000, v151
  v_lshlrev_b32 v47, 16, v221
  v_mul_f32 v32, v32, v40
  v_mul_f32 v33, v33, v41
  v_mul_f32 v34, v34, v42
  v_mul_f32 v35, v35, v43
  v_mul_f32 v36, v36, v44
  v_mul_f32 v37, v37, v45
  v_mul_f32 v38, v38, v46
  v_mul_f32 v39, v39, v47
  v_cvt_pk_bf16_f32 v228, v32, v33
  v_cvt_pk_bf16_f32 v229, v34, v35
  v_cvt_pk_bf16_f32 v230, v36, v37
  v_cvt_pk_bf16_f32 v231, v38, v39
  s_mov_b32 s65, 20480
  buffer_store_dwordx4 v[228:231], v5, s[60:63], s65 offen offset:2048
  v_lshlrev_b32 v32, 16, v152
  v_and_b32 v40, 0xffff0000, v192
  v_and_b32 v33, 0xffff0000, v152
  v_and_b32 v41, 0xffff0000, v196
  v_lshlrev_b32 v34, 16, v153
  v_and_b32 v42, 0xffff0000, v200
  v_and_b32 v35, 0xffff0000, v153
  v_and_b32 v43, 0xffff0000, v204
  v_lshlrev_b32 v36, 16, v154
  v_and_b32 v44, 0xffff0000, v208
  v_and_b32 v37, 0xffff0000, v154
  v_and_b32 v45, 0xffff0000, v212
  v_lshlrev_b32 v38, 16, v155
  v_and_b32 v46, 0xffff0000, v216
  v_and_b32 v39, 0xffff0000, v155
  v_and_b32 v47, 0xffff0000, v220
  v_mul_f32 v32, v32, v40
  v_mul_f32 v33, v33, v41
  v_mul_f32 v34, v34, v42
  v_mul_f32 v35, v35, v43
  v_mul_f32 v36, v36, v44
  v_mul_f32 v37, v37, v45
  v_mul_f32 v38, v38, v46
  v_mul_f32 v39, v39, v47
  v_cvt_pk_bf16_f32 v232, v32, v33
  v_cvt_pk_bf16_f32 v233, v34, v35
  v_cvt_pk_bf16_f32 v234, v36, v37
  v_cvt_pk_bf16_f32 v235, v38, v39
  s_mov_b32 s65, 24576
  buffer_store_dwordx4 v[232:235], v5, s[60:63], s65 offen offset:2048
  v_lshlrev_b32 v32, 16, v156
  v_lshlrev_b32 v40, 16, v192
  v_and_b32 v33, 0xffff0000, v156
  v_lshlrev_b32 v41, 16, v196
  v_lshlrev_b32 v34, 16, v157
  v_lshlrev_b32 v42, 16, v200
  v_and_b32 v35, 0xffff0000, v157
  v_lshlrev_b32 v43, 16, v204
  v_lshlrev_b32 v36, 16, v158
  v_lshlrev_b32 v44, 16, v208
  v_and_b32 v37, 0xffff0000, v158
  v_lshlrev_b32 v45, 16, v212
  v_lshlrev_b32 v38, 16, v159
  v_lshlrev_b32 v46, 16, v216
  v_and_b32 v39, 0xffff0000, v159
  v_lshlrev_b32 v47, 16, v220
  v_mul_f32 v32, v32, v40
  v_mul_f32 v33, v33, v41
  v_mul_f32 v34, v34, v42
  v_mul_f32 v35, v35, v43
  v_mul_f32 v36, v36, v44
  v_mul_f32 v37, v37, v45
  v_mul_f32 v38, v38, v46
  v_mul_f32 v39, v39, v47
  v_cvt_pk_bf16_f32 v236, v32, v33
  v_cvt_pk_bf16_f32 v237, v34, v35
  v_cvt_pk_bf16_f32 v238, v36, v37
  v_cvt_pk_bf16_f32 v239, v38, v39
  s_mov_b32 s65, 28672
  buffer_store_dwordx4 v[236:239], v5, s[60:63], s65 offen offset:2048
  ds_read_b128 v[192:195], v251 offset:0
  ds_read_b128 v[196:199], v251 offset:4576
  ds_read_b128 v[200:203], v251 offset:9152
  ds_read_b128 v[204:207], v251 offset:13728
  ds_read_b128 v[208:211], v251 offset:18304
  ds_read_b128 v[212:215], v251 offset:22880
  ds_read_b128 v[216:219], v251 offset:27456
  ds_read_b128 v[220:223], v251 offset:32032
  s_waitcnt lgkmcnt(0)
  v_lshlrev_b32 v32, 16, v160
  v_and_b32 v40, 0xffff0000, v195
  v_and_b32 v33, 0xffff0000, v160
  v_and_b32 v41, 0xffff0000, v199
  v_lshlrev_b32 v34, 16, v161
  v_and_b32 v42, 0xffff0000, v203
  v_and_b32 v35, 0xffff0000, v161
  v_and_b32 v43, 0xffff0000, v207
  v_lshlrev_b32 v36, 16, v162
  v_and_b32 v44, 0xffff0000, v211
  v_and_b32 v37, 0xffff0000, v162
  v_and_b32 v45, 0xffff0000, v215
  v_lshlrev_b32 v38, 16, v163
  v_and_b32 v46, 0xffff0000, v219
  v_and_b32 v39, 0xffff0000, v163
  v_and_b32 v47, 0xffff0000, v223
  v_mul_f32 v32, v32, v40
  v_mul_f32 v33, v33, v41
  v_mul_f32 v34, v34, v42
  v_mul_f32 v35, v35, v43
  v_mul_f32 v36, v36, v44
  v_mul_f32 v37, v37, v45
  v_mul_f32 v38, v38, v46
  v_mul_f32 v39, v39, v47
  v_cvt_pk_bf16_f32 v224, v32, v33
  v_cvt_pk_bf16_f32 v225, v34, v35
  v_cvt_pk_bf16_f32 v226, v36, v37
  v_cvt_pk_bf16_f32 v227, v38, v39
  s_mov_b32 s65, 0
  buffer_store_dwordx4 v[224:227], v6, s[60:63], s65 offen offset:2048
  v_lshlrev_b32 v32, 16, v164
  v_lshlrev_b32 v40, 16, v195
  v_and_b32 v33, 0xffff0000, v164
  v_lshlrev_b32 v41, 16, v199
  v_lshlrev_b32 v34, 16, v165
  v_lshlrev_b32 v42, 16, v203
  v_and_b32 v35, 0xffff0000, v165
  v_lshlrev_b32 v43, 16, v207
  v_lshlrev_b32 v36, 16, v166
  v_lshlrev_b32 v44, 16, v211
  v_and_b32 v37, 0xffff0000, v166
  v_lshlrev_b32 v45, 16, v215
  v_lshlrev_b32 v38, 16, v167
  v_lshlrev_b32 v46, 16, v219
  v_and_b32 v39, 0xffff0000, v167
  v_lshlrev_b32 v47, 16, v223
  v_mul_f32 v32, v32, v40
  v_mul_f32 v33, v33, v41
  v_mul_f32 v34, v34, v42
  v_mul_f32 v35, v35, v43
  v_mul_f32 v36, v36, v44
  v_mul_f32 v37, v37, v45
  v_mul_f32 v38, v38, v46
  v_mul_f32 v39, v39, v47
  v_cvt_pk_bf16_f32 v228, v32, v33
  v_cvt_pk_bf16_f32 v229, v34, v35
  v_cvt_pk_bf16_f32 v230, v36, v37
  v_cvt_pk_bf16_f32 v231, v38, v39
  s_mov_b32 s65, 4096
  buffer_store_dwordx4 v[228:231], v6, s[60:63], s65 offen offset:2048
  v_lshlrev_b32 v32, 16, v168
  v_and_b32 v40, 0xffff0000, v194
  v_and_b32 v33, 0xffff0000, v168
  v_and_b32 v41, 0xffff0000, v198
  v_lshlrev_b32 v34, 16, v169
  v_and_b32 v42, 0xffff0000, v202
  v_and_b32 v35, 0xffff0000, v169
  v_and_b32 v43, 0xffff0000, v206
  v_lshlrev_b32 v36, 16, v170
  v_and_b32 v44, 0xffff0000, v210
  v_and_b32 v37, 0xffff0000, v170
  v_and_b32 v45, 0xffff0000, v214
  v_lshlrev_b32 v38, 16, v171
  v_and_b32 v46, 0xffff0000, v218
  v_and_b32 v39, 0xffff0000, v171
  v_and_b32 v47, 0xffff0000, v222
  v_mul_f32 v32, v32, v40
  v_mul_f32 v33, v33, v41
  v_mul_f32 v34, v34, v42
  v_mul_f32 v35, v35, v43
  v_mul_f32 v36, v36, v44
  v_mul_f32 v37, v37, v45
  v_mul_f32 v38, v38, v46
  v_mul_f32 v39, v39, v47
  v_cvt_pk_bf16_f32 v232, v32, v33
  v_cvt_pk_bf16_f32 v233, v34, v35
  v_cvt_pk_bf16_f32 v234, v36, v37
  v_cvt_pk_bf16_f32 v235, v38, v39
  s_mov_b32 s65, 8192
  buffer_store_dwordx4 v[232:235], v6, s[60:63], s65 offen offset:2048
  v_lshlrev_b32 v32, 16, v172
  v_lshlrev_b32 v40, 16, v194
  v_and_b32 v33, 0xffff0000, v172
  v_lshlrev_b32 v41, 16, v198
  v_lshlrev_b32 v34, 16, v173
  v_lshlrev_b32 v42, 16, v202
  v_and_b32 v35, 0xffff0000, v173
  v_lshlrev_b32 v43, 16, v206
  v_lshlrev_b32 v36, 16, v174
  v_lshlrev_b32 v44, 16, v210
  v_and_b32 v37, 0xffff0000, v174
  v_lshlrev_b32 v45, 16, v214
  v_lshlrev_b32 v38, 16, v175
  v_lshlrev_b32 v46, 16, v218
  v_and_b32 v39, 0xffff0000, v175
  v_lshlrev_b32 v47, 16, v222
  v_mul_f32 v32, v32, v40
  v_mul_f32 v33, v33, v41
  v_mul_f32 v34, v34, v42
  v_mul_f32 v35, v35, v43
  v_mul_f32 v36, v36, v44
  v_mul_f32 v37, v37, v45
  v_mul_f32 v38, v38, v46
  v_mul_f32 v39, v39, v47
  v_cvt_pk_bf16_f32 v236, v32, v33
  v_cvt_pk_bf16_f32 v237, v34, v35
  v_cvt_pk_bf16_f32 v238, v36, v37
  v_cvt_pk_bf16_f32 v239, v38, v39
  s_mov_b32 s65, 12288
  buffer_store_dwordx4 v[236:239], v6, s[60:63], s65 offen offset:2048
  v_lshlrev_b32 v32, 16, v176
  v_and_b32 v40, 0xffff0000, v193
  v_and_b32 v33, 0xffff0000, v176
  v_and_b32 v41, 0xffff0000, v197
  v_lshlrev_b32 v34, 16, v177
  v_and_b32 v42, 0xffff0000, v201
  v_and_b32 v35, 0xffff0000, v177
  v_and_b32 v43, 0xffff0000, v205
  v_lshlrev_b32 v36, 16, v178
  v_and_b32 v44, 0xffff0000, v209
  v_and_b32 v37, 0xffff0000, v178
  v_and_b32 v45, 0xffff0000, v213
  v_lshlrev_b32 v38, 16, v179
  v_and_b32 v46, 0xffff0000, v217
  v_and_b32 v39, 0xffff0000, v179
  v_and_b32 v47, 0xffff0000, v221
  v_mul_f32 v32, v32, v40
  v_mul_f32 v33, v33, v41
  v_mul_f32 v34, v34, v42
  v_mul_f32 v35, v35, v43
  v_mul_f32 v36, v36, v44
  v_mul_f32 v37, v37, v45
  v_mul_f32 v38, v38, v46
  v_mul_f32 v39, v39, v47
  v_cvt_pk_bf16_f32 v224, v32, v33
  v_cvt_pk_bf16_f32 v225, v34, v35
  v_cvt_pk_bf16_f32 v226, v36, v37
  v_cvt_pk_bf16_f32 v227, v38, v39
  s_mov_b32 s65, 16384
  buffer_store_dwordx4 v[224:227], v6, s[60:63], s65 offen offset:2048
  v_lshlrev_b32 v32, 16, v180
  v_lshlrev_b32 v40, 16, v193
  v_and_b32 v33, 0xffff0000, v180
  v_lshlrev_b32 v41, 16, v197
  v_lshlrev_b32 v34, 16, v181
  v_lshlrev_b32 v42, 16, v201
  v_and_b32 v35, 0xffff0000, v181
  v_lshlrev_b32 v43, 16, v205
  v_lshlrev_b32 v36, 16, v182
  v_lshlrev_b32 v44, 16, v209
  v_and_b32 v37, 0xffff0000, v182
  v_lshlrev_b32 v45, 16, v213
  v_lshlrev_b32 v38, 16, v183
  v_lshlrev_b32 v46, 16, v217
  v_and_b32 v39, 0xffff0000, v183
  v_lshlrev_b32 v47, 16, v221
  v_mul_f32 v32, v32, v40
  v_mul_f32 v33, v33, v41
  v_mul_f32 v34, v34, v42
  v_mul_f32 v35, v35, v43
  v_mul_f32 v36, v36, v44
  v_mul_f32 v37, v37, v45
  v_mul_f32 v38, v38, v46
  v_mul_f32 v39, v39, v47
  v_cvt_pk_bf16_f32 v228, v32, v33
  v_cvt_pk_bf16_f32 v229, v34, v35
  v_cvt_pk_bf16_f32 v230, v36, v37
  v_cvt_pk_bf16_f32 v231, v38, v39
  s_mov_b32 s65, 20480
  buffer_store_dwordx4 v[228:231], v6, s[60:63], s65 offen offset:2048
  v_lshlrev_b32 v32, 16, v184
  v_and_b32 v40, 0xffff0000, v192
  v_and_b32 v33, 0xffff0000, v184
  v_and_b32 v41, 0xffff0000, v196
  v_lshlrev_b32 v34, 16, v185
  v_and_b32 v42, 0xffff0000, v200
  v_and_b32 v35, 0xffff0000, v185
  v_and_b32 v43, 0xffff0000, v204
  v_lshlrev_b32 v36, 16, v186
  v_and_b32 v44, 0xffff0000, v208
  v_and_b32 v37, 0xffff0000, v186
  v_and_b32 v45, 0xffff0000, v212
  v_lshlrev_b32 v38, 16, v187
  v_and_b32 v46, 0xffff0000, v216
  v_and_b32 v39, 0xffff0000, v187
  v_and_b32 v47, 0xffff0000, v220
  v_mul_f32 v32, v32, v40
  v_mul_f32 v33, v33, v41
  v_mul_f32 v34, v34, v42
  v_mul_f32 v35, v35, v43
  v_mul_f32 v36, v36, v44
  v_mul_f32 v37, v37, v45
  v_mul_f32 v38, v38, v46
  v_mul_f32 v39, v39, v47
  v_cvt_pk_bf16_f32 v232, v32, v33
  v_cvt_pk_bf16_f32 v233, v34, v35
  v_cvt_pk_bf16_f32 v234, v36, v37
  v_cvt_pk_bf16_f32 v235, v38, v39
  s_mov_b32 s65, 24576
  buffer_store_dwordx4 v[232:235], v6, s[60:63], s65 offen offset:2048
  v_lshlrev_b32 v32, 16, v188
  v_lshlrev_b32 v40, 16, v192
  v_and_b32 v33, 0xffff0000, v188
  v_lshlrev_b32 v41, 16, v196
  v_lshlrev_b32 v34, 16, v189
  v_lshlrev_b32 v42, 16, v200
  v_and_b32 v35, 0xffff0000, v189
  v_lshlrev_b32 v43, 16, v204
  v_lshlrev_b32 v36, 16, v190
  v_lshlrev_b32 v44, 16, v208
  v_and_b32 v37, 0xffff0000, v190
  v_lshlrev_b32 v45, 16, v212
  v_lshlrev_b32 v38, 16, v191
  v_lshlrev_b32 v46, 16, v216
  v_and_b32 v39, 0xffff0000, v191
  v_lshlrev_b32 v47, 16, v220
  v_mul_f32 v32, v32, v40
  v_mul_f32 v33, v33, v41
  v_mul_f32 v34, v34, v42
  v_mul_f32 v35, v35, v43
  v_mul_f32 v36, v36, v44
  v_mul_f32 v37, v37, v45
  v_mul_f32 v38, v38, v46
  v_mul_f32 v39, v39, v47
  v_cvt_pk_bf16_f32 v236, v32, v33
  v_cvt_pk_bf16_f32 v237, v34, v35
  v_cvt_pk_bf16_f32 v238, v36, v37
  v_cvt_pk_bf16_f32 v239, v38, v39
  s_mov_b32 s65, 28672
  buffer_store_dwordx4 v[236:239], v6, s[60:63], s65 offen offset:2048
  s_endpgm
L_cq_23_0:
  s_mov_b32 s65, 0
  buffer_load_dwordx4 v[128:131], v3, s[44:47], s65 offen
  s_mov_b32 s65, 2048
  buffer_load_dwordx4 v[132:135], v3, s[44:47], s65 offen
  s_branch L_cq_23
L_cq_23_1:
  s_mov_b32 s65, 8192
  buffer_load_dwordx4 v[144:147], v3, s[44:47], s65 offen
  s_mov_b32 s65, 10240
  buffer_load_dwordx4 v[148:151], v3, s[44:47], s65 offen
  s_branch L_cq_23
L_cq_23_2:
  s_mov_b32 s65, 0
  buffer_load_dwordx4 v[160:163], v250, s[44:47], s65 offen
  s_mov_b32 s65, 2048
  buffer_load_dwordx4 v[164:167], v250, s[44:47], s65 offen
  s_branch L_cq_23
L_cq_24_0:
  s_mov_b32 s65, 4096
  buffer_load_dwordx4 v[136:139], v3, s[44:47], s65 offen
  s_mov_b32 s65, 6144
  buffer_load_dwordx4 v[140:143], v3, s[44:47], s65 offen
  s_branch L_cq_24
L_cq_24_1:
  s_mov_b32 s65, 12288
  buffer_load_dwordx4 v[152:155], v3, s[44:47], s65 offen
  s_mov_b32 s65, 14336
  buffer_load_dwordx4 v[156:159], v3, s[44:47], s65 offen
  s_branch L_cq_24
L_cq_24_2:
  s_mov_b32 s65, 4096
  buffer_load_dwordx4 v[168:171], v250, s[44:47], s65 offen
  s_mov_b32 s65, 6144
  buffer_load_dwordx4 v[172:175], v250, s[44:47], s65 offen
  s_branch L_cq_24
L_qa:
  v_mov_b32 v95, v91
  v_mov_b32 v94, v90
  v_mov_b32 v93, v89
  v_mov_b32 v92, v88
  v_mov_b32 v91, v87
  v_mov_b32 v90, v86
  v_mov_b32 v89, v85
  v_mov_b32 v88, v84
  s_lshl_b32 s40, s38, 12
  s_lshl_b32 s41, s36, 10
  s_add_u32 s40, s40, s41
  s_add_u32 s40, s40, 67108864
  v_lshl_add_u32 v225, v0, 2, s40
  v_lshrrev_b32 v224, 2, v0
  v_lshlrev_b32 v224, 1, v224
  v_and_b32 v1, 1, v0
  v_add_u32 v224, v1, v224
  v_lshl_add_u32 v224, v224, 4, s40
  s_lshl_b32 s40, s38, 8
  s_lshl_b32 s41, s36, 6
  s_add_u32 s40, s40, s41
  s_add_u32 s88, s40, 76546048
  s_lshl_b32 s40, s36, 12
  s_add_u32 s40, s40, 131072
  v_lshl_add_u32 v228, v0, 4, s40
  s_add_u32 s40, s40, 3072
  v_lshl_add_u32 v229, v0, 3, s40
  s_mov_b32 s40, 147456
  v_lshl_add_u32 v236, v0, 4, s40
  s_add_u32 s40, s40, 2048
  v_lshl_add_u32 v234, v0, 2, s40
  s_and_b32 s40, s36, 1
  s_lshl_b32 s40, s40, 3
  v_and_b32 v1, 0x37, v0
  v_add_u32 v1, s40, v1
  v_bfe_u32 v235, v0, 3, 1
  s_lshr_b32 s42, s36, 1
  s_lshl_b32 s40, s42, 10
  v_mul_lo_u32 v230, v235, s40
  s_add_u32 s41, s40, 131072
  v_add_u32 v230, s41, v230
  v_lshl_add_u32 v230, v1, 4, v230
  s_add_u32 s41, s40, 147456
  v_lshl_add_u32 v232, v1, 4, s41
  v_lshl_add_u32 v232, v235, 3, v232
  s_lshl_b32 s40, s42, 9
  s_add_u32 s40, s40, 134144
  v_lshl_add_u32 v231, v1, 3, s40
  v_lshl_add_u32 v231, v235, 2, v231
  s_lshl_b32 s40, s42, 8
  s_add_u32 s40, s40, 149504
  v_lshl_add_u32 v233, v1, 2, s40
  v_lshl_add_u32 v233, v235, 1, v233
  s_lshl_b32 s40, s36, 3
  v_and_b32 v1, 7, v0
  v_add_u32 v1, s40, v1
  v_lshlrev_b32 v235, 4, v235
  v_sub_u32 v1, v1, v235
  v_lshrrev_b32 v235, 4, v0
  v_lshlrev_b32 v235, 2, v235
  v_sub_u32 v1, v1, v235
  v_mov_b32 v235, 0xf149f2ca
  s_mov_b32 s82, 0x3e0293ee
  s_mov_b32 s66, -1
  s_mov_b32 s67, 0x80000000
  s_mov_b32 s72, 0
  s_mov_b32 s73, 0x80000000
  v_cmp_le_i32 s[74:75], 0, v1
  v_cmp_le_i32 s[76:77], 1, v1
  v_cmp_le_i32 s[78:79], 2, v1
  v_cmp_le_i32 s[80:81], 3, v1
  v_mov_b32 v96, 0
  v_mov_b32 v97, 0
  v_mov_b32 v98, 0
  v_mov_b32 v99, 0
  v_mov_b32 v100, 0
  v_mov_b32 v101, 0
  v_mov_b32 v102, 0
  v_mov_b32 v103, 0
  v_mov_b32 v240, 0
  v_mov_b32 v241, 0
  v_mov_b32 v242, 0
  v_mov_b32 v243, 0
  v_mov_b32 v244, 0
  v_mov_b32 v245, 0
  v_mov_b32 v246, 0
  v_mov_b32 v247, 0
  v_mov_b32 v116, 0
  v_mov_b32 v117, 0
  v_mov_b32 v118, 0
  v_mov_b32 v119, 0
  v_mov_b32 v120, 0
  v_mov_b32 v121, 0
  v_mov_b32 v122, 0
  v_mov_b32 v123, 0
  v_mov_b32 v192, 0
  v_mov_b32 v193, 0
  v_mov_b32 v194, 0
  v_mov_b32 v195, 0
  v_mov_b32 v196, 0
  v_mov_b32 v197, 0
  v_mov_b32 v198, 0
  v_mov_b32 v199, 0
  v_mov_b32 v1, 252
  v_mov_b32 v178, 151552
  s_cmp_eq_u32 s36, 0
  s_cbranch_scc0 L_wib_27
L_wi_25:
  global_load_dword v227, v1, s[32:33] sc1
  s_waitcnt vmcnt(0)
  v_cmp_ne_u32 vcc, 0, v227
  s_cbranch_vccnz L_wid_26
  s_sleep 2
  s_sub_u32 s39, s39, 1
  s_cbranch_scc0 L_wi_25
  s_endpgm
L_wid_26:
  ds_write_b32 v178, v227 offset:0
  s_waitcnt lgkmcnt(0)
L_wib_27:
  s_barrier
  ds_read_b32 v227, v178 offset:0
  s_waitcnt lgkmcnt(0)
  s_mov_b32 s84, 0
  s_mov_b32 s85, 0
  s_mov_b32 s86, 0
  s_mov_b32 s89, 0
  s_mov_b64 exec, 0
  s_cmp_eq_u32 s36, 0
  s_cbranch_scc1 L_qt_w0
  s_cmp_eq_u32 s36, 1
  s_cbranch_scc1 L_qt_w1
  s_cmp_eq_u32 s36, 2
  s_cbranch_scc1 L_qt_w2
  s_branch L_qt_w3
L_qt_done:
L_qa_loop:
  s_waitcnt vmcnt(16)
  s_barrier
  s_add_u32 s57, s60, 0x10000
  s_waitcnt lgkmcnt(4)
  v_mfma_f32_16x16x32_bf16 v[16:19], a[0:3], v[48:51], 0
  ds_read_b128 v[72:75], v9 offset:4096
  s_sub_u32 s40, s84, 1
  s_min_i32 s40, s40, s85
  s_min_i32 s40, s40, s86
  s_cmp_gt_i32 s40, s66
  s_cbranch_scc0 L_qf_28_s
L_qf_28:
  s_add_u32 s40, s66, 0
  s_lshl_b32 s72, s40, 17
  s_cmp_lt_i32 s40, 0
  s_cselect_b32 s72, 0x80000000, s72
  v_mfma_f32_16x16x32_bf16 v[20:23], a[4:7], v[48:51], 0
  buffer_load_dwordx4 v[104:107], v224, s[52:55], s72 offen sc1
  v_mfma_f32_16x16x32_bf16 v[24:27], a[0:3], v[52:55], 0
  ds_read_b128 v[76:79], v9 offset:6144
  s_add_u32 s73, s67, 16777216
  v_mfma_f32_16x16x32_bf16 v[28:31], a[4:7], v[52:55], 0
  s_waitcnt vmcnt(10)
  v_mfma_f32_16x16x32_bf16 v[124:127], v[96:99], v[240:243], 0
  s_waitcnt lgkmcnt(4)
  v_mfma_f32_16x16x32_bf16 v[16:19], a[8:11], v[56:59], v[16:19]
  ds_read_b128 v[48:51], v8 offset:8192
  s_add_u32 m0, s61, 97280
  v_mfma_f32_16x16x32_bf16 v[20:23], a[12:15], v[56:59], v[20:23]
  buffer_load_dwordx4 v4, s[48:51], s57 offen offset:1024 lds
  v_mfma_f32_16x16x32_bf16 v[128:131], v[96:99], v[244:247], 0
  v_mfma_f32_16x16x32_bf16 v[24:27], a[8:11], v[60:63], v[24:27]
  ds_read_b128 v[52:55], v8 offset:10240
  v_mfma_f32_16x16x32_bf16 v[28:31], a[12:15], v[60:63], v[28:31]
  v_mfma_f32_16x16x32_bf16 v[132:135], v[100:103], v[244:247], 0
  s_waitcnt lgkmcnt(4)
  v_mfma_f32_16x16x32_bf16 v[16:19], a[16:19], v[64:67], v[16:19]
  ds_read_b128 v[56:59], v9 offset:8192
  v_mfma_f32_16x16x32_bf16 v[20:23], a[20:23], v[64:67], v[20:23]
  buffer_load_dword v116, v225, s[52:55], s72 offen offset:512 sc1
  v_mfma_f32_16x16x32_bf16 v[24:27], a[16:19], v[68:71], v[24:27]
  ds_read_b128 v[60:63], v9 offset:10240
  v_mfma_f32_16x16x32_bf16 v[28:31], a[20:23], v[68:71], v[28:31]
  ds_write_b128 v228, v[124:127] offset:0
  s_waitcnt lgkmcnt(5)
  v_mfma_f32_16x16x32_bf16 v[16:19], a[24:27], v[72:75], v[16:19]
  ds_read_b128 v[64:67], v8 offset:12288
  s_add_u32 m0, s61, 101248
  v_mfma_f32_16x16x32_bf16 v[20:23], a[28:31], v[72:75], v[20:23]
  buffer_load_dwordx4 v4, s[48:51], s57 offen offset:1152 lds
  v_mfma_f32_16x16x32_bf16 v[24:27], a[24:27], v[76:79], v[24:27]
  ds_read_b128 v[68:71], v8 offset:14336
  v_mfma_f32_16x16x32_bf16 v[28:31], a[28:31], v[76:79], v[28:31]
  ds_write_b128 v228, v[128:131] offset:1024
  s_waitcnt lgkmcnt(6)
  v_mfma_f32_16x16x32_bf16 v[16:19], a[32:35], v[48:51], v[16:19]
  ds_read_b128 v[72:75], v9 offset:12288
  v_mfma_f32_16x16x32_bf16 v[20:23], a[36:39], v[48:51], v[20:23]
  buffer_load_dword v120, v225, s[52:55], s72 offen offset:768 sc1
  v_mfma_f32_16x16x32_bf16 v[24:27], a[32:35], v[52:55], v[24:27]
  ds_read_b128 v[76:79], v9 offset:14336
  v_mfma_f32_16x16x32_bf16 v[28:31], a[36:39], v[52:55], v[28:31]
  ds_write_b128 v228, v[132:135] offset:2048
  s_waitcnt lgkmcnt(7)
  v_mfma_f32_16x16x32_bf16 v[16:19], a[40:43], v[56:59], v[16:19]
  ds_read_b128 v[48:51], v8 offset:16384
  s_add_u32 m0, s61, 105216
  v_mfma_f32_16x16x32_bf16 v[20:23], a[44:47], v[56:59], v[20:23]
  buffer_load_dwordx4 v4, s[48:51], s57 offen offset:1280 lds
  v_cvt_pk_bf16_f32 v80, v32, v33
  v_mfma_f32_16x16x32_bf16 v[24:27], a[40:43], v[60:63], v[24:27]
  ds_read_b128 v[52:55], v8 offset:18432
  v_cvt_pk_bf16_f32 v81, v34, v35
  v_mfma_f32_16x16x32_bf16 v[28:31], a[44:47], v[60:63], v[28:31]
  v_cvt_pk_bf16_f32 v82, v36, v37
  s_waitcnt lgkmcnt(6)
  v_mfma_f32_16x16x32_bf16 v[16:19], a[48:51], v[64:67], v[16:19]
  ds_read_b128 v[56:59], v9 offset:16384
  v_mfma_f32_16x16x32_bf16 v[20:23], a[52:55], v[64:67], v[20:23]
  buffer_load_dwordx4 v[108:111], v5, s[52:55], s73 offen offset:0 sc1
  v_cvt_pk_bf16_f32 v83, v38, v39
  v_mfma_f32_16x16x32_bf16 v[24:27], a[48:51], v[68:71], v[24:27]
  ds_read_b128 v[60:63], v9 offset:18432
  v_cvt_pk_bf16_f32 v84, v40, v41
  v_mfma_f32_16x16x32_bf16 v[28:31], a[52:55], v[68:71], v[28:31]
  v_cvt_pk_bf16_f32 v85, v42, v43
  s_waitcnt lgkmcnt(5)
  v_mfma_f32_16x16x32_bf16 v[16:19], a[56:59], v[72:75], v[16:19]
  ds_read_b128 v[64:67], v8 offset:20480
  s_add_u32 m0, s61, 109184
  v_mfma_f32_16x16x32_bf16 v[20:23], a[60:63], v[72:75], v[20:23]
  buffer_load_dwordx4 v4, s[48:51], s57 offen offset:1408 lds
  v_cvt_pk_bf16_f32 v86, v44, v45
  v_mfma_f32_16x16x32_bf16 v[24:27], a[56:59], v[76:79], v[24:27]
  ds_read_b128 v[68:71], v8 offset:22528
  v_cvt_pk_bf16_f32 v87, v46, v47
  v_mfma_f32_16x16x32_bf16 v[28:31], a[60:63], v[76:79], v[28:31]
  s_waitcnt lgkmcnt(6)
  s_waitcnt vmcnt(16)
  s_barrier
  s_waitcnt lgkmcnt(4)
  v_mfma_f32_16x16x32_bf16 v[16:19], a[64:67], v[48:51], v[16:19]
  ds_read_b128 v[72:75], v9 offset:20480
  ds_read_b128 v[144:147], v230 offset:0
  v_mfma_f32_16x16x32_bf16 v[20:23], a[68:71], v[48:51], v[20:23]
  buffer_load_dwordx4 v[112:115], v5, s[52:55], s73 offen offset:1024 sc1
  ds_read_b128 v[148:151], v230 offset:4096
  v_mfma_f32_16x16x32_bf16 v[24:27], a[64:67], v[52:55], v[24:27]
  ds_read_b128 v[76:79], v9 offset:22528
  ds_read_b128 v[152:155], v230 offset:8192
  v_mfma_f32_16x16x32_bf16 v[28:31], a[68:71], v[52:55], v[28:31]
  ds_read_b128 v[156:159], v230 offset:12288
  s_waitcnt lgkmcnt(8)
  v_mfma_f32_16x16x32_bf16 v[16:19], a[72:75], v[56:59], v[16:19]
  ds_read_b128 v[48:51], v8 offset:24576
  s_add_u32 m0, s61, 113152
  v_mfma_f32_16x16x32_bf16 v[20:23], a[76:79], v[56:59], v[20:23]
  buffer_load_dwordx4 v4, s[48:51], s57 offen offset:1536 lds
  v_mfma_f32_16x16x32_bf16 v[24:27], a[72:75], v[60:63], v[24:27]
  ds_read_b128 v[52:55], v8 offset:26624
  s_waitcnt lgkmcnt(5)
  v_mfma_f32_16x16x32_bf16 v[28:31], a[76:79], v[60:63], v[28:31]
  v_add_f32 v144, v144, v148
  v_mfma_f32_16x16x32_bf16 v[16:19], a[80:83], v[64:67], v[16:19]
  ds_read_b128 v[56:59], v9 offset:24576
  v_add_f32 v145, v145, v149
  v_mfma_f32_16x16x32_bf16 v[20:23], a[84:87], v[64:67], v[20:23]
  buffer_load_dword v7, v6, s[48:51], s60 offen
  v_mfma_f32_16x16x32_bf16 v[24:27], a[80:83], v[68:71], v[24:27]
  ds_read_b128 v[60:63], v9 offset:26624
  v_add_f32 v146, v146, v150
  v_mfma_f32_16x16x32_bf16 v[28:31], a[84:87], v[68:71], v[28:31]
  v_add_f32 v147, v147, v151
  s_waitcnt lgkmcnt(6)
  v_mfma_f32_16x16x32_bf16 v[16:19], a[88:91], v[72:75], v[16:19]
  ds_read_b128 v[64:67], v8 offset:28672
  s_add_u32 m0, s61, 117120
  s_waitcnt lgkmcnt(5)
  v_mfma_f32_16x16x32_bf16 v[20:23], a[92:95], v[72:75], v[20:23]
  buffer_load_dwordx4 v4, s[48:51], s57 offen offset:1664 lds
  v_mfma_f32_16x16x32_bf16 v[24:27], a[88:91], v[76:79], v[24:27]
  ds_read_b128 v[68:71], v8 offset:30720
  v_add_f32 v152, v152, v156
  v_mfma_f32_16x16x32_bf16 v[28:31], a[92:95], v[76:79], v[28:31]
  v_add_f32 v153, v153, v157
  s_waitcnt vmcnt(13)
  s_max_i32 s40, s66, s89
  s_sub_u32 s92, s40, s89
  s_mov_b32 s89, s40
  s_atomic_add s92, s[34:35], s83
  s_waitcnt lgkmcnt(4)
  v_mfma_f32_16x16x32_bf16 v[16:19], a[96:99], v[48:51], v[16:19]
  ds_read_b128 v[72:75], v9 offset:28672
  v_add_f32 v154, v154, v158
  v_mfma_f32_16x16x32_bf16 v[20:23], a[100:103], v[48:51], v[20:23]
  s_add_u32 s73, s67, 50331648
  v_mfma_f32_16x16x32_bf16 v[24:27], a[96:99], v[52:55], v[24:27]
  ds_read_b128 v[76:79], v9 offset:30720
  v_add_f32 v155, v155, v159
  s_waitcnt vmcnt(11)
  v_mfma_f32_16x16x32_bf16 v[136:139], v[104:107], v[240:243], 0
  v_mfma_f32_16x16x32_bf16 v[28:31], a[100:103], v[52:55], v[28:31]
  v_add_f32 v164, v144, v152
  v_mfma_f32_16x16x32_bf16 v[140:143], v[104:107], v[244:247], 0
  s_waitcnt lgkmcnt(4)
  v_mfma_f32_16x16x32_bf16 v[16:19], a[104:107], v[56:59], v[16:19]
  ds_read_b128 v[48:51], v8 offset:32768
  s_add_u32 m0, s61, 121088
  v_mfma_f32_16x16x32_bf16 v[20:23], a[108:111], v[56:59], v[20:23]
  buffer_load_dwordx4 v4, s[48:51], s57 offen offset:1792 lds
  v_add_f32 v165, v145, v153
  v_mfma_f32_16x16x32_bf16 v[24:27], a[104:107], v[60:63], v[24:27]
  ds_read_b128 v[52:55], v8 offset:34816
  v_add_f32 v166, v146, v154
  v_mfma_f32_16x16x32_bf16 v[28:31], a[108:111], v[60:63], v[28:31]
  v_add_f32 v167, v147, v155
  ds_write_b64 v229, v[136:137] offset:0
  s_waitcnt lgkmcnt(5)
  v_mfma_f32_16x16x32_bf16 v[16:19], a[112:115], v[64:67], v[16:19]
  ds_read_b128 v[56:59], v9 offset:32768
  v_mfma_f32_16x16x32_bf16 v[20:23], a[116:119], v[64:67], v[20:23]
  v_cndmask_b32 v164, v235, v164, s[74:75]
  s_add_u32 s40, s66, 1
  s_lshl_b32 s67, s40, 18
  s_cmp_lt_i32 s40, 0
  s_cselect_b32 s67, 0x80000000, s67
  v_mfma_f32_16x16x32_bf16 v[24:27], a[112:115], v[68:71], v[24:27]
  ds_read_b128 v[60:63], v9 offset:34816
  v_cndmask_b32 v165, v235, v165, s[76:77]
  ds_write_b64 v229, v[140:141] offset:512
  v_mfma_f32_16x16x32_bf16 v[28:31], a[116:119], v[68:71], v[28:31]
  v_cndmask_b32 v166, v235, v166, s[78:79]
  s_waitcnt lgkmcnt(6)
  v_mfma_f32_16x16x32_bf16 v[16:19], a[120:123], v[72:75], v[16:19]
  ds_read_b128 v[64:67], v8 offset:36864
  s_add_u32 m0, s61, 125056
  v_mfma_f32_16x16x32_bf16 v[20:23], a[124:127], v[72:75], v[20:23]
  buffer_load_dwordx4 v4, s[48:51], s57 offen offset:1920 lds
  v_cndmask_b32 v167, v235, v167, s[80:81]
  v_mfma_f32_16x16x32_bf16 v[24:27], a[120:123], v[76:79], v[24:27]
  ds_read_b128 v[68:71], v8 offset:38912
  v_max3_f32 v176, v164, v165, v166
  v_mfma_f32_16x16x32_bf16 v[28:31], a[124:127], v[76:79], v[28:31]
  s_waitcnt lgkmcnt(2)
  s_waitcnt vmcnt(16)
  s_barrier
  s_add_u32 s57, s60, 0x20000
  v_mfma_f32_16x16x32_bf16 v[16:19], a[128:131], v[48:51], v[16:19]
  ds_read_b128 v[72:75], v9 offset:36864
  ds_read_b32 v160, v231 offset:0
  ds_read_b32 v161, v231 offset:4096
  v_mfma_f32_16x16x32_bf16 v[20:23], a[132:135], v[48:51], v[20:23]
  buffer_load_dwordx4 v[96:99], v5, s[52:55], s67 offen offset:0 sc1
  ds_read_b32 v162, v231 offset:8192
  ds_read_b32 v163, v231 offset:12288
  v_mfma_f32_16x16x32_bf16 v[24:27], a[128:131], v[52:55], v[24:27]
  ds_read_b128 v[76:79], v9 offset:38912
  v_mfma_f32_16x16x32_bf16 v[28:31], a[132:135], v[52:55], v[28:31]
  v_mfma_f32_16x16x32_bf16 v[16:19], a[136:139], v[56:59], v[16:19]
  ds_read_b128 v[48:51], v8 offset:40960
  s_add_u32 m0, s61, 0
  s_waitcnt lgkmcnt(2)
  v_add_f32 v160, v160, v161
  v_add_f32 v162, v162, v163
  v_mfma_f32_16x16x32_bf16 v[20:23], a[140:143], v[56:59], v[20:23]
  buffer_load_dwordx4 v4, s[48:51], s57 offen offset:0 lds
  v_add_f32 v168, v160, v162
  v_max3_f32 v176, v176, v167, v168
  v_mfma_f32_16x16x32_bf16 v[24:27], a[136:139], v[60:63], v[24:27]
  ds_read_b128 v[52:55], v8 offset:43008
  v_max_f32_dpp v176, v176, v176 row_ror:8 row_mask:0xf bank_mask:0xf
  v_mov_b32 v178, v176
  v_mfma_f32_16x16x32_bf16 v[28:31], a[140:143], v[60:63], v[28:31]
  s_nop 0
  v_permlane16_swap_b32 v178, v176
  v_max_f32 v176, v176, v178
  v_mfma_f32_16x16x32_bf16 v[16:19], a[144:147], v[64:67], v[16:19]
  ds_read_b128 v[56:59], v9 offset:40960
  v_mov_b32 v178, v176
  v_mfma_f32_16x16x32_bf16 v[20:23], a[148:151], v[64:67], v[20:23]
  buffer_load_dwordx4 v[100:103], v5, s[52:55], s67 offen offset:1024 sc1
  v_permlane32_swap_b32 v178, v176
  v_max_f32 v176, v176, v178
  v_mfma_f32_16x16x32_bf16 v[24:27], a[144:147], v[68:71], v[24:27]
  ds_read_b128 v[60:63], v9 offset:43008
  v_mul_f32 v176, s82, v176
  v_fma_f32 v170, v164, s82, -v176
  v_mfma_f32_16x16x32_bf16 v[28:31], a[148:151], v[68:71], v[28:31]
  v_fma_f32 v171, v165, s82, -v176
  v_fma_f32 v172, v166, s82, -v176
  s_waitcnt lgkmcnt(4)
  v_mfma_f32_16x16x32_bf16 v[16:19], a[152:155], v[72:75], v[16:19]
  ds_read_b128 v[64:67], v8 offset:45056
  s_add_u32 m0, s61, 3968
  v_fma_f32 v173, v167, s82, -v176
  v_mfma_f32_16x16x32_bf16 v[20:23], a[156:159], v[72:75], v[20:23]
  buffer_load_dwordx4 v4, s[48:51], s57 offen offset:128 lds
  v_fma_f32 v174, v168, s82, -v176
  v_exp_f32 v170, v170
  v_mfma_f32_16x16x32_bf16 v[24:27], a[152:155], v[76:79], v[24:27]
  ds_read_b128 v[68:71], v8 offset:47104
  v_exp_f32 v171, v171
  v_exp_f32 v172, v172
  v_mfma_f32_16x16x32_bf16 v[28:31], a[156:159], v[76:79], v[28:31]
  v_exp_f32 v173, v173
  v_exp_f32 v174, v174
  s_waitcnt lgkmcnt(4)
  v_mfma_f32_16x16x32_bf16 v[16:19], a[160:163], v[48:51], v[16:19]
  ds_read_b128 v[72:75], v9 offset:45056
  v_add_f32 v164, v170, v171
  v_mfma_f32_16x16x32_bf16 v[20:23], a[164:167], v[48:51], v[20:23]
  v_add_f32 v165, v172, v173
  v_add_f32 v164, v164, v174
  v_mfma_f32_16x16x32_bf16 v[24:27], a[160:163], v[52:55], v[24:27]
  ds_read_b128 v[76:79], v9 offset:47104
  v_add_f32 v176, v164, v165
  s_nop 1
  v_add_f32_dpp v176, v176, v176 row_ror:8 row_mask:0xf bank_mask:0xf
  v_mfma_f32_16x16x32_bf16 v[28:31], a[164:167], v[52:55], v[28:31]
  v_mov_b32 v178, v176
  s_nop 1
  v_permlane16_swap_b32 v178, v176
  s_waitcnt lgkmcnt(4)
  v_mfma_f32_16x16x32_bf16 v[16:19], a[168:171], v[56:59], v[16:19]
  ds_read_b128 v[48:51], v8 offset:49152
  s_add_u32 m0, s61, 7936
  v_add_f32 v176, v176, v178
  v_mfma_f32_16x16x32_bf16 v[20:23], a[172:175], v[56:59], v[20:23]
  buffer_load_dwordx4 v4, s[48:51], s57 offen offset:256 lds
  v_mov_b32 v178, v176
  s_nop 1
  v_permlane32_swap_b32 v178, v176
  v_mfma_f32_16x16x32_bf16 v[24:27], a[168:171], v[60:63], v[24:27]
  ds_read_b128 v[52:55], v8 offset:51200
  v_add_f32 v176, v176, v178
  v_rcp_f32 v176, v176
  v_mfma_f32_16x16x32_bf16 v[28:31], a[172:175], v[60:63], v[28:31]
  v_mul_f32 v174, v174, v176
  v_mul_f32 v170, v170, v176
  s_waitcnt lgkmcnt(4)
  v_mfma_f32_16x16x32_bf16 v[16:19], a[176:179], v[64:67], v[16:19]
  ds_read_b128 v[56:59], v9 offset:49152
  v_mul_f32 v171, v171, v176
  v_mfma_f32_16x16x32_bf16 v[20:23], a[180:183], v[64:67], v[20:23]
  v_mul_f32 v172, v172, v176
  v_mul_f32 v173, v173, v176
  v_mfma_f32_16x16x32_bf16 v[24:27], a[176:179], v[68:71], v[24:27]
  ds_read_b128 v[60:63], v9 offset:51200
  v_cvt_pk_bf16_f32 v182, v174, v174
  ds_write_b16 v233, v182
  v_mfma_f32_16x16x32_bf16 v[28:31], a[180:183], v[68:71], v[28:31]
  v_cvt_pk_bf16_f32 v180, v170, v171
  v_cvt_pk_bf16_f32 v181, v172, v173
  s_waitcnt lgkmcnt(5)
  v_mfma_f32_16x16x32_bf16 v[16:19], a[184:187], v[72:75], v[16:19]
  ds_read_b128 v[64:67], v8 offset:53248
  s_add_u32 m0, s61, 11904
  ds_write_b64 v232, v[180:181]
  v_mfma_f32_16x16x32_bf16 v[20:23], a[188:191], v[72:75], v[20:23]
  buffer_load_dwordx4 v4, s[48:51], s57 offen offset:384 lds
  v_mfma_f32_16x16x32_bf16 v[24:27], a[184:187], v[76:79], v[24:27]
  ds_read_b128 v[68:71], v8 offset:55296
  v_mfma_f32_16x16x32_bf16 v[28:31], a[188:191], v[76:79], v[28:31]
  s_waitcnt lgkmcnt(1)
  s_waitcnt vmcnt(16)
  s_barrier
  v_mfma_f32_16x16x32_bf16 v[16:19], a[192:195], v[48:51], v[16:19]
  ds_read_b128 v[72:75], v9 offset:53248
  s_load_dwordx4 s[84:87], s[34:35], s88 glc
  ds_read_b128 v[184:187], v236 offset:0
  ds_read_b32 v192, v234 offset:0
  v_mfma_f32_16x16x32_bf16 v[20:23], a[196:199], v[48:51], v[20:23]
  ds_read_b128 v[188:191], v236 offset:1024
  ds_read_b32 v196, v234 offset:256
  v_mfma_f32_16x16x32_bf16 v[24:27], a[192:195], v[52:55], v[24:27]
  ds_read_b128 v[76:79], v9 offset:55296
  v_mov_b32 v240, v88
  v_mov_b32 v241, v89
  v_mfma_f32_16x16x32_bf16 v[28:31], a[196:199], v[52:55], v[28:31]
  v_mov_b32 v242, v90
  v_mov_b32 v243, v91
  v_mfma_f32_16x16x32_bf16 v[16:19], a[200:203], v[56:59], v[16:19]
  ds_read_b128 v[48:51], v8 offset:57344
  s_add_u32 m0, s61, 15872
  v_mov_b32 v244, v92
  v_mfma_f32_16x16x32_bf16 v[20:23], a[204:207], v[56:59], v[20:23]
  buffer_load_dwordx4 v4, s[48:51], s57 offen offset:512 lds
  v_mov_b32 v245, v93
  v_mov_b32 v246, v94
  v_mfma_f32_16x16x32_bf16 v[24:27], a[200:203], v[60:63], v[24:27]
  ds_read_b128 v[52:55], v8 offset:59392
  v_mov_b32 v247, v95
  s_waitcnt vmcnt(12)
  s_waitcnt lgkmcnt(3)
  v_mfma_f32_16x16x32_bf16 v[28:31], a[204:207], v[60:63], v[28:31]
  v_mfma_f32_16x16x32_bf16 v[200:203], v[108:111], v[184:187], 0
  v_mfma_f32_16x16x32_bf16 v[16:19], a[208:211], v[64:67], v[16:19]
  ds_read_b128 v[56:59], v9 offset:57344
  v_mfma_f32_16x16x32_bf16 v[204:207], v[112:115], v[184:187], 0
  v_mfma_f32_16x16x32_bf16 v[20:23], a[212:215], v[64:67], v[20:23]
  v_mfma_f32_16x16x32_bf16 v[208:211], v[108:111], v[188:191], 0
  v_mfma_f32_16x16x32_bf16 v[24:27], a[208:211], v[68:71], v[24:27]
  ds_read_b128 v[60:63], v9 offset:59392
  v_mfma_f32_16x16x32_bf16 v[212:215], v[112:115], v[188:191], 0
  v_mfma_f32_16x16x32_bf16 v[28:31], a[212:215], v[68:71], v[28:31]
  v_mfma_f32_16x16x32_bf16 v[200:203], v[116:119], v[192:195], v[200:203]
  s_waitcnt lgkmcnt(4)
  v_mfma_f32_16x16x32_bf16 v[16:19], a[216:219], v[72:75], v[16:19]
  ds_read_b128 v[64:67], v8 offset:61440
  s_add_u32 m0, s61, 19840
  v_mfma_f32_16x16x32_bf16 v[204:207], v[120:123], v[192:195], v[204:207]
  v_mfma_f32_16x16x32_bf16 v[20:23], a[220:223], v[72:75], v[20:23]
  buffer_load_dwordx4 v4, s[48:51], s57 offen offset:640 lds
  v_mfma_f32_16x16x32_bf16 v[208:211], v[116:119], v[196:199], v[208:211]
  v_mfma_f32_16x16x32_bf16 v[24:27], a[216:219], v[76:79], v[24:27]
  ds_read_b128 v[68:71], v8 offset:63488
  v_mfma_f32_16x16x32_bf16 v[212:215], v[120:123], v[196:199], v[212:215]
  v_mfma_f32_16x16x32_bf16 v[28:31], a[220:223], v[76:79], v[28:31]
  s_waitcnt lgkmcnt(4)
  v_mfma_f32_16x16x32_bf16 v[16:19], a[224:227], v[48:51], v[16:19]
  ds_read_b128 v[72:75], v9 offset:61440
  v_mfma_f32_16x16x32_bf16 v[20:23], a[228:231], v[48:51], v[20:23]
  v_cvt_pk_bf16_f32 v216, v200, v201
  v_mfma_f32_16x16x32_bf16 v[24:27], a[224:227], v[52:55], v[24:27]
  ds_read_b128 v[76:79], v9 offset:63488
  v_cvt_pk_bf16_f32 v217, v202, v203
  v_mfma_f32_16x16x32_bf16 v[28:31], a[228:231], v[52:55], v[28:31]
  v_cvt_pk_bf16_f32 v218, v204, v205
  s_waitcnt lgkmcnt(4)
  v_mfma_f32_16x16x32_bf16 v[16:19], a[232:235], v[56:59], v[16:19]
  ds_read_b128 v[48:51], v10 offset:0
  s_add_u32 m0, s61, 23808
  v_cvt_pk_bf16_f32 v219, v206, v207
  v_mfma_f32_16x16x32_bf16 v[20:23], a[236:239], v[56:59], v[20:23]
  buffer_load_dwordx4 v4, s[48:51], s57 offen offset:768 lds
  buffer_store_dwordx4 v[216:219], v5, s[52:55], s73 offen offset:0 sc1
  v_mfma_f32_16x16x32_bf16 v[24:27], a[232:235], v[60:63], v[24:27]
  ds_read_b128 v[52:55], v10 offset:2048
  v_cvt_pk_bf16_f32 v220, v208, v209
  v_mfma_f32_16x16x32_bf16 v[28:31], a[236:239], v[60:63], v[28:31]
  v_cvt_pk_bf16_f32 v221, v210, v211
  s_waitcnt lgkmcnt(4)
  v_mfma_f32_16x16x32_bf16 v[16:19], a[240:243], v[64:67], v[16:19]
  ds_read_b128 v[56:59], v11 offset:0
  v_cvt_pk_bf16_f32 v222, v212, v213
  v_mfma_f32_16x16x32_bf16 v[20:23], a[244:247], v[64:67], v[20:23]
  v_cvt_pk_bf16_f32 v223, v214, v215
  v_mfma_f32_16x16x32_bf16 v[24:27], a[240:243], v[68:71], v[24:27]
  ds_read_b128 v[60:63], v11 offset:2048
  v_mfma_f32_16x16x32_bf16 v[28:31], a[244:247], v[68:71], v[28:31]
  buffer_store_dwordx4 v[220:223], v5, s[52:55], s73 offen offset:1024 sc1
  s_waitcnt lgkmcnt(4)
  v_mfma_f32_16x16x32_bf16 v[16:19], a[248:251], v[72:75], v[16:19]
  ds_read_b128 v[64:67], v10 offset:4096
  s_add_u32 m0, s61, 27776
  v_mfma_f32_16x16x32_bf16 v[20:23], a[252:255], v[72:75], v[20:23]
  buffer_load_dwordx4 v4, s[48:51], s57 offen offset:896 lds
  v_mfma_f32_16x16x32_bf16 v[24:27], a[248:251], v[76:79], v[24:27]
  ds_read_b128 v[68:71], v10 offset:6144
  s_add_u32 s66, s66, 1
  s_add_u32 s60, s60, 0x10000
  v_mfma_f32_16x16x32_bf16 v[28:31], a[252:255], v[76:79], v[28:31]
  s_waitcnt vmcnt(16)
  s_barrier
  s_add_u32 s57, s60, 0x10000
  s_waitcnt lgkmcnt(4)
  v_mfma_f32_16x16x32_bf16 v[32:35], a[0:3], v[48:51], 0
  ds_read_b128 v[72:75], v11 offset:4096
  s_sub_u32 s40, s84, 1
  s_min_i32 s40, s40, s85
  s_min_i32 s40, s40, s86
  s_cmp_gt_i32 s40, s66
  s_cbranch_scc0 L_qf_29_s
L_qf_29:
  s_add_u32 s40, s66, 0
  s_lshl_b32 s72, s40, 17
  s_cmp_lt_i32 s40, 0
  s_cselect_b32 s72, 0x80000000, s72
  v_mfma_f32_16x16x32_bf16 v[36:39], a[4:7], v[48:51], 0
  buffer_load_dwordx4 v[104:107], v224, s[52:55], s72 offen sc1
  v_mfma_f32_16x16x32_bf16 v[40:43], a[0:3], v[52:55], 0
  ds_read_b128 v[76:79], v11 offset:6144
  s_add_u32 s73, s67, 16777216
  v_mfma_f32_16x16x32_bf16 v[44:47], a[4:7], v[52:55], 0
  s_waitcnt vmcnt(10)
  v_mfma_f32_16x16x32_bf16 v[124:127], v[96:99], v[240:243], 0
  s_waitcnt lgkmcnt(4)
  v_mfma_f32_16x16x32_bf16 v[32:35], a[8:11], v[56:59], v[32:35]
  ds_read_b128 v[48:51], v10 offset:8192
  s_add_u32 m0, s61, 31744
  v_mfma_f32_16x16x32_bf16 v[36:39], a[12:15], v[56:59], v[36:39]
  buffer_load_dwordx4 v4, s[48:51], s57 offen offset:1024 lds
  v_mfma_f32_16x16x32_bf16 v[128:131], v[96:99], v[244:247], 0
  v_mfma_f32_16x16x32_bf16 v[40:43], a[8:11], v[60:63], v[40:43]
  ds_read_b128 v[52:55], v10 offset:10240
  v_mfma_f32_16x16x32_bf16 v[44:47], a[12:15], v[60:63], v[44:47]
  v_mfma_f32_16x16x32_bf16 v[132:135], v[100:103], v[244:247], 0
  s_waitcnt lgkmcnt(4)
  v_mfma_f32_16x16x32_bf16 v[32:35], a[16:19], v[64:67], v[32:35]
  ds_read_b128 v[56:59], v11 offset:8192
  v_mfma_f32_16x16x32_bf16 v[36:39], a[20:23], v[64:67], v[36:39]
  buffer_load_dword v116, v225, s[52:55], s72 offen offset:512 sc1
  v_mfma_f32_16x16x32_bf16 v[40:43], a[16:19], v[68:71], v[40:43]
  ds_read_b128 v[60:63], v11 offset:10240
  v_mfma_f32_16x16x32_bf16 v[44:47], a[20:23], v[68:71], v[44:47]
  ds_write_b128 v228, v[124:127] offset:0
  s_waitcnt lgkmcnt(5)
  v_mfma_f32_16x16x32_bf16 v[32:35], a[24:27], v[72:75], v[32:35]
  ds_read_b128 v[64:67], v10 offset:12288
  s_add_u32 m0, s61, 35712
  v_mfma_f32_16x16x32_bf16 v[36:39], a[28:31], v[72:75], v[36:39]
  buffer_load_dwordx4 v4, s[48:51], s57 offen offset:1152 lds
  v_mfma_f32_16x16x32_bf16 v[40:43], a[24:27], v[76:79], v[40:43]
  ds_read_b128 v[68:71], v10 offset:14336
  v_mfma_f32_16x16x32_bf16 v[44:47], a[28:31], v[76:79], v[44:47]
  ds_write_b128 v228, v[128:131] offset:1024
  s_waitcnt lgkmcnt(6)
  v_mfma_f32_16x16x32_bf16 v[32:35], a[32:35], v[48:51], v[32:35]
  ds_read_b128 v[72:75], v11 offset:12288
  v_mfma_f32_16x16x32_bf16 v[36:39], a[36:39], v[48:51], v[36:39]
  buffer_load_dword v120, v225, s[52:55], s72 offen offset:768 sc1
  v_mfma_f32_16x16x32_bf16 v[40:43], a[32:35], v[52:55], v[40:43]
  ds_read_b128 v[76:79], v11 offset:14336
  v_mfma_f32_16x16x32_bf16 v[44:47], a[36:39], v[52:55], v[44:47]
  ds_write_b128 v228, v[132:135] offset:2048
  s_waitcnt lgkmcnt(7)
  v_mfma_f32_16x16x32_bf16 v[32:35], a[40:43], v[56:59], v[32:35]
  ds_read_b128 v[48:51], v10 offset:16384
  s_add_u32 m0, s61, 39680
  v_mfma_f32_16x16x32_bf16 v[36:39], a[44:47], v[56:59], v[36:39]
  buffer_load_dwordx4 v4, s[48:51], s57 offen offset:1280 lds
  v_cvt_pk_bf16_f32 v88, v16, v17
  v_mfma_f32_16x16x32_bf16 v[40:43], a[40:43], v[60:63], v[40:43]
  ds_read_b128 v[52:55], v10 offset:18432
  v_cvt_pk_bf16_f32 v89, v18, v19
  v_mfma_f32_16x16x32_bf16 v[44:47], a[44:47], v[60:63], v[44:47]
  v_cvt_pk_bf16_f32 v90, v20, v21
  s_waitcnt lgkmcnt(6)
  v_mfma_f32_16x16x32_bf16 v[32:35], a[48:51], v[64:67], v[32:35]
  ds_read_b128 v[56:59], v11 offset:16384
  v_mfma_f32_16x16x32_bf16 v[36:39], a[52:55], v[64:67], v[36:39]
  buffer_load_dwordx4 v[108:111], v5, s[52:55], s73 offen offset:0 sc1
  v_cvt_pk_bf16_f32 v91, v22, v23
  v_mfma_f32_16x16x32_bf16 v[40:43], a[48:51], v[68:71], v[40:43]
  ds_read_b128 v[60:63], v11 offset:18432
  v_cvt_pk_bf16_f32 v92, v24, v25
  v_mfma_f32_16x16x32_bf16 v[44:47], a[52:55], v[68:71], v[44:47]
  v_cvt_pk_bf16_f32 v93, v26, v27
  s_waitcnt lgkmcnt(5)
  v_mfma_f32_16x16x32_bf16 v[32:35], a[56:59], v[72:75], v[32:35]
  ds_read_b128 v[64:67], v10 offset:20480
  s_add_u32 m0, s61, 43648
  v_mfma_f32_16x16x32_bf16 v[36:39], a[60:63], v[72:75], v[36:39]
  buffer_load_dwordx4 v4, s[48:51], s57 offen offset:1408 lds
  v_cvt_pk_bf16_f32 v94, v28, v29
  v_mfma_f32_16x16x32_bf16 v[40:43], a[56:59], v[76:79], v[40:43]
  ds_read_b128 v[68:71], v10 offset:22528
  v_cvt_pk_bf16_f32 v95, v30, v31
  v_mfma_f32_16x16x32_bf16 v[44:47], a[60:63], v[76:79], v[44:47]
  s_waitcnt lgkmcnt(6)
  s_waitcnt vmcnt(16)
  s_barrier
  s_waitcnt lgkmcnt(4)
  v_mfma_f32_16x16x32_bf16 v[32:35], a[64:67], v[48:51], v[32:35]
  ds_read_b128 v[72:75], v11 offset:20480
  ds_read_b128 v[144:147], v230 offset:0
  v_mfma_f32_16x16x32_bf16 v[36:39], a[68:71], v[48:51], v[36:39]
  buffer_load_dwordx4 v[112:115], v5, s[52:55], s73 offen offset:1024 sc1
  ds_read_b128 v[148:151], v230 offset:4096
  v_mfma_f32_16x16x32_bf16 v[40:43], a[64:67], v[52:55], v[40:43]
  ds_read_b128 v[76:79], v11 offset:22528
  ds_read_b128 v[152:155], v230 offset:8192
  v_mfma_f32_16x16x32_bf16 v[44:47], a[68:71], v[52:55], v[44:47]
  ds_read_b128 v[156:159], v230 offset:12288
  s_waitcnt lgkmcnt(8)
  v_mfma_f32_16x16x32_bf16 v[32:35], a[72:75], v[56:59], v[32:35]
  ds_read_b128 v[48:51], v10 offset:24576
  s_add_u32 m0, s61, 47616
  v_mfma_f32_16x16x32_bf16 v[36:39], a[76:79], v[56:59], v[36:39]
  buffer_load_dwordx4 v4, s[48:51], s57 offen offset:1536 lds
  v_mfma_f32_16x16x32_bf16 v[40:43], a[72:75], v[60:63], v[40:43]
  ds_read_b128 v[52:55], v10 offset:26624
  s_waitcnt lgkmcnt(5)
  v_mfma_f32_16x16x32_bf16 v[44:47], a[76:79], v[60:63], v[44:47]
  v_add_f32 v144, v144, v148
  v_mfma_f32_16x16x32_bf16 v[32:35], a[80:83], v[64:67], v[32:35]
  ds_read_b128 v[56:59], v11 offset:24576
  v_add_f32 v145, v145, v149
  v_mfma_f32_16x16x32_bf16 v[36:39], a[84:87], v[64:67], v[36:39]
  buffer_load_dword v7, v6, s[48:51], s60 offen
  v_mfma_f32_16x16x32_bf16 v[40:43], a[80:83], v[68:71], v[40:43]
  ds_read_b128 v[60:63], v11 offset:26624
  v_add_f32 v146, v146, v150
  v_mfma_f32_16x16x32_bf16 v[44:47], a[84:87], v[68:71], v[44:47]
  v_add_f32 v147, v147, v151
  s_waitcnt lgkmcnt(6)
  v_mfma_f32_16x16x32_bf16 v[32:35], a[88:91], v[72:75], v[32:35]
  ds_read_b128 v[64:67], v10 offset:28672
  s_add_u32 m0, s61, 51584
  s_waitcnt lgkmcnt(5)
  v_mfma_f32_16x16x32_bf16 v[36:39], a[92:95], v[72:75], v[36:39]
  buffer_load_dwordx4 v4, s[48:51], s57 offen offset:1664 lds
  v_mfma_f32_16x16x32_bf16 v[40:43], a[88:91], v[76:79], v[40:43]
  ds_read_b128 v[68:71], v10 offset:30720
  v_add_f32 v152, v152, v156
  v_mfma_f32_16x16x32_bf16 v[44:47], a[92:95], v[76:79], v[44:47]
  v_add_f32 v153, v153, v157
  s_waitcnt vmcnt(13)
  s_max_i32 s40, s66, s89
  s_sub_u32 s92, s40, s89
  s_mov_b32 s89, s40
  s_atomic_add s92, s[34:35], s83
  s_waitcnt lgkmcnt(4)
  v_mfma_f32_16x16x32_bf16 v[32:35], a[96:99], v[48:51], v[32:35]
  ds_read_b128 v[72:75], v11 offset:28672
  v_add_f32 v154, v154, v158
  v_mfma_f32_16x16x32_bf16 v[36:39], a[100:103], v[48:51], v[36:39]
  s_add_u32 s73, s67, 50331648
  v_mfma_f32_16x16x32_bf16 v[40:43], a[96:99], v[52:55], v[40:43]
  ds_read_b128 v[76:79], v11 offset:30720
  v_add_f32 v155, v155, v159
  s_waitcnt vmcnt(11)
  v_mfma_f32_16x16x32_bf16 v[136:139], v[104:107], v[240:243], 0
  v_mfma_f32_16x16x32_bf16 v[44:47], a[100:103], v[52:55], v[44:47]
  v_add_f32 v164, v144, v152
  v_mfma_f32_16x16x32_bf16 v[140:143], v[104:107], v[244:247], 0
  s_waitcnt lgkmcnt(4)
  v_mfma_f32_16x16x32_bf16 v[32:35], a[104:107], v[56:59], v[32:35]
  ds_read_b128 v[48:51], v10 offset:32768
  s_add_u32 m0, s61, 55552
  v_mfma_f32_16x16x32_bf16 v[36:39], a[108:111], v[56:59], v[36:39]
  buffer_load_dwordx4 v4, s[48:51], s57 offen offset:1792 lds
  v_add_f32 v165, v145, v153
  v_mfma_f32_16x16x32_bf16 v[40:43], a[104:107], v[60:63], v[40:43]
  ds_read_b128 v[52:55], v10 offset:34816
  v_add_f32 v166, v146, v154
  v_mfma_f32_16x16x32_bf16 v[44:47], a[108:111], v[60:63], v[44:47]
  v_add_f32 v167, v147, v155
  ds_write_b64 v229, v[136:137] offset:0
  s_waitcnt lgkmcnt(5)
  v_mfma_f32_16x16x32_bf16 v[32:35], a[112:115], v[64:67], v[32:35]
  ds_read_b128 v[56:59], v11 offset:32768
  v_mfma_f32_16x16x32_bf16 v[36:39], a[116:119], v[64:67], v[36:39]
  v_cndmask_b32 v164, v235, v164, s[74:75]
  s_add_u32 s40, s66, 1
  s_lshl_b32 s67, s40, 18
  s_cmp_lt_i32 s40, 0
  s_cselect_b32 s67, 0x80000000, s67
  v_mfma_f32_16x16x32_bf16 v[40:43], a[112:115], v[68:71], v[40:43]
  ds_read_b128 v[60:63], v11 offset:34816
  v_cndmask_b32 v165, v235, v165, s[76:77]
  ds_write_b64 v229, v[140:141] offset:512
  v_mfma_f32_16x16x32_bf16 v[44:47], a[116:119], v[68:71], v[44:47]
  v_cndmask_b32 v166, v235, v166, s[78:79]
  s_waitcnt lgkmcnt(6)
  v_mfma_f32_16x16x32_bf16 v[32:35], a[120:123], v[72:75], v[32:35]
  ds_read_b128 v[64:67], v10 offset:36864
  s_add_u32 m0, s61, 59520
  v_mfma_f32_16x16x32_bf16 v[36:39], a[124:127], v[72:75], v[36:39]
  buffer_load_dwordx4 v4, s[48:51], s57 offen offset:1920 lds
  v_cndmask_b32 v167, v235, v167, s[80:81]
  v_mfma_f32_16x16x32_bf16 v[40:43], a[120:123], v[76:79], v[40:43]
  ds_read_b128 v[68:71], v10 offset:38912
  v_max3_f32 v176, v164, v165, v166
  v_mfma_f32_16x16x32_bf16 v[44:47], a[124:127], v[76:79], v[44:47]
  s_waitcnt lgkmcnt(2)
  s_waitcnt vmcnt(16)
  s_barrier
  s_add_u32 s57, s60, 0x20000
  v_mfma_f32_16x16x32_bf16 v[32:35], a[128:131], v[48:51], v[32:35]
  ds_read_b128 v[72:75], v11 offset:36864
  ds_read_b32 v160, v231 offset:0
  ds_read_b32 v161, v231 offset:4096
  v_mfma_f32_16x16x32_bf16 v[36:39], a[132:135], v[48:51], v[36:39]
  buffer_load_dwordx4 v[96:99], v5, s[52:55], s67 offen offset:0 sc1
  ds_read_b32 v162, v231 offset:8192
  ds_read_b32 v163, v231 offset:12288
  v_mfma_f32_16x16x32_bf16 v[40:43], a[128:131], v[52:55], v[40:43]
  ds_read_b128 v[76:79], v11 offset:38912
  v_mfma_f32_16x16x32_bf16 v[44:47], a[132:135], v[52:55], v[44:47]
  v_mfma_f32_16x16x32_bf16 v[32:35], a[136:139], v[56:59], v[32:35]
  ds_read_b128 v[48:51], v10 offset:40960
  s_add_u32 m0, s61, 65536
  s_waitcnt lgkmcnt(2)
  v_add_f32 v160, v160, v161
  v_add_f32 v162, v162, v163
  v_mfma_f32_16x16x32_bf16 v[36:39], a[140:143], v[56:59], v[36:39]
  buffer_load_dwordx4 v4, s[48:51], s57 offen offset:0 lds
  v_add_f32 v168, v160, v162
  v_max3_f32 v176, v176, v167, v168
  v_mfma_f32_16x16x32_bf16 v[40:43], a[136:139], v[60:63], v[40:43]
  ds_read_b128 v[52:55], v10 offset:43008
  v_max_f32_dpp v176, v176, v176 row_ror:8 row_mask:0xf bank_mask:0xf
  v_mov_b32 v178, v176
  v_mfma_f32_16x16x32_bf16 v[44:47], a[140:143], v[60:63], v[44:47]
  s_nop 0
  v_permlane16_swap_b32 v178, v176
  v_max_f32 v176, v176, v178
  v_mfma_f32_16x16x32_bf16 v[32:35], a[144:147], v[64:67], v[32:35]
  ds_read_b128 v[56:59], v11 offset:40960
  v_mov_b32 v178, v176
  v_mfma_f32_16x16x32_bf16 v[36:39], a[148:151], v[64:67], v[36:39]
  buffer_load_dwordx4 v[100:103], v5, s[52:55], s67 offen offset:1024 sc1
  v_permlane32_swap_b32 v178, v176
  v_max_f32 v176, v176, v178
  v_mfma_f32_16x16x32_bf16 v[40:43], a[144:147], v[68:71], v[40:43]
  ds_read_b128 v[60:63], v11 offset:43008
  v_mul_f32 v176, s82, v176
  v_fma_f32 v170, v164, s82, -v176
  v_mfma_f32_16x16x32_bf16 v[44:47], a[148:151], v[68:71], v[44:47]
  v_fma_f32 v171, v165, s82, -v176
  v_fma_f32 v172, v166, s82, -v176
  s_waitcnt lgkmcnt(4)
  v_mfma_f32_16x16x32_bf16 v[32:35], a[152:155], v[72:75], v[32:35]
  ds_read_b128 v[64:67], v10 offset:45056
  s_add_u32 m0, s61, 69504
  v_fma_f32 v173, v167, s82, -v176
  v_mfma_f32_16x16x32_bf16 v[36:39], a[156:159], v[72:75], v[36:39]
  buffer_load_dwordx4 v4, s[48:51], s57 offen offset:128 lds
  v_fma_f32 v174, v168, s82, -v176
  v_exp_f32 v170, v170
  v_mfma_f32_16x16x32_bf16 v[40:43], a[152:155], v[76:79], v[40:43]
  ds_read_b128 v[68:71], v10 offset:47104
  v_exp_f32 v171, v171
  v_exp_f32 v172, v172
  v_mfma_f32_16x16x32_bf16 v[44:47], a[156:159], v[76:79], v[44:47]
  v_exp_f32 v173, v173
  v_exp_f32 v174, v174
  s_waitcnt lgkmcnt(4)
  v_mfma_f32_16x16x32_bf16 v[32:35], a[160:163], v[48:51], v[32:35]
  ds_read_b128 v[72:75], v11 offset:45056
  v_add_f32 v164, v170, v171
  v_mfma_f32_16x16x32_bf16 v[36:39], a[164:167], v[48:51], v[36:39]
  v_add_f32 v165, v172, v173
  v_add_f32 v164, v164, v174
  v_mfma_f32_16x16x32_bf16 v[40:43], a[160:163], v[52:55], v[40:43]
  ds_read_b128 v[76:79], v11 offset:47104
  v_add_f32 v176, v164, v165
  s_nop 1
  v_add_f32_dpp v176, v176, v176 row_ror:8 row_mask:0xf bank_mask:0xf
  v_mfma_f32_16x16x32_bf16 v[44:47], a[164:167], v[52:55], v[44:47]
  v_mov_b32 v178, v176
  s_nop 1
  v_permlane16_swap_b32 v178, v176
  s_waitcnt lgkmcnt(4)
  v_mfma_f32_16x16x32_bf16 v[32:35], a[168:171], v[56:59], v[32:35]
  ds_read_b128 v[48:51], v10 offset:49152
  s_add_u32 m0, s61, 73472
  v_add_f32 v176, v176, v178
  v_mfma_f32_16x16x32_bf16 v[36:39], a[172:175], v[56:59], v[36:39]
  buffer_load_dwordx4 v4, s[48:51], s57 offen offset:256 lds
  v_mov_b32 v178, v176
  s_nop 1
  v_permlane32_swap_b32 v178, v176
  v_mfma_f32_16x16x32_bf16 v[40:43], a[168:171], v[60:63], v[40:43]
  ds_read_b128 v[52:55], v10 offset:51200
  v_add_f32 v176, v176, v178
  v_rcp_f32 v176, v176
  v_mfma_f32_16x16x32_bf16 v[44:47], a[172:175], v[60:63], v[44:47]
  v_mul_f32 v174, v174, v176
  v_mul_f32 v170, v170, v176
  s_waitcnt lgkmcnt(4)
  v_mfma_f32_16x16x32_bf16 v[32:35], a[176:179], v[64:67], v[32:35]
  ds_read_b128 v[56:59], v11 offset:49152
  v_mul_f32 v171, v171, v176
  v_mfma_f32_16x16x32_bf16 v[36:39], a[180:183], v[64:67], v[36:39]
  v_mul_f32 v172, v172, v176
  v_mul_f32 v173, v173, v176
  v_mfma_f32_16x16x32_bf16 v[40:43], a[176:179], v[68:71], v[40:43]
  ds_read_b128 v[60:63], v11 offset:51200
  v_cvt_pk_bf16_f32 v182, v174, v174
  ds_write_b16 v233, v182
  v_mfma_f32_16x16x32_bf16 v[44:47], a[180:183], v[68:71], v[44:47]
  v_cvt_pk_bf16_f32 v180, v170, v171
  v_cvt_pk_bf16_f32 v181, v172, v173
  s_waitcnt lgkmcnt(5)
  v_mfma_f32_16x16x32_bf16 v[32:35], a[184:187], v[72:75], v[32:35]
  ds_read_b128 v[64:67], v10 offset:53248
  s_add_u32 m0, s61, 77440
  ds_write_b64 v232, v[180:181]
  v_mfma_f32_16x16x32_bf16 v[36:39], a[188:191], v[72:75], v[36:39]
  buffer_load_dwordx4 v4, s[48:51], s57 offen offset:384 lds
  v_mfma_f32_16x16x32_bf16 v[40:43], a[184:187], v[76:79], v[40:43]
  ds_read_b128 v[68:71], v10 offset:55296
  v_mfma_f32_16x16x32_bf16 v[44:47], a[188:191], v[76:79], v[44:47]
  s_waitcnt lgkmcnt(1)
  s_waitcnt vmcnt(16)
  s_barrier
  v_mfma_f32_16x16x32_bf16 v[32:35], a[192:195], v[48:51], v[32:35]
  ds_read_b128 v[72:75], v11 offset:53248
  s_load_dwordx4 s[84:87], s[34:35], s88 glc
  ds_read_b128 v[184:187], v236 offset:0
  ds_read_b32 v192, v234 offset:0
  v_mfma_f32_16x16x32_bf16 v[36:39], a[196:199], v[48:51], v[36:39]
  ds_read_b128 v[188:191], v236 offset:1024
  ds_read_b32 v196, v234 offset:256
  v_mfma_f32_16x16x32_bf16 v[40:43], a[192:195], v[52:55], v[40:43]
  ds_read_b128 v[76:79], v11 offset:55296
  v_mov_b32 v240, v80
  v_mov_b32 v241, v81
  v_mfma_f32_16x16x32_bf16 v[44:47], a[196:199], v[52:55], v[44:47]
  v_mov_b32 v242, v82
  v_mov_b32 v243, v83
  v_mfma_f32_16x16x32_bf16 v[32:35], a[200:203], v[56:59], v[32:35]
  ds_read_b128 v[48:51], v10 offset:57344
  s_add_u32 m0, s61, 81408
  v_mov_b32 v244, v84
  v_mfma_f32_16x16x32_bf16 v[36:39], a[204:207], v[56:59], v[36:39]
  buffer_load_dwordx4 v4, s[48:51], s57 offen offset:512 lds
  v_mov_b32 v245, v85
  v_mov_b32 v246, v86
  v_mfma_f32_16x16x32_bf16 v[40:43], a[200:203], v[60:63], v[40:43]
  ds_read_b128 v[52:55], v10 offset:59392
  v_mov_b32 v247, v87
  s_waitcnt vmcnt(12)
  s_waitcnt lgkmcnt(3)
  v_mfma_f32_16x16x32_bf16 v[44:47], a[204:207], v[60:63], v[44:47]
  v_mfma_f32_16x16x32_bf16 v[200:203], v[108:111], v[184:187], 0
  v_mfma_f32_16x16x32_bf16 v[32:35], a[208:211], v[64:67], v[32:35]
  ds_read_b128 v[56:59], v11 offset:57344
  v_mfma_f32_16x16x32_bf16 v[204:207], v[112:115], v[184:187], 0
  v_mfma_f32_16x16x32_bf16 v[36:39], a[212:215], v[64:67], v[36:39]
  v_mfma_f32_16x16x32_bf16 v[208:211], v[108:111], v[188:191], 0
  v_mfma_f32_16x16x32_bf16 v[40:43], a[208:211], v[68:71], v[40:43]
  ds_read_b128 v[60:63], v11 offset:59392
  v_mfma_f32_16x16x32_bf16 v[212:215], v[112:115], v[188:191], 0
  v_mfma_f32_16x16x32_bf16 v[44:47], a[212:215], v[68:71], v[44:47]
  v_mfma_f32_16x16x32_bf16 v[200:203], v[116:119], v[192:195], v[200:203]
  s_waitcnt lgkmcnt(4)
  v_mfma_f32_16x16x32_bf16 v[32:35], a[216:219], v[72:75], v[32:35]
  ds_read_b128 v[64:67], v10 offset:61440
  s_add_u32 m0, s61, 85376
  v_mfma_f32_16x16x32_bf16 v[204:207], v[120:123], v[192:195], v[204:207]
  v_mfma_f32_16x16x32_bf16 v[36:39], a[220:223], v[72:75], v[36:39]
  buffer_load_dwordx4 v4, s[48:51], s57 offen offset:640 lds
  v_mfma_f32_16x16x32_bf16 v[208:211], v[116:119], v[196:199], v[208:211]
  v_mfma_f32_16x16x32_bf16 v[40:43], a[216:219], v[76:79], v[40:43]
  ds_read_b128 v[68:71], v10 offset:63488
  v_mfma_f32_16x16x32_bf16 v[212:215], v[120:123], v[196:199], v[212:215]
  v_mfma_f32_16x16x32_bf16 v[44:47], a[220:223], v[76:79], v[44:47]
  s_waitcnt lgkmcnt(4)
  v_mfma_f32_16x16x32_bf16 v[32:35], a[224:227], v[48:51], v[32:35]
  ds_read_b128 v[72:75], v11 offset:61440
  v_mfma_f32_16x16x32_bf16 v[36:39], a[228:231], v[48:51], v[36:39]
  v_cvt_pk_bf16_f32 v216, v200, v201
  v_mfma_f32_16x16x32_bf16 v[40:43], a[224:227], v[52:55], v[40:43]
  ds_read_b128 v[76:79], v11 offset:63488
  v_cvt_pk_bf16_f32 v217, v202, v203
  v_mfma_f32_16x16x32_bf16 v[44:47], a[228:231], v[52:55], v[44:47]
  v_cvt_pk_bf16_f32 v218, v204, v205
  s_waitcnt lgkmcnt(4)
  v_mfma_f32_16x16x32_bf16 v[32:35], a[232:235], v[56:59], v[32:35]
  ds_read_b128 v[48:51], v8 offset:0
  s_add_u32 m0, s61, 89344
  v_cvt_pk_bf16_f32 v219, v206, v207
  v_mfma_f32_16x16x32_bf16 v[36:39], a[236:239], v[56:59], v[36:39]
  buffer_load_dwordx4 v4, s[48:51], s57 offen offset:768 lds
  buffer_store_dwordx4 v[216:219], v5, s[52:55], s73 offen offset:0 sc1
  v_mfma_f32_16x16x32_bf16 v[40:43], a[232:235], v[60:63], v[40:43]
  ds_read_b128 v[52:55], v8 offset:2048
  v_cvt_pk_bf16_f32 v220, v208, v209
  v_mfma_f32_16x16x32_bf16 v[44:47], a[236:239], v[60:63], v[44:47]
  v_cvt_pk_bf16_f32 v221, v210, v211
  s_waitcnt lgkmcnt(4)
  v_mfma_f32_16x16x32_bf16 v[32:35], a[240:243], v[64:67], v[32:35]
  ds_read_b128 v[56:59], v9 offset:0
  v_cvt_pk_bf16_f32 v222, v212, v213
  v_mfma_f32_16x16x32_bf16 v[36:39], a[244:247], v[64:67], v[36:39]
  v_cvt_pk_bf16_f32 v223, v214, v215
  v_mfma_f32_16x16x32_bf16 v[40:43], a[240:243], v[68:71], v[40:43]
  ds_read_b128 v[60:63], v9 offset:2048
  v_mfma_f32_16x16x32_bf16 v[44:47], a[244:247], v[68:71], v[44:47]
  buffer_store_dwordx4 v[220:223], v5, s[52:55], s73 offen offset:1024 sc1
  s_waitcnt lgkmcnt(4)
  v_mfma_f32_16x16x32_bf16 v[32:35], a[248:251], v[72:75], v[32:35]
  ds_read_b128 v[64:67], v8 offset:4096
  s_add_u32 m0, s61, 93312
  v_mfma_f32_16x16x32_bf16 v[36:39], a[252:255], v[72:75], v[36:39]
  buffer_load_dwordx4 v4, s[48:51], s57 offen offset:896 lds
  v_mfma_f32_16x16x32_bf16 v[40:43], a[248:251], v[76:79], v[40:43]
  ds_read_b128 v[68:71], v8 offset:6144
  s_add_u32 s66, s66, 1
  s_add_u32 s60, s60, 0x10000
  v_mfma_f32_16x16x32_bf16 v[44:47], a[252:255], v[76:79], v[44:47]
  s_cmp_lt_i32 s66, 61
  s_cbranch_scc1 L_qa_loop
L_qa_kv:
L_qt_w0:
L_qt_0:
  s_cbranch_execz L_qt_1
  s_min_u32 s40, s84, s85
  s_cmp_eq_u32 s40, 64
  s_cbranch_scc1 L_qa_kvd
  s_load_dwordx4 s[84:87], s[34:35], s88 glc
  s_waitcnt lgkmcnt(0)
  s_sub_u32 s39, s39, 1
  s_cbranch_scc0 L_qa_kv
  s_endpgm
L_qa_kvd:
  s_nop 4
  v_cvt_pk_bf16_f32 v80, v32, v33
  v_cvt_pk_bf16_f32 v81, v34, v35
  v_cvt_pk_bf16_f32 v82, v36, v37
  v_cvt_pk_bf16_f32 v83, v38, v39
L_qt_1:
  s_cbranch_execz L_qt_2
  v_cvt_pk_bf16_f32 v84, v40, v41
  v_cvt_pk_bf16_f32 v85, v42, v43
  v_cvt_pk_bf16_f32 v86, v44, v45
  v_cvt_pk_bf16_f32 v87, v46, v47
  v_bfe_u32 v1, v0, 2, 1
  v_mul_u32_u24 v226, 960, v1
  v_add_u32 v226, v5, v226
  v_mul_u32_u24 v227, 240, v1
  v_add_u32 v227, v225, v227
  s_waitcnt lgkmcnt(0)
  v_mov_b32 v68, 0
  v_mov_b32 v69, 0
  v_mov_b32 v70, 0
  v_mov_b32 v71, 0
L_qt_2:
  s_cbranch_execz L_qt_3
  v_mov_b32 v72, 0
  v_mov_b32 v73, 0
  v_mov_b32 v74, 0
  v_mov_b32 v75, 0
  s_mov_b32 s72, 7995392
  buffer_load_dwordx4 v[104:107], v224, s[52:55], s72 offen sc1
  buffer_load_dword v116, v227, s[52:55], s72 offen offset:512 sc1
  buffer_load_dword v120, v227, s[52:55], s72 offen offset:528 sc1
  s_mov_b32 s73, 32768000
  buffer_load_dwordx4 v[108:111], v226, s[52:55], s73 offen offset:0 sc1
  buffer_load_dwordx4 v[112:115], v226, s[52:55], s73 offen offset:64 sc1
  s_mov_b32 s73, 16252928
  buffer_load_dwordx4 v[16:19], v5, s[52:55], s73 offen offset:0 sc1
  buffer_load_dwordx4 v[20:23], v5, s[52:55], s73 offen offset:1024 sc1
L_qt_3:
  s_cbranch_execz L_qt_4
  s_mov_b32 s73, 33030144
  buffer_load_dwordx4 v[48:51], v226, s[52:55], s73 offen offset:0 sc1
  buffer_load_dwordx4 v[52:55], v226, s[52:55], s73 offen offset:64 sc1
  s_mov_b32 s73, 16515072
  buffer_load_dwordx4 v[24:27], v5, s[52:55], s73 offen offset:0 sc1
  buffer_load_dwordx4 v[28:31], v5, s[52:55], s73 offen offset:1024 sc1
  s_mov_b32 s73, 33292288
  buffer_load_dwordx4 v[56:59], v226, s[52:55], s73 offen offset:0 sc1
  buffer_load_dwordx4 v[60:63], v226, s[52:55], s73 offen offset:64 sc1
  s_sub_u32 s40, 61, s89
  v_mov_b32 v32, s83
  v_mov_b32 v33, s40
  s_waitcnt vmcnt(22)
  v_mfma_f32_16x16x32_bf16 v[124:127], v[96:99], v[240:243], 0
L_qt_4:
  s_cbranch_execz L_qt_5
  v_mfma_f32_16x16x32_bf16 v[128:131], v[96:99], v[244:247], 0
  v_mfma_f32_16x16x32_bf16 v[132:135], v[100:103], v[244:247], 0
  s_nop 5
  ds_write_b128 v228, v[124:127] offset:0
  ds_write_b128 v228, v[128:131] offset:1024
  ds_write_b128 v228, v[132:135] offset:2048
  s_waitcnt lgkmcnt(0)
  s_barrier
  ds_read_b128 v[144:147], v230 offset:0
  ds_read_b128 v[148:151], v230 offset:4096
  ds_read_b128 v[152:155], v230 offset:8192
  ds_read_b128 v[156:159], v230 offset:12288
  s_waitcnt lgkmcnt(2)
  v_add_f32 v144, v144, v148
L_qt_5:
  s_cbranch_execz L_qt_6
  v_add_f32 v145, v145, v149
  v_add_f32 v146, v146, v150
  v_add_f32 v147, v147, v151
  s_waitcnt lgkmcnt(0)
  v_add_f32 v152, v152, v156
  v_add_f32 v153, v153, v157
  v_add_f32 v154, v154, v158
  v_add_f32 v155, v155, v159
  v_add_f32 v164, v144, v152
  v_add_f32 v165, v145, v153
  v_add_f32 v166, v146, v154
  v_add_f32 v167, v147, v155
  v_cndmask_b32 v164, v235, v164, s[74:75]
  v_cndmask_b32 v165, v235, v165, s[76:77]
L_qt_6:
  s_cbranch_execz L_qt_7
  v_cndmask_b32 v166, v235, v166, s[78:79]
  v_cndmask_b32 v167, v235, v167, s[80:81]
  v_max3_f32 v176, v164, v165, v166
  s_waitcnt vmcnt(14)
  s_mov_b64 exec, 1
  buffer_atomic_add v33, v32, s[52:55], 0 offen
  s_mov_b64 exec, -1
  s_waitcnt vmcnt(11)
L_qp_30:
  v_max3_u32 v1, v107, v116, v120
  v_cmp_eq_u32 vcc, -1, v1
  s_cbranch_vccnz L_qp_30_s
  v_mfma_f32_16x16x32_bf16 v[136:139], v[104:107], v[240:243], 0
  v_mfma_f32_16x16x32_bf16 v[140:143], v[104:107], v[244:247], 0
L_qt_7:
  s_cbranch_execz L_qt_34
  s_nop 6
  ds_write_b64 v229, v[136:137] offset:0
  ds_write_b64 v229, v[140:141] offset:512
  s_mov_b32 s72, 8126464
  buffer_load_dwordx4 v[64:67], v224, s[52:55], s72 offen sc1
  buffer_load_dword v68, v227, s[52:55], s72 offen offset:512 sc1
  buffer_load_dword v72, v227, s[52:55], s72 offen offset:528 sc1
  s_waitcnt lgkmcnt(0)
  s_barrier
  ds_read_b32 v160, v231 offset:0
  ds_read_b32 v161, v231 offset:4096
  ds_read_b32 v162, v231 offset:8192
  ds_read_b32 v163, v231 offset:12288
  s_waitcnt lgkmcnt(0)
L_qt_w1:
L_qt_8:
  s_cbranch_execz L_qt_9
  v_add_f32 v160, v160, v161
  v_add_f32 v162, v162, v163
  v_add_f32 v168, v160, v162
  v_max3_f32 v176, v176, v167, v168
  s_nop 1
  v_max_f32_dpp v176, v176, v176 row_ror:8 row_mask:0xf bank_mask:0xf
  v_mov_b32 v178, v176
  s_nop 1
  v_permlane16_swap_b32 v178, v176
  v_max_f32 v176, v176, v178
  v_mov_b32 v178, v176
  s_nop 1
  v_permlane32_swap_b32 v178, v176
  v_max_f32 v176, v176, v178
L_qt_9:
  s_cbranch_execz L_qt_10
  v_mul_f32 v176, s82, v176
  v_fma_f32 v170, v164, s82, -v176
  v_fma_f32 v171, v165, s82, -v176
  v_fma_f32 v172, v166, s82, -v176
  v_fma_f32 v173, v167, s82, -v176
  v_fma_f32 v174, v168, s82, -v176
  v_exp_f32 v170, v170
  v_exp_f32 v171, v171
  v_exp_f32 v172, v172
  v_exp_f32 v173, v173
  v_exp_f32 v174, v174
  v_add_f32 v164, v170, v171
  v_add_f32 v165, v172, v173
  v_add_f32 v164, v164, v174
L_qt_10:
  s_cbranch_execz L_qt_11
  v_add_f32 v176, v164, v165
  s_nop 1
  v_add_f32_dpp v176, v176, v176 row_ror:8 row_mask:0xf bank_mask:0xf
  v_mov_b32 v178, v176
  s_nop 1
  v_permlane16_swap_b32 v178, v176
  v_add_f32 v176, v176, v178
  v_mov_b32 v178, v176
  s_nop 1
  v_permlane32_swap_b32 v178, v176
  v_add_f32 v176, v176, v178
  v_rcp_f32 v176, v176
  s_nop 0
  v_mul_f32 v174, v174, v176
L_qt_11:
  s_cbranch_execz L_qt_12
  v_mul_f32 v170, v170, v176
  v_mul_f32 v171, v171, v176
  v_mul_f32 v172, v172, v176
  v_mul_f32 v173, v173, v176
  v_cvt_pk_bf16_f32 v182, v174, v174
  ds_write_b16 v233, v182
  v_cvt_pk_bf16_f32 v180, v170, v171
  v_cvt_pk_bf16_f32 v181, v172, v173
  ds_write_b64 v232, v[180:181]
  s_waitcnt lgkmcnt(0)
  s_barrier
  ds_read_b128 v[184:187], v236 offset:0
  ds_read_b32 v192, v234 offset:0
  ds_read_b128 v[188:191], v236 offset:1024
L_qt_12:
  s_cbranch_execz L_qt_13
  ds_read_b32 v196, v234 offset:256
  s_waitcnt vmcnt(4)
  s_waitcnt lgkmcnt(0)
  v_mfma_f32_16x16x32_bf16 v[200:203], v[108:111], v[184:187], 0
  v_mfma_f32_16x16x32_bf16 v[204:207], v[112:115], v[184:187], 0
  v_mfma_f32_16x16x32_bf16 v[208:211], v[108:111], v[188:191], 0
  v_mfma_f32_16x16x32_bf16 v[212:215], v[112:115], v[188:191], 0
  v_mfma_f32_16x16x32_bf16 v[200:203], v[116:119], v[192:195], v[200:203]
  v_mfma_f32_16x16x32_bf16 v[204:207], v[120:123], v[192:195], v[204:207]
  v_mfma_f32_16x16x32_bf16 v[208:211], v[116:119], v[196:199], v[208:211]
  v_mfma_f32_16x16x32_bf16 v[212:215], v[120:123], v[196:199], v[212:215]
  s_mov_b32 s73, 66322432
  s_nop 3
  v_cvt_pk_bf16_f32 v216, v200, v201
L_qt_13:
  s_cbranch_execz L_qt_14
  v_cvt_pk_bf16_f32 v218, v202, v203
  v_cvt_pk_bf16_f32 v217, v204, v205
  v_cvt_pk_bf16_f32 v219, v206, v207
  buffer_store_dwordx4 v[216:219], v5, s[52:55], s73 offen offset:0 sc1
  v_cvt_pk_bf16_f32 v220, v208, v209
  v_cvt_pk_bf16_f32 v222, v210, v211
  v_cvt_pk_bf16_f32 v221, v212, v213
  v_cvt_pk_bf16_f32 v223, v214, v215
  buffer_store_dwordx4 v[220:223], v5, s[52:55], s73 offen offset:1024 sc1
  v_mfma_f32_16x16x32_bf16 v[124:127], v[16:19], v[88:91], 0
  v_mfma_f32_16x16x32_bf16 v[128:131], v[16:19], v[92:95], 0
  v_mfma_f32_16x16x32_bf16 v[132:135], v[20:23], v[92:95], 0
  s_nop 5
  ds_write_b128 v228, v[124:127] offset:0
L_qt_14:
  s_cbranch_execz L_qt_15
  ds_write_b128 v228, v[128:131] offset:1024
  ds_write_b128 v228, v[132:135] offset:2048
  s_waitcnt lgkmcnt(0)
  s_barrier
  ds_read_b128 v[144:147], v230 offset:0
  ds_read_b128 v[148:151], v230 offset:4096
  ds_read_b128 v[152:155], v230 offset:8192
  ds_read_b128 v[156:159], v230 offset:12288
  s_waitcnt lgkmcnt(2)
  v_add_f32 v144, v144, v148
  v_add_f32 v145, v145, v149
  v_add_f32 v146, v146, v150
  v_add_f32 v147, v147, v151
  s_waitcnt lgkmcnt(0)
L_qt_15:
  s_cbranch_execz L_qt_16
  v_add_f32 v152, v152, v156
  v_add_f32 v153, v153, v157
  v_add_f32 v154, v154, v158
  v_add_f32 v155, v155, v159
  v_add_f32 v164, v144, v152
  v_add_f32 v165, v145, v153
  v_add_f32 v166, v146, v154
  v_add_f32 v167, v147, v155
  v_cndmask_b32 v164, v235, v164, s[74:75]
  v_cndmask_b32 v165, v235, v165, s[76:77]
  v_cndmask_b32 v166, v235, v166, s[78:79]
  v_cndmask_b32 v167, v235, v167, s[80:81]
  v_max3_f32 v176, v164, v165, v166
  s_waitcnt vmcnt(2)
L_qp_31:
L_qt_16:
  s_cbranch_execz L_qt_34
  v_max3_u32 v1, v67, v68, v72
  v_cmp_eq_u32 vcc, -1, v1
  s_cbranch_vccnz L_qp_31_s
  v_mfma_f32_16x16x32_bf16 v[136:139], v[64:67], v[88:91], 0
  v_mfma_f32_16x16x32_bf16 v[140:143], v[64:67], v[92:95], 0
  s_nop 6
  ds_write_b64 v229, v[136:137] offset:0
  ds_write_b64 v229, v[140:141] offset:512
  s_waitcnt lgkmcnt(0)
  s_barrier
  ds_read_b32 v160, v231 offset:0
  ds_read_b32 v161, v231 offset:4096
  ds_read_b32 v162, v231 offset:8192
  ds_read_b32 v163, v231 offset:12288
L_qt_w2:
L_qt_17:
  s_cbranch_execz L_qt_18
  s_waitcnt lgkmcnt(0)
  v_add_f32 v160, v160, v161
  v_add_f32 v162, v162, v163
  v_add_f32 v168, v160, v162
  v_max3_f32 v176, v176, v167, v168
  s_nop 1
  v_max_f32_dpp v176, v176, v176 row_ror:8 row_mask:0xf bank_mask:0xf
  v_mov_b32 v178, v176
  s_nop 1
  v_permlane16_swap_b32 v178, v176
  v_max_f32 v176, v176, v178
  v_mov_b32 v178, v176
  s_nop 1
  v_permlane32_swap_b32 v178, v176
L_qt_18:
  s_cbranch_execz L_qt_19
  v_max_f32 v176, v176, v178
  v_mul_f32 v176, s82, v176
  v_fma_f32 v170, v164, s82, -v176
  v_fma_f32 v171, v165, s82, -v176
  v_fma_f32 v172, v166, s82, -v176
  v_fma_f32 v173, v167, s82, -v176
  v_fma_f32 v174, v168, s82, -v176
  v_exp_f32 v170, v170
  v_exp_f32 v171, v171
  v_exp_f32 v172, v172
  v_exp_f32 v173, v173
  v_exp_f32 v174, v174
  v_add_f32 v164, v170, v171
  v_add_f32 v165, v172, v173
L_qt_19:
  s_cbranch_execz L_qt_20
  v_add_f32 v164, v164, v174
  v_add_f32 v176, v164, v165
  s_nop 1
  v_add_f32_dpp v176, v176, v176 row_ror:8 row_mask:0xf bank_mask:0xf
  v_mov_b32 v178, v176
  s_nop 1
  v_permlane16_swap_b32 v178, v176
  v_add_f32 v176, v176, v178
  v_mov_b32 v178, v176
  s_nop 1
  v_permlane32_swap_b32 v178, v176
  v_add_f32 v176, v176, v178
  v_rcp_f32 v176, v176
  s_nop 0
L_qt_20:
  s_cbranch_execz L_qt_21
  v_mul_f32 v174, v174, v176
  v_mul_f32 v170, v170, v176
  v_mul_f32 v171, v171, v176
  v_mul_f32 v172, v172, v176
  v_mul_f32 v173, v173, v176
  v_cvt_pk_bf16_f32 v182, v174, v174
  ds_write_b16 v233, v182
  v_cvt_pk_bf16_f32 v180, v170, v171
  v_cvt_pk_bf16_f32 v181, v172, v173
  ds_write_b64 v232, v[180:181]
  s_waitcnt lgkmcnt(0)
  s_barrier
  ds_read_b128 v[184:187], v236 offset:0
  ds_read_b32 v192, v234 offset:0
L_qt_21:
  s_cbranch_execz L_qt_22
  ds_read_b128 v[188:191], v236 offset:1024
  ds_read_b32 v196, v234 offset:256
  s_waitcnt lgkmcnt(0)
  v_mfma_f32_16x16x32_bf16 v[200:203], v[48:51], v[184:187], 0
  v_mfma_f32_16x16x32_bf16 v[204:207], v[52:55], v[184:187], 0
  v_mfma_f32_16x16x32_bf16 v[208:211], v[48:51], v[188:191], 0
  v_mfma_f32_16x16x32_bf16 v[212:215], v[52:55], v[188:191], 0
  v_mfma_f32_16x16x32_bf16 v[200:203], v[68:71], v[192:195], v[200:203]
  v_mfma_f32_16x16x32_bf16 v[204:207], v[72:75], v[192:195], v[204:207]
  v_mfma_f32_16x16x32_bf16 v[208:211], v[68:71], v[196:199], v[208:211]
  v_mfma_f32_16x16x32_bf16 v[212:215], v[72:75], v[196:199], v[212:215]
  s_mov_b32 s73, 66584576
  s_nop 3
  v_cvt_pk_bf16_f32 v216, v200, v201
L_qt_22:
  s_cbranch_execz L_qt_23
  v_cvt_pk_bf16_f32 v218, v202, v203
  v_cvt_pk_bf16_f32 v217, v204, v205
  v_cvt_pk_bf16_f32 v219, v206, v207
  buffer_store_dwordx4 v[216:219], v5, s[52:55], s73 offen offset:0 sc1
  v_cvt_pk_bf16_f32 v220, v208, v209
  v_cvt_pk_bf16_f32 v222, v210, v211
  v_cvt_pk_bf16_f32 v221, v212, v213
  v_cvt_pk_bf16_f32 v223, v214, v215
  buffer_store_dwordx4 v[220:223], v5, s[52:55], s73 offen offset:1024 sc1
  v_mfma_f32_16x16x32_bf16 v[124:127], v[24:27], v[80:83], 0
  v_mfma_f32_16x16x32_bf16 v[128:131], v[24:27], v[84:87], 0
  v_mfma_f32_16x16x32_bf16 v[132:135], v[28:31], v[84:87], 0
  s_nop 5
  ds_write_b128 v228, v[124:127] offset:0
L_qt_23:
  s_cbranch_execz L_qt_24
  ds_write_b128 v228, v[128:131] offset:1024
  ds_write_b128 v228, v[132:135] offset:2048
  s_waitcnt lgkmcnt(0)
  s_barrier
  ds_read_b128 v[144:147], v230 offset:0
  ds_read_b128 v[148:151], v230 offset:4096
  ds_read_b128 v[152:155], v230 offset:8192
  ds_read_b128 v[156:159], v230 offset:12288
  s_waitcnt lgkmcnt(2)
  v_add_f32 v144, v144, v148
  v_add_f32 v145, v145, v149
  v_add_f32 v146, v146, v150
  v_add_f32 v147, v147, v151
  s_waitcnt lgkmcnt(0)
L_qt_24:
  s_cbranch_execz L_qt_34
  v_add_f32 v152, v152, v156
  v_add_f32 v153, v153, v157
  v_add_f32 v154, v154, v158
  v_add_f32 v155, v155, v159
  v_add_f32 v164, v144, v152
  v_add_f32 v165, v145, v153
  v_add_f32 v166, v146, v154
  v_add_f32 v167, v147, v155
  v_cndmask_b32 v164, v235, v164, s[74:75]
  v_cndmask_b32 v165, v235, v165, s[76:77]
  v_cndmask_b32 v166, v235, v166, s[78:79]
  v_cndmask_b32 v167, v235, v167, s[80:81]
  v_max3_f32 v176, v164, v165, v166
  s_mov_b32 s72, 8257536
L_qt_w3:
L_qt_25:
  s_cbranch_execz L_qt_26
  buffer_load_dwordx4 v[104:107], v224, s[52:55], s72 offen sc1
  buffer_load_dword v116, v227, s[52:55], s72 offen offset:512 sc1
  buffer_load_dword v120, v227, s[52:55], s72 offen offset:528 sc1
  s_waitcnt vmcnt(0)
L_qp_32:
  v_max3_u32 v1, v107, v116, v120
  v_cmp_eq_u32 vcc, -1, v1
  s_cbranch_vccnz L_qp_32_s
  v_mfma_f32_16x16x32_bf16 v[136:139], v[104:107], v[80:83], 0
  v_mfma_f32_16x16x32_bf16 v[140:143], v[104:107], v[84:87], 0
  s_nop 6
  ds_write_b64 v229, v[136:137] offset:0
  ds_write_b64 v229, v[140:141] offset:512
  s_waitcnt lgkmcnt(0)
L_qt_26:
  s_cbranch_execz L_qt_27
  s_barrier
  ds_read_b32 v160, v231 offset:0
  ds_read_b32 v161, v231 offset:4096
  ds_read_b32 v162, v231 offset:8192
  ds_read_b32 v163, v231 offset:12288
  s_waitcnt lgkmcnt(0)
  v_add_f32 v160, v160, v161
  v_add_f32 v162, v162, v163
  v_add_f32 v168, v160, v162
  v_max3_f32 v176, v176, v167, v168
  s_nop 1
  v_max_f32_dpp v176, v176, v176 row_ror:8 row_mask:0xf bank_mask:0xf
  v_mov_b32 v178, v176
  s_nop 1
L_qt_27:
  s_cbranch_execz L_qt_28
  v_permlane16_swap_b32 v178, v176
  v_max_f32 v176, v176, v178
  v_mov_b32 v178, v176
  s_nop 1
  v_permlane32_swap_b32 v178, v176
  v_max_f32 v176, v176, v178
  v_mul_f32 v176, s82, v176
  v_fma_f32 v170, v164, s82, -v176
  v_fma_f32 v171, v165, s82, -v176
  v_fma_f32 v172, v166, s82, -v176
  v_fma_f32 v173, v167, s82, -v176
  v_fma_f32 v174, v168, s82, -v176
  v_exp_f32 v170, v170
  v_exp_f32 v171, v171
L_qt_28:
  s_cbranch_execz L_qt_29
  v_exp_f32 v172, v172
  v_exp_f32 v173, v173
  v_exp_f32 v174, v174
  v_add_f32 v164, v170, v171
  v_add_f32 v165, v172, v173
  v_add_f32 v164, v164, v174
  v_add_f32 v176, v164, v165
  s_nop 1
  v_add_f32_dpp v176, v176, v176 row_ror:8 row_mask:0xf bank_mask:0xf
  v_mov_b32 v178, v176
  s_nop 1
  v_permlane16_swap_b32 v178, v176
  v_add_f32 v176, v176, v178
  v_mov_b32 v178, v176
L_qt_29:
  s_cbranch_execz L_qt_30
  s_nop 1
  v_permlane32_swap_b32 v178, v176
  v_add_f32 v176, v176, v178
  v_rcp_f32 v176, v176
  s_nop 0
  v_mul_f32 v174, v174, v176
  v_mul_f32 v170, v170, v176
  v_mul_f32 v171, v171, v176
  v_mul_f32 v172, v172, v176
  v_mul_f32 v173, v173, v176
  v_cvt_pk_bf16_f32 v182, v174, v174
  ds_write_b16 v233, v182
  v_cvt_pk_bf16_f32 v180, v170, v171
  v_cvt_pk_bf16_f32 v181, v172, v173
L_qt_30:
  s_cbranch_execz L_qt_31
  ds_write_b64 v232, v[180:181]
  s_waitcnt lgkmcnt(0)
  s_barrier
  ds_read_b128 v[184:187], v236 offset:0
  ds_read_b32 v192, v234 offset:0
  ds_read_b128 v[188:191], v236 offset:1024
  ds_read_b32 v196, v234 offset:256
  s_waitcnt lgkmcnt(0)
  v_mfma_f32_16x16x32_bf16 v[200:203], v[56:59], v[184:187], 0
  v_mfma_f32_16x16x32_bf16 v[204:207], v[60:63], v[184:187], 0
  v_mfma_f32_16x16x32_bf16 v[208:211], v[56:59], v[188:191], 0
  v_mfma_f32_16x16x32_bf16 v[212:215], v[60:63], v[188:191], 0
  v_mfma_f32_16x16x32_bf16 v[200:203], v[116:119], v[192:195], v[200:203]
  v_mfma_f32_16x16x32_bf16 v[204:207], v[120:123], v[192:195], v[204:207]
L_qt_31:
  s_cbranch_execz L_qt_32
  v_mfma_f32_16x16x32_bf16 v[208:211], v[116:119], v[196:199], v[208:211]
  v_mfma_f32_16x16x32_bf16 v[212:215], v[120:123], v[196:199], v[212:215]
  s_mov_b32 s73, 66846720
  s_nop 3
  v_cvt_pk_bf16_f32 v216, v200, v201
  v_cvt_pk_bf16_f32 v218, v202, v203
  v_cvt_pk_bf16_f32 v217, v204, v205
  v_cvt_pk_bf16_f32 v219, v206, v207
  buffer_store_dwordx4 v[216:219], v5, s[52:55], s73 offen offset:0 sc1
  v_cvt_pk_bf16_f32 v220, v208, v209
  v_cvt_pk_bf16_f32 v222, v210, v211
  v_cvt_pk_bf16_f32 v221, v212, v213
  v_cvt_pk_bf16_f32 v223, v214, v215
  buffer_store_dwordx4 v[220:223], v5, s[52:55], s73 offen offset:1024 sc1
L_qt_32:
  s_cbranch_execz L_qt_33
  s_endpgm
L_qp_30_s:
  s_mov_b32 s72, 7995392
  buffer_load_dwordx4 v[104:107], v224, s[52:55], s72 offen sc1
  buffer_load_dword v116, v227, s[52:55], s72 offen offset:512 sc1
  buffer_load_dword v120, v227, s[52:55], s72 offen offset:528 sc1
  s_waitcnt vmcnt(0)
  s_sub_u32 s39, s39, 1
  s_cbranch_scc0 L_qp_30
  s_endpgm
L_qp_31_s:
  s_mov_b32 s72, 8126464
  buffer_load_dwordx4 v[64:67], v224, s[52:55], s72 offen sc1
  buffer_load_dword v68, v227, s[52:55], s72 offen offset:512 sc1
L_qt_33:
  s_cbranch_execz L_qt_34
  buffer_load_dword v72, v227, s[52:55], s72 offen offset:528 sc1
  s_waitcnt vmcnt(0)
  s_sub_u32 s39, s39, 1
  s_cbranch_scc0 L_qp_31
  s_endpgm
L_qp_32_s:
  s_mov_b32 s72, 8257536
  buffer_load_dwordx4 v[104:107], v224, s[52:55], s72 offen sc1
  buffer_load_dword v116, v227, s[52:55], s72 offen offset:512 sc1
  buffer_load_dword v120, v227, s[52:55], s72 offen offset:528 sc1
  s_waitcnt vmcnt(0)
  s_sub_u32 s39, s39, 1
  s_cbranch_scc0 L_qp_32
  s_endpgm
L_qt_34:
  s_mov_b64 exec, -1
  s_branch L_qt_done
L_em_20_s:
  v_mov_b32 v92, -1
  v_mov_b32 v93, -1
  v_mov_b32 v94, -1
  v_mov_b32 v95, -1
  s_lshl_b32 s40, s38, 2
  s_add_u32 s40, s40, s36
  s_lshl_b32 s40, s40, 10
  v_lshl_add_u32 v1, v0, 4, s40
  s_mov_b32 s40, 75104256
  buffer_store_dwordx4 v[92:95], v1, s[52:55], s40 offen offset:0 sc1
  s_mov_b32 s40, 75235328
  buffer_store_dwordx4 v[92:95], v1, s[52:55], s40 offen offset:0 sc1
  s_mov_b32 s40, 75366400
  buffer_store_dwordx4 v[92:95], v1, s[52:55], s40 offen offset:0 sc1
  s_branch L_em_20
L_em_22_s:
  v_mov_b32 v92, -1
  v_mov_b32 v93, -1
  v_mov_b32 v94, -1
  v_mov_b32 v95, -1
  s_lshl_b32 s40, s38, 2
  s_add_u32 s40, s40, s36
  s_lshl_b32 s40, s40, 11
  v_lshl_add_u32 v1, v0, 4, s40
  s_mov_b32 s40, 66322432
  buffer_store_dwordx4 v[92:95], v1, s[52:55], s40 offen offset:0 sc1
  buffer_store_dwordx4 v[92:95], v1, s[52:55], s40 offen offset:1024 sc1
  s_mov_b32 s40, 66584576
  buffer_store_dwordx4 v[92:95], v1, s[52:55], s40 offen offset:0 sc1
  buffer_store_dwordx4 v[92:95], v1, s[52:55], s40 offen offset:1024 sc1
  s_mov_b32 s40, 66846720
  buffer_store_dwordx4 v[92:95], v1, s[52:55], s40 offen offset:0 sc1
  buffer_store_dwordx4 v[92:95], v1, s[52:55], s40 offen offset:1024 sc1
  s_branch L_em_22
L_qf_28_s:
  s_load_dwordx4 s[84:87], s[34:35], s88 glc
  s_waitcnt vmcnt(0)
  s_max_i32 s40, s66, s89
  s_sub_u32 s92, s40, s89
  s_mov_b32 s89, s40
  s_atomic_add s92, s[34:35], s83
L_qf_28_p:
  s_waitcnt lgkmcnt(0)
  s_sub_u32 s40, s84, 1
  s_min_i32 s40, s40, s85
  s_min_i32 s40, s40, s86
  s_cmp_gt_i32 s40, s66
  s_cbranch_scc1 L_qf_28
  s_load_dwordx4 s[84:87], s[34:35], s88 glc
  s_sub_u32 s39, s39, 1
  s_cbranch_scc0 L_qf_28_p
  s_endpgm
L_qf_29_s:
  s_load_dwordx4 s[84:87], s[34:35], s88 glc
  s_waitcnt vmcnt(0)
  s_max_i32 s40, s66, s89
  s_sub_u32 s92, s40, s89
  s_mov_b32 s89, s40
  s_atomic_add s92, s[34:35], s83
L_qf_29_p:
  s_waitcnt lgkmcnt(0)
  s_sub_u32 s40, s84, 1
  s_min_i32 s40, s40, s85
  s_min_i32 s40, s40, s86
  s_cmp_gt_i32 s40, s66
  s_cbranch_scc1 L_qf_29
  s_load_dwordx4 s[84:87], s[34:35], s88 glc
  s_sub_u32 s39, s39, 1
  s_cbranch_scc0 L_qf_29_p
  s_endpgm

.section .rodata,"a"
.p2align 6
.amdhsa_kernel concat_heads__memory_aug_recurrent_mem_tr__ssm_conv_h3__prompt_kernel
  .amdhsa_next_free_vgpr 512
  .amdhsa_next_free_sgpr 102
  .amdhsa_accum_offset 256
  .amdhsa_group_segment_fixed_size 0
  .amdhsa_kernarg_size 128
  .amdhsa_user_sgpr_count 2
  .amdhsa_user_sgpr_kernarg_segment_ptr 1
  .amdhsa_system_sgpr_workgroup_id_x 1
.end_amdhsa_kernel
```
